```python
import torch

def _softmax(x, axis=-1):
    return torch.softmax(x, dim=axis)

def _gelu(x):
    return torch.nn.functional.gelu(x, approximate='tanh')

def _silu(x):
    return torch.nn.functional.silu(x)

def _sigmoid(x):
    return torch.sigmoid(x)

def _layernorm(x, axis=-1, eps=1e-05):
    m = x.mean(dim=axis, keepdim=True)
    v = x.var(dim=axis, keepdim=True, unbiased=False)
    return (x - m) / torch.sqrt(v + eps)

def _scatter_add(tgt, idx, src, axis=0):
    return tgt.clone().index_add_(axis, idx, src)

def _segment_sum(src, seg, n):
    out = torch.zeros((n,) + src.shape[1:], dtype=src.dtype)
    return out.index_add_(0, seg, src)

def _pad(x, pw):
    flat = tuple((v for pair in reversed(pw) for v in pair))
    return torch.nn.functional.pad(x, flat)
kernel_name = 'concat_heads__memory_aug_recurrent_mem_tr__linear_kernel_hedgehog__prompt'

def setup_inputs():

    _w = lambda a: (lambda t: t.to(torch.bfloat16) if t.is_floating_point() else t)(torch.as_tensor(a))

    def _A_setup():
        B, S, Dm = (1, 2048, 640)
        H, Dh = (32, 192)
        M, seg = (8, 32)
        seg = min(seg, S)
        S = S // seg * seg
        return {'x': _w((lambda *s: torch.randn(*s, dtype=torch.bfloat16) * 0.05)(B, S, Dm)), 'mem0': _w((lambda *s: torch.randn(*s, dtype=torch.bfloat16) * 1.6)(B, M, Dm)), 'Wq': _w((lambda *s: torch.randn(*s, dtype=torch.bfloat16) * 0.8)(Dm, H, Dh) * Dm ** (-0.5)), 'Wk': _w((lambda *s: torch.randn(*s, dtype=torch.bfloat16) * 0.8)(Dm, H, Dh) * Dm ** (-0.5)), 'Wv': _w((lambda *s: torch.randn(*s, dtype=torch.bfloat16) * 1.6)(Dm, H, Dh) * Dm ** (-0.5)), 'Wo': _w((lambda *s: torch.randn(*s, dtype=torch.bfloat16) * 1.6)(H, Dh, Dm) * (H * Dh) ** (-0.5)), 'seg_len': seg}
    _A_in = _A_setup()

    def _B_setup():
        B, S, D, H = (1, 2048, 640, 32)
        Dh = D // H
        return {'x': _w((lambda *s: torch.randn(*s, dtype=torch.bfloat16) * 0.8)(B, S, D)), 'wqkv': _w((lambda *s: torch.randn(*s, dtype=torch.bfloat16) * 0.8)(D, 3 * D)), 'w_phi': _w((lambda *s: torch.randn(*s, dtype=torch.bfloat16) * 0.8)(H, Dh, Dh) * Dh ** (-0.5)), 'wo': _w((lambda *s: torch.randn(*s, dtype=torch.bfloat16) * 0.05)(D, D))}
    _B_in = _B_setup()
    return {'A_x': _A_in['x'], 'A_mem0': _A_in['mem0'], 'A_Wq': _A_in['Wq'], 'A_Wk': _A_in['Wk'], 'A_Wv': _A_in['Wv'], 'A_Wo': _A_in['Wo'], 'A_seg_len': _A_in['seg_len'], 'B_x': _B_in['x'], 'B_wqkv': _B_in['wqkv'], 'B_w_phi': _B_in['w_phi'], 'B_wo': _B_in['wo']}

def reference(A_x, A_mem0, A_Wq, A_Wk, A_Wv, A_Wo, A_seg_len, B_x, B_wqkv, B_w_phi, B_wo):

    def _A_ref(x, mem0, Wq, Wk, Wv, Wo, seg_len):
        B, S, Dm = x.shape
        H, Dh = (Wq.shape[1], Wq.shape[2])
        M = mem0.shape[1]
        scale = Dh ** (-0.5)
        n_seg = S // seg_len
        L = M + seg_len
        idx = torch.arange(L)
        mask = (idx[:, None] < M) | (idx[:, None] >= idx[None, :])
        mem = mem0
        outs = []
        for s in range(n_seg):
            xs = x[:, s * seg_len:(s + 1) * seg_len, :].clone()
            h = torch.concatenate([mem, xs], axis=1)
            q = torch.einsum('btd,dhe->bhte', h, Wq)
            k = torch.einsum('btd,dhe->bhte', h, Wk)
            v = torch.einsum('btd,dhe->bhte', h, Wv)
            scores = torch.einsum('bhqe,bhke->bhqk', q, k) * scale
            scores = torch.where(mask[None, None], scores, -1000000000.0)
            p = _softmax(scores, axis=-1)
            o = torch.einsum('bhqk,bhke->bhqe', p, v)
            o = torch.einsum('bhte,hed->btd', o, Wo)
            mem = o[:, :M, :].clone()
            outs.append(o[:, M:, :])
        return torch.concatenate(outs, axis=1)

    def _B_ref(x, wqkv, w_phi, wo):
        B, S, D = x.shape
        H = 32
        Dh = D // H
        qkv = (lambda x, *d: x.permute(*d))((x @ wqkv).reshape(B, S, 3, H, Dh), 2, 0, 3, 1, 4)
        q, k, v = (qkv[0], qkv[1], qkv[2])
        pq = torch.einsum('bhsd,hdf->bhsf', q, w_phi)
        pk = torch.einsum('bhsd,hdf->bhsf', k, w_phi)
        phi_q = torch.concatenate([_softmax(pq, axis=-1), _softmax(-pq, axis=-1)], axis=-1)
        phi_k = torch.concatenate([_softmax(pk, axis=-1), _softmax(-pk, axis=-1)], axis=-1)
        kv = torch.einsum('bhsf,bhsd->bhfd', phi_k, v)
        z = torch.einsum('bhsf->bhf', phi_k)
        num = torch.einsum('bhqf,bhfd->bhqd', phi_q, kv)
        den = torch.einsum('bhqf,bhf->bhq', phi_q, z)[..., None] + 1e-06
        o = num / den
        return (lambda x, *d: x.permute(*d))(o, 0, 2, 1, 3).reshape(B, S, D) @ wo
    a = _A_ref(A_x, A_mem0, A_Wq, A_Wk, A_Wv, A_Wo, A_seg_len)
    b = _B_ref(B_x, B_wqkv, B_w_phi, B_wo)
    return torch.concatenate([a, b], axis=-1)
```

```asm
; @launch grid=(256,1,1) block=(256,1,1) lds=163840
.amdgcn_target "amdgcn-amd-amdhsa--gfx950"
.text
.globl concat_heads__memory_aug_recurrent_mem_tr__linear_kernel_hedgehog__prompt_kernel
.p2align 8
.type concat_heads__memory_aug_recurrent_mem_tr__linear_kernel_hedgehog__prompt_kernel,@function
concat_heads__memory_aug_recurrent_mem_tr__linear_kernel_hedgehog__prompt_kernel:
    s_cmp_ge_u32 s2, 256
    s_cbranch_scc1 EXIT0
    s_load_dwordx4 s[4:7], s[0:1], 96
    v_lshrrev_b32 v1, 6, v0
    v_and_b32 v2, 63, v0
    v_readfirstlane_b32 s32, v1
    s_mov_b32 s33, 1000000
    s_waitcnt lgkmcnt(0)
    s_add_u32 s6, s6, 0x1fffff
    s_addc_u32 s7, s7, 0
    s_and_b32 s6, s6, 0xffe00000
    s_mov_b32 s8, s6
    s_mov_b32 s9, s7
    s_mov_b32 s10, 266338304
    s_mov_b32 s11, 0x20000
    s_mov_b32 s12, s4
    s_mov_b32 s13, s5
    s_mov_b32 s14, 256
    s_mov_b32 s15, 0x20000
    s_mov_b32 s94, s2
    s_getreg_b32 s3, hwreg(HW_REG_XCC_ID, 0, 3)
    s_lshr_b32 s4, s2, 3
    s_lshl_b32 s2, s4, 3
    s_or_b32 s2, s2, s3
    s_mov_b32 s54, 1
    s_mov_b32 s95, 0
    s_cmp_lg_u32 s32, 3
    s_cbranch_scc1 DISPATCH
    s_lshl_b32 s4, 1, s4
    v_mov_b32 v4, s4
    v_mov_b32 v5, 0x100
    s_lshl_b32 s3, s3, 3
    s_mov_b64 exec, 1
    buffer_atomic_add_x2 v[4:5], off, s[12:15], s3 offset:128 sc1
    s_mov_b64 exec, -1
DISPATCH:
    s_bfe_u32 s3, s2, 0x10002
    s_lshr_b32 s4, s2, 3
    s_lshl_b32 s4, s4, 2
    s_and_b32 s2, s2, 3
    s_or_b32 s2, s2, s4
    s_lshl_b32 s52, s3, 7
    s_or_b32 s52, s52, s2
    s_cmp_eq_u32 s3, 0
    s_cbranch_scc1 CHAIN_HALF
    s_cmp_ge_u32 s2, 96
    s_cbranch_scc1 DS_1
    s_branch ROLE_P
DS_1:
    s_sub_u32 s2, s2, 96
    s_branch ROLE_W
CHAIN_HALF:
    s_cmp_ge_u32 s2, 32
    s_cbranch_scc1 DS_2
    s_branch ROLE_A
DS_2:
    s_sub_u32 s2, s2, 32
    s_cmp_ge_u32 s2, 32
    s_cbranch_scc1 DS_3
    s_branch ROLE_U
DS_3:
    s_sub_u32 s2, s2, 32
    s_cmp_ge_u32 s2, 40
    s_cbranch_scc1 DS_4
    s_branch ROLE_R
DS_4:
    s_sub_u32 s2, s2, 40
    s_cmp_ge_u32 s2, 4
    s_cbranch_scc1 DS_5
    s_branch ROLE_T
DS_5:
    s_sub_u32 s2, s2, 4
    s_cmp_ge_u32 s2, 20
    s_cbranch_scc1 DS_6
    s_branch ROLE_H
DS_6:
    s_sub_u32 s2, s2, 20
EXIT0:
    s_endpgm
RESTART:
    s_mov_b64 exec, -1
    s_waitcnt vmcnt(0) lgkmcnt(0)
    s_barrier
    s_cmp_lg_u32 s32, 0
    s_cbranch_scc1 RST_W
    v_mov_b32 v4, 1
    s_mov_b64 exec, 1
    buffer_atomic_add v4, off, s[12:15], 0 offset:12 sc1
    s_mov_b64 exec, -1
RST_W:
    s_sleep 10
    buffer_load_dword v4, off, s[12:15], 0 offset:12 sc1
    s_sub_u32 s33, s33, 1
    s_cbranch_scc1 EXIT0
    s_waitcnt vmcnt(0)
    v_readfirstlane_b32 s4, v4
    s_nop 0
    s_cmp_lt_u32 s4, 256
    s_cbranch_scc1 RST_W
    v_mbcnt_lo_u32_b32 v2, -1, 0
    v_mbcnt_hi_u32_b32 v2, -1, v2
    s_lshl_b32 s4, s32, 6
    v_add_u32 v0, s4, v2
    s_mov_b32 s2, s94
    s_mov_b32 s54, 0
    s_mov_b32 s95, 96
    s_branch DISPATCH
.p2align 6
ROLE_A:
    s_load_dwordx4 s[40:43], s[0:1], 16
    s_mul_i32 s37, s2, 384
    s_waitcnt lgkmcnt(0)
    s_mov_b32 s16, s40
    s_mov_b32 s17, s41
    s_mov_b32 s18, 7864320
    s_mov_b32 s19, 0x20000
    s_mov_b32 s20, s42
    s_mov_b32 s21, s43
    s_mov_b32 s22, 7864320
    s_mov_b32 s23, 0x20000
    s_and_b32 s56, s52, 3
    s_lshl_b32 s35, s32, 1
    s_add_u32 s35, s35, 1
    s_cmp_eq_u32 s32, 0
    s_cselect_b32 s35, 0, s35
    s_mul_i32 s39, s32, 6144
    s_movk_i32 s46, 2731
    s_mul_i32 s47, s32, 384
    v_add_u32 v15, s47, v2
    v_add_u32 v15, 0, v15
    v_mul_lo_u32 v16, v15, s46
    v_lshrrev_b32 v16, 16, v16
    v_mul_u32_u24 v17, 24, v16
    v_sub_u32 v17, v15, v17
    v_bfe_u32 v18, v16, 4, 1
    v_lshlrev_b32 v18, 2, v18
    v_bfe_u32 v19, v16, 2, 1
    v_lshl_add_u32 v18, v19, 1, v18
    v_xor_b32 v17, v17, v18
    v_mul_u32_u24 v16, 12288, v16
    v_lshl_add_u32 v16, v17, 4, v16
    v_add_u32 v6, s37, v16
    v_add_u32 v15, s47, v2
    v_add_u32 v15, 64, v15
    v_mul_lo_u32 v16, v15, s46
    v_lshrrev_b32 v16, 16, v16
    v_mul_u32_u24 v17, 24, v16
    v_sub_u32 v17, v15, v17
    v_bfe_u32 v18, v16, 4, 1
    v_lshlrev_b32 v18, 2, v18
    v_bfe_u32 v19, v16, 2, 1
    v_lshl_add_u32 v18, v19, 1, v18
    v_xor_b32 v17, v17, v18
    v_mul_u32_u24 v16, 12288, v16
    v_lshl_add_u32 v16, v17, 4, v16
    v_add_u32 v7, s37, v16
    v_add_u32 v15, s47, v2
    v_add_u32 v15, 128, v15
    v_mul_lo_u32 v16, v15, s46
    v_lshrrev_b32 v16, 16, v16
    v_mul_u32_u24 v17, 24, v16
    v_sub_u32 v17, v15, v17
    v_bfe_u32 v18, v16, 4, 1
    v_lshlrev_b32 v18, 2, v18
    v_bfe_u32 v19, v16, 2, 1
    v_lshl_add_u32 v18, v19, 1, v18
    v_xor_b32 v17, v17, v18
    v_mul_u32_u24 v16, 12288, v16
    v_lshl_add_u32 v16, v17, 4, v16
    v_add_u32 v8, s37, v16
    v_add_u32 v15, s47, v2
    v_add_u32 v15, 192, v15
    v_mul_lo_u32 v16, v15, s46
    v_lshrrev_b32 v16, 16, v16
    v_mul_u32_u24 v17, 24, v16
    v_sub_u32 v17, v15, v17
    v_bfe_u32 v18, v16, 4, 1
    v_lshlrev_b32 v18, 2, v18
    v_bfe_u32 v19, v16, 2, 1
    v_lshl_add_u32 v18, v19, 1, v18
    v_xor_b32 v17, v17, v18
    v_mul_u32_u24 v16, 12288, v16
    v_lshl_add_u32 v16, v17, 4, v16
    v_add_u32 v9, s37, v16
    v_add_u32 v15, s47, v2
    v_add_u32 v15, 256, v15
    v_mul_lo_u32 v16, v15, s46
    v_lshrrev_b32 v16, 16, v16
    v_mul_u32_u24 v17, 24, v16
    v_sub_u32 v17, v15, v17
    v_bfe_u32 v18, v16, 4, 1
    v_lshlrev_b32 v18, 2, v18
    v_bfe_u32 v19, v16, 2, 1
    v_lshl_add_u32 v18, v19, 1, v18
    v_xor_b32 v17, v17, v18
    v_mul_u32_u24 v16, 12288, v16
    v_lshl_add_u32 v16, v17, 4, v16
    v_add_u32 v10, s37, v16
    v_add_u32 v15, s47, v2
    v_add_u32 v15, 320, v15
    v_mul_lo_u32 v16, v15, s46
    v_lshrrev_b32 v16, 16, v16
    v_mul_u32_u24 v17, 24, v16
    v_sub_u32 v17, v15, v17
    v_bfe_u32 v18, v16, 4, 1
    v_lshlrev_b32 v18, 2, v18
    v_bfe_u32 v19, v16, 2, 1
    v_lshl_add_u32 v18, v19, 1, v18
    v_xor_b32 v17, v17, v18
    v_mul_u32_u24 v16, 12288, v16
    v_lshl_add_u32 v16, v17, 4, v16
    v_add_u32 v11, s37, v16
    v_lshrrev_b32 v15, 5, v2
    v_lshlrev_b32 v15, 3, v15
    v_bfe_u32 v16, v2, 4, 1
    v_lshl_add_u32 v15, v16, 1, v15
    v_bfe_u32 v16, v2, 3, 1
    v_lshl_add_u32 v15, v16, 2, v15
    v_lshlrev_b32 v18, 1, v16
    v_bfe_u32 v16, v2, 2, 1
    v_lshl_add_u32 v15, v16, 4, v15
    v_lshl_add_u32 v18, v16, 2, v18
    v_mul_u32_u24 v15, 384, v15
    v_and_b32 v16, 3, v2
    v_lshl_add_u32 v15, v16, 3, v15
    s_mul_i32 s46, s32, 2
    s_add_u32 s46, s46, 0
    v_xor_b32 v16, s46, v18
    v_lshl_add_u32 v12, v16, 4, v15
    s_mul_i32 s46, s32, 2
    s_add_u32 s46, s46, 8
    v_xor_b32 v16, s46, v18
    v_lshl_add_u32 v13, v16, 4, v15
    s_mul_i32 s46, s32, 2
    s_add_u32 s46, s46, 16
    v_xor_b32 v16, s46, v18
    v_lshl_add_u32 v14, v16, 4, v15
    s_cmp_eq_u32 s32, 1
    s_cbranch_scc1 A_L1
    s_cmp_eq_u32 s32, 2
    s_cbranch_scc1 A_L2
    s_cmp_eq_u32 s32, 3
    s_cbranch_scc1 A_L3
    s_mov_b32 s46, 0
    s_add_u32 m0, s39, 0
    s_nop 0
    buffer_load_dwordx4 v6, s[16:19], s46 offen  lds
    s_add_u32 m0, s39, 1024
    s_nop 0
    buffer_load_dwordx4 v7, s[16:19], s46 offen  lds
    s_add_u32 m0, s39, 2048
    s_nop 0
    buffer_load_dwordx4 v8, s[16:19], s46 offen  lds
    s_add_u32 m0, s39, 3072
    s_nop 0
    buffer_load_dwordx4 v9, s[16:19], s46 offen  lds
    s_add_u32 m0, s39, 4096
    s_nop 0
    buffer_load_dwordx4 v10, s[16:19], s46 offen  lds
    s_add_u32 m0, s39, 5120
    s_nop 0
    buffer_load_dwordx4 v11, s[16:19], s46 offen  lds
    s_mov_b32 s46, 0
    s_add_u32 m0, s39, 24576
    s_nop 0
    buffer_load_dwordx4 v6, s[20:23], s46 offen  lds
    s_add_u32 m0, s39, 25600
    s_nop 0
    buffer_load_dwordx4 v7, s[20:23], s46 offen  lds
    s_add_u32 m0, s39, 26624
    s_nop 0
    buffer_load_dwordx4 v8, s[20:23], s46 offen  lds
    s_add_u32 m0, s39, 27648
    s_nop 0
    buffer_load_dwordx4 v9, s[20:23], s46 offen  lds
    s_add_u32 m0, s39, 28672
    s_nop 0
    buffer_load_dwordx4 v10, s[20:23], s46 offen  lds
    s_add_u32 m0, s39, 29696
    s_nop 0
    buffer_load_dwordx4 v11, s[20:23], s46 offen  lds
    s_mov_b32 s46, 786432
    s_add_u32 m0, s39, 49152
    s_nop 0
    buffer_load_dwordx4 v6, s[16:19], s46 offen  lds
    s_add_u32 m0, s39, 50176
    s_nop 0
    buffer_load_dwordx4 v7, s[16:19], s46 offen  lds
    s_add_u32 m0, s39, 51200
    s_nop 0
    buffer_load_dwordx4 v8, s[16:19], s46 offen  lds
    s_add_u32 m0, s39, 52224
    s_nop 0
    buffer_load_dwordx4 v9, s[16:19], s46 offen  lds
    s_add_u32 m0, s39, 53248
    s_nop 0
    buffer_load_dwordx4 v10, s[16:19], s46 offen  lds
    s_add_u32 m0, s39, 54272
    s_nop 0
    buffer_load_dwordx4 v11, s[16:19], s46 offen  lds
    s_mov_b32 s46, 786432
    s_add_u32 m0, s39, 73728
    s_nop 0
    buffer_load_dwordx4 v6, s[20:23], s46 offen  lds
    s_add_u32 m0, s39, 74752
    s_nop 0
    buffer_load_dwordx4 v7, s[20:23], s46 offen  lds
    s_add_u32 m0, s39, 75776
    s_nop 0
    buffer_load_dwordx4 v8, s[20:23], s46 offen  lds
    s_add_u32 m0, s39, 76800
    s_nop 0
    buffer_load_dwordx4 v9, s[20:23], s46 offen  lds
    s_add_u32 m0, s39, 77824
    s_nop 0
    buffer_load_dwordx4 v10, s[20:23], s46 offen  lds
    s_add_u32 m0, s39, 78848
    s_nop 0
    buffer_load_dwordx4 v11, s[20:23], s46 offen  lds
    s_mov_b32 s46, 1572864
    s_add_u32 m0, s39, 98304
    s_nop 0
    buffer_load_dwordx4 v6, s[16:19], s46 offen  lds
    s_add_u32 m0, s39, 99328
    s_nop 0
    buffer_load_dwordx4 v7, s[16:19], s46 offen  lds
    s_add_u32 m0, s39, 100352
    s_nop 0
    buffer_load_dwordx4 v8, s[16:19], s46 offen  lds
    s_add_u32 m0, s39, 101376
    s_nop 0
    buffer_load_dwordx4 v9, s[16:19], s46 offen  lds
    s_add_u32 m0, s39, 102400
    s_nop 0
    buffer_load_dwordx4 v10, s[16:19], s46 offen  lds
    s_add_u32 m0, s39, 103424
    s_nop 0
    buffer_load_dwordx4 v11, s[16:19], s46 offen  lds
    s_waitcnt vmcnt(24)
    s_barrier
    ds_read_b64_tr_b16 a[0:1], v12 offset:0
    ds_read_b64_tr_b16 a[2:3], v12 offset:384
    ds_read_b64_tr_b16 a[4:5], v12 offset:12288
    ds_read_b64_tr_b16 a[6:7], v12 offset:12672
    ds_read_b64_tr_b16 v[32:33], v13 offset:0
    ds_read_b64_tr_b16 v[34:35], v13 offset:384
    ds_read_b64_tr_b16 v[36:37], v13 offset:12288
    ds_read_b64_tr_b16 v[38:39], v13 offset:12672
    ds_read_b64_tr_b16 v[40:41], v14 offset:0
    ds_read_b64_tr_b16 v[42:43], v14 offset:384
    ds_read_b64_tr_b16 v[44:45], v14 offset:12288
    ds_read_b64_tr_b16 v[46:47], v14 offset:12672
    s_mov_b32 s46, 1572864
    s_add_u32 m0, s39, 122880
    s_nop 0
    buffer_load_dwordx4 v6, s[20:23], s46 offen  lds
    s_add_u32 m0, s39, 123904
    s_nop 0
    buffer_load_dwordx4 v7, s[20:23], s46 offen  lds
    s_add_u32 m0, s39, 124928
    s_nop 0
    buffer_load_dwordx4 v8, s[20:23], s46 offen  lds
    s_add_u32 m0, s39, 125952
    s_nop 0
    buffer_load_dwordx4 v9, s[20:23], s46 offen  lds
    s_add_u32 m0, s39, 126976
    s_nop 0
    buffer_load_dwordx4 v10, s[20:23], s46 offen  lds
    s_add_u32 m0, s39, 128000
    s_nop 0
    buffer_load_dwordx4 v11, s[20:23], s46 offen  lds
    s_waitcnt lgkmcnt(0)
    s_waitcnt vmcnt(24)
    s_barrier
    ds_read_b64_tr_b16 a[8:9], v12 offset:24576
    ds_read_b64_tr_b16 a[10:11], v12 offset:24960
    ds_read_b64_tr_b16 a[12:13], v12 offset:36864
    ds_read_b64_tr_b16 a[14:15], v12 offset:37248
    ds_read_b64_tr_b16 a[16:17], v13 offset:24576
    ds_read_b64_tr_b16 a[18:19], v13 offset:24960
    ds_read_b64_tr_b16 a[20:21], v13 offset:36864
    ds_read_b64_tr_b16 a[22:23], v13 offset:37248
    ds_read_b64_tr_b16 v[48:49], v14 offset:24576
    ds_read_b64_tr_b16 v[50:51], v14 offset:24960
    ds_read_b64_tr_b16 v[52:53], v14 offset:36864
    ds_read_b64_tr_b16 v[54:55], v14 offset:37248
    s_mov_b32 s46, 2359296
    s_add_u32 m0, s39, 0
    s_nop 0
    buffer_load_dwordx4 v6, s[16:19], s46 offen  lds
    s_add_u32 m0, s39, 1024
    s_nop 0
    buffer_load_dwordx4 v7, s[16:19], s46 offen  lds
    s_add_u32 m0, s39, 2048
    s_nop 0
    buffer_load_dwordx4 v8, s[16:19], s46 offen  lds
    s_add_u32 m0, s39, 3072
    s_nop 0
    buffer_load_dwordx4 v9, s[16:19], s46 offen  lds
    s_add_u32 m0, s39, 4096
    s_nop 0
    buffer_load_dwordx4 v10, s[16:19], s46 offen  lds
    s_add_u32 m0, s39, 5120
    s_nop 0
    buffer_load_dwordx4 v11, s[16:19], s46 offen  lds
    s_waitcnt lgkmcnt(0)
    v_add_u32 v12, 49152, v12
    v_add_u32 v13, 49152, v13
    v_add_u32 v14, 49152, v14
    s_waitcnt vmcnt(24)
    s_barrier
    ds_read_b64_tr_b16 a[24:25], v12 offset:0
    ds_read_b64_tr_b16 a[26:27], v12 offset:384
    ds_read_b64_tr_b16 a[28:29], v12 offset:12288
    ds_read_b64_tr_b16 a[30:31], v12 offset:12672
    ds_read_b64_tr_b16 a[32:33], v13 offset:0
    ds_read_b64_tr_b16 a[34:35], v13 offset:384
    ds_read_b64_tr_b16 a[36:37], v13 offset:12288
    ds_read_b64_tr_b16 a[38:39], v13 offset:12672
    ds_read_b64_tr_b16 a[40:41], v14 offset:0
    ds_read_b64_tr_b16 a[42:43], v14 offset:384
    ds_read_b64_tr_b16 a[44:45], v14 offset:12288
    ds_read_b64_tr_b16 a[46:47], v14 offset:12672
    s_mov_b32 s46, 2359296
    s_add_u32 m0, s39, 24576
    s_nop 0
    buffer_load_dwordx4 v6, s[20:23], s46 offen  lds
    s_add_u32 m0, s39, 25600
    s_nop 0
    buffer_load_dwordx4 v7, s[20:23], s46 offen  lds
    s_add_u32 m0, s39, 26624
    s_nop 0
    buffer_load_dwordx4 v8, s[20:23], s46 offen  lds
    s_add_u32 m0, s39, 27648
    s_nop 0
    buffer_load_dwordx4 v9, s[20:23], s46 offen  lds
    s_add_u32 m0, s39, 28672
    s_nop 0
    buffer_load_dwordx4 v10, s[20:23], s46 offen  lds
    s_add_u32 m0, s39, 29696
    s_nop 0
    buffer_load_dwordx4 v11, s[20:23], s46 offen  lds
    s_waitcnt lgkmcnt(0)
    s_waitcnt vmcnt(24)
    s_barrier
    ds_read_b64_tr_b16 a[48:49], v12 offset:24576
    ds_read_b64_tr_b16 a[50:51], v12 offset:24960
    ds_read_b64_tr_b16 a[52:53], v12 offset:36864
    ds_read_b64_tr_b16 a[54:55], v12 offset:37248
    ds_read_b64_tr_b16 a[56:57], v13 offset:24576
    ds_read_b64_tr_b16 a[58:59], v13 offset:24960
    ds_read_b64_tr_b16 a[60:61], v13 offset:36864
    ds_read_b64_tr_b16 a[62:63], v13 offset:37248
    ds_read_b64_tr_b16 v[56:57], v14 offset:24576
    ds_read_b64_tr_b16 v[58:59], v14 offset:24960
    ds_read_b64_tr_b16 v[60:61], v14 offset:36864
    ds_read_b64_tr_b16 v[62:63], v14 offset:37248
    s_mov_b32 s46, 3145728
    s_add_u32 m0, s39, 49152
    s_nop 0
    buffer_load_dwordx4 v6, s[16:19], s46 offen  lds
    s_add_u32 m0, s39, 50176
    s_nop 0
    buffer_load_dwordx4 v7, s[16:19], s46 offen  lds
    s_add_u32 m0, s39, 51200
    s_nop 0
    buffer_load_dwordx4 v8, s[16:19], s46 offen  lds
    s_add_u32 m0, s39, 52224
    s_nop 0
    buffer_load_dwordx4 v9, s[16:19], s46 offen  lds
    s_add_u32 m0, s39, 53248
    s_nop 0
    buffer_load_dwordx4 v10, s[16:19], s46 offen  lds
    s_add_u32 m0, s39, 54272
    s_nop 0
    buffer_load_dwordx4 v11, s[16:19], s46 offen  lds
    s_waitcnt lgkmcnt(0)
    v_add_u32 v12, 49152, v12
    v_add_u32 v13, 49152, v13
    v_add_u32 v14, 49152, v14
    s_waitcnt vmcnt(24)
    s_barrier
    ds_read_b64_tr_b16 a[64:65], v12 offset:0
    ds_read_b64_tr_b16 a[66:67], v12 offset:384
    ds_read_b64_tr_b16 a[68:69], v12 offset:12288
    ds_read_b64_tr_b16 a[70:71], v12 offset:12672
    ds_read_b64_tr_b16 a[72:73], v13 offset:0
    ds_read_b64_tr_b16 a[74:75], v13 offset:384
    ds_read_b64_tr_b16 a[76:77], v13 offset:12288
    ds_read_b64_tr_b16 a[78:79], v13 offset:12672
    ds_read_b64_tr_b16 a[80:81], v14 offset:0
    ds_read_b64_tr_b16 a[82:83], v14 offset:384
    ds_read_b64_tr_b16 a[84:85], v14 offset:12288
    ds_read_b64_tr_b16 a[86:87], v14 offset:12672
    s_mov_b32 s46, 3145728
    s_add_u32 m0, s39, 73728
    s_nop 0
    buffer_load_dwordx4 v6, s[20:23], s46 offen  lds
    s_add_u32 m0, s39, 74752
    s_nop 0
    buffer_load_dwordx4 v7, s[20:23], s46 offen  lds
    s_add_u32 m0, s39, 75776
    s_nop 0
    buffer_load_dwordx4 v8, s[20:23], s46 offen  lds
    s_add_u32 m0, s39, 76800
    s_nop 0
    buffer_load_dwordx4 v9, s[20:23], s46 offen  lds
    s_add_u32 m0, s39, 77824
    s_nop 0
    buffer_load_dwordx4 v10, s[20:23], s46 offen  lds
    s_add_u32 m0, s39, 78848
    s_nop 0
    buffer_load_dwordx4 v11, s[20:23], s46 offen  lds
    s_waitcnt lgkmcnt(0)
    s_waitcnt vmcnt(24)
    s_barrier
    ds_read_b64_tr_b16 v[64:65], v12 offset:24576
    ds_read_b64_tr_b16 v[66:67], v12 offset:24960
    ds_read_b64_tr_b16 v[68:69], v12 offset:36864
    ds_read_b64_tr_b16 v[70:71], v12 offset:37248
    ds_read_b64_tr_b16 a[88:89], v13 offset:24576
    ds_read_b64_tr_b16 a[90:91], v13 offset:24960
    ds_read_b64_tr_b16 a[92:93], v13 offset:36864
    ds_read_b64_tr_b16 a[94:95], v13 offset:37248
    ds_read_b64_tr_b16 a[96:97], v14 offset:24576
    ds_read_b64_tr_b16 a[98:99], v14 offset:24960
    ds_read_b64_tr_b16 a[100:101], v14 offset:36864
    ds_read_b64_tr_b16 a[102:103], v14 offset:37248
    s_mov_b32 s46, 3932160
    s_add_u32 m0, s39, 98304
    s_nop 0
    buffer_load_dwordx4 v6, s[16:19], s46 offen  lds
    s_add_u32 m0, s39, 99328
    s_nop 0
    buffer_load_dwordx4 v7, s[16:19], s46 offen  lds
    s_add_u32 m0, s39, 100352
    s_nop 0
    buffer_load_dwordx4 v8, s[16:19], s46 offen  lds
    s_add_u32 m0, s39, 101376
    s_nop 0
    buffer_load_dwordx4 v9, s[16:19], s46 offen  lds
    s_add_u32 m0, s39, 102400
    s_nop 0
    buffer_load_dwordx4 v10, s[16:19], s46 offen  lds
    s_add_u32 m0, s39, 103424
    s_nop 0
    buffer_load_dwordx4 v11, s[16:19], s46 offen  lds
    s_waitcnt lgkmcnt(0)
    v_add_u32 v12, 4294868992, v12
    v_add_u32 v13, 4294868992, v13
    v_add_u32 v14, 4294868992, v14
    s_waitcnt vmcnt(24)
    s_barrier
    ds_read_b64_tr_b16 v[72:73], v12 offset:0
    ds_read_b64_tr_b16 v[74:75], v12 offset:384
    ds_read_b64_tr_b16 v[76:77], v12 offset:12288
    ds_read_b64_tr_b16 v[78:79], v12 offset:12672
    ds_read_b64_tr_b16 v[96:97], v13 offset:0
    ds_read_b64_tr_b16 v[98:99], v13 offset:384
    ds_read_b64_tr_b16 v[100:101], v13 offset:12288
    ds_read_b64_tr_b16 v[102:103], v13 offset:12672
    ds_read_b64_tr_b16 a[168:169], v14 offset:0
    ds_read_b64_tr_b16 a[170:171], v14 offset:384
    ds_read_b64_tr_b16 a[172:173], v14 offset:12288
    ds_read_b64_tr_b16 a[174:175], v14 offset:12672
    s_mov_b32 s46, 3932160
    s_add_u32 m0, s39, 122880
    s_nop 0
    buffer_load_dwordx4 v6, s[20:23], s46 offen  lds
    s_add_u32 m0, s39, 123904
    s_nop 0
    buffer_load_dwordx4 v7, s[20:23], s46 offen  lds
    s_add_u32 m0, s39, 124928
    s_nop 0
    buffer_load_dwordx4 v8, s[20:23], s46 offen  lds
    s_add_u32 m0, s39, 125952
    s_nop 0
    buffer_load_dwordx4 v9, s[20:23], s46 offen  lds
    s_add_u32 m0, s39, 126976
    s_nop 0
    buffer_load_dwordx4 v10, s[20:23], s46 offen  lds
    s_add_u32 m0, s39, 128000
    s_nop 0
    buffer_load_dwordx4 v11, s[20:23], s46 offen  lds
    s_waitcnt lgkmcnt(0)
    s_waitcnt vmcnt(24)
    s_barrier
    ds_read_b64_tr_b16 a[200:201], v12 offset:24576
    ds_read_b64_tr_b16 a[202:203], v12 offset:24960
    ds_read_b64_tr_b16 a[204:205], v12 offset:36864
    ds_read_b64_tr_b16 a[206:207], v12 offset:37248
    ds_read_b64_tr_b16 a[232:233], v13 offset:24576
    ds_read_b64_tr_b16 a[234:235], v13 offset:24960
    ds_read_b64_tr_b16 a[236:237], v13 offset:36864
    ds_read_b64_tr_b16 a[238:239], v13 offset:37248
    ds_read_b64_tr_b16 v[200:201], v14 offset:24576
    ds_read_b64_tr_b16 v[202:203], v14 offset:24960
    ds_read_b64_tr_b16 v[204:205], v14 offset:36864
    ds_read_b64_tr_b16 v[206:207], v14 offset:37248
    s_mov_b32 s46, 4718592
    s_add_u32 m0, s39, 0
    s_nop 0
    buffer_load_dwordx4 v6, s[16:19], s46 offen  lds
    s_add_u32 m0, s39, 1024
    s_nop 0
    buffer_load_dwordx4 v7, s[16:19], s46 offen  lds
    s_add_u32 m0, s39, 2048
    s_nop 0
    buffer_load_dwordx4 v8, s[16:19], s46 offen  lds
    s_add_u32 m0, s39, 3072
    s_nop 0
    buffer_load_dwordx4 v9, s[16:19], s46 offen  lds
    s_add_u32 m0, s39, 4096
    s_nop 0
    buffer_load_dwordx4 v10, s[16:19], s46 offen  lds
    s_add_u32 m0, s39, 5120
    s_nop 0
    buffer_load_dwordx4 v11, s[16:19], s46 offen  lds
    s_waitcnt lgkmcnt(0)
    v_add_u32 v12, 49152, v12
    v_add_u32 v13, 49152, v13
    v_add_u32 v14, 49152, v14
    s_waitcnt vmcnt(24)
    s_barrier
    ds_read_b64_tr_b16 a[104:105], v12 offset:0
    ds_read_b64_tr_b16 a[106:107], v12 offset:384
    ds_read_b64_tr_b16 a[108:109], v12 offset:12288
    ds_read_b64_tr_b16 a[110:111], v12 offset:12672
    ds_read_b64_tr_b16 a[136:137], v13 offset:0
    ds_read_b64_tr_b16 a[138:139], v13 offset:384
    ds_read_b64_tr_b16 a[140:141], v13 offset:12288
    ds_read_b64_tr_b16 a[142:143], v13 offset:12672
    ds_read_b64_tr_b16 v[120:121], v14 offset:0
    ds_read_b64_tr_b16 v[122:123], v14 offset:384
    ds_read_b64_tr_b16 v[124:125], v14 offset:12288
    ds_read_b64_tr_b16 v[126:127], v14 offset:12672
    s_mov_b32 s46, 4718592
    s_add_u32 m0, s39, 24576
    s_nop 0
    buffer_load_dwordx4 v6, s[20:23], s46 offen  lds
    s_add_u32 m0, s39, 25600
    s_nop 0
    buffer_load_dwordx4 v7, s[20:23], s46 offen  lds
    s_add_u32 m0, s39, 26624
    s_nop 0
    buffer_load_dwordx4 v8, s[20:23], s46 offen  lds
    s_add_u32 m0, s39, 27648
    s_nop 0
    buffer_load_dwordx4 v9, s[20:23], s46 offen  lds
    s_add_u32 m0, s39, 28672
    s_nop 0
    buffer_load_dwordx4 v10, s[20:23], s46 offen  lds
    s_add_u32 m0, s39, 29696
    s_nop 0
    buffer_load_dwordx4 v11, s[20:23], s46 offen  lds
    s_waitcnt lgkmcnt(0)
    s_waitcnt vmcnt(24)
    s_barrier
    ds_read_b64_tr_b16 a[208:209], v12 offset:24576
    ds_read_b64_tr_b16 a[210:211], v12 offset:24960
    ds_read_b64_tr_b16 a[212:213], v12 offset:36864
    ds_read_b64_tr_b16 a[214:215], v12 offset:37248
    ds_read_b64_tr_b16 v[168:169], v13 offset:24576
    ds_read_b64_tr_b16 v[170:171], v13 offset:24960
    ds_read_b64_tr_b16 v[172:173], v13 offset:36864
    ds_read_b64_tr_b16 v[174:175], v13 offset:37248
    ds_read_b64_tr_b16 v[208:209], v14 offset:24576
    ds_read_b64_tr_b16 v[210:211], v14 offset:24960
    ds_read_b64_tr_b16 v[212:213], v14 offset:36864
    ds_read_b64_tr_b16 v[214:215], v14 offset:37248
    s_mov_b32 s46, 5505024
    s_add_u32 m0, s39, 49152
    s_nop 0
    buffer_load_dwordx4 v6, s[16:19], s46 offen  lds
    s_add_u32 m0, s39, 50176
    s_nop 0
    buffer_load_dwordx4 v7, s[16:19], s46 offen  lds
    s_add_u32 m0, s39, 51200
    s_nop 0
    buffer_load_dwordx4 v8, s[16:19], s46 offen  lds
    s_add_u32 m0, s39, 52224
    s_nop 0
    buffer_load_dwordx4 v9, s[16:19], s46 offen  lds
    s_add_u32 m0, s39, 53248
    s_nop 0
    buffer_load_dwordx4 v10, s[16:19], s46 offen  lds
    s_add_u32 m0, s39, 54272
    s_nop 0
    buffer_load_dwordx4 v11, s[16:19], s46 offen  lds
    s_waitcnt lgkmcnt(0)
    v_add_u32 v12, 49152, v12
    v_add_u32 v13, 49152, v13
    v_add_u32 v14, 49152, v14
    s_waitcnt vmcnt(24)
    s_barrier
    ds_read_b64_tr_b16 a[112:113], v12 offset:0
    ds_read_b64_tr_b16 a[114:115], v12 offset:384
    ds_read_b64_tr_b16 a[116:117], v12 offset:12288
    ds_read_b64_tr_b16 a[118:119], v12 offset:12672
    ds_read_b64_tr_b16 v[104:105], v13 offset:0
    ds_read_b64_tr_b16 v[106:107], v13 offset:384
    ds_read_b64_tr_b16 v[108:109], v13 offset:12288
    ds_read_b64_tr_b16 v[110:111], v13 offset:12672
    ds_read_b64_tr_b16 a[176:177], v14 offset:0
    ds_read_b64_tr_b16 a[178:179], v14 offset:384
    ds_read_b64_tr_b16 a[180:181], v14 offset:12288
    ds_read_b64_tr_b16 a[182:183], v14 offset:12672
    s_mov_b32 s46, 5505024
    s_add_u32 m0, s39, 73728
    s_nop 0
    buffer_load_dwordx4 v6, s[20:23], s46 offen  lds
    s_add_u32 m0, s39, 74752
    s_nop 0
    buffer_load_dwordx4 v7, s[20:23], s46 offen  lds
    s_add_u32 m0, s39, 75776
    s_nop 0
    buffer_load_dwordx4 v8, s[20:23], s46 offen  lds
    s_add_u32 m0, s39, 76800
    s_nop 0
    buffer_load_dwordx4 v9, s[20:23], s46 offen  lds
    s_add_u32 m0, s39, 77824
    s_nop 0
    buffer_load_dwordx4 v10, s[20:23], s46 offen  lds
    s_add_u32 m0, s39, 78848
    s_nop 0
    buffer_load_dwordx4 v11, s[20:23], s46 offen  lds
    s_waitcnt lgkmcnt(0)
    s_waitcnt vmcnt(24)
    s_barrier
    ds_read_b64_tr_b16 v[144:145], v12 offset:24576
    ds_read_b64_tr_b16 v[146:147], v12 offset:24960
    ds_read_b64_tr_b16 v[148:149], v12 offset:36864
    ds_read_b64_tr_b16 v[150:151], v12 offset:37248
    ds_read_b64_tr_b16 a[240:241], v13 offset:24576
    ds_read_b64_tr_b16 a[242:243], v13 offset:24960
    ds_read_b64_tr_b16 a[244:245], v13 offset:36864
    ds_read_b64_tr_b16 a[246:247], v13 offset:37248
    ds_read_b64_tr_b16 v[216:217], v14 offset:24576
    ds_read_b64_tr_b16 v[218:219], v14 offset:24960
    ds_read_b64_tr_b16 v[220:221], v14 offset:36864
    ds_read_b64_tr_b16 v[222:223], v14 offset:37248
    s_mov_b32 s46, 6291456
    s_add_u32 m0, s39, 98304
    s_nop 0
    buffer_load_dwordx4 v6, s[16:19], s46 offen  lds
    s_add_u32 m0, s39, 99328
    s_nop 0
    buffer_load_dwordx4 v7, s[16:19], s46 offen  lds
    s_add_u32 m0, s39, 100352
    s_nop 0
    buffer_load_dwordx4 v8, s[16:19], s46 offen  lds
    s_add_u32 m0, s39, 101376
    s_nop 0
    buffer_load_dwordx4 v9, s[16:19], s46 offen  lds
    s_add_u32 m0, s39, 102400
    s_nop 0
    buffer_load_dwordx4 v10, s[16:19], s46 offen  lds
    s_add_u32 m0, s39, 103424
    s_nop 0
    buffer_load_dwordx4 v11, s[16:19], s46 offen  lds
    s_waitcnt lgkmcnt(0)
    v_add_u32 v12, 4294868992, v12
    v_add_u32 v13, 4294868992, v13
    v_add_u32 v14, 4294868992, v14
    s_waitcnt vmcnt(24)
    s_barrier
    ds_read_b64_tr_b16 v[80:81], v12 offset:0
    ds_read_b64_tr_b16 v[82:83], v12 offset:384
    ds_read_b64_tr_b16 v[84:85], v12 offset:12288
    ds_read_b64_tr_b16 v[86:87], v12 offset:12672
    ds_read_b64_tr_b16 a[144:145], v13 offset:0
    ds_read_b64_tr_b16 a[146:147], v13 offset:384
    ds_read_b64_tr_b16 a[148:149], v13 offset:12288
    ds_read_b64_tr_b16 a[150:151], v13 offset:12672
    ds_read_b64_tr_b16 v[128:129], v14 offset:0
    ds_read_b64_tr_b16 v[130:131], v14 offset:384
    ds_read_b64_tr_b16 v[132:133], v14 offset:12288
    ds_read_b64_tr_b16 v[134:135], v14 offset:12672
    s_mov_b32 s46, 6291456
    s_add_u32 m0, s39, 122880
    s_nop 0
    buffer_load_dwordx4 v6, s[20:23], s46 offen  lds
    s_add_u32 m0, s39, 123904
    s_nop 0
    buffer_load_dwordx4 v7, s[20:23], s46 offen  lds
    s_add_u32 m0, s39, 124928
    s_nop 0
    buffer_load_dwordx4 v8, s[20:23], s46 offen  lds
    s_add_u32 m0, s39, 125952
    s_nop 0
    buffer_load_dwordx4 v9, s[20:23], s46 offen  lds
    s_add_u32 m0, s39, 126976
    s_nop 0
    buffer_load_dwordx4 v10, s[20:23], s46 offen  lds
    s_add_u32 m0, s39, 128000
    s_nop 0
    buffer_load_dwordx4 v11, s[20:23], s46 offen  lds
    s_waitcnt lgkmcnt(0)
    s_waitcnt vmcnt(24)
    s_barrier
    ds_read_b64_tr_b16 a[216:217], v12 offset:24576
    ds_read_b64_tr_b16 a[218:219], v12 offset:24960
    ds_read_b64_tr_b16 a[220:221], v12 offset:36864
    ds_read_b64_tr_b16 a[222:223], v12 offset:37248
    ds_read_b64_tr_b16 a[248:249], v13 offset:24576
    ds_read_b64_tr_b16 a[250:251], v13 offset:24960
    ds_read_b64_tr_b16 a[252:253], v13 offset:36864
    ds_read_b64_tr_b16 a[254:255], v13 offset:37248
    ds_read_b64_tr_b16 v[224:225], v14 offset:24576
    ds_read_b64_tr_b16 v[226:227], v14 offset:24960
    ds_read_b64_tr_b16 v[228:229], v14 offset:36864
    ds_read_b64_tr_b16 v[230:231], v14 offset:37248
    s_mov_b32 s46, 7077888
    s_add_u32 m0, s39, 0
    s_nop 0
    buffer_load_dwordx4 v6, s[16:19], s46 offen  lds
    s_add_u32 m0, s39, 1024
    s_nop 0
    buffer_load_dwordx4 v7, s[16:19], s46 offen  lds
    s_add_u32 m0, s39, 2048
    s_nop 0
    buffer_load_dwordx4 v8, s[16:19], s46 offen  lds
    s_add_u32 m0, s39, 3072
    s_nop 0
    buffer_load_dwordx4 v9, s[16:19], s46 offen  lds
    s_add_u32 m0, s39, 4096
    s_nop 0
    buffer_load_dwordx4 v10, s[16:19], s46 offen  lds
    s_add_u32 m0, s39, 5120
    s_nop 0
    buffer_load_dwordx4 v11, s[16:19], s46 offen  lds
    s_waitcnt lgkmcnt(0)
    v_add_u32 v12, 49152, v12
    v_add_u32 v13, 49152, v13
    v_add_u32 v14, 49152, v14
    s_waitcnt vmcnt(24)
    s_barrier
    ds_read_b64_tr_b16 a[120:121], v12 offset:0
    ds_read_b64_tr_b16 a[122:123], v12 offset:384
    ds_read_b64_tr_b16 a[124:125], v12 offset:12288
    ds_read_b64_tr_b16 a[126:127], v12 offset:12672
    ds_read_b64_tr_b16 v[112:113], v13 offset:0
    ds_read_b64_tr_b16 v[114:115], v13 offset:384
    ds_read_b64_tr_b16 v[116:117], v13 offset:12288
    ds_read_b64_tr_b16 v[118:119], v13 offset:12672
    ds_read_b64_tr_b16 a[184:185], v14 offset:0
    ds_read_b64_tr_b16 a[186:187], v14 offset:384
    ds_read_b64_tr_b16 a[188:189], v14 offset:12288
    ds_read_b64_tr_b16 a[190:191], v14 offset:12672
    s_mov_b32 s46, 7077888
    s_add_u32 m0, s39, 24576
    s_nop 0
    buffer_load_dwordx4 v6, s[20:23], s46 offen  lds
    s_add_u32 m0, s39, 25600
    s_nop 0
    buffer_load_dwordx4 v7, s[20:23], s46 offen  lds
    s_add_u32 m0, s39, 26624
    s_nop 0
    buffer_load_dwordx4 v8, s[20:23], s46 offen  lds
    s_add_u32 m0, s39, 27648
    s_nop 0
    buffer_load_dwordx4 v9, s[20:23], s46 offen  lds
    s_add_u32 m0, s39, 28672
    s_nop 0
    buffer_load_dwordx4 v10, s[20:23], s46 offen  lds
    s_add_u32 m0, s39, 29696
    s_nop 0
    buffer_load_dwordx4 v11, s[20:23], s46 offen  lds
    s_waitcnt lgkmcnt(0)
    s_waitcnt vmcnt(24)
    s_barrier
    ds_read_b64_tr_b16 v[152:153], v12 offset:24576
    ds_read_b64_tr_b16 v[154:155], v12 offset:24960
    ds_read_b64_tr_b16 v[156:157], v12 offset:36864
    ds_read_b64_tr_b16 v[158:159], v12 offset:37248
    ds_read_b64_tr_b16 v[176:177], v13 offset:24576
    ds_read_b64_tr_b16 v[178:179], v13 offset:24960
    ds_read_b64_tr_b16 v[180:181], v13 offset:36864
    ds_read_b64_tr_b16 v[182:183], v13 offset:37248
    ds_read_b64_tr_b16 v[232:233], v14 offset:24576
    ds_read_b64_tr_b16 v[234:235], v14 offset:24960
    ds_read_b64_tr_b16 v[236:237], v14 offset:36864
    ds_read_b64_tr_b16 v[238:239], v14 offset:37248
    s_waitcnt lgkmcnt(0)
    v_add_u32 v12, 49152, v12
    v_add_u32 v13, 49152, v13
    v_add_u32 v14, 49152, v14
    s_waitcnt vmcnt(18)
    s_barrier
    ds_read_b64_tr_b16 v[88:89], v12 offset:0
    ds_read_b64_tr_b16 v[90:91], v12 offset:384
    ds_read_b64_tr_b16 v[92:93], v12 offset:12288
    ds_read_b64_tr_b16 v[94:95], v12 offset:12672
    ds_read_b64_tr_b16 a[152:153], v13 offset:0
    ds_read_b64_tr_b16 a[154:155], v13 offset:384
    ds_read_b64_tr_b16 a[156:157], v13 offset:12288
    ds_read_b64_tr_b16 a[158:159], v13 offset:12672
    ds_read_b64_tr_b16 a[192:193], v14 offset:0
    ds_read_b64_tr_b16 a[194:195], v14 offset:384
    ds_read_b64_tr_b16 a[196:197], v14 offset:12288
    ds_read_b64_tr_b16 a[198:199], v14 offset:12672
    s_waitcnt lgkmcnt(0)
    s_waitcnt vmcnt(12)
    s_barrier
    ds_read_b64_tr_b16 a[224:225], v12 offset:24576
    ds_read_b64_tr_b16 a[226:227], v12 offset:24960
    ds_read_b64_tr_b16 a[228:229], v12 offset:36864
    ds_read_b64_tr_b16 a[230:231], v12 offset:37248
    ds_read_b64_tr_b16 v[184:185], v13 offset:24576
    ds_read_b64_tr_b16 v[186:187], v13 offset:24960
    ds_read_b64_tr_b16 v[188:189], v13 offset:36864
    ds_read_b64_tr_b16 v[190:191], v13 offset:37248
    ds_read_b64_tr_b16 v[240:241], v14 offset:24576
    ds_read_b64_tr_b16 v[242:243], v14 offset:24960
    ds_read_b64_tr_b16 v[244:245], v14 offset:36864
    ds_read_b64_tr_b16 v[246:247], v14 offset:37248
    s_waitcnt lgkmcnt(0)
    v_add_u32 v12, 4294868992, v12
    v_add_u32 v13, 4294868992, v13
    v_add_u32 v14, 4294868992, v14
    s_waitcnt vmcnt(6)
    s_barrier
    ds_read_b64_tr_b16 a[128:129], v12 offset:0
    ds_read_b64_tr_b16 a[130:131], v12 offset:384
    ds_read_b64_tr_b16 a[132:133], v12 offset:12288
    ds_read_b64_tr_b16 a[134:135], v12 offset:12672
    ds_read_b64_tr_b16 a[160:161], v13 offset:0
    ds_read_b64_tr_b16 a[162:163], v13 offset:384
    ds_read_b64_tr_b16 a[164:165], v13 offset:12288
    ds_read_b64_tr_b16 a[166:167], v13 offset:12672
    ds_read_b64_tr_b16 v[136:137], v14 offset:0
    ds_read_b64_tr_b16 v[138:139], v14 offset:384
    ds_read_b64_tr_b16 v[140:141], v14 offset:12288
    ds_read_b64_tr_b16 v[142:143], v14 offset:12672
    s_waitcnt lgkmcnt(0)
    s_waitcnt vmcnt(0)
    s_barrier
    ds_read_b64_tr_b16 v[160:161], v12 offset:24576
    ds_read_b64_tr_b16 v[162:163], v12 offset:24960
    ds_read_b64_tr_b16 v[164:165], v12 offset:36864
    ds_read_b64_tr_b16 v[166:167], v12 offset:37248
    ds_read_b64_tr_b16 v[192:193], v13 offset:24576
    ds_read_b64_tr_b16 v[194:195], v13 offset:24960
    ds_read_b64_tr_b16 v[196:197], v13 offset:36864
    ds_read_b64_tr_b16 v[198:199], v13 offset:37248
    ds_read_b64_tr_b16 v[248:249], v14 offset:24576
    ds_read_b64_tr_b16 v[250:251], v14 offset:24960
    ds_read_b64_tr_b16 v[252:253], v14 offset:36864
    ds_read_b64_tr_b16 v[254:255], v14 offset:37248
    s_waitcnt lgkmcnt(0)
    v_add_u32 v12, 49152, v12
    v_add_u32 v13, 49152, v13
    v_add_u32 v14, 49152, v14
    s_barrier
    s_branch A_LD
A_L1:
    s_mov_b32 s46, 0
    s_add_u32 m0, s39, 0
    s_nop 0
    buffer_load_dwordx4 v6, s[16:19], s46 offen  lds
    s_add_u32 m0, s39, 1024
    s_nop 0
    buffer_load_dwordx4 v7, s[16:19], s46 offen  lds
    s_add_u32 m0, s39, 2048
    s_nop 0
    buffer_load_dwordx4 v8, s[16:19], s46 offen  lds
    s_add_u32 m0, s39, 3072
    s_nop 0
    buffer_load_dwordx4 v9, s[16:19], s46 offen  lds
    s_add_u32 m0, s39, 4096
    s_nop 0
    buffer_load_dwordx4 v10, s[16:19], s46 offen  lds
    s_add_u32 m0, s39, 5120
    s_nop 0
    buffer_load_dwordx4 v11, s[16:19], s46 offen  lds
    s_mov_b32 s46, 0
    s_add_u32 m0, s39, 24576
    s_nop 0
    buffer_load_dwordx4 v6, s[20:23], s46 offen  lds
    s_add_u32 m0, s39, 25600
    s_nop 0
    buffer_load_dwordx4 v7, s[20:23], s46 offen  lds
    s_add_u32 m0, s39, 26624
    s_nop 0
    buffer_load_dwordx4 v8, s[20:23], s46 offen  lds
    s_add_u32 m0, s39, 27648
    s_nop 0
    buffer_load_dwordx4 v9, s[20:23], s46 offen  lds
    s_add_u32 m0, s39, 28672
    s_nop 0
    buffer_load_dwordx4 v10, s[20:23], s46 offen  lds
    s_add_u32 m0, s39, 29696
    s_nop 0
    buffer_load_dwordx4 v11, s[20:23], s46 offen  lds
    s_mov_b32 s46, 786432
    s_add_u32 m0, s39, 49152
    s_nop 0
    buffer_load_dwordx4 v6, s[16:19], s46 offen  lds
    s_add_u32 m0, s39, 50176
    s_nop 0
    buffer_load_dwordx4 v7, s[16:19], s46 offen  lds
    s_add_u32 m0, s39, 51200
    s_nop 0
    buffer_load_dwordx4 v8, s[16:19], s46 offen  lds
    s_add_u32 m0, s39, 52224
    s_nop 0
    buffer_load_dwordx4 v9, s[16:19], s46 offen  lds
    s_add_u32 m0, s39, 53248
    s_nop 0
    buffer_load_dwordx4 v10, s[16:19], s46 offen  lds
    s_add_u32 m0, s39, 54272
    s_nop 0
    buffer_load_dwordx4 v11, s[16:19], s46 offen  lds
    s_mov_b32 s46, 786432
    s_add_u32 m0, s39, 73728
    s_nop 0
    buffer_load_dwordx4 v6, s[20:23], s46 offen  lds
    s_add_u32 m0, s39, 74752
    s_nop 0
    buffer_load_dwordx4 v7, s[20:23], s46 offen  lds
    s_add_u32 m0, s39, 75776
    s_nop 0
    buffer_load_dwordx4 v8, s[20:23], s46 offen  lds
    s_add_u32 m0, s39, 76800
    s_nop 0
    buffer_load_dwordx4 v9, s[20:23], s46 offen  lds
    s_add_u32 m0, s39, 77824
    s_nop 0
    buffer_load_dwordx4 v10, s[20:23], s46 offen  lds
    s_add_u32 m0, s39, 78848
    s_nop 0
    buffer_load_dwordx4 v11, s[20:23], s46 offen  lds
    s_mov_b32 s46, 1572864
    s_add_u32 m0, s39, 98304
    s_nop 0
    buffer_load_dwordx4 v6, s[16:19], s46 offen  lds
    s_add_u32 m0, s39, 99328
    s_nop 0
    buffer_load_dwordx4 v7, s[16:19], s46 offen  lds
    s_add_u32 m0, s39, 100352
    s_nop 0
    buffer_load_dwordx4 v8, s[16:19], s46 offen  lds
    s_add_u32 m0, s39, 101376
    s_nop 0
    buffer_load_dwordx4 v9, s[16:19], s46 offen  lds
    s_add_u32 m0, s39, 102400
    s_nop 0
    buffer_load_dwordx4 v10, s[16:19], s46 offen  lds
    s_add_u32 m0, s39, 103424
    s_nop 0
    buffer_load_dwordx4 v11, s[16:19], s46 offen  lds
    s_waitcnt vmcnt(24)
    s_barrier
    ds_read_b64_tr_b16 a[120:121], v12 offset:0
    ds_read_b64_tr_b16 a[122:123], v12 offset:384
    ds_read_b64_tr_b16 a[124:125], v12 offset:12288
    ds_read_b64_tr_b16 a[126:127], v12 offset:12672
    ds_read_b64_tr_b16 v[112:113], v13 offset:0
    ds_read_b64_tr_b16 v[114:115], v13 offset:384
    ds_read_b64_tr_b16 v[116:117], v13 offset:12288
    ds_read_b64_tr_b16 v[118:119], v13 offset:12672
    ds_read_b64_tr_b16 a[184:185], v14 offset:0
    ds_read_b64_tr_b16 a[186:187], v14 offset:384
    ds_read_b64_tr_b16 a[188:189], v14 offset:12288
    ds_read_b64_tr_b16 a[190:191], v14 offset:12672
    s_mov_b32 s46, 1572864
    s_add_u32 m0, s39, 122880
    s_nop 0
    buffer_load_dwordx4 v6, s[20:23], s46 offen  lds
    s_add_u32 m0, s39, 123904
    s_nop 0
    buffer_load_dwordx4 v7, s[20:23], s46 offen  lds
    s_add_u32 m0, s39, 124928
    s_nop 0
    buffer_load_dwordx4 v8, s[20:23], s46 offen  lds
    s_add_u32 m0, s39, 125952
    s_nop 0
    buffer_load_dwordx4 v9, s[20:23], s46 offen  lds
    s_add_u32 m0, s39, 126976
    s_nop 0
    buffer_load_dwordx4 v10, s[20:23], s46 offen  lds
    s_add_u32 m0, s39, 128000
    s_nop 0
    buffer_load_dwordx4 v11, s[20:23], s46 offen  lds
    s_waitcnt lgkmcnt(0)
    s_waitcnt vmcnt(24)
    s_barrier
    ds_read_b64_tr_b16 v[152:153], v12 offset:24576
    ds_read_b64_tr_b16 v[154:155], v12 offset:24960
    ds_read_b64_tr_b16 v[156:157], v12 offset:36864
    ds_read_b64_tr_b16 v[158:159], v12 offset:37248
    ds_read_b64_tr_b16 v[176:177], v13 offset:24576
    ds_read_b64_tr_b16 v[178:179], v13 offset:24960
    ds_read_b64_tr_b16 v[180:181], v13 offset:36864
    ds_read_b64_tr_b16 v[182:183], v13 offset:37248
    ds_read_b64_tr_b16 v[232:233], v14 offset:24576
    ds_read_b64_tr_b16 v[234:235], v14 offset:24960
    ds_read_b64_tr_b16 v[236:237], v14 offset:36864
    ds_read_b64_tr_b16 v[238:239], v14 offset:37248
    s_mov_b32 s46, 2359296
    s_add_u32 m0, s39, 0
    s_nop 0
    buffer_load_dwordx4 v6, s[16:19], s46 offen  lds
    s_add_u32 m0, s39, 1024
    s_nop 0
    buffer_load_dwordx4 v7, s[16:19], s46 offen  lds
    s_add_u32 m0, s39, 2048
    s_nop 0
    buffer_load_dwordx4 v8, s[16:19], s46 offen  lds
    s_add_u32 m0, s39, 3072
    s_nop 0
    buffer_load_dwordx4 v9, s[16:19], s46 offen  lds
    s_add_u32 m0, s39, 4096
    s_nop 0
    buffer_load_dwordx4 v10, s[16:19], s46 offen  lds
    s_add_u32 m0, s39, 5120
    s_nop 0
    buffer_load_dwordx4 v11, s[16:19], s46 offen  lds
    s_waitcnt lgkmcnt(0)
    v_add_u32 v12, 49152, v12
    v_add_u32 v13, 49152, v13
    v_add_u32 v14, 49152, v14
    s_waitcnt vmcnt(24)
    s_barrier
    ds_read_b64_tr_b16 v[88:89], v12 offset:0
    ds_read_b64_tr_b16 v[90:91], v12 offset:384
    ds_read_b64_tr_b16 v[92:93], v12 offset:12288
    ds_read_b64_tr_b16 v[94:95], v12 offset:12672
    ds_read_b64_tr_b16 a[152:153], v13 offset:0
    ds_read_b64_tr_b16 a[154:155], v13 offset:384
    ds_read_b64_tr_b16 a[156:157], v13 offset:12288
    ds_read_b64_tr_b16 a[158:159], v13 offset:12672
    ds_read_b64_tr_b16 a[192:193], v14 offset:0
    ds_read_b64_tr_b16 a[194:195], v14 offset:384
    ds_read_b64_tr_b16 a[196:197], v14 offset:12288
    ds_read_b64_tr_b16 a[198:199], v14 offset:12672
    s_mov_b32 s46, 2359296
    s_add_u32 m0, s39, 24576
    s_nop 0
    buffer_load_dwordx4 v6, s[20:23], s46 offen  lds
    s_add_u32 m0, s39, 25600
    s_nop 0
    buffer_load_dwordx4 v7, s[20:23], s46 offen  lds
    s_add_u32 m0, s39, 26624
    s_nop 0
    buffer_load_dwordx4 v8, s[20:23], s46 offen  lds
    s_add_u32 m0, s39, 27648
    s_nop 0
    buffer_load_dwordx4 v9, s[20:23], s46 offen  lds
    s_add_u32 m0, s39, 28672
    s_nop 0
    buffer_load_dwordx4 v10, s[20:23], s46 offen  lds
    s_add_u32 m0, s39, 29696
    s_nop 0
    buffer_load_dwordx4 v11, s[20:23], s46 offen  lds
    s_waitcnt lgkmcnt(0)
    s_waitcnt vmcnt(24)
    s_barrier
    ds_read_b64_tr_b16 a[224:225], v12 offset:24576
    ds_read_b64_tr_b16 a[226:227], v12 offset:24960
    ds_read_b64_tr_b16 a[228:229], v12 offset:36864
    ds_read_b64_tr_b16 a[230:231], v12 offset:37248
    ds_read_b64_tr_b16 v[184:185], v13 offset:24576
    ds_read_b64_tr_b16 v[186:187], v13 offset:24960
    ds_read_b64_tr_b16 v[188:189], v13 offset:36864
    ds_read_b64_tr_b16 v[190:191], v13 offset:37248
    ds_read_b64_tr_b16 v[240:241], v14 offset:24576
    ds_read_b64_tr_b16 v[242:243], v14 offset:24960
    ds_read_b64_tr_b16 v[244:245], v14 offset:36864
    ds_read_b64_tr_b16 v[246:247], v14 offset:37248
    s_mov_b32 s46, 3145728
    s_add_u32 m0, s39, 49152
    s_nop 0
    buffer_load_dwordx4 v6, s[16:19], s46 offen  lds
    s_add_u32 m0, s39, 50176
    s_nop 0
    buffer_load_dwordx4 v7, s[16:19], s46 offen  lds
    s_add_u32 m0, s39, 51200
    s_nop 0
    buffer_load_dwordx4 v8, s[16:19], s46 offen  lds
    s_add_u32 m0, s39, 52224
    s_nop 0
    buffer_load_dwordx4 v9, s[16:19], s46 offen  lds
    s_add_u32 m0, s39, 53248
    s_nop 0
    buffer_load_dwordx4 v10, s[16:19], s46 offen  lds
    s_add_u32 m0, s39, 54272
    s_nop 0
    buffer_load_dwordx4 v11, s[16:19], s46 offen  lds
    s_waitcnt lgkmcnt(0)
    v_add_u32 v12, 49152, v12
    v_add_u32 v13, 49152, v13
    v_add_u32 v14, 49152, v14
    s_waitcnt vmcnt(24)
    s_barrier
    ds_read_b64_tr_b16 a[128:129], v12 offset:0
    ds_read_b64_tr_b16 a[130:131], v12 offset:384
    ds_read_b64_tr_b16 a[132:133], v12 offset:12288
    ds_read_b64_tr_b16 a[134:135], v12 offset:12672
    ds_read_b64_tr_b16 a[160:161], v13 offset:0
    ds_read_b64_tr_b16 a[162:163], v13 offset:384
    ds_read_b64_tr_b16 a[164:165], v13 offset:12288
    ds_read_b64_tr_b16 a[166:167], v13 offset:12672
    ds_read_b64_tr_b16 v[136:137], v14 offset:0
    ds_read_b64_tr_b16 v[138:139], v14 offset:384
    ds_read_b64_tr_b16 v[140:141], v14 offset:12288
    ds_read_b64_tr_b16 v[142:143], v14 offset:12672
    s_mov_b32 s46, 3145728
    s_add_u32 m0, s39, 73728
    s_nop 0
    buffer_load_dwordx4 v6, s[20:23], s46 offen  lds
    s_add_u32 m0, s39, 74752
    s_nop 0
    buffer_load_dwordx4 v7, s[20:23], s46 offen  lds
    s_add_u32 m0, s39, 75776
    s_nop 0
    buffer_load_dwordx4 v8, s[20:23], s46 offen  lds
    s_add_u32 m0, s39, 76800
    s_nop 0
    buffer_load_dwordx4 v9, s[20:23], s46 offen  lds
    s_add_u32 m0, s39, 77824
    s_nop 0
    buffer_load_dwordx4 v10, s[20:23], s46 offen  lds
    s_add_u32 m0, s39, 78848
    s_nop 0
    buffer_load_dwordx4 v11, s[20:23], s46 offen  lds
    s_waitcnt lgkmcnt(0)
    s_waitcnt vmcnt(24)
    s_barrier
    ds_read_b64_tr_b16 v[160:161], v12 offset:24576
    ds_read_b64_tr_b16 v[162:163], v12 offset:24960
    ds_read_b64_tr_b16 v[164:165], v12 offset:36864
    ds_read_b64_tr_b16 v[166:167], v12 offset:37248
    ds_read_b64_tr_b16 v[192:193], v13 offset:24576
    ds_read_b64_tr_b16 v[194:195], v13 offset:24960
    ds_read_b64_tr_b16 v[196:197], v13 offset:36864
    ds_read_b64_tr_b16 v[198:199], v13 offset:37248
    ds_read_b64_tr_b16 v[248:249], v14 offset:24576
    ds_read_b64_tr_b16 v[250:251], v14 offset:24960
    ds_read_b64_tr_b16 v[252:253], v14 offset:36864
    ds_read_b64_tr_b16 v[254:255], v14 offset:37248
    s_mov_b32 s46, 3932160
    s_add_u32 m0, s39, 98304
    s_nop 0
    buffer_load_dwordx4 v6, s[16:19], s46 offen  lds
    s_add_u32 m0, s39, 99328
    s_nop 0
    buffer_load_dwordx4 v7, s[16:19], s46 offen  lds
    s_add_u32 m0, s39, 100352
    s_nop 0
    buffer_load_dwordx4 v8, s[16:19], s46 offen  lds
    s_add_u32 m0, s39, 101376
    s_nop 0
    buffer_load_dwordx4 v9, s[16:19], s46 offen  lds
    s_add_u32 m0, s39, 102400
    s_nop 0
    buffer_load_dwordx4 v10, s[16:19], s46 offen  lds
    s_add_u32 m0, s39, 103424
    s_nop 0
    buffer_load_dwordx4 v11, s[16:19], s46 offen  lds
    s_waitcnt lgkmcnt(0)
    v_add_u32 v12, 4294868992, v12
    v_add_u32 v13, 4294868992, v13
    v_add_u32 v14, 4294868992, v14
    s_waitcnt vmcnt(24)
    s_barrier
    ds_read_b64_tr_b16 a[0:1], v12 offset:0
    ds_read_b64_tr_b16 a[2:3], v12 offset:384
    ds_read_b64_tr_b16 a[4:5], v12 offset:12288
    ds_read_b64_tr_b16 a[6:7], v12 offset:12672
    ds_read_b64_tr_b16 v[32:33], v13 offset:0
    ds_read_b64_tr_b16 v[34:35], v13 offset:384
    ds_read_b64_tr_b16 v[36:37], v13 offset:12288
    ds_read_b64_tr_b16 v[38:39], v13 offset:12672
    ds_read_b64_tr_b16 v[40:41], v14 offset:0
    ds_read_b64_tr_b16 v[42:43], v14 offset:384
    ds_read_b64_tr_b16 v[44:45], v14 offset:12288
    ds_read_b64_tr_b16 v[46:47], v14 offset:12672
    s_mov_b32 s46, 3932160
    s_add_u32 m0, s39, 122880
    s_nop 0
    buffer_load_dwordx4 v6, s[20:23], s46 offen  lds
    s_add_u32 m0, s39, 123904
    s_nop 0
    buffer_load_dwordx4 v7, s[20:23], s46 offen  lds
    s_add_u32 m0, s39, 124928
    s_nop 0
    buffer_load_dwordx4 v8, s[20:23], s46 offen  lds
    s_add_u32 m0, s39, 125952
    s_nop 0
    buffer_load_dwordx4 v9, s[20:23], s46 offen  lds
    s_add_u32 m0, s39, 126976
    s_nop 0
    buffer_load_dwordx4 v10, s[20:23], s46 offen  lds
    s_add_u32 m0, s39, 128000
    s_nop 0
    buffer_load_dwordx4 v11, s[20:23], s46 offen  lds
    s_waitcnt lgkmcnt(0)
    s_waitcnt vmcnt(24)
    s_barrier
    ds_read_b64_tr_b16 a[8:9], v12 offset:24576
    ds_read_b64_tr_b16 a[10:11], v12 offset:24960
    ds_read_b64_tr_b16 a[12:13], v12 offset:36864
    ds_read_b64_tr_b16 a[14:15], v12 offset:37248
    ds_read_b64_tr_b16 a[16:17], v13 offset:24576
    ds_read_b64_tr_b16 a[18:19], v13 offset:24960
    ds_read_b64_tr_b16 a[20:21], v13 offset:36864
    ds_read_b64_tr_b16 a[22:23], v13 offset:37248
    ds_read_b64_tr_b16 v[48:49], v14 offset:24576
    ds_read_b64_tr_b16 v[50:51], v14 offset:24960
    ds_read_b64_tr_b16 v[52:53], v14 offset:36864
    ds_read_b64_tr_b16 v[54:55], v14 offset:37248
    s_mov_b32 s46, 4718592
    s_add_u32 m0, s39, 0
    s_nop 0
    buffer_load_dwordx4 v6, s[16:19], s46 offen  lds
    s_add_u32 m0, s39, 1024
    s_nop 0
    buffer_load_dwordx4 v7, s[16:19], s46 offen  lds
    s_add_u32 m0, s39, 2048
    s_nop 0
    buffer_load_dwordx4 v8, s[16:19], s46 offen  lds
    s_add_u32 m0, s39, 3072
    s_nop 0
    buffer_load_dwordx4 v9, s[16:19], s46 offen  lds
    s_add_u32 m0, s39, 4096
    s_nop 0
    buffer_load_dwordx4 v10, s[16:19], s46 offen  lds
    s_add_u32 m0, s39, 5120
    s_nop 0
    buffer_load_dwordx4 v11, s[16:19], s46 offen  lds
    s_waitcnt lgkmcnt(0)
    v_add_u32 v12, 49152, v12
    v_add_u32 v13, 49152, v13
    v_add_u32 v14, 49152, v14
    s_waitcnt vmcnt(24)
    s_barrier
    ds_read_b64_tr_b16 a[24:25], v12 offset:0
    ds_read_b64_tr_b16 a[26:27], v12 offset:384
    ds_read_b64_tr_b16 a[28:29], v12 offset:12288
    ds_read_b64_tr_b16 a[30:31], v12 offset:12672
    ds_read_b64_tr_b16 a[32:33], v13 offset:0
    ds_read_b64_tr_b16 a[34:35], v13 offset:384
    ds_read_b64_tr_b16 a[36:37], v13 offset:12288
    ds_read_b64_tr_b16 a[38:39], v13 offset:12672
    ds_read_b64_tr_b16 a[40:41], v14 offset:0
    ds_read_b64_tr_b16 a[42:43], v14 offset:384
    ds_read_b64_tr_b16 a[44:45], v14 offset:12288
    ds_read_b64_tr_b16 a[46:47], v14 offset:12672
    s_mov_b32 s46, 4718592
    s_add_u32 m0, s39, 24576
    s_nop 0
    buffer_load_dwordx4 v6, s[20:23], s46 offen  lds
    s_add_u32 m0, s39, 25600
    s_nop 0
    buffer_load_dwordx4 v7, s[20:23], s46 offen  lds
    s_add_u32 m0, s39, 26624
    s_nop 0
    buffer_load_dwordx4 v8, s[20:23], s46 offen  lds
    s_add_u32 m0, s39, 27648
    s_nop 0
    buffer_load_dwordx4 v9, s[20:23], s46 offen  lds
    s_add_u32 m0, s39, 28672
    s_nop 0
    buffer_load_dwordx4 v10, s[20:23], s46 offen  lds
    s_add_u32 m0, s39, 29696
    s_nop 0
    buffer_load_dwordx4 v11, s[20:23], s46 offen  lds
    s_waitcnt lgkmcnt(0)
    s_waitcnt vmcnt(24)
    s_barrier
    ds_read_b64_tr_b16 a[48:49], v12 offset:24576
    ds_read_b64_tr_b16 a[50:51], v12 offset:24960
    ds_read_b64_tr_b16 a[52:53], v12 offset:36864
    ds_read_b64_tr_b16 a[54:55], v12 offset:37248
    ds_read_b64_tr_b16 a[56:57], v13 offset:24576
    ds_read_b64_tr_b16 a[58:59], v13 offset:24960
    ds_read_b64_tr_b16 a[60:61], v13 offset:36864
    ds_read_b64_tr_b16 a[62:63], v13 offset:37248
    ds_read_b64_tr_b16 v[56:57], v14 offset:24576
    ds_read_b64_tr_b16 v[58:59], v14 offset:24960
    ds_read_b64_tr_b16 v[60:61], v14 offset:36864
    ds_read_b64_tr_b16 v[62:63], v14 offset:37248
    s_mov_b32 s46, 5505024
    s_add_u32 m0, s39, 49152
    s_nop 0
    buffer_load_dwordx4 v6, s[16:19], s46 offen  lds
    s_add_u32 m0, s39, 50176
    s_nop 0
    buffer_load_dwordx4 v7, s[16:19], s46 offen  lds
    s_add_u32 m0, s39, 51200
    s_nop 0
    buffer_load_dwordx4 v8, s[16:19], s46 offen  lds
    s_add_u32 m0, s39, 52224
    s_nop 0
    buffer_load_dwordx4 v9, s[16:19], s46 offen  lds
    s_add_u32 m0, s39, 53248
    s_nop 0
    buffer_load_dwordx4 v10, s[16:19], s46 offen  lds
    s_add_u32 m0, s39, 54272
    s_nop 0
    buffer_load_dwordx4 v11, s[16:19], s46 offen  lds
    s_waitcnt lgkmcnt(0)
    v_add_u32 v12, 49152, v12
    v_add_u32 v13, 49152, v13
    v_add_u32 v14, 49152, v14
    s_waitcnt vmcnt(24)
    s_barrier
    ds_read_b64_tr_b16 a[64:65], v12 offset:0
    ds_read_b64_tr_b16 a[66:67], v12 offset:384
    ds_read_b64_tr_b16 a[68:69], v12 offset:12288
    ds_read_b64_tr_b16 a[70:71], v12 offset:12672
    ds_read_b64_tr_b16 a[72:73], v13 offset:0
    ds_read_b64_tr_b16 a[74:75], v13 offset:384
    ds_read_b64_tr_b16 a[76:77], v13 offset:12288
    ds_read_b64_tr_b16 a[78:79], v13 offset:12672
    ds_read_b64_tr_b16 a[80:81], v14 offset:0
    ds_read_b64_tr_b16 a[82:83], v14 offset:384
    ds_read_b64_tr_b16 a[84:85], v14 offset:12288
    ds_read_b64_tr_b16 a[86:87], v14 offset:12672
    s_mov_b32 s46, 5505024
    s_add_u32 m0, s39, 73728
    s_nop 0
    buffer_load_dwordx4 v6, s[20:23], s46 offen  lds
    s_add_u32 m0, s39, 74752
    s_nop 0
    buffer_load_dwordx4 v7, s[20:23], s46 offen  lds
    s_add_u32 m0, s39, 75776
    s_nop 0
    buffer_load_dwordx4 v8, s[20:23], s46 offen  lds
    s_add_u32 m0, s39, 76800
    s_nop 0
    buffer_load_dwordx4 v9, s[20:23], s46 offen  lds
    s_add_u32 m0, s39, 77824
    s_nop 0
    buffer_load_dwordx4 v10, s[20:23], s46 offen  lds
    s_add_u32 m0, s39, 78848
    s_nop 0
    buffer_load_dwordx4 v11, s[20:23], s46 offen  lds
    s_waitcnt lgkmcnt(0)
    s_waitcnt vmcnt(24)
    s_barrier
    ds_read_b64_tr_b16 v[64:65], v12 offset:24576
    ds_read_b64_tr_b16 v[66:67], v12 offset:24960
    ds_read_b64_tr_b16 v[68:69], v12 offset:36864
    ds_read_b64_tr_b16 v[70:71], v12 offset:37248
    ds_read_b64_tr_b16 a[88:89], v13 offset:24576
    ds_read_b64_tr_b16 a[90:91], v13 offset:24960
    ds_read_b64_tr_b16 a[92:93], v13 offset:36864
    ds_read_b64_tr_b16 a[94:95], v13 offset:37248
    ds_read_b64_tr_b16 a[96:97], v14 offset:24576
    ds_read_b64_tr_b16 a[98:99], v14 offset:24960
    ds_read_b64_tr_b16 a[100:101], v14 offset:36864
    ds_read_b64_tr_b16 a[102:103], v14 offset:37248
    s_mov_b32 s46, 6291456
    s_add_u32 m0, s39, 98304
    s_nop 0
    buffer_load_dwordx4 v6, s[16:19], s46 offen  lds
    s_add_u32 m0, s39, 99328
    s_nop 0
    buffer_load_dwordx4 v7, s[16:19], s46 offen  lds
    s_add_u32 m0, s39, 100352
    s_nop 0
    buffer_load_dwordx4 v8, s[16:19], s46 offen  lds
    s_add_u32 m0, s39, 101376
    s_nop 0
    buffer_load_dwordx4 v9, s[16:19], s46 offen  lds
    s_add_u32 m0, s39, 102400
    s_nop 0
    buffer_load_dwordx4 v10, s[16:19], s46 offen  lds
    s_add_u32 m0, s39, 103424
    s_nop 0
    buffer_load_dwordx4 v11, s[16:19], s46 offen  lds
    s_waitcnt lgkmcnt(0)
    v_add_u32 v12, 4294868992, v12
    v_add_u32 v13, 4294868992, v13
    v_add_u32 v14, 4294868992, v14
    s_waitcnt vmcnt(24)
    s_barrier
    ds_read_b64_tr_b16 v[72:73], v12 offset:0
    ds_read_b64_tr_b16 v[74:75], v12 offset:384
    ds_read_b64_tr_b16 v[76:77], v12 offset:12288
    ds_read_b64_tr_b16 v[78:79], v12 offset:12672
    ds_read_b64_tr_b16 v[96:97], v13 offset:0
    ds_read_b64_tr_b16 v[98:99], v13 offset:384
    ds_read_b64_tr_b16 v[100:101], v13 offset:12288
    ds_read_b64_tr_b16 v[102:103], v13 offset:12672
    ds_read_b64_tr_b16 a[168:169], v14 offset:0
    ds_read_b64_tr_b16 a[170:171], v14 offset:384
    ds_read_b64_tr_b16 a[172:173], v14 offset:12288
    ds_read_b64_tr_b16 a[174:175], v14 offset:12672
    s_mov_b32 s46, 6291456
    s_add_u32 m0, s39, 122880
    s_nop 0
    buffer_load_dwordx4 v6, s[20:23], s46 offen  lds
    s_add_u32 m0, s39, 123904
    s_nop 0
    buffer_load_dwordx4 v7, s[20:23], s46 offen  lds
    s_add_u32 m0, s39, 124928
    s_nop 0
    buffer_load_dwordx4 v8, s[20:23], s46 offen  lds
    s_add_u32 m0, s39, 125952
    s_nop 0
    buffer_load_dwordx4 v9, s[20:23], s46 offen  lds
    s_add_u32 m0, s39, 126976
    s_nop 0
    buffer_load_dwordx4 v10, s[20:23], s46 offen  lds
    s_add_u32 m0, s39, 128000
    s_nop 0
    buffer_load_dwordx4 v11, s[20:23], s46 offen  lds
    s_waitcnt lgkmcnt(0)
    s_waitcnt vmcnt(24)
    s_barrier
    ds_read_b64_tr_b16 a[200:201], v12 offset:24576
    ds_read_b64_tr_b16 a[202:203], v12 offset:24960
    ds_read_b64_tr_b16 a[204:205], v12 offset:36864
    ds_read_b64_tr_b16 a[206:207], v12 offset:37248
    ds_read_b64_tr_b16 a[232:233], v13 offset:24576
    ds_read_b64_tr_b16 a[234:235], v13 offset:24960
    ds_read_b64_tr_b16 a[236:237], v13 offset:36864
    ds_read_b64_tr_b16 a[238:239], v13 offset:37248
    ds_read_b64_tr_b16 v[200:201], v14 offset:24576
    ds_read_b64_tr_b16 v[202:203], v14 offset:24960
    ds_read_b64_tr_b16 v[204:205], v14 offset:36864
    ds_read_b64_tr_b16 v[206:207], v14 offset:37248
    s_mov_b32 s46, 7077888
    s_add_u32 m0, s39, 0
    s_nop 0
    buffer_load_dwordx4 v6, s[16:19], s46 offen  lds
    s_add_u32 m0, s39, 1024
    s_nop 0
    buffer_load_dwordx4 v7, s[16:19], s46 offen  lds
    s_add_u32 m0, s39, 2048
    s_nop 0
    buffer_load_dwordx4 v8, s[16:19], s46 offen  lds
    s_add_u32 m0, s39, 3072
    s_nop 0
    buffer_load_dwordx4 v9, s[16:19], s46 offen  lds
    s_add_u32 m0, s39, 4096
    s_nop 0
    buffer_load_dwordx4 v10, s[16:19], s46 offen  lds
    s_add_u32 m0, s39, 5120
    s_nop 0
    buffer_load_dwordx4 v11, s[16:19], s46 offen  lds
    s_waitcnt lgkmcnt(0)
    v_add_u32 v12, 49152, v12
    v_add_u32 v13, 49152, v13
    v_add_u32 v14, 49152, v14
    s_waitcnt vmcnt(24)
    s_barrier
    ds_read_b64_tr_b16 a[104:105], v12 offset:0
    ds_read_b64_tr_b16 a[106:107], v12 offset:384
    ds_read_b64_tr_b16 a[108:109], v12 offset:12288
    ds_read_b64_tr_b16 a[110:111], v12 offset:12672
    ds_read_b64_tr_b16 a[136:137], v13 offset:0
    ds_read_b64_tr_b16 a[138:139], v13 offset:384
    ds_read_b64_tr_b16 a[140:141], v13 offset:12288
    ds_read_b64_tr_b16 a[142:143], v13 offset:12672
    ds_read_b64_tr_b16 v[120:121], v14 offset:0
    ds_read_b64_tr_b16 v[122:123], v14 offset:384
    ds_read_b64_tr_b16 v[124:125], v14 offset:12288
    ds_read_b64_tr_b16 v[126:127], v14 offset:12672
    s_mov_b32 s46, 7077888
    s_add_u32 m0, s39, 24576
    s_nop 0
    buffer_load_dwordx4 v6, s[20:23], s46 offen  lds
    s_add_u32 m0, s39, 25600
    s_nop 0
    buffer_load_dwordx4 v7, s[20:23], s46 offen  lds
    s_add_u32 m0, s39, 26624
    s_nop 0
    buffer_load_dwordx4 v8, s[20:23], s46 offen  lds
    s_add_u32 m0, s39, 27648
    s_nop 0
    buffer_load_dwordx4 v9, s[20:23], s46 offen  lds
    s_add_u32 m0, s39, 28672
    s_nop 0
    buffer_load_dwordx4 v10, s[20:23], s46 offen  lds
    s_add_u32 m0, s39, 29696
    s_nop 0
    buffer_load_dwordx4 v11, s[20:23], s46 offen  lds
    s_waitcnt lgkmcnt(0)
    s_waitcnt vmcnt(24)
    s_barrier
    ds_read_b64_tr_b16 a[208:209], v12 offset:24576
    ds_read_b64_tr_b16 a[210:211], v12 offset:24960
    ds_read_b64_tr_b16 a[212:213], v12 offset:36864
    ds_read_b64_tr_b16 a[214:215], v12 offset:37248
    ds_read_b64_tr_b16 v[168:169], v13 offset:24576
    ds_read_b64_tr_b16 v[170:171], v13 offset:24960
    ds_read_b64_tr_b16 v[172:173], v13 offset:36864
    ds_read_b64_tr_b16 v[174:175], v13 offset:37248
    ds_read_b64_tr_b16 v[208:209], v14 offset:24576
    ds_read_b64_tr_b16 v[210:211], v14 offset:24960
    ds_read_b64_tr_b16 v[212:213], v14 offset:36864
    ds_read_b64_tr_b16 v[214:215], v14 offset:37248
    s_waitcnt lgkmcnt(0)
    v_add_u32 v12, 49152, v12
    v_add_u32 v13, 49152, v13
    v_add_u32 v14, 49152, v14
    s_waitcnt vmcnt(18)
    s_barrier
    ds_read_b64_tr_b16 a[112:113], v12 offset:0
    ds_read_b64_tr_b16 a[114:115], v12 offset:384
    ds_read_b64_tr_b16 a[116:117], v12 offset:12288
    ds_read_b64_tr_b16 a[118:119], v12 offset:12672
    ds_read_b64_tr_b16 v[104:105], v13 offset:0
    ds_read_b64_tr_b16 v[106:107], v13 offset:384
    ds_read_b64_tr_b16 v[108:109], v13 offset:12288
    ds_read_b64_tr_b16 v[110:111], v13 offset:12672
    ds_read_b64_tr_b16 a[176:177], v14 offset:0
    ds_read_b64_tr_b16 a[178:179], v14 offset:384
    ds_read_b64_tr_b16 a[180:181], v14 offset:12288
    ds_read_b64_tr_b16 a[182:183], v14 offset:12672
    s_waitcnt lgkmcnt(0)
    s_waitcnt vmcnt(12)
    s_barrier
    ds_read_b64_tr_b16 v[144:145], v12 offset:24576
    ds_read_b64_tr_b16 v[146:147], v12 offset:24960
    ds_read_b64_tr_b16 v[148:149], v12 offset:36864
    ds_read_b64_tr_b16 v[150:151], v12 offset:37248
    ds_read_b64_tr_b16 a[240:241], v13 offset:24576
    ds_read_b64_tr_b16 a[242:243], v13 offset:24960
    ds_read_b64_tr_b16 a[244:245], v13 offset:36864
    ds_read_b64_tr_b16 a[246:247], v13 offset:37248
    ds_read_b64_tr_b16 v[216:217], v14 offset:24576
    ds_read_b64_tr_b16 v[218:219], v14 offset:24960
    ds_read_b64_tr_b16 v[220:221], v14 offset:36864
    ds_read_b64_tr_b16 v[222:223], v14 offset:37248
    s_waitcnt lgkmcnt(0)
    v_add_u32 v12, 4294868992, v12
    v_add_u32 v13, 4294868992, v13
    v_add_u32 v14, 4294868992, v14
    s_waitcnt vmcnt(6)
    s_barrier
    ds_read_b64_tr_b16 v[80:81], v12 offset:0
    ds_read_b64_tr_b16 v[82:83], v12 offset:384
    ds_read_b64_tr_b16 v[84:85], v12 offset:12288
    ds_read_b64_tr_b16 v[86:87], v12 offset:12672
    ds_read_b64_tr_b16 a[144:145], v13 offset:0
    ds_read_b64_tr_b16 a[146:147], v13 offset:384
    ds_read_b64_tr_b16 a[148:149], v13 offset:12288
    ds_read_b64_tr_b16 a[150:151], v13 offset:12672
    ds_read_b64_tr_b16 v[128:129], v14 offset:0
    ds_read_b64_tr_b16 v[130:131], v14 offset:384
    ds_read_b64_tr_b16 v[132:133], v14 offset:12288
    ds_read_b64_tr_b16 v[134:135], v14 offset:12672
    s_waitcnt lgkmcnt(0)
    s_waitcnt vmcnt(0)
    s_barrier
    ds_read_b64_tr_b16 a[216:217], v12 offset:24576
    ds_read_b64_tr_b16 a[218:219], v12 offset:24960
    ds_read_b64_tr_b16 a[220:221], v12 offset:36864
    ds_read_b64_tr_b16 a[222:223], v12 offset:37248
    ds_read_b64_tr_b16 a[248:249], v13 offset:24576
    ds_read_b64_tr_b16 a[250:251], v13 offset:24960
    ds_read_b64_tr_b16 a[252:253], v13 offset:36864
    ds_read_b64_tr_b16 a[254:255], v13 offset:37248
    ds_read_b64_tr_b16 v[224:225], v14 offset:24576
    ds_read_b64_tr_b16 v[226:227], v14 offset:24960
    ds_read_b64_tr_b16 v[228:229], v14 offset:36864
    ds_read_b64_tr_b16 v[230:231], v14 offset:37248
    s_waitcnt lgkmcnt(0)
    v_add_u32 v12, 49152, v12
    v_add_u32 v13, 49152, v13
    v_add_u32 v14, 49152, v14
    s_barrier
    s_branch A_LD
A_L2:
    s_mov_b32 s46, 0
    s_add_u32 m0, s39, 0
    s_nop 0
    buffer_load_dwordx4 v6, s[16:19], s46 offen  lds
    s_add_u32 m0, s39, 1024
    s_nop 0
    buffer_load_dwordx4 v7, s[16:19], s46 offen  lds
    s_add_u32 m0, s39, 2048
    s_nop 0
    buffer_load_dwordx4 v8, s[16:19], s46 offen  lds
    s_add_u32 m0, s39, 3072
    s_nop 0
    buffer_load_dwordx4 v9, s[16:19], s46 offen  lds
    s_add_u32 m0, s39, 4096
    s_nop 0
    buffer_load_dwordx4 v10, s[16:19], s46 offen  lds
    s_add_u32 m0, s39, 5120
    s_nop 0
    buffer_load_dwordx4 v11, s[16:19], s46 offen  lds
    s_mov_b32 s46, 0
    s_add_u32 m0, s39, 24576
    s_nop 0
    buffer_load_dwordx4 v6, s[20:23], s46 offen  lds
    s_add_u32 m0, s39, 25600
    s_nop 0
    buffer_load_dwordx4 v7, s[20:23], s46 offen  lds
    s_add_u32 m0, s39, 26624
    s_nop 0
    buffer_load_dwordx4 v8, s[20:23], s46 offen  lds
    s_add_u32 m0, s39, 27648
    s_nop 0
    buffer_load_dwordx4 v9, s[20:23], s46 offen  lds
    s_add_u32 m0, s39, 28672
    s_nop 0
    buffer_load_dwordx4 v10, s[20:23], s46 offen  lds
    s_add_u32 m0, s39, 29696
    s_nop 0
    buffer_load_dwordx4 v11, s[20:23], s46 offen  lds
    s_mov_b32 s46, 786432
    s_add_u32 m0, s39, 49152
    s_nop 0
    buffer_load_dwordx4 v6, s[16:19], s46 offen  lds
    s_add_u32 m0, s39, 50176
    s_nop 0
    buffer_load_dwordx4 v7, s[16:19], s46 offen  lds
    s_add_u32 m0, s39, 51200
    s_nop 0
    buffer_load_dwordx4 v8, s[16:19], s46 offen  lds
    s_add_u32 m0, s39, 52224
    s_nop 0
    buffer_load_dwordx4 v9, s[16:19], s46 offen  lds
    s_add_u32 m0, s39, 53248
    s_nop 0
    buffer_load_dwordx4 v10, s[16:19], s46 offen  lds
    s_add_u32 m0, s39, 54272
    s_nop 0
    buffer_load_dwordx4 v11, s[16:19], s46 offen  lds
    s_mov_b32 s46, 786432
    s_add_u32 m0, s39, 73728
    s_nop 0
    buffer_load_dwordx4 v6, s[20:23], s46 offen  lds
    s_add_u32 m0, s39, 74752
    s_nop 0
    buffer_load_dwordx4 v7, s[20:23], s46 offen  lds
    s_add_u32 m0, s39, 75776
    s_nop 0
    buffer_load_dwordx4 v8, s[20:23], s46 offen  lds
    s_add_u32 m0, s39, 76800
    s_nop 0
    buffer_load_dwordx4 v9, s[20:23], s46 offen  lds
    s_add_u32 m0, s39, 77824
    s_nop 0
    buffer_load_dwordx4 v10, s[20:23], s46 offen  lds
    s_add_u32 m0, s39, 78848
    s_nop 0
    buffer_load_dwordx4 v11, s[20:23], s46 offen  lds
    s_mov_b32 s46, 1572864
    s_add_u32 m0, s39, 98304
    s_nop 0
    buffer_load_dwordx4 v6, s[16:19], s46 offen  lds
    s_add_u32 m0, s39, 99328
    s_nop 0
    buffer_load_dwordx4 v7, s[16:19], s46 offen  lds
    s_add_u32 m0, s39, 100352
    s_nop 0
    buffer_load_dwordx4 v8, s[16:19], s46 offen  lds
    s_add_u32 m0, s39, 101376
    s_nop 0
    buffer_load_dwordx4 v9, s[16:19], s46 offen  lds
    s_add_u32 m0, s39, 102400
    s_nop 0
    buffer_load_dwordx4 v10, s[16:19], s46 offen  lds
    s_add_u32 m0, s39, 103424
    s_nop 0
    buffer_load_dwordx4 v11, s[16:19], s46 offen  lds
    s_waitcnt vmcnt(24)
    s_barrier
    ds_read_b64_tr_b16 a[112:113], v12 offset:0
    ds_read_b64_tr_b16 a[114:115], v12 offset:384
    ds_read_b64_tr_b16 a[116:117], v12 offset:12288
    ds_read_b64_tr_b16 a[118:119], v12 offset:12672
    ds_read_b64_tr_b16 v[104:105], v13 offset:0
    ds_read_b64_tr_b16 v[106:107], v13 offset:384
    ds_read_b64_tr_b16 v[108:109], v13 offset:12288
    ds_read_b64_tr_b16 v[110:111], v13 offset:12672
    ds_read_b64_tr_b16 a[176:177], v14 offset:0
    ds_read_b64_tr_b16 a[178:179], v14 offset:384
    ds_read_b64_tr_b16 a[180:181], v14 offset:12288
    ds_read_b64_tr_b16 a[182:183], v14 offset:12672
    s_mov_b32 s46, 1572864
    s_add_u32 m0, s39, 122880
    s_nop 0
    buffer_load_dwordx4 v6, s[20:23], s46 offen  lds
    s_add_u32 m0, s39, 123904
    s_nop 0
    buffer_load_dwordx4 v7, s[20:23], s46 offen  lds
    s_add_u32 m0, s39, 124928
    s_nop 0
    buffer_load_dwordx4 v8, s[20:23], s46 offen  lds
    s_add_u32 m0, s39, 125952
    s_nop 0
    buffer_load_dwordx4 v9, s[20:23], s46 offen  lds
    s_add_u32 m0, s39, 126976
    s_nop 0
    buffer_load_dwordx4 v10, s[20:23], s46 offen  lds
    s_add_u32 m0, s39, 128000
    s_nop 0
    buffer_load_dwordx4 v11, s[20:23], s46 offen  lds
    s_waitcnt lgkmcnt(0)
    s_waitcnt vmcnt(24)
    s_barrier
    ds_read_b64_tr_b16 v[144:145], v12 offset:24576
    ds_read_b64_tr_b16 v[146:147], v12 offset:24960
    ds_read_b64_tr_b16 v[148:149], v12 offset:36864
    ds_read_b64_tr_b16 v[150:151], v12 offset:37248
    ds_read_b64_tr_b16 a[240:241], v13 offset:24576
    ds_read_b64_tr_b16 a[242:243], v13 offset:24960
    ds_read_b64_tr_b16 a[244:245], v13 offset:36864
    ds_read_b64_tr_b16 a[246:247], v13 offset:37248
    ds_read_b64_tr_b16 v[216:217], v14 offset:24576
    ds_read_b64_tr_b16 v[218:219], v14 offset:24960
    ds_read_b64_tr_b16 v[220:221], v14 offset:36864
    ds_read_b64_tr_b16 v[222:223], v14 offset:37248
    s_mov_b32 s46, 2359296
    s_add_u32 m0, s39, 0
    s_nop 0
    buffer_load_dwordx4 v6, s[16:19], s46 offen  lds
    s_add_u32 m0, s39, 1024
    s_nop 0
    buffer_load_dwordx4 v7, s[16:19], s46 offen  lds
    s_add_u32 m0, s39, 2048
    s_nop 0
    buffer_load_dwordx4 v8, s[16:19], s46 offen  lds
    s_add_u32 m0, s39, 3072
    s_nop 0
    buffer_load_dwordx4 v9, s[16:19], s46 offen  lds
    s_add_u32 m0, s39, 4096
    s_nop 0
    buffer_load_dwordx4 v10, s[16:19], s46 offen  lds
    s_add_u32 m0, s39, 5120
    s_nop 0
    buffer_load_dwordx4 v11, s[16:19], s46 offen  lds
    s_waitcnt lgkmcnt(0)
    v_add_u32 v12, 49152, v12
    v_add_u32 v13, 49152, v13
    v_add_u32 v14, 49152, v14
    s_waitcnt vmcnt(24)
    s_barrier
    ds_read_b64_tr_b16 v[80:81], v12 offset:0
    ds_read_b64_tr_b16 v[82:83], v12 offset:384
    ds_read_b64_tr_b16 v[84:85], v12 offset:12288
    ds_read_b64_tr_b16 v[86:87], v12 offset:12672
    ds_read_b64_tr_b16 a[144:145], v13 offset:0
    ds_read_b64_tr_b16 a[146:147], v13 offset:384
    ds_read_b64_tr_b16 a[148:149], v13 offset:12288
    ds_read_b64_tr_b16 a[150:151], v13 offset:12672
    ds_read_b64_tr_b16 v[128:129], v14 offset:0
    ds_read_b64_tr_b16 v[130:131], v14 offset:384
    ds_read_b64_tr_b16 v[132:133], v14 offset:12288
    ds_read_b64_tr_b16 v[134:135], v14 offset:12672
    s_mov_b32 s46, 2359296
    s_add_u32 m0, s39, 24576
    s_nop 0
    buffer_load_dwordx4 v6, s[20:23], s46 offen  lds
    s_add_u32 m0, s39, 25600
    s_nop 0
    buffer_load_dwordx4 v7, s[20:23], s46 offen  lds
    s_add_u32 m0, s39, 26624
    s_nop 0
    buffer_load_dwordx4 v8, s[20:23], s46 offen  lds
    s_add_u32 m0, s39, 27648
    s_nop 0
    buffer_load_dwordx4 v9, s[20:23], s46 offen  lds
    s_add_u32 m0, s39, 28672
    s_nop 0
    buffer_load_dwordx4 v10, s[20:23], s46 offen  lds
    s_add_u32 m0, s39, 29696
    s_nop 0
    buffer_load_dwordx4 v11, s[20:23], s46 offen  lds
    s_waitcnt lgkmcnt(0)
    s_waitcnt vmcnt(24)
    s_barrier
    ds_read_b64_tr_b16 a[216:217], v12 offset:24576
    ds_read_b64_tr_b16 a[218:219], v12 offset:24960
    ds_read_b64_tr_b16 a[220:221], v12 offset:36864
    ds_read_b64_tr_b16 a[222:223], v12 offset:37248
    ds_read_b64_tr_b16 a[248:249], v13 offset:24576
    ds_read_b64_tr_b16 a[250:251], v13 offset:24960
    ds_read_b64_tr_b16 a[252:253], v13 offset:36864
    ds_read_b64_tr_b16 a[254:255], v13 offset:37248
    ds_read_b64_tr_b16 v[224:225], v14 offset:24576
    ds_read_b64_tr_b16 v[226:227], v14 offset:24960
    ds_read_b64_tr_b16 v[228:229], v14 offset:36864
    ds_read_b64_tr_b16 v[230:231], v14 offset:37248
    s_mov_b32 s46, 3145728
    s_add_u32 m0, s39, 49152
    s_nop 0
    buffer_load_dwordx4 v6, s[16:19], s46 offen  lds
    s_add_u32 m0, s39, 50176
    s_nop 0
    buffer_load_dwordx4 v7, s[16:19], s46 offen  lds
    s_add_u32 m0, s39, 51200
    s_nop 0
    buffer_load_dwordx4 v8, s[16:19], s46 offen  lds
    s_add_u32 m0, s39, 52224
    s_nop 0
    buffer_load_dwordx4 v9, s[16:19], s46 offen  lds
    s_add_u32 m0, s39, 53248
    s_nop 0
    buffer_load_dwordx4 v10, s[16:19], s46 offen  lds
    s_add_u32 m0, s39, 54272
    s_nop 0
    buffer_load_dwordx4 v11, s[16:19], s46 offen  lds
    s_waitcnt lgkmcnt(0)
    v_add_u32 v12, 49152, v12
    v_add_u32 v13, 49152, v13
    v_add_u32 v14, 49152, v14
    s_waitcnt vmcnt(24)
    s_barrier
    ds_read_b64_tr_b16 a[120:121], v12 offset:0
    ds_read_b64_tr_b16 a[122:123], v12 offset:384
    ds_read_b64_tr_b16 a[124:125], v12 offset:12288
    ds_read_b64_tr_b16 a[126:127], v12 offset:12672
    ds_read_b64_tr_b16 v[112:113], v13 offset:0
    ds_read_b64_tr_b16 v[114:115], v13 offset:384
    ds_read_b64_tr_b16 v[116:117], v13 offset:12288
    ds_read_b64_tr_b16 v[118:119], v13 offset:12672
    ds_read_b64_tr_b16 a[184:185], v14 offset:0
    ds_read_b64_tr_b16 a[186:187], v14 offset:384
    ds_read_b64_tr_b16 a[188:189], v14 offset:12288
    ds_read_b64_tr_b16 a[190:191], v14 offset:12672
    s_mov_b32 s46, 3145728
    s_add_u32 m0, s39, 73728
    s_nop 0
    buffer_load_dwordx4 v6, s[20:23], s46 offen  lds
    s_add_u32 m0, s39, 74752
    s_nop 0
    buffer_load_dwordx4 v7, s[20:23], s46 offen  lds
    s_add_u32 m0, s39, 75776
    s_nop 0
    buffer_load_dwordx4 v8, s[20:23], s46 offen  lds
    s_add_u32 m0, s39, 76800
    s_nop 0
    buffer_load_dwordx4 v9, s[20:23], s46 offen  lds
    s_add_u32 m0, s39, 77824
    s_nop 0
    buffer_load_dwordx4 v10, s[20:23], s46 offen  lds
    s_add_u32 m0, s39, 78848
    s_nop 0
    buffer_load_dwordx4 v11, s[20:23], s46 offen  lds
    s_waitcnt lgkmcnt(0)
    s_waitcnt vmcnt(24)
    s_barrier
    ds_read_b64_tr_b16 v[152:153], v12 offset:24576
    ds_read_b64_tr_b16 v[154:155], v12 offset:24960
    ds_read_b64_tr_b16 v[156:157], v12 offset:36864
    ds_read_b64_tr_b16 v[158:159], v12 offset:37248
    ds_read_b64_tr_b16 v[176:177], v13 offset:24576
    ds_read_b64_tr_b16 v[178:179], v13 offset:24960
    ds_read_b64_tr_b16 v[180:181], v13 offset:36864
    ds_read_b64_tr_b16 v[182:183], v13 offset:37248
    ds_read_b64_tr_b16 v[232:233], v14 offset:24576
    ds_read_b64_tr_b16 v[234:235], v14 offset:24960
    ds_read_b64_tr_b16 v[236:237], v14 offset:36864
    ds_read_b64_tr_b16 v[238:239], v14 offset:37248
    s_mov_b32 s46, 3932160
    s_add_u32 m0, s39, 98304
    s_nop 0
    buffer_load_dwordx4 v6, s[16:19], s46 offen  lds
    s_add_u32 m0, s39, 99328
    s_nop 0
    buffer_load_dwordx4 v7, s[16:19], s46 offen  lds
    s_add_u32 m0, s39, 100352
    s_nop 0
    buffer_load_dwordx4 v8, s[16:19], s46 offen  lds
    s_add_u32 m0, s39, 101376
    s_nop 0
    buffer_load_dwordx4 v9, s[16:19], s46 offen  lds
    s_add_u32 m0, s39, 102400
    s_nop 0
    buffer_load_dwordx4 v10, s[16:19], s46 offen  lds
    s_add_u32 m0, s39, 103424
    s_nop 0
    buffer_load_dwordx4 v11, s[16:19], s46 offen  lds
    s_waitcnt lgkmcnt(0)
    v_add_u32 v12, 4294868992, v12
    v_add_u32 v13, 4294868992, v13
    v_add_u32 v14, 4294868992, v14
    s_waitcnt vmcnt(24)
    s_barrier
    ds_read_b64_tr_b16 v[88:89], v12 offset:0
    ds_read_b64_tr_b16 v[90:91], v12 offset:384
    ds_read_b64_tr_b16 v[92:93], v12 offset:12288
    ds_read_b64_tr_b16 v[94:95], v12 offset:12672
    ds_read_b64_tr_b16 a[152:153], v13 offset:0
    ds_read_b64_tr_b16 a[154:155], v13 offset:384
    ds_read_b64_tr_b16 a[156:157], v13 offset:12288
    ds_read_b64_tr_b16 a[158:159], v13 offset:12672
    ds_read_b64_tr_b16 a[192:193], v14 offset:0
    ds_read_b64_tr_b16 a[194:195], v14 offset:384
    ds_read_b64_tr_b16 a[196:197], v14 offset:12288
    ds_read_b64_tr_b16 a[198:199], v14 offset:12672
    s_mov_b32 s46, 3932160
    s_add_u32 m0, s39, 122880
    s_nop 0
    buffer_load_dwordx4 v6, s[20:23], s46 offen  lds
    s_add_u32 m0, s39, 123904
    s_nop 0
    buffer_load_dwordx4 v7, s[20:23], s46 offen  lds
    s_add_u32 m0, s39, 124928
    s_nop 0
    buffer_load_dwordx4 v8, s[20:23], s46 offen  lds
    s_add_u32 m0, s39, 125952
    s_nop 0
    buffer_load_dwordx4 v9, s[20:23], s46 offen  lds
    s_add_u32 m0, s39, 126976
    s_nop 0
    buffer_load_dwordx4 v10, s[20:23], s46 offen  lds
    s_add_u32 m0, s39, 128000
    s_nop 0
    buffer_load_dwordx4 v11, s[20:23], s46 offen  lds
    s_waitcnt lgkmcnt(0)
    s_waitcnt vmcnt(24)
    s_barrier
    ds_read_b64_tr_b16 a[224:225], v12 offset:24576
    ds_read_b64_tr_b16 a[226:227], v12 offset:24960
    ds_read_b64_tr_b16 a[228:229], v12 offset:36864
    ds_read_b64_tr_b16 a[230:231], v12 offset:37248
    ds_read_b64_tr_b16 v[184:185], v13 offset:24576
    ds_read_b64_tr_b16 v[186:187], v13 offset:24960
    ds_read_b64_tr_b16 v[188:189], v13 offset:36864
    ds_read_b64_tr_b16 v[190:191], v13 offset:37248
    ds_read_b64_tr_b16 v[240:241], v14 offset:24576
    ds_read_b64_tr_b16 v[242:243], v14 offset:24960
    ds_read_b64_tr_b16 v[244:245], v14 offset:36864
    ds_read_b64_tr_b16 v[246:247], v14 offset:37248
    s_mov_b32 s46, 4718592
    s_add_u32 m0, s39, 0
    s_nop 0
    buffer_load_dwordx4 v6, s[16:19], s46 offen  lds
    s_add_u32 m0, s39, 1024
    s_nop 0
    buffer_load_dwordx4 v7, s[16:19], s46 offen  lds
    s_add_u32 m0, s39, 2048
    s_nop 0
    buffer_load_dwordx4 v8, s[16:19], s46 offen  lds
    s_add_u32 m0, s39, 3072
    s_nop 0
    buffer_load_dwordx4 v9, s[16:19], s46 offen  lds
    s_add_u32 m0, s39, 4096
    s_nop 0
    buffer_load_dwordx4 v10, s[16:19], s46 offen  lds
    s_add_u32 m0, s39, 5120
    s_nop 0
    buffer_load_dwordx4 v11, s[16:19], s46 offen  lds
    s_waitcnt lgkmcnt(0)
    v_add_u32 v12, 49152, v12
    v_add_u32 v13, 49152, v13
    v_add_u32 v14, 49152, v14
    s_waitcnt vmcnt(24)
    s_barrier
    ds_read_b64_tr_b16 a[128:129], v12 offset:0
    ds_read_b64_tr_b16 a[130:131], v12 offset:384
    ds_read_b64_tr_b16 a[132:133], v12 offset:12288
    ds_read_b64_tr_b16 a[134:135], v12 offset:12672
    ds_read_b64_tr_b16 a[160:161], v13 offset:0
    ds_read_b64_tr_b16 a[162:163], v13 offset:384
    ds_read_b64_tr_b16 a[164:165], v13 offset:12288
    ds_read_b64_tr_b16 a[166:167], v13 offset:12672
    ds_read_b64_tr_b16 v[136:137], v14 offset:0
    ds_read_b64_tr_b16 v[138:139], v14 offset:384
    ds_read_b64_tr_b16 v[140:141], v14 offset:12288
    ds_read_b64_tr_b16 v[142:143], v14 offset:12672
    s_mov_b32 s46, 4718592
    s_add_u32 m0, s39, 24576
    s_nop 0
    buffer_load_dwordx4 v6, s[20:23], s46 offen  lds
    s_add_u32 m0, s39, 25600
    s_nop 0
    buffer_load_dwordx4 v7, s[20:23], s46 offen  lds
    s_add_u32 m0, s39, 26624
    s_nop 0
    buffer_load_dwordx4 v8, s[20:23], s46 offen  lds
    s_add_u32 m0, s39, 27648
    s_nop 0
    buffer_load_dwordx4 v9, s[20:23], s46 offen  lds
    s_add_u32 m0, s39, 28672
    s_nop 0
    buffer_load_dwordx4 v10, s[20:23], s46 offen  lds
    s_add_u32 m0, s39, 29696
    s_nop 0
    buffer_load_dwordx4 v11, s[20:23], s46 offen  lds
    s_waitcnt lgkmcnt(0)
    s_waitcnt vmcnt(24)
    s_barrier
    ds_read_b64_tr_b16 v[160:161], v12 offset:24576
    ds_read_b64_tr_b16 v[162:163], v12 offset:24960
    ds_read_b64_tr_b16 v[164:165], v12 offset:36864
    ds_read_b64_tr_b16 v[166:167], v12 offset:37248
    ds_read_b64_tr_b16 v[192:193], v13 offset:24576
    ds_read_b64_tr_b16 v[194:195], v13 offset:24960
    ds_read_b64_tr_b16 v[196:197], v13 offset:36864
    ds_read_b64_tr_b16 v[198:199], v13 offset:37248
    ds_read_b64_tr_b16 v[248:249], v14 offset:24576
    ds_read_b64_tr_b16 v[250:251], v14 offset:24960
    ds_read_b64_tr_b16 v[252:253], v14 offset:36864
    ds_read_b64_tr_b16 v[254:255], v14 offset:37248
    s_mov_b32 s46, 5505024
    s_add_u32 m0, s39, 49152
    s_nop 0
    buffer_load_dwordx4 v6, s[16:19], s46 offen  lds
    s_add_u32 m0, s39, 50176
    s_nop 0
    buffer_load_dwordx4 v7, s[16:19], s46 offen  lds
    s_add_u32 m0, s39, 51200
    s_nop 0
    buffer_load_dwordx4 v8, s[16:19], s46 offen  lds
    s_add_u32 m0, s39, 52224
    s_nop 0
    buffer_load_dwordx4 v9, s[16:19], s46 offen  lds
    s_add_u32 m0, s39, 53248
    s_nop 0
    buffer_load_dwordx4 v10, s[16:19], s46 offen  lds
    s_add_u32 m0, s39, 54272
    s_nop 0
    buffer_load_dwordx4 v11, s[16:19], s46 offen  lds
    s_waitcnt lgkmcnt(0)
    v_add_u32 v12, 49152, v12
    v_add_u32 v13, 49152, v13
    v_add_u32 v14, 49152, v14
    s_waitcnt vmcnt(24)
    s_barrier
    ds_read_b64_tr_b16 a[0:1], v12 offset:0
    ds_read_b64_tr_b16 a[2:3], v12 offset:384
    ds_read_b64_tr_b16 a[4:5], v12 offset:12288
    ds_read_b64_tr_b16 a[6:7], v12 offset:12672
    ds_read_b64_tr_b16 v[32:33], v13 offset:0
    ds_read_b64_tr_b16 v[34:35], v13 offset:384
    ds_read_b64_tr_b16 v[36:37], v13 offset:12288
    ds_read_b64_tr_b16 v[38:39], v13 offset:12672
    ds_read_b64_tr_b16 v[40:41], v14 offset:0
    ds_read_b64_tr_b16 v[42:43], v14 offset:384
    ds_read_b64_tr_b16 v[44:45], v14 offset:12288
    ds_read_b64_tr_b16 v[46:47], v14 offset:12672
    s_mov_b32 s46, 5505024
    s_add_u32 m0, s39, 73728
    s_nop 0
    buffer_load_dwordx4 v6, s[20:23], s46 offen  lds
    s_add_u32 m0, s39, 74752
    s_nop 0
    buffer_load_dwordx4 v7, s[20:23], s46 offen  lds
    s_add_u32 m0, s39, 75776
    s_nop 0
    buffer_load_dwordx4 v8, s[20:23], s46 offen  lds
    s_add_u32 m0, s39, 76800
    s_nop 0
    buffer_load_dwordx4 v9, s[20:23], s46 offen  lds
    s_add_u32 m0, s39, 77824
    s_nop 0
    buffer_load_dwordx4 v10, s[20:23], s46 offen  lds
    s_add_u32 m0, s39, 78848
    s_nop 0
    buffer_load_dwordx4 v11, s[20:23], s46 offen  lds
    s_waitcnt lgkmcnt(0)
    s_waitcnt vmcnt(24)
    s_barrier
    ds_read_b64_tr_b16 a[8:9], v12 offset:24576
    ds_read_b64_tr_b16 a[10:11], v12 offset:24960
    ds_read_b64_tr_b16 a[12:13], v12 offset:36864
    ds_read_b64_tr_b16 a[14:15], v12 offset:37248
    ds_read_b64_tr_b16 a[16:17], v13 offset:24576
    ds_read_b64_tr_b16 a[18:19], v13 offset:24960
    ds_read_b64_tr_b16 a[20:21], v13 offset:36864
    ds_read_b64_tr_b16 a[22:23], v13 offset:37248
    ds_read_b64_tr_b16 v[48:49], v14 offset:24576
    ds_read_b64_tr_b16 v[50:51], v14 offset:24960
    ds_read_b64_tr_b16 v[52:53], v14 offset:36864
    ds_read_b64_tr_b16 v[54:55], v14 offset:37248
    s_mov_b32 s46, 6291456
    s_add_u32 m0, s39, 98304
    s_nop 0
    buffer_load_dwordx4 v6, s[16:19], s46 offen  lds
    s_add_u32 m0, s39, 99328
    s_nop 0
    buffer_load_dwordx4 v7, s[16:19], s46 offen  lds
    s_add_u32 m0, s39, 100352
    s_nop 0
    buffer_load_dwordx4 v8, s[16:19], s46 offen  lds
    s_add_u32 m0, s39, 101376
    s_nop 0
    buffer_load_dwordx4 v9, s[16:19], s46 offen  lds
    s_add_u32 m0, s39, 102400
    s_nop 0
    buffer_load_dwordx4 v10, s[16:19], s46 offen  lds
    s_add_u32 m0, s39, 103424
    s_nop 0
    buffer_load_dwordx4 v11, s[16:19], s46 offen  lds
    s_waitcnt lgkmcnt(0)
    v_add_u32 v12, 4294868992, v12
    v_add_u32 v13, 4294868992, v13
    v_add_u32 v14, 4294868992, v14
    s_waitcnt vmcnt(24)
    s_barrier
    ds_read_b64_tr_b16 a[24:25], v12 offset:0
    ds_read_b64_tr_b16 a[26:27], v12 offset:384
    ds_read_b64_tr_b16 a[28:29], v12 offset:12288
    ds_read_b64_tr_b16 a[30:31], v12 offset:12672
    ds_read_b64_tr_b16 a[32:33], v13 offset:0
    ds_read_b64_tr_b16 a[34:35], v13 offset:384
    ds_read_b64_tr_b16 a[36:37], v13 offset:12288
    ds_read_b64_tr_b16 a[38:39], v13 offset:12672
    ds_read_b64_tr_b16 a[40:41], v14 offset:0
    ds_read_b64_tr_b16 a[42:43], v14 offset:384
    ds_read_b64_tr_b16 a[44:45], v14 offset:12288
    ds_read_b64_tr_b16 a[46:47], v14 offset:12672
    s_mov_b32 s46, 6291456
    s_add_u32 m0, s39, 122880
    s_nop 0
    buffer_load_dwordx4 v6, s[20:23], s46 offen  lds
    s_add_u32 m0, s39, 123904
    s_nop 0
    buffer_load_dwordx4 v7, s[20:23], s46 offen  lds
    s_add_u32 m0, s39, 124928
    s_nop 0
    buffer_load_dwordx4 v8, s[20:23], s46 offen  lds
    s_add_u32 m0, s39, 125952
    s_nop 0
    buffer_load_dwordx4 v9, s[20:23], s46 offen  lds
    s_add_u32 m0, s39, 126976
    s_nop 0
    buffer_load_dwordx4 v10, s[20:23], s46 offen  lds
    s_add_u32 m0, s39, 128000
    s_nop 0
    buffer_load_dwordx4 v11, s[20:23], s46 offen  lds
    s_waitcnt lgkmcnt(0)
    s_waitcnt vmcnt(24)
    s_barrier
    ds_read_b64_tr_b16 a[48:49], v12 offset:24576
    ds_read_b64_tr_b16 a[50:51], v12 offset:24960
    ds_read_b64_tr_b16 a[52:53], v12 offset:36864
    ds_read_b64_tr_b16 a[54:55], v12 offset:37248
    ds_read_b64_tr_b16 a[56:57], v13 offset:24576
    ds_read_b64_tr_b16 a[58:59], v13 offset:24960
    ds_read_b64_tr_b16 a[60:61], v13 offset:36864
    ds_read_b64_tr_b16 a[62:63], v13 offset:37248
    ds_read_b64_tr_b16 v[56:57], v14 offset:24576
    ds_read_b64_tr_b16 v[58:59], v14 offset:24960
    ds_read_b64_tr_b16 v[60:61], v14 offset:36864
    ds_read_b64_tr_b16 v[62:63], v14 offset:37248
    s_mov_b32 s46, 7077888
    s_add_u32 m0, s39, 0
    s_nop 0
    buffer_load_dwordx4 v6, s[16:19], s46 offen  lds
    s_add_u32 m0, s39, 1024
    s_nop 0
    buffer_load_dwordx4 v7, s[16:19], s46 offen  lds
    s_add_u32 m0, s39, 2048
    s_nop 0
    buffer_load_dwordx4 v8, s[16:19], s46 offen  lds
    s_add_u32 m0, s39, 3072
    s_nop 0
    buffer_load_dwordx4 v9, s[16:19], s46 offen  lds
    s_add_u32 m0, s39, 4096
    s_nop 0
    buffer_load_dwordx4 v10, s[16:19], s46 offen  lds
    s_add_u32 m0, s39, 5120
    s_nop 0
    buffer_load_dwordx4 v11, s[16:19], s46 offen  lds
    s_waitcnt lgkmcnt(0)
    v_add_u32 v12, 49152, v12
    v_add_u32 v13, 49152, v13
    v_add_u32 v14, 49152, v14
    s_waitcnt vmcnt(24)
    s_barrier
    ds_read_b64_tr_b16 a[64:65], v12 offset:0
    ds_read_b64_tr_b16 a[66:67], v12 offset:384
    ds_read_b64_tr_b16 a[68:69], v12 offset:12288
    ds_read_b64_tr_b16 a[70:71], v12 offset:12672
    ds_read_b64_tr_b16 a[72:73], v13 offset:0
    ds_read_b64_tr_b16 a[74:75], v13 offset:384
    ds_read_b64_tr_b16 a[76:77], v13 offset:12288
    ds_read_b64_tr_b16 a[78:79], v13 offset:12672
    ds_read_b64_tr_b16 a[80:81], v14 offset:0
    ds_read_b64_tr_b16 a[82:83], v14 offset:384
    ds_read_b64_tr_b16 a[84:85], v14 offset:12288
    ds_read_b64_tr_b16 a[86:87], v14 offset:12672
    s_mov_b32 s46, 7077888
    s_add_u32 m0, s39, 24576
    s_nop 0
    buffer_load_dwordx4 v6, s[20:23], s46 offen  lds
    s_add_u32 m0, s39, 25600
    s_nop 0
    buffer_load_dwordx4 v7, s[20:23], s46 offen  lds
    s_add_u32 m0, s39, 26624
    s_nop 0
    buffer_load_dwordx4 v8, s[20:23], s46 offen  lds
    s_add_u32 m0, s39, 27648
    s_nop 0
    buffer_load_dwordx4 v9, s[20:23], s46 offen  lds
    s_add_u32 m0, s39, 28672
    s_nop 0
    buffer_load_dwordx4 v10, s[20:23], s46 offen  lds
    s_add_u32 m0, s39, 29696
    s_nop 0
    buffer_load_dwordx4 v11, s[20:23], s46 offen  lds
    s_waitcnt lgkmcnt(0)
    s_waitcnt vmcnt(24)
    s_barrier
    ds_read_b64_tr_b16 v[64:65], v12 offset:24576
    ds_read_b64_tr_b16 v[66:67], v12 offset:24960
    ds_read_b64_tr_b16 v[68:69], v12 offset:36864
    ds_read_b64_tr_b16 v[70:71], v12 offset:37248
    ds_read_b64_tr_b16 a[88:89], v13 offset:24576
    ds_read_b64_tr_b16 a[90:91], v13 offset:24960
    ds_read_b64_tr_b16 a[92:93], v13 offset:36864
    ds_read_b64_tr_b16 a[94:95], v13 offset:37248
    ds_read_b64_tr_b16 a[96:97], v14 offset:24576
    ds_read_b64_tr_b16 a[98:99], v14 offset:24960
    ds_read_b64_tr_b16 a[100:101], v14 offset:36864
    ds_read_b64_tr_b16 a[102:103], v14 offset:37248
    s_waitcnt lgkmcnt(0)
    v_add_u32 v12, 49152, v12
    v_add_u32 v13, 49152, v13
    v_add_u32 v14, 49152, v14
    s_waitcnt vmcnt(18)
    s_barrier
    ds_read_b64_tr_b16 v[72:73], v12 offset:0
    ds_read_b64_tr_b16 v[74:75], v12 offset:384
    ds_read_b64_tr_b16 v[76:77], v12 offset:12288
    ds_read_b64_tr_b16 v[78:79], v12 offset:12672
    ds_read_b64_tr_b16 v[96:97], v13 offset:0
    ds_read_b64_tr_b16 v[98:99], v13 offset:384
    ds_read_b64_tr_b16 v[100:101], v13 offset:12288
    ds_read_b64_tr_b16 v[102:103], v13 offset:12672
    ds_read_b64_tr_b16 a[168:169], v14 offset:0
    ds_read_b64_tr_b16 a[170:171], v14 offset:384
    ds_read_b64_tr_b16 a[172:173], v14 offset:12288
    ds_read_b64_tr_b16 a[174:175], v14 offset:12672
    s_waitcnt lgkmcnt(0)
    s_waitcnt vmcnt(12)
    s_barrier
    ds_read_b64_tr_b16 a[200:201], v12 offset:24576
    ds_read_b64_tr_b16 a[202:203], v12 offset:24960
    ds_read_b64_tr_b16 a[204:205], v12 offset:36864
    ds_read_b64_tr_b16 a[206:207], v12 offset:37248
    ds_read_b64_tr_b16 a[232:233], v13 offset:24576
    ds_read_b64_tr_b16 a[234:235], v13 offset:24960
    ds_read_b64_tr_b16 a[236:237], v13 offset:36864
    ds_read_b64_tr_b16 a[238:239], v13 offset:37248
    ds_read_b64_tr_b16 v[200:201], v14 offset:24576
    ds_read_b64_tr_b16 v[202:203], v14 offset:24960
    ds_read_b64_tr_b16 v[204:205], v14 offset:36864
    ds_read_b64_tr_b16 v[206:207], v14 offset:37248
    s_waitcnt lgkmcnt(0)
    v_add_u32 v12, 4294868992, v12
    v_add_u32 v13, 4294868992, v13
    v_add_u32 v14, 4294868992, v14
    s_waitcnt vmcnt(6)
    s_barrier
    ds_read_b64_tr_b16 a[104:105], v12 offset:0
    ds_read_b64_tr_b16 a[106:107], v12 offset:384
    ds_read_b64_tr_b16 a[108:109], v12 offset:12288
    ds_read_b64_tr_b16 a[110:111], v12 offset:12672
    ds_read_b64_tr_b16 a[136:137], v13 offset:0
    ds_read_b64_tr_b16 a[138:139], v13 offset:384
    ds_read_b64_tr_b16 a[140:141], v13 offset:12288
    ds_read_b64_tr_b16 a[142:143], v13 offset:12672
    ds_read_b64_tr_b16 v[120:121], v14 offset:0
    ds_read_b64_tr_b16 v[122:123], v14 offset:384
    ds_read_b64_tr_b16 v[124:125], v14 offset:12288
    ds_read_b64_tr_b16 v[126:127], v14 offset:12672
    s_waitcnt lgkmcnt(0)
    s_waitcnt vmcnt(0)
    s_barrier
    ds_read_b64_tr_b16 a[208:209], v12 offset:24576
    ds_read_b64_tr_b16 a[210:211], v12 offset:24960
    ds_read_b64_tr_b16 a[212:213], v12 offset:36864
    ds_read_b64_tr_b16 a[214:215], v12 offset:37248
    ds_read_b64_tr_b16 v[168:169], v13 offset:24576
    ds_read_b64_tr_b16 v[170:171], v13 offset:24960
    ds_read_b64_tr_b16 v[172:173], v13 offset:36864
    ds_read_b64_tr_b16 v[174:175], v13 offset:37248
    ds_read_b64_tr_b16 v[208:209], v14 offset:24576
    ds_read_b64_tr_b16 v[210:211], v14 offset:24960
    ds_read_b64_tr_b16 v[212:213], v14 offset:36864
    ds_read_b64_tr_b16 v[214:215], v14 offset:37248
    s_waitcnt lgkmcnt(0)
    v_add_u32 v12, 49152, v12
    v_add_u32 v13, 49152, v13
    v_add_u32 v14, 49152, v14
    s_barrier
    s_branch A_LD
A_L3:
    s_mov_b32 s46, 0
    s_add_u32 m0, s39, 0
    s_nop 0
    buffer_load_dwordx4 v6, s[16:19], s46 offen  lds
    s_add_u32 m0, s39, 1024
    s_nop 0
    buffer_load_dwordx4 v7, s[16:19], s46 offen  lds
    s_add_u32 m0, s39, 2048
    s_nop 0
    buffer_load_dwordx4 v8, s[16:19], s46 offen  lds
    s_add_u32 m0, s39, 3072
    s_nop 0
    buffer_load_dwordx4 v9, s[16:19], s46 offen  lds
    s_add_u32 m0, s39, 4096
    s_nop 0
    buffer_load_dwordx4 v10, s[16:19], s46 offen  lds
    s_add_u32 m0, s39, 5120
    s_nop 0
    buffer_load_dwordx4 v11, s[16:19], s46 offen  lds
    s_mov_b32 s46, 0
    s_add_u32 m0, s39, 24576
    s_nop 0
    buffer_load_dwordx4 v6, s[20:23], s46 offen  lds
    s_add_u32 m0, s39, 25600
    s_nop 0
    buffer_load_dwordx4 v7, s[20:23], s46 offen  lds
    s_add_u32 m0, s39, 26624
    s_nop 0
    buffer_load_dwordx4 v8, s[20:23], s46 offen  lds
    s_add_u32 m0, s39, 27648
    s_nop 0
    buffer_load_dwordx4 v9, s[20:23], s46 offen  lds
    s_add_u32 m0, s39, 28672
    s_nop 0
    buffer_load_dwordx4 v10, s[20:23], s46 offen  lds
    s_add_u32 m0, s39, 29696
    s_nop 0
    buffer_load_dwordx4 v11, s[20:23], s46 offen  lds
    s_mov_b32 s46, 786432
    s_add_u32 m0, s39, 49152
    s_nop 0
    buffer_load_dwordx4 v6, s[16:19], s46 offen  lds
    s_add_u32 m0, s39, 50176
    s_nop 0
    buffer_load_dwordx4 v7, s[16:19], s46 offen  lds
    s_add_u32 m0, s39, 51200
    s_nop 0
    buffer_load_dwordx4 v8, s[16:19], s46 offen  lds
    s_add_u32 m0, s39, 52224
    s_nop 0
    buffer_load_dwordx4 v9, s[16:19], s46 offen  lds
    s_add_u32 m0, s39, 53248
    s_nop 0
    buffer_load_dwordx4 v10, s[16:19], s46 offen  lds
    s_add_u32 m0, s39, 54272
    s_nop 0
    buffer_load_dwordx4 v11, s[16:19], s46 offen  lds
    s_mov_b32 s46, 786432
    s_add_u32 m0, s39, 73728
    s_nop 0
    buffer_load_dwordx4 v6, s[20:23], s46 offen  lds
    s_add_u32 m0, s39, 74752
    s_nop 0
    buffer_load_dwordx4 v7, s[20:23], s46 offen  lds
    s_add_u32 m0, s39, 75776
    s_nop 0
    buffer_load_dwordx4 v8, s[20:23], s46 offen  lds
    s_add_u32 m0, s39, 76800
    s_nop 0
    buffer_load_dwordx4 v9, s[20:23], s46 offen  lds
    s_add_u32 m0, s39, 77824
    s_nop 0
    buffer_load_dwordx4 v10, s[20:23], s46 offen  lds
    s_add_u32 m0, s39, 78848
    s_nop 0
    buffer_load_dwordx4 v11, s[20:23], s46 offen  lds
    s_mov_b32 s46, 1572864
    s_add_u32 m0, s39, 98304
    s_nop 0
    buffer_load_dwordx4 v6, s[16:19], s46 offen  lds
    s_add_u32 m0, s39, 99328
    s_nop 0
    buffer_load_dwordx4 v7, s[16:19], s46 offen  lds
    s_add_u32 m0, s39, 100352
    s_nop 0
    buffer_load_dwordx4 v8, s[16:19], s46 offen  lds
    s_add_u32 m0, s39, 101376
    s_nop 0
    buffer_load_dwordx4 v9, s[16:19], s46 offen  lds
    s_add_u32 m0, s39, 102400
    s_nop 0
    buffer_load_dwordx4 v10, s[16:19], s46 offen  lds
    s_add_u32 m0, s39, 103424
    s_nop 0
    buffer_load_dwordx4 v11, s[16:19], s46 offen  lds
    s_waitcnt vmcnt(24)
    s_barrier
    ds_read_b64_tr_b16 v[72:73], v12 offset:0
    ds_read_b64_tr_b16 v[74:75], v12 offset:384
    ds_read_b64_tr_b16 v[76:77], v12 offset:12288
    ds_read_b64_tr_b16 v[78:79], v12 offset:12672
    ds_read_b64_tr_b16 v[96:97], v13 offset:0
    ds_read_b64_tr_b16 v[98:99], v13 offset:384
    ds_read_b64_tr_b16 v[100:101], v13 offset:12288
    ds_read_b64_tr_b16 v[102:103], v13 offset:12672
    ds_read_b64_tr_b16 a[168:169], v14 offset:0
    ds_read_b64_tr_b16 a[170:171], v14 offset:384
    ds_read_b64_tr_b16 a[172:173], v14 offset:12288
    ds_read_b64_tr_b16 a[174:175], v14 offset:12672
    s_mov_b32 s46, 1572864
    s_add_u32 m0, s39, 122880
    s_nop 0
    buffer_load_dwordx4 v6, s[20:23], s46 offen  lds
    s_add_u32 m0, s39, 123904
    s_nop 0
    buffer_load_dwordx4 v7, s[20:23], s46 offen  lds
    s_add_u32 m0, s39, 124928
    s_nop 0
    buffer_load_dwordx4 v8, s[20:23], s46 offen  lds
    s_add_u32 m0, s39, 125952
    s_nop 0
    buffer_load_dwordx4 v9, s[20:23], s46 offen  lds
    s_add_u32 m0, s39, 126976
    s_nop 0
    buffer_load_dwordx4 v10, s[20:23], s46 offen  lds
    s_add_u32 m0, s39, 128000
    s_nop 0
    buffer_load_dwordx4 v11, s[20:23], s46 offen  lds
    s_waitcnt lgkmcnt(0)
    s_waitcnt vmcnt(24)
    s_barrier
    ds_read_b64_tr_b16 a[200:201], v12 offset:24576
    ds_read_b64_tr_b16 a[202:203], v12 offset:24960
    ds_read_b64_tr_b16 a[204:205], v12 offset:36864
    ds_read_b64_tr_b16 a[206:207], v12 offset:37248
    ds_read_b64_tr_b16 a[232:233], v13 offset:24576
    ds_read_b64_tr_b16 a[234:235], v13 offset:24960
    ds_read_b64_tr_b16 a[236:237], v13 offset:36864
    ds_read_b64_tr_b16 a[238:239], v13 offset:37248
    ds_read_b64_tr_b16 v[200:201], v14 offset:24576
    ds_read_b64_tr_b16 v[202:203], v14 offset:24960
    ds_read_b64_tr_b16 v[204:205], v14 offset:36864
    ds_read_b64_tr_b16 v[206:207], v14 offset:37248
    s_mov_b32 s46, 2359296
    s_add_u32 m0, s39, 0
    s_nop 0
    buffer_load_dwordx4 v6, s[16:19], s46 offen  lds
    s_add_u32 m0, s39, 1024
    s_nop 0
    buffer_load_dwordx4 v7, s[16:19], s46 offen  lds
    s_add_u32 m0, s39, 2048
    s_nop 0
    buffer_load_dwordx4 v8, s[16:19], s46 offen  lds
    s_add_u32 m0, s39, 3072
    s_nop 0
    buffer_load_dwordx4 v9, s[16:19], s46 offen  lds
    s_add_u32 m0, s39, 4096
    s_nop 0
    buffer_load_dwordx4 v10, s[16:19], s46 offen  lds
    s_add_u32 m0, s39, 5120
    s_nop 0
    buffer_load_dwordx4 v11, s[16:19], s46 offen  lds
    s_waitcnt lgkmcnt(0)
    v_add_u32 v12, 49152, v12
    v_add_u32 v13, 49152, v13
    v_add_u32 v14, 49152, v14
    s_waitcnt vmcnt(24)
    s_barrier
    ds_read_b64_tr_b16 a[104:105], v12 offset:0
    ds_read_b64_tr_b16 a[106:107], v12 offset:384
    ds_read_b64_tr_b16 a[108:109], v12 offset:12288
    ds_read_b64_tr_b16 a[110:111], v12 offset:12672
    ds_read_b64_tr_b16 a[136:137], v13 offset:0
    ds_read_b64_tr_b16 a[138:139], v13 offset:384
    ds_read_b64_tr_b16 a[140:141], v13 offset:12288
    ds_read_b64_tr_b16 a[142:143], v13 offset:12672
    ds_read_b64_tr_b16 v[120:121], v14 offset:0
    ds_read_b64_tr_b16 v[122:123], v14 offset:384
    ds_read_b64_tr_b16 v[124:125], v14 offset:12288
    ds_read_b64_tr_b16 v[126:127], v14 offset:12672
    s_mov_b32 s46, 2359296
    s_add_u32 m0, s39, 24576
    s_nop 0
    buffer_load_dwordx4 v6, s[20:23], s46 offen  lds
    s_add_u32 m0, s39, 25600
    s_nop 0
    buffer_load_dwordx4 v7, s[20:23], s46 offen  lds
    s_add_u32 m0, s39, 26624
    s_nop 0
    buffer_load_dwordx4 v8, s[20:23], s46 offen  lds
    s_add_u32 m0, s39, 27648
    s_nop 0
    buffer_load_dwordx4 v9, s[20:23], s46 offen  lds
    s_add_u32 m0, s39, 28672
    s_nop 0
    buffer_load_dwordx4 v10, s[20:23], s46 offen  lds
    s_add_u32 m0, s39, 29696
    s_nop 0
    buffer_load_dwordx4 v11, s[20:23], s46 offen  lds
    s_waitcnt lgkmcnt(0)
    s_waitcnt vmcnt(24)
    s_barrier
    ds_read_b64_tr_b16 a[208:209], v12 offset:24576
    ds_read_b64_tr_b16 a[210:211], v12 offset:24960
    ds_read_b64_tr_b16 a[212:213], v12 offset:36864
    ds_read_b64_tr_b16 a[214:215], v12 offset:37248
    ds_read_b64_tr_b16 v[168:169], v13 offset:24576
    ds_read_b64_tr_b16 v[170:171], v13 offset:24960
    ds_read_b64_tr_b16 v[172:173], v13 offset:36864
    ds_read_b64_tr_b16 v[174:175], v13 offset:37248
    ds_read_b64_tr_b16 v[208:209], v14 offset:24576
    ds_read_b64_tr_b16 v[210:211], v14 offset:24960
    ds_read_b64_tr_b16 v[212:213], v14 offset:36864
    ds_read_b64_tr_b16 v[214:215], v14 offset:37248
    s_mov_b32 s46, 3145728
    s_add_u32 m0, s39, 49152
    s_nop 0
    buffer_load_dwordx4 v6, s[16:19], s46 offen  lds
    s_add_u32 m0, s39, 50176
    s_nop 0
    buffer_load_dwordx4 v7, s[16:19], s46 offen  lds
    s_add_u32 m0, s39, 51200
    s_nop 0
    buffer_load_dwordx4 v8, s[16:19], s46 offen  lds
    s_add_u32 m0, s39, 52224
    s_nop 0
    buffer_load_dwordx4 v9, s[16:19], s46 offen  lds
    s_add_u32 m0, s39, 53248
    s_nop 0
    buffer_load_dwordx4 v10, s[16:19], s46 offen  lds
    s_add_u32 m0, s39, 54272
    s_nop 0
    buffer_load_dwordx4 v11, s[16:19], s46 offen  lds
    s_waitcnt lgkmcnt(0)
    v_add_u32 v12, 49152, v12
    v_add_u32 v13, 49152, v13
    v_add_u32 v14, 49152, v14
    s_waitcnt vmcnt(24)
    s_barrier
    ds_read_b64_tr_b16 a[112:113], v12 offset:0
    ds_read_b64_tr_b16 a[114:115], v12 offset:384
    ds_read_b64_tr_b16 a[116:117], v12 offset:12288
    ds_read_b64_tr_b16 a[118:119], v12 offset:12672
    ds_read_b64_tr_b16 v[104:105], v13 offset:0
    ds_read_b64_tr_b16 v[106:107], v13 offset:384
    ds_read_b64_tr_b16 v[108:109], v13 offset:12288
    ds_read_b64_tr_b16 v[110:111], v13 offset:12672
    ds_read_b64_tr_b16 a[176:177], v14 offset:0
    ds_read_b64_tr_b16 a[178:179], v14 offset:384
    ds_read_b64_tr_b16 a[180:181], v14 offset:12288
    ds_read_b64_tr_b16 a[182:183], v14 offset:12672
    s_mov_b32 s46, 3145728
    s_add_u32 m0, s39, 73728
    s_nop 0
    buffer_load_dwordx4 v6, s[20:23], s46 offen  lds
    s_add_u32 m0, s39, 74752
    s_nop 0
    buffer_load_dwordx4 v7, s[20:23], s46 offen  lds
    s_add_u32 m0, s39, 75776
    s_nop 0
    buffer_load_dwordx4 v8, s[20:23], s46 offen  lds
    s_add_u32 m0, s39, 76800
    s_nop 0
    buffer_load_dwordx4 v9, s[20:23], s46 offen  lds
    s_add_u32 m0, s39, 77824
    s_nop 0
    buffer_load_dwordx4 v10, s[20:23], s46 offen  lds
    s_add_u32 m0, s39, 78848
    s_nop 0
    buffer_load_dwordx4 v11, s[20:23], s46 offen  lds
    s_waitcnt lgkmcnt(0)
    s_waitcnt vmcnt(24)
    s_barrier
    ds_read_b64_tr_b16 v[144:145], v12 offset:24576
    ds_read_b64_tr_b16 v[146:147], v12 offset:24960
    ds_read_b64_tr_b16 v[148:149], v12 offset:36864
    ds_read_b64_tr_b16 v[150:151], v12 offset:37248
    ds_read_b64_tr_b16 a[240:241], v13 offset:24576
    ds_read_b64_tr_b16 a[242:243], v13 offset:24960
    ds_read_b64_tr_b16 a[244:245], v13 offset:36864
    ds_read_b64_tr_b16 a[246:247], v13 offset:37248
    ds_read_b64_tr_b16 v[216:217], v14 offset:24576
    ds_read_b64_tr_b16 v[218:219], v14 offset:24960
    ds_read_b64_tr_b16 v[220:221], v14 offset:36864
    ds_read_b64_tr_b16 v[222:223], v14 offset:37248
    s_mov_b32 s46, 3932160
    s_add_u32 m0, s39, 98304
    s_nop 0
    buffer_load_dwordx4 v6, s[16:19], s46 offen  lds
    s_add_u32 m0, s39, 99328
    s_nop 0
    buffer_load_dwordx4 v7, s[16:19], s46 offen  lds
    s_add_u32 m0, s39, 100352
    s_nop 0
    buffer_load_dwordx4 v8, s[16:19], s46 offen  lds
    s_add_u32 m0, s39, 101376
    s_nop 0
    buffer_load_dwordx4 v9, s[16:19], s46 offen  lds
    s_add_u32 m0, s39, 102400
    s_nop 0
    buffer_load_dwordx4 v10, s[16:19], s46 offen  lds
    s_add_u32 m0, s39, 103424
    s_nop 0
    buffer_load_dwordx4 v11, s[16:19], s46 offen  lds
    s_waitcnt lgkmcnt(0)
    v_add_u32 v12, 4294868992, v12
    v_add_u32 v13, 4294868992, v13
    v_add_u32 v14, 4294868992, v14
    s_waitcnt vmcnt(24)
    s_barrier
    ds_read_b64_tr_b16 v[80:81], v12 offset:0
    ds_read_b64_tr_b16 v[82:83], v12 offset:384
    ds_read_b64_tr_b16 v[84:85], v12 offset:12288
    ds_read_b64_tr_b16 v[86:87], v12 offset:12672
    ds_read_b64_tr_b16 a[144:145], v13 offset:0
    ds_read_b64_tr_b16 a[146:147], v13 offset:384
    ds_read_b64_tr_b16 a[148:149], v13 offset:12288
    ds_read_b64_tr_b16 a[150:151], v13 offset:12672
    ds_read_b64_tr_b16 v[128:129], v14 offset:0
    ds_read_b64_tr_b16 v[130:131], v14 offset:384
    ds_read_b64_tr_b16 v[132:133], v14 offset:12288
    ds_read_b64_tr_b16 v[134:135], v14 offset:12672
    s_mov_b32 s46, 3932160
    s_add_u32 m0, s39, 122880
    s_nop 0
    buffer_load_dwordx4 v6, s[20:23], s46 offen  lds
    s_add_u32 m0, s39, 123904
    s_nop 0
    buffer_load_dwordx4 v7, s[20:23], s46 offen  lds
    s_add_u32 m0, s39, 124928
    s_nop 0
    buffer_load_dwordx4 v8, s[20:23], s46 offen  lds
    s_add_u32 m0, s39, 125952
    s_nop 0
    buffer_load_dwordx4 v9, s[20:23], s46 offen  lds
    s_add_u32 m0, s39, 126976
    s_nop 0
    buffer_load_dwordx4 v10, s[20:23], s46 offen  lds
    s_add_u32 m0, s39, 128000
    s_nop 0
    buffer_load_dwordx4 v11, s[20:23], s46 offen  lds
    s_waitcnt lgkmcnt(0)
    s_waitcnt vmcnt(24)
    s_barrier
    ds_read_b64_tr_b16 a[216:217], v12 offset:24576
    ds_read_b64_tr_b16 a[218:219], v12 offset:24960
    ds_read_b64_tr_b16 a[220:221], v12 offset:36864
    ds_read_b64_tr_b16 a[222:223], v12 offset:37248
    ds_read_b64_tr_b16 a[248:249], v13 offset:24576
    ds_read_b64_tr_b16 a[250:251], v13 offset:24960
    ds_read_b64_tr_b16 a[252:253], v13 offset:36864
    ds_read_b64_tr_b16 a[254:255], v13 offset:37248
    ds_read_b64_tr_b16 v[224:225], v14 offset:24576
    ds_read_b64_tr_b16 v[226:227], v14 offset:24960
    ds_read_b64_tr_b16 v[228:229], v14 offset:36864
    ds_read_b64_tr_b16 v[230:231], v14 offset:37248
    s_mov_b32 s46, 4718592
    s_add_u32 m0, s39, 0
    s_nop 0
    buffer_load_dwordx4 v6, s[16:19], s46 offen  lds
    s_add_u32 m0, s39, 1024
    s_nop 0
    buffer_load_dwordx4 v7, s[16:19], s46 offen  lds
    s_add_u32 m0, s39, 2048
    s_nop 0
    buffer_load_dwordx4 v8, s[16:19], s46 offen  lds
    s_add_u32 m0, s39, 3072
    s_nop 0
    buffer_load_dwordx4 v9, s[16:19], s46 offen  lds
    s_add_u32 m0, s39, 4096
    s_nop 0
    buffer_load_dwordx4 v10, s[16:19], s46 offen  lds
    s_add_u32 m0, s39, 5120
    s_nop 0
    buffer_load_dwordx4 v11, s[16:19], s46 offen  lds
    s_waitcnt lgkmcnt(0)
    v_add_u32 v12, 49152, v12
    v_add_u32 v13, 49152, v13
    v_add_u32 v14, 49152, v14
    s_waitcnt vmcnt(24)
    s_barrier
    ds_read_b64_tr_b16 a[120:121], v12 offset:0
    ds_read_b64_tr_b16 a[122:123], v12 offset:384
    ds_read_b64_tr_b16 a[124:125], v12 offset:12288
    ds_read_b64_tr_b16 a[126:127], v12 offset:12672
    ds_read_b64_tr_b16 v[112:113], v13 offset:0
    ds_read_b64_tr_b16 v[114:115], v13 offset:384
    ds_read_b64_tr_b16 v[116:117], v13 offset:12288
    ds_read_b64_tr_b16 v[118:119], v13 offset:12672
    ds_read_b64_tr_b16 a[184:185], v14 offset:0
    ds_read_b64_tr_b16 a[186:187], v14 offset:384
    ds_read_b64_tr_b16 a[188:189], v14 offset:12288
    ds_read_b64_tr_b16 a[190:191], v14 offset:12672
    s_mov_b32 s46, 4718592
    s_add_u32 m0, s39, 24576
    s_nop 0
    buffer_load_dwordx4 v6, s[20:23], s46 offen  lds
    s_add_u32 m0, s39, 25600
    s_nop 0
    buffer_load_dwordx4 v7, s[20:23], s46 offen  lds
    s_add_u32 m0, s39, 26624
    s_nop 0
    buffer_load_dwordx4 v8, s[20:23], s46 offen  lds
    s_add_u32 m0, s39, 27648
    s_nop 0
    buffer_load_dwordx4 v9, s[20:23], s46 offen  lds
    s_add_u32 m0, s39, 28672
    s_nop 0
    buffer_load_dwordx4 v10, s[20:23], s46 offen  lds
    s_add_u32 m0, s39, 29696
    s_nop 0
    buffer_load_dwordx4 v11, s[20:23], s46 offen  lds
    s_waitcnt lgkmcnt(0)
    s_waitcnt vmcnt(24)
    s_barrier
    ds_read_b64_tr_b16 v[152:153], v12 offset:24576
    ds_read_b64_tr_b16 v[154:155], v12 offset:24960
    ds_read_b64_tr_b16 v[156:157], v12 offset:36864
    ds_read_b64_tr_b16 v[158:159], v12 offset:37248
    ds_read_b64_tr_b16 v[176:177], v13 offset:24576
    ds_read_b64_tr_b16 v[178:179], v13 offset:24960
    ds_read_b64_tr_b16 v[180:181], v13 offset:36864
    ds_read_b64_tr_b16 v[182:183], v13 offset:37248
    ds_read_b64_tr_b16 v[232:233], v14 offset:24576
    ds_read_b64_tr_b16 v[234:235], v14 offset:24960
    ds_read_b64_tr_b16 v[236:237], v14 offset:36864
    ds_read_b64_tr_b16 v[238:239], v14 offset:37248
    s_mov_b32 s46, 5505024
    s_add_u32 m0, s39, 49152
    s_nop 0
    buffer_load_dwordx4 v6, s[16:19], s46 offen  lds
    s_add_u32 m0, s39, 50176
    s_nop 0
    buffer_load_dwordx4 v7, s[16:19], s46 offen  lds
    s_add_u32 m0, s39, 51200
    s_nop 0
    buffer_load_dwordx4 v8, s[16:19], s46 offen  lds
    s_add_u32 m0, s39, 52224
    s_nop 0
    buffer_load_dwordx4 v9, s[16:19], s46 offen  lds
    s_add_u32 m0, s39, 53248
    s_nop 0
    buffer_load_dwordx4 v10, s[16:19], s46 offen  lds
    s_add_u32 m0, s39, 54272
    s_nop 0
    buffer_load_dwordx4 v11, s[16:19], s46 offen  lds
    s_waitcnt lgkmcnt(0)
    v_add_u32 v12, 49152, v12
    v_add_u32 v13, 49152, v13
    v_add_u32 v14, 49152, v14
    s_waitcnt vmcnt(24)
    s_barrier
    ds_read_b64_tr_b16 v[88:89], v12 offset:0
    ds_read_b64_tr_b16 v[90:91], v12 offset:384
    ds_read_b64_tr_b16 v[92:93], v12 offset:12288
    ds_read_b64_tr_b16 v[94:95], v12 offset:12672
    ds_read_b64_tr_b16 a[152:153], v13 offset:0
    ds_read_b64_tr_b16 a[154:155], v13 offset:384
    ds_read_b64_tr_b16 a[156:157], v13 offset:12288
    ds_read_b64_tr_b16 a[158:159], v13 offset:12672
    ds_read_b64_tr_b16 a[192:193], v14 offset:0
    ds_read_b64_tr_b16 a[194:195], v14 offset:384
    ds_read_b64_tr_b16 a[196:197], v14 offset:12288
    ds_read_b64_tr_b16 a[198:199], v14 offset:12672
    s_mov_b32 s46, 5505024
    s_add_u32 m0, s39, 73728
    s_nop 0
    buffer_load_dwordx4 v6, s[20:23], s46 offen  lds
    s_add_u32 m0, s39, 74752
    s_nop 0
    buffer_load_dwordx4 v7, s[20:23], s46 offen  lds
    s_add_u32 m0, s39, 75776
    s_nop 0
    buffer_load_dwordx4 v8, s[20:23], s46 offen  lds
    s_add_u32 m0, s39, 76800
    s_nop 0
    buffer_load_dwordx4 v9, s[20:23], s46 offen  lds
    s_add_u32 m0, s39, 77824
    s_nop 0
    buffer_load_dwordx4 v10, s[20:23], s46 offen  lds
    s_add_u32 m0, s39, 78848
    s_nop 0
    buffer_load_dwordx4 v11, s[20:23], s46 offen  lds
    s_waitcnt lgkmcnt(0)
    s_waitcnt vmcnt(24)
    s_barrier
    ds_read_b64_tr_b16 a[224:225], v12 offset:24576
    ds_read_b64_tr_b16 a[226:227], v12 offset:24960
    ds_read_b64_tr_b16 a[228:229], v12 offset:36864
    ds_read_b64_tr_b16 a[230:231], v12 offset:37248
    ds_read_b64_tr_b16 v[184:185], v13 offset:24576
    ds_read_b64_tr_b16 v[186:187], v13 offset:24960
    ds_read_b64_tr_b16 v[188:189], v13 offset:36864
    ds_read_b64_tr_b16 v[190:191], v13 offset:37248
    ds_read_b64_tr_b16 v[240:241], v14 offset:24576
    ds_read_b64_tr_b16 v[242:243], v14 offset:24960
    ds_read_b64_tr_b16 v[244:245], v14 offset:36864
    ds_read_b64_tr_b16 v[246:247], v14 offset:37248
    s_mov_b32 s46, 6291456
    s_add_u32 m0, s39, 98304
    s_nop 0
    buffer_load_dwordx4 v6, s[16:19], s46 offen  lds
    s_add_u32 m0, s39, 99328
    s_nop 0
    buffer_load_dwordx4 v7, s[16:19], s46 offen  lds
    s_add_u32 m0, s39, 100352
    s_nop 0
    buffer_load_dwordx4 v8, s[16:19], s46 offen  lds
    s_add_u32 m0, s39, 101376
    s_nop 0
    buffer_load_dwordx4 v9, s[16:19], s46 offen  lds
    s_add_u32 m0, s39, 102400
    s_nop 0
    buffer_load_dwordx4 v10, s[16:19], s46 offen  lds
    s_add_u32 m0, s39, 103424
    s_nop 0
    buffer_load_dwordx4 v11, s[16:19], s46 offen  lds
    s_waitcnt lgkmcnt(0)
    v_add_u32 v12, 4294868992, v12
    v_add_u32 v13, 4294868992, v13
    v_add_u32 v14, 4294868992, v14
    s_waitcnt vmcnt(24)
    s_barrier
    ds_read_b64_tr_b16 a[128:129], v12 offset:0
    ds_read_b64_tr_b16 a[130:131], v12 offset:384
    ds_read_b64_tr_b16 a[132:133], v12 offset:12288
    ds_read_b64_tr_b16 a[134:135], v12 offset:12672
    ds_read_b64_tr_b16 a[160:161], v13 offset:0
    ds_read_b64_tr_b16 a[162:163], v13 offset:384
    ds_read_b64_tr_b16 a[164:165], v13 offset:12288
    ds_read_b64_tr_b16 a[166:167], v13 offset:12672
    ds_read_b64_tr_b16 v[136:137], v14 offset:0
    ds_read_b64_tr_b16 v[138:139], v14 offset:384
    ds_read_b64_tr_b16 v[140:141], v14 offset:12288
    ds_read_b64_tr_b16 v[142:143], v14 offset:12672
    s_mov_b32 s46, 6291456
    s_add_u32 m0, s39, 122880
    s_nop 0
    buffer_load_dwordx4 v6, s[20:23], s46 offen  lds
    s_add_u32 m0, s39, 123904
    s_nop 0
    buffer_load_dwordx4 v7, s[20:23], s46 offen  lds
    s_add_u32 m0, s39, 124928
    s_nop 0
    buffer_load_dwordx4 v8, s[20:23], s46 offen  lds
    s_add_u32 m0, s39, 125952
    s_nop 0
    buffer_load_dwordx4 v9, s[20:23], s46 offen  lds
    s_add_u32 m0, s39, 126976
    s_nop 0
    buffer_load_dwordx4 v10, s[20:23], s46 offen  lds
    s_add_u32 m0, s39, 128000
    s_nop 0
    buffer_load_dwordx4 v11, s[20:23], s46 offen  lds
    s_waitcnt lgkmcnt(0)
    s_waitcnt vmcnt(24)
    s_barrier
    ds_read_b64_tr_b16 v[160:161], v12 offset:24576
    ds_read_b64_tr_b16 v[162:163], v12 offset:24960
    ds_read_b64_tr_b16 v[164:165], v12 offset:36864
    ds_read_b64_tr_b16 v[166:167], v12 offset:37248
    ds_read_b64_tr_b16 v[192:193], v13 offset:24576
    ds_read_b64_tr_b16 v[194:195], v13 offset:24960
    ds_read_b64_tr_b16 v[196:197], v13 offset:36864
    ds_read_b64_tr_b16 v[198:199], v13 offset:37248
    ds_read_b64_tr_b16 v[248:249], v14 offset:24576
    ds_read_b64_tr_b16 v[250:251], v14 offset:24960
    ds_read_b64_tr_b16 v[252:253], v14 offset:36864
    ds_read_b64_tr_b16 v[254:255], v14 offset:37248
    s_mov_b32 s46, 7077888
    s_add_u32 m0, s39, 0
    s_nop 0
    buffer_load_dwordx4 v6, s[16:19], s46 offen  lds
    s_add_u32 m0, s39, 1024
    s_nop 0
    buffer_load_dwordx4 v7, s[16:19], s46 offen  lds
    s_add_u32 m0, s39, 2048
    s_nop 0
    buffer_load_dwordx4 v8, s[16:19], s46 offen  lds
    s_add_u32 m0, s39, 3072
    s_nop 0
    buffer_load_dwordx4 v9, s[16:19], s46 offen  lds
    s_add_u32 m0, s39, 4096
    s_nop 0
    buffer_load_dwordx4 v10, s[16:19], s46 offen  lds
    s_add_u32 m0, s39, 5120
    s_nop 0
    buffer_load_dwordx4 v11, s[16:19], s46 offen  lds
    s_waitcnt lgkmcnt(0)
    v_add_u32 v12, 49152, v12
    v_add_u32 v13, 49152, v13
    v_add_u32 v14, 49152, v14
    s_waitcnt vmcnt(24)
    s_barrier
    ds_read_b64_tr_b16 a[0:1], v12 offset:0
    ds_read_b64_tr_b16 a[2:3], v12 offset:384
    ds_read_b64_tr_b16 a[4:5], v12 offset:12288
    ds_read_b64_tr_b16 a[6:7], v12 offset:12672
    ds_read_b64_tr_b16 v[32:33], v13 offset:0
    ds_read_b64_tr_b16 v[34:35], v13 offset:384
    ds_read_b64_tr_b16 v[36:37], v13 offset:12288
    ds_read_b64_tr_b16 v[38:39], v13 offset:12672
    ds_read_b64_tr_b16 v[40:41], v14 offset:0
    ds_read_b64_tr_b16 v[42:43], v14 offset:384
    ds_read_b64_tr_b16 v[44:45], v14 offset:12288
    ds_read_b64_tr_b16 v[46:47], v14 offset:12672
    s_mov_b32 s46, 7077888
    s_add_u32 m0, s39, 24576
    s_nop 0
    buffer_load_dwordx4 v6, s[20:23], s46 offen  lds
    s_add_u32 m0, s39, 25600
    s_nop 0
    buffer_load_dwordx4 v7, s[20:23], s46 offen  lds
    s_add_u32 m0, s39, 26624
    s_nop 0
    buffer_load_dwordx4 v8, s[20:23], s46 offen  lds
    s_add_u32 m0, s39, 27648
    s_nop 0
    buffer_load_dwordx4 v9, s[20:23], s46 offen  lds
    s_add_u32 m0, s39, 28672
    s_nop 0
    buffer_load_dwordx4 v10, s[20:23], s46 offen  lds
    s_add_u32 m0, s39, 29696
    s_nop 0
    buffer_load_dwordx4 v11, s[20:23], s46 offen  lds
    s_waitcnt lgkmcnt(0)
    s_waitcnt vmcnt(24)
    s_barrier
    ds_read_b64_tr_b16 a[8:9], v12 offset:24576
    ds_read_b64_tr_b16 a[10:11], v12 offset:24960
    ds_read_b64_tr_b16 a[12:13], v12 offset:36864
    ds_read_b64_tr_b16 a[14:15], v12 offset:37248
    ds_read_b64_tr_b16 a[16:17], v13 offset:24576
    ds_read_b64_tr_b16 a[18:19], v13 offset:24960
    ds_read_b64_tr_b16 a[20:21], v13 offset:36864
    ds_read_b64_tr_b16 a[22:23], v13 offset:37248
    ds_read_b64_tr_b16 v[48:49], v14 offset:24576
    ds_read_b64_tr_b16 v[50:51], v14 offset:24960
    ds_read_b64_tr_b16 v[52:53], v14 offset:36864
    ds_read_b64_tr_b16 v[54:55], v14 offset:37248
    s_waitcnt lgkmcnt(0)
    v_add_u32 v12, 49152, v12
    v_add_u32 v13, 49152, v13
    v_add_u32 v14, 49152, v14
    s_waitcnt vmcnt(18)
    s_barrier
    ds_read_b64_tr_b16 a[24:25], v12 offset:0
    ds_read_b64_tr_b16 a[26:27], v12 offset:384
    ds_read_b64_tr_b16 a[28:29], v12 offset:12288
    ds_read_b64_tr_b16 a[30:31], v12 offset:12672
    ds_read_b64_tr_b16 a[32:33], v13 offset:0
    ds_read_b64_tr_b16 a[34:35], v13 offset:384
    ds_read_b64_tr_b16 a[36:37], v13 offset:12288
    ds_read_b64_tr_b16 a[38:39], v13 offset:12672
    ds_read_b64_tr_b16 a[40:41], v14 offset:0
    ds_read_b64_tr_b16 a[42:43], v14 offset:384
    ds_read_b64_tr_b16 a[44:45], v14 offset:12288
    ds_read_b64_tr_b16 a[46:47], v14 offset:12672
    s_waitcnt lgkmcnt(0)
    s_waitcnt vmcnt(12)
    s_barrier
    ds_read_b64_tr_b16 a[48:49], v12 offset:24576
    ds_read_b64_tr_b16 a[50:51], v12 offset:24960
    ds_read_b64_tr_b16 a[52:53], v12 offset:36864
    ds_read_b64_tr_b16 a[54:55], v12 offset:37248
    ds_read_b64_tr_b16 a[56:57], v13 offset:24576
    ds_read_b64_tr_b16 a[58:59], v13 offset:24960
    ds_read_b64_tr_b16 a[60:61], v13 offset:36864
    ds_read_b64_tr_b16 a[62:63], v13 offset:37248
    ds_read_b64_tr_b16 v[56:57], v14 offset:24576
    ds_read_b64_tr_b16 v[58:59], v14 offset:24960
    ds_read_b64_tr_b16 v[60:61], v14 offset:36864
    ds_read_b64_tr_b16 v[62:63], v14 offset:37248
    s_waitcnt lgkmcnt(0)
    v_add_u32 v12, 4294868992, v12
    v_add_u32 v13, 4294868992, v13
    v_add_u32 v14, 4294868992, v14
    s_waitcnt vmcnt(6)
    s_barrier
    ds_read_b64_tr_b16 a[64:65], v12 offset:0
    ds_read_b64_tr_b16 a[66:67], v12 offset:384
    ds_read_b64_tr_b16 a[68:69], v12 offset:12288
    ds_read_b64_tr_b16 a[70:71], v12 offset:12672
    ds_read_b64_tr_b16 a[72:73], v13 offset:0
    ds_read_b64_tr_b16 a[74:75], v13 offset:384
    ds_read_b64_tr_b16 a[76:77], v13 offset:12288
    ds_read_b64_tr_b16 a[78:79], v13 offset:12672
    ds_read_b64_tr_b16 a[80:81], v14 offset:0
    ds_read_b64_tr_b16 a[82:83], v14 offset:384
    ds_read_b64_tr_b16 a[84:85], v14 offset:12288
    ds_read_b64_tr_b16 a[86:87], v14 offset:12672
    s_waitcnt lgkmcnt(0)
    s_waitcnt vmcnt(0)
    s_barrier
    ds_read_b64_tr_b16 v[64:65], v12 offset:24576
    ds_read_b64_tr_b16 v[66:67], v12 offset:24960
    ds_read_b64_tr_b16 v[68:69], v12 offset:36864
    ds_read_b64_tr_b16 v[70:71], v12 offset:37248
    ds_read_b64_tr_b16 a[88:89], v13 offset:24576
    ds_read_b64_tr_b16 a[90:91], v13 offset:24960
    ds_read_b64_tr_b16 a[92:93], v13 offset:36864
    ds_read_b64_tr_b16 a[94:95], v13 offset:37248
    ds_read_b64_tr_b16 a[96:97], v14 offset:24576
    ds_read_b64_tr_b16 a[98:99], v14 offset:24960
    ds_read_b64_tr_b16 a[100:101], v14 offset:36864
    ds_read_b64_tr_b16 a[102:103], v14 offset:37248
    s_waitcnt lgkmcnt(0)
    v_add_u32 v12, 49152, v12
    v_add_u32 v13, 49152, v13
    v_add_u32 v14, 49152, v14
    s_barrier
A_LD:
    s_mul_i32 s39, s32, 36864
    buffer_load_dwordx2 v[28:29], off, s[12:15], s95 sc1
    v_and_b32 v30, 7, v2
    v_lshlrev_b32 v30, 3, v30
    buffer_load_dwordx2 v[30:31], v30, s[12:15], 0 offen offset:128 sc1
    s_lshl_b32 s47, s35, 10
    v_lshl_add_u32 v12, v2, 4, s47
    s_lshl_b32 s57, s56, 16
    s_add_u32 s57, s57, 2097152
    v_lshlrev_b32 v16, 4, v2
    v_add_u32 v25, s39, v16
    v_add_u32 v16, 147456, v16
    s_lshl_b32 s47, s35, 10
    v_add_u32 v15, s47, v16
    v_mov_b32 v17, 0x4444
    v_mov_b32 v10, 0xeeee
    v_and_b32 v11, 1, v2
    v_cmp_ne_u32 vcc, 0, v11
    s_nop 1
    v_cndmask_b32 v17, v17, v10, vcc
    s_add_u32 s46, s35, 3
    s_cmp_ge_u32 s46, 10
    s_cselect_b32 s47, 10, 0
    s_sub_u32 s46, s46, s47
    s_lshl_b32 s46, s46, 10
    v_add_u32 v18, s46, v16
    s_add_u32 s46, s35, 4
    s_cmp_ge_u32 s46, 10
    s_cselect_b32 s47, 10, 0
    s_sub_u32 s46, s46, s47
    s_lshl_b32 s46, s46, 10
    v_add_u32 v19, s46, v16
    s_add_u32 s46, s35, 5
    s_cmp_ge_u32 s46, 10
    s_cselect_b32 s47, 10, 0
    s_sub_u32 s46, s46, s47
    s_lshl_b32 s46, s46, 10
    v_add_u32 v20, s46, v16
    s_add_u32 s46, s35, 6
    s_cmp_ge_u32 s46, 10
    s_cselect_b32 s47, 10, 0
    s_sub_u32 s46, s46, s47
    s_lshl_b32 s46, s46, 10
    v_add_u32 v21, s46, v16
    s_add_u32 s46, s35, 7
    s_cmp_ge_u32 s46, 10
    s_cselect_b32 s47, 10, 0
    s_sub_u32 s46, s46, s47
    s_lshl_b32 s46, s46, 10
    v_add_u32 v22, s46, v16
    s_add_u32 s46, s35, 8
    s_cmp_ge_u32 s46, 10
    s_cselect_b32 s47, 10, 0
    s_sub_u32 s46, s46, s47
    s_lshl_b32 s46, s46, 10
    v_add_u32 v23, s46, v16
    s_add_u32 s46, s35, 9
    s_cmp_ge_u32 s46, 10
    s_cselect_b32 s47, 10, 0
    s_sub_u32 s46, s46, s47
    s_lshl_b32 s46, s46, 10
    v_add_u32 v24, s46, v16
    s_lshl_b32 s46, s32, 8
    s_add_u32 s46, s46, 157696
    v_bfe_u32 v10, v2, 2, 2
    v_lshlrev_b32 v10, 6, v10
    v_and_b32 v11, 1, v2
    v_lshl_add_u32 v10, v11, 5, v10
    v_and_b32 v11, 2, v2
    v_add_u32 v10, v10, v11
    v_lshrrev_b32 v11, 4, v2
    v_lshl_add_u32 v10, v11, 3, v10
    v_add_u32 v16, s46, v10
    v_and_b32 v10, 15, v2
    v_lshlrev_b32 v10, 4, v10
    v_lshl_add_u32 v10, v11, 2, v10
    v_add_u32 v26, s46, v10
    s_barrier
    ds_write_b128 v25, v[32:35] offset:0
    ds_write_b128 v25, v[36:39] offset:1024
    ds_write_b128 v25, v[40:43] offset:2048
    ds_write_b128 v25, v[44:47] offset:3072
    ds_write_b128 v25, v[48:51] offset:4096
    ds_write_b128 v25, v[52:55] offset:5120
    ds_write_b128 v25, v[56:59] offset:6144
    ds_write_b128 v25, v[60:63] offset:7168
    s_waitcnt lgkmcnt(0)
    ds_write_b128 v25, v[64:67] offset:8192
    ds_write_b128 v25, v[68:71] offset:9216
    ds_write_b128 v25, v[72:75] offset:10240
    ds_write_b128 v25, v[76:79] offset:11264
    ds_write_b128 v25, v[80:83] offset:12288
    ds_write_b128 v25, v[84:87] offset:13312
    ds_write_b128 v25, v[88:91] offset:14336
    ds_write_b128 v25, v[92:95] offset:15360
    s_waitcnt lgkmcnt(0)
    s_lshl_b32 s46, s2, 7
    s_add_u32 s46, s46, 4198400
    s_waitcnt vmcnt(0)
    buffer_load_dword v27, off, s[8:11], s46 sc1
    ds_write_b128 v25, v[96:99] offset:16384
    ds_write_b128 v25, v[100:103] offset:17408
    ds_write_b128 v25, v[104:107] offset:18432
    ds_write_b128 v25, v[108:111] offset:19456
    ds_write_b128 v25, v[112:115] offset:20480
    ds_write_b128 v25, v[116:119] offset:21504
    ds_write_b128 v25, v[120:123] offset:22528
    ds_write_b128 v25, v[124:127] offset:23552
    s_waitcnt lgkmcnt(0)
    ds_write_b128 v25, v[128:131] offset:24576
    ds_write_b128 v25, v[132:135] offset:25600
    ds_write_b128 v25, v[136:139] offset:26624
    ds_write_b128 v25, v[140:143] offset:27648
    ds_write_b128 v25, v[144:147] offset:28672
    ds_write_b128 v25, v[148:151] offset:29696
    ds_write_b128 v25, v[152:155] offset:30720
    ds_write_b128 v25, v[156:159] offset:31744
    s_waitcnt lgkmcnt(0)
    ds_write_b128 v25, v[160:163] offset:32768
    ds_write_b128 v25, v[164:167] offset:33792
    ds_write_b128 v25, v[168:171] offset:34816
    ds_write_b128 v25, v[172:175] offset:35840
    s_waitcnt lgkmcnt(0)
    s_branch WST_7_chk
WST_7:
    v_mov_b32 v27, 0
    s_sleep 10
WST_7_go:
    buffer_load_dwordx2 v[28:29], off, s[12:15], s95 sc1
    v_and_b32 v30, 7, v2
    v_lshlrev_b32 v30, 3, v30
    buffer_load_dwordx2 v[30:31], v30, s[12:15], 0 offen offset:128 sc1
WST_7_chk:
    s_sub_u32 s33, s33, 1
    s_cbranch_scc1 EXIT
    s_waitcnt vmcnt(0)
    s_cmp_eq_u32 s54, 0
    s_cbranch_scc1 WST_7_v
    v_not_b32 v30, v30
    v_xor_b32 v31, 8192, v31
    v_or_b32 v30, v30, v31
    v_cmp_ne_u32 vcc, 0, v30
    s_cbranch_vccz WST_7_v
    v_xor_b32 v31, 8192, v31
    v_lshrrev_b32 v31, 8, v31
    s_nop 1
    v_add_u32_dpp v31, v31, v31 row_ror:4 row_mask:0xf bank_mask:0xf
    s_nop 1
    v_add_u32_dpp v31, v31, v31 row_ror:2 row_mask:0xf bank_mask:0xf
    s_nop 1
    v_add_u32_dpp v31, v31, v31 row_ror:1 row_mask:0xf bank_mask:0xf
    s_nop 0
    v_readfirstlane_b32 s4, v31
    s_nop 0
    s_cmp_lt_u32 s4, 256
    s_cbranch_scc1 WST_7
    s_branch RESTART
WST_7_v:
    v_readfirstlane_b32 s4, v28
    v_readfirstlane_b32 s5, v29
    s_cmp_lt_u32 s4, 40
    s_cbranch_scc1 WST_7
    s_bitcmp1_b32 s5, 1
    s_cbranch_scc0 WST_7
    s_and_b32 s53, s5, 1
    s_lshl_b32 s53, s53, 13
    v_readfirstlane_b32 s41, v27
    v_lshrrev_b32 v10, 4, v2
    v_lshlrev_b32 v10, 3, v10
    v_bfe_u32 v11, v2, 2, 2
    v_add_u32 v10, v10, v11
    v_lshlrev_b32 v4, 5, v10
    v_and_b32 v11, 3, v2
    v_lshl_add_u32 v4, v11, 3, v4
    v_add_u32 v3, 157696, v4
    v_lshlrev_b32 v4, 4, v10
    v_and_b32 v11, 1, v2
    v_lshl_add_u32 v4, v11, 3, v4
    v_add_u32 v27, 157696, v4
    v_lshrrev_b32 v4, 4, v2
    v_lshlrev_b32 v4, 9, v4
    s_cmp_ge_u32 s32, 2
    s_cbranch_scc1 A_SETX
    v_and_b32 v11, 8, v2
    v_lshl_add_u32 v28, v11, 4, v4
    v_and_b32 v11, 3, v2
    v_lshl_add_u32 v28, v11, 5, v28
    v_and_b32 v11, 4, v2
    v_lshl_add_u32 v28, v11, 2, v28
    v_add_u32 v29, 256, v28
    s_lshr_b32 s46, s2, 2
    s_mul_i32 s46, s46, 640
    s_add_u32 s46, s46, 40960
    s_lshl_b32 s47, s32, 8
    s_add_u32 s47, s47, s46
    v_bfe_u32 v10, v2, 3, 1
    v_lshlrev_b32 v10, 7, v10
    v_lshrrev_b32 v11, 4, v2
    v_lshl_add_u32 v10, v11, 5, v10
    v_and_b32 v11, 7, v2
    v_lshl_add_u32 v10, v11, 2, v10
    v_add_u32 v30, s47, v10
    v_lshrrev_b32 v10, 4, v2
    v_lshlrev_b32 v10, 4, v10
    v_bfe_u32 v11, v2, 1, 1
    v_lshl_add_u32 v10, v11, 3, v10
    v_and_b32 v11, 4, v2
    s_lshl_b32 s47, s32, 6
    s_add_u32 s46, s46, s47
    s_add_u32 s46, s46, 512
    v_add3_u32 v31, v10, v11, s46
    s_lshl_b32 s46, s32, 2
    v_subrev_u32 v11, s46, v3
    s_branch A_SETD
A_SETX:
    v_and_b32 v11, 15, v2
    v_lshl_add_u32 v28, v11, 4, v4
    v_add_u32 v29, 256, v28
    s_and_b32 s46, s32, 1
    s_lshl_b32 s47, s46, 8
    v_lshl_add_u32 v10, v11, 4, s47
    v_add_u32 v3, v10, v4
    v_bfe_u32 v31, v2, 4, 1
    v_lshl_add_u32 v31, v31, 3, v10
    v_add_u32 v31, 2048, v31
    s_lshl_b32 s47, s46, 10
    v_lshl_add_u32 v30, v2, 4, s47
    s_lshl_b32 s47, s46, 4
    v_add_u32 v11, s47, v11
    v_lshrrev_b32 v10, 4, v2
    v_lshlrev_b32 v10, 3, v10
    v_sub_u32 v11, v11, v10
A_SETD:
    s_lshl_b32 s46, s2, 7
    s_add_u32 s46, s46, 4198400
    v_mov_b32 v10, s46
    s_mov_b32 s59, 0
    s_mul_i32 s45, s2, 12288
    s_add_u32 s45, s45, 8388608
    s_mul_i32 s44, s2, 2560
    s_add_u32 s44, s44, 190382080
    s_lshl_b32 s43, s2, 1
    s_and_b32 s46, s32, 1
    s_add_u32 s43, s43, s46
    s_lshl_b32 s43, s43, 7
    s_add_u32 s43, s43, 4247552
    s_mov_b32 s40, 1037384597
    s_cmp_eq_u32 s32, 1
    s_cselect_b64 s[36:37], -1, 0
    s_mov_b32 s38, 0x00550055
    s_mov_b32 s39, 0x00550055
    s_mov_b32 s34, 0
    v_min_u32 v2, 47, v2
    v_lshlrev_b32 v2, 7, v2
    s_and_b32 s42, s32, 1
    s_mul_i32 s42, s42, 6144
    s_cmp_lt_u32 s32, 2
    s_cselect_b32 s46, 393216, 0
    s_add_u32 s42, s42, s46
    s_add_u32 s42, s42, 1179648
    s_mov_b32 s60, s44
    s_mov_b32 s50, 1
    s_cmp_ge_u32 s41, s50
    s_cbranch_scc1 FWD_9
    s_branch FW_8_go
FW_8:
    s_sleep 3
    s_sub_u32 s33, s33, 1
    s_cbranch_scc1 EXIT
FW_8_go:
    buffer_load_dword v4, v10, s[8:11], 0 offen sc1
    s_waitcnt vmcnt(0)
    v_cmp_gt_u32 vcc, s50, v4
    s_cbranch_vccnz FW_8
    s_mov_b32 s41, s50
    s_add_u32 s4, s50, 1
    v_cmp_gt_u32 vcc, s4, v4
    s_cbranch_vccnz FWD_9
    s_mov_b32 s41, s4
    s_add_u32 s4, s50, 3
    v_cmp_gt_u32 vcc, s4, v4
    s_cbranch_vccnz FWD_9
    s_mov_b32 s41, s4
    s_add_u32 s4, s50, 8
    v_cmp_gt_u32 vcc, s4, v4
    s_cbranch_vccnz FWD_9
    s_mov_b32 s41, s4
    s_add_u32 s4, s50, 20
    v_cmp_gt_u32 vcc, s4, v4
    s_cbranch_vccnz FWD_9
    s_mov_b32 s41, s4
FWD_9:
    s_add_u32 s48, s45, 393216
    buffer_load_dwordx4 v[128:131], v28, s[8:11], s48 offen offset:0 sc1
    buffer_load_dwordx4 v[152:155], v29, s[8:11], s48 offen offset:0 sc1
    buffer_load_dwordx4 v[132:135], v28, s[8:11], s48 offen offset:2048 sc1
    buffer_load_dwordx4 v[156:159], v29, s[8:11], s48 offen offset:2048 sc1
    s_add_u32 s48, s48, 4096
    buffer_load_dwordx4 v[136:139], v28, s[8:11], s48 offen offset:0 sc1
    buffer_load_dwordx4 v[160:163], v29, s[8:11], s48 offen offset:0 sc1
    buffer_load_dwordx4 v[140:143], v28, s[8:11], s48 offen offset:2048 sc1
    buffer_load_dwordx4 v[164:167], v29, s[8:11], s48 offen offset:2048 sc1
    s_add_u32 s48, s48, 4096
    buffer_load_dwordx4 v[144:147], v28, s[8:11], s48 offen offset:0 sc1
    buffer_load_dwordx4 v[168:171], v29, s[8:11], s48 offen offset:0 sc1
    buffer_load_dwordx4 v[148:151], v28, s[8:11], s48 offen offset:2048 sc1
    buffer_load_dwordx4 v[172:175], v29, s[8:11], s48 offen offset:2048 sc1
    s_cmp_ge_u32 s32, 2
    s_cbranch_scc1 A_OTHER
    s_cmp_eq_u32 s54, 0
    s_cbranch_scc1 A_LOOP_S
    s_cmp_eq_u32 s32, 1
    s_cbranch_scc1 A_LOOP_1
.p2align 6
A_LOOP:
    ds_read_b128 v[72:75], v25 offset:0
    ds_read_b128 v[76:79], v25 offset:1024
    ds_read_b128 v[80:83], v25 offset:2048
    ds_read_b128 v[84:87], v25 offset:3072
    ds_read_b128 v[88:91], v25 offset:4096
    ds_read_b128 v[92:95], v25 offset:5120
    ds_read_b128 v[96:99], v25 offset:6144
    ds_read_b128 v[100:103], v25 offset:7168
    v_mov_b32 v104, 0
    v_mov_b32 v105, 0
    v_mov_b32 v106, 0
    v_mov_b32 v107, 0
    v_mov_b32 v108, 0
    v_mov_b32 v109, 0
    v_mov_b32 v110, 0
    v_mov_b32 v111, 0
    v_mov_b32 v112, 0
    v_mov_b32 v113, 0
    v_mov_b32 v114, 0
    v_mov_b32 v115, 0
    v_mov_b32 v116, 0
    v_mov_b32 v117, 0
    v_mov_b32 v118, 0
    v_mov_b32 v119, 0
    v_mov_b32 v120, 0
    v_mov_b32 v121, 0
    v_mov_b32 v122, 0
    v_mov_b32 v123, 0
    v_mov_b32 v124, 0
    v_mov_b32 v125, 0
    v_mov_b32 v126, 0
    v_mov_b32 v127, 0
    s_add_u32 s55, s34, 0
    s_and_b32 s55, s55, 3
    s_mul_i32 s55, s55, 10240
    s_add_u32 s55, s55, s57
    s_add_u32 s58, s34, 0
    s_and_b32 s58, s58, 3
    s_mul_i32 s58, s58, 5120
    s_add_u32 s58, s58, s57
    s_waitcnt lgkmcnt(0)
    s_add_u32 s51, s45, s42
QP_10:
    buffer_load_dwordx4 v[32:35], v12, s[8:11], s55 offen offset:0 sc1
    buffer_load_dwordx4 v[36:39], v12, s[8:11], s55 offen offset:1024 sc1
    buffer_load_dwordx4 v[40:43], v12, s[8:11], s55 offen offset:2048 sc1
    s_sub_u32 s33, s33, 1
    s_cbranch_scc1 EXIT
    s_waitcnt vmcnt(0)
    v_max3_u32 v4, v32, v36, v40
    v_cmp_eq_u32 vcc, -1, v4
    s_cbranch_vccnz QP_10
    v_smfmac_f32_16x16x64_bf16 v[104:107], v[32:35], a[0:7], v17
    ds_write_b128 v15, v[32:35] offset:0
    v_max3_u32 v4, v33, v34, v35
    v_smfmac_f32_16x16x64_bf16 v[108:111], v[32:35], v[72:79], v17
    ds_write_b128 v15, v[36:39] offset:1024
    v_max3_u32 v4, v4, v37, v38
    v_smfmac_f32_16x16x64_bf16 v[112:115], v[32:35], v[80:87], v17
    ds_write_b128 v15, v[40:43] offset:2048
    v_max3_u32 v4, v4, v39, v41
    v_smfmac_f32_16x16x64_bf16 v[116:119], v[32:35], a[8:15], v17
    ds_read_b128 v[72:75], v25 offset:8192
    v_max3_u32 v4, v4, v42, v43
    v_smfmac_f32_16x16x64_bf16 v[120:123], v[32:35], a[16:23], v17
    ds_read_b128 v[76:79], v25 offset:9216
    v_cmp_eq_u32 vcc, -1, v4
    v_smfmac_f32_16x16x64_bf16 v[124:127], v[32:35], v[88:95], v17
    ds_read_b128 v[80:83], v25 offset:10240
    v_smfmac_f32_16x16x64_bf16 v[104:107], v[36:39], a[24:31], v17
    ds_read_b128 v[84:87], v25 offset:11264
    v_smfmac_f32_16x16x64_bf16 v[108:111], v[36:39], a[32:39], v17
    ds_read_b128 v[88:91], v25 offset:12288
    v_smfmac_f32_16x16x64_bf16 v[112:115], v[36:39], a[40:47], v17
    s_cbranch_vccnz A_LOOP
    s_waitcnt lgkmcnt(5)
    s_barrier
    ds_read_b128 v[44:47], v18
    v_smfmac_f32_16x16x64_bf16 v[116:119], v[36:39], a[48:55], v17
    ds_read_b128 v[48:51], v19
    v_smfmac_f32_16x16x64_bf16 v[120:123], v[36:39], a[56:63], v17
    ds_read_b128 v[52:55], v20
    v_smfmac_f32_16x16x64_bf16 v[124:127], v[36:39], v[96:103], v17
    ds_read_b128 v[56:59], v21
    v_smfmac_f32_16x16x64_bf16 v[104:107], v[40:43], a[64:71], v17
    ds_read_b128 v[60:63], v22
    v_smfmac_f32_16x16x64_bf16 v[108:111], v[40:43], a[72:79], v17
    ds_read_b128 v[64:67], v23
    v_smfmac_f32_16x16x64_bf16 v[112:115], v[40:43], a[80:87], v17
    ds_read_b128 v[68:71], v24
    s_waitcnt lgkmcnt(10)
    v_smfmac_f32_16x16x64_bf16 v[116:119], v[40:43], v[72:79], v17
    ds_read_b128 v[92:95], v25 offset:13312
    v_smfmac_f32_16x16x64_bf16 v[120:123], v[40:43], a[88:95], v17
    ds_read_b128 v[96:99], v25 offset:14336
    v_smfmac_f32_16x16x64_bf16 v[124:127], v[40:43], a[96:103], v17
    ds_read_b128 v[100:103], v25 offset:15360
    s_waitcnt lgkmcnt(9)
    v_smfmac_f32_16x16x64_bf16 v[104:107], v[44:47], v[80:87], v17
    ds_read_b128 v[72:75], v25 offset:16384
    s_waitcnt lgkmcnt(9)
    v_smfmac_f32_16x16x64_bf16 v[104:107], v[48:51], a[104:111], v17
    ds_read_b128 v[76:79], v25 offset:17408
    s_waitcnt lgkmcnt(9)
    v_smfmac_f32_16x16x64_bf16 v[104:107], v[52:55], a[112:119], v17
    ds_read_b128 v[80:83], v25 offset:18432
    s_waitcnt lgkmcnt(5)
    v_smfmac_f32_16x16x64_bf16 v[104:107], v[56:59], v[88:95], v17
    ds_read_b128 v[84:87], v25 offset:19456
    v_smfmac_f32_16x16x64_bf16 v[104:107], v[60:63], a[120:127], v17
    ds_read_b128 v[88:91], v25 offset:20480
    s_waitcnt lgkmcnt(5)
    v_smfmac_f32_16x16x64_bf16 v[104:107], v[64:67], v[96:103], v17
    ds_read_b128 v[92:95], v25 offset:21504
    v_smfmac_f32_16x16x64_bf16 v[104:107], v[68:71], a[128:135], v17
    ds_read_b128 v[96:99], v25 offset:22528
    s_waitcnt lgkmcnt(5)
    v_smfmac_f32_16x16x64_bf16 v[108:111], v[44:47], v[72:79], v17
    ds_read_b128 v[100:103], v25 offset:23552
    v_smfmac_f32_16x16x64_bf16 v[108:111], v[48:51], a[136:143], v17
    ds_read_b128 v[72:75], v25 offset:24576
    s_waitcnt lgkmcnt(5)
    v_smfmac_f32_16x16x64_bf16 v[108:111], v[52:55], v[80:87], v17
    ds_read_b128 v[76:79], v25 offset:25600
    v_add_f32 v104, v104, v105
    v_smfmac_f32_16x16x64_bf16 v[108:111], v[56:59], a[144:151], v17
    ds_read_b128 v[80:83], v25 offset:26624
    s_waitcnt lgkmcnt(5)
    v_add_f32 v106, v106, v107
    v_smfmac_f32_16x16x64_bf16 v[108:111], v[60:63], v[88:95], v17
    ds_read_b128 v[84:87], v25 offset:27648
    v_cvt_pk_bf16_f32 v105, v104, v106
    v_smfmac_f32_16x16x64_bf16 v[108:111], v[64:67], a[152:159], v17
    ds_write_b16 v16, v105 offset:0
    v_smfmac_f32_16x16x64_bf16 v[108:111], v[68:71], a[160:167], v17
    ds_write_b16_d16_hi v16, v105 offset:4
    s_waitcnt lgkmcnt(4)
    v_smfmac_f32_16x16x64_bf16 v[112:115], v[44:47], a[168:175], v17
    ds_read_b128 v[88:91], v25 offset:28672
    v_mov_b32 v104, 0
    v_smfmac_f32_16x16x64_bf16 v[112:115], v[48:51], v[96:103], v17
    ds_read_b128 v[92:95], v25 offset:29696
    v_mov_b32 v105, 0
    v_smfmac_f32_16x16x64_bf16 v[112:115], v[52:55], a[176:183], v17
    ds_read_b128 v[96:99], v25 offset:30720
    v_add_f32 v108, v108, v109
    v_smfmac_f32_16x16x64_bf16 v[112:115], v[56:59], v[72:79], v17
    ds_read_b128 v[100:103], v25 offset:31744
    v_add_f32 v110, v110, v111
    v_smfmac_f32_16x16x64_bf16 v[112:115], v[60:63], a[184:191], v17
    ds_read_b128 v[72:75], v25 offset:32768
    v_cvt_pk_bf16_f32 v109, v108, v110
    v_smfmac_f32_16x16x64_bf16 v[112:115], v[64:67], a[192:199], v17
    ds_write_b16 v16, v109 offset:1024
    s_waitcnt lgkmcnt(8)
    v_mov_b32 v106, 0
    v_smfmac_f32_16x16x64_bf16 v[112:115], v[68:71], v[80:87], v17
    ds_write_b16_d16_hi v16, v109 offset:1028
    v_mov_b32 v107, 0
    v_smfmac_f32_16x16x64_bf16 v[116:119], v[44:47], a[200:207], v17
    ds_read_b128 v[76:79], v25 offset:33792
    v_mov_b32 v108, 0
    v_smfmac_f32_16x16x64_bf16 v[116:119], v[48:51], a[208:215], v17
    ds_read_b128 v[80:83], v25 offset:34816
    s_waitcnt lgkmcnt(7)
    v_mov_b32 v109, 0
    v_smfmac_f32_16x16x64_bf16 v[116:119], v[52:55], v[88:95], v17
    ds_read_b128 v[84:87], v25 offset:35840
    v_add_f32 v112, v112, v113
    v_smfmac_f32_16x16x64_bf16 v[116:119], v[56:59], a[216:223], v17
    s_waitcnt lgkmcnt(6)
    v_add_f32 v114, v114, v115
    v_smfmac_f32_16x16x64_bf16 v[116:119], v[60:63], v[96:103], v17
    v_cvt_pk_bf16_f32 v113, v112, v114
    v_smfmac_f32_16x16x64_bf16 v[116:119], v[64:67], a[224:231], v17
    ds_write_b16 v16, v113 offset:2048
    s_waitcnt lgkmcnt(3)
    v_mov_b32 v110, 0
    v_smfmac_f32_16x16x64_bf16 v[116:119], v[68:71], v[72:79], v17
    ds_write_b16_d16_hi v16, v113 offset:2052
    v_mov_b32 v111, 0
    v_smfmac_f32_16x16x64_bf16 v[120:123], v[44:47], a[232:239], v17
    s_waitcnt lgkmcnt(2)
    v_smfmac_f32_16x16x64_bf16 v[120:123], v[48:51], v[80:87], v17
    v_mov_b32 v112, 0
    v_smfmac_f32_16x16x64_bf16 v[120:123], v[52:55], a[240:247], v17
    s_waitcnt lgkmcnt(0)
    s_barrier
    ds_read_b64_tr_b16 v[88:89], v3 offset:0
    v_smfmac_f32_16x16x64_bf16 v[120:123], v[56:59], a[248:255], v17
    ds_read_b64_tr_b16 v[90:91], v3 offset:128
    v_add_f32 v116, v116, v117
    v_smfmac_f32_16x16x64_bf16 v[120:123], v[60:63], v[176:183], v17
    ds_read_b64_tr_b16 v[92:93], v3 offset:1024
    v_add_f32 v118, v118, v119
    v_smfmac_f32_16x16x64_bf16 v[120:123], v[64:67], v[184:191], v17
    ds_read_b64_tr_b16 v[94:95], v3 offset:1152
    v_cvt_pk_bf16_f32 v117, v116, v118
    v_smfmac_f32_16x16x64_bf16 v[120:123], v[68:71], v[192:199], v17
    ds_write_b32 v26, v117 offset:3072
    v_mov_b32 v113, 0
    v_smfmac_f32_16x16x64_bf16 v[124:127], v[44:47], v[200:207], v17
    ds_read_b64_tr_b16 v[96:97], v3 offset:2048
    v_mov_b32 v114, 0
    v_smfmac_f32_16x16x64_bf16 v[124:127], v[48:51], v[208:215], v17
    ds_read_b64_tr_b16 v[98:99], v3 offset:2176
    v_mov_b32 v115, 0
    v_smfmac_f32_16x16x64_bf16 v[124:127], v[52:55], v[216:223], v17
    v_add_f32 v120, v120, v121
    v_smfmac_f32_16x16x64_bf16 v[124:127], v[56:59], v[224:231], v17
    s_waitcnt lgkmcnt(2)
    s_barrier
    ds_read_b64_tr_b16 v[32:33], v27 offset:3072
    v_add_f32 v122, v122, v123
    v_smfmac_f32_16x16x64_bf16 v[124:127], v[60:63], v[232:239], v17
    ds_read_b64_tr_b16 v[34:35], v27 offset:3136
    v_cvt_pk_bf16_f32 v121, v120, v122
    v_smfmac_f32_16x16x64_bf16 v[124:127], v[64:67], v[240:247], v17
    ds_write_b32 v26, v121 offset:4096
    v_smfmac_f32_16x16x64_bf16 v[124:127], v[68:71], v[248:255], v17
    ds_read_b64_tr_b16 v[36:37], v27 offset:3584
    s_waitcnt lgkmcnt(4)
    v_smfmac_f32_16x16x64_bf16 v[104:107], v[88:91], v[128:135], v17
    ds_read_b64_tr_b16 v[38:39], v27 offset:3648
    v_smfmac_f32_16x16x64_bf16 v[104:107], v[92:95], v[136:143], v17
    s_nop 2
    v_add_f32 v124, v124, v125
    v_add_f32 v126, v126, v127
    v_cvt_pk_bf16_f32 v125, v124, v126
    v_smfmac_f32_16x16x64_bf16 v[104:107], v[96:99], v[144:151], v17
    ds_write_b32 v26, v125 offset:5120
    v_smfmac_f32_16x16x64_bf16 v[108:111], v[88:91], v[152:159], v17
    v_smfmac_f32_16x16x64_bf16 v[108:111], v[92:95], v[160:167], v17
    v_smfmac_f32_16x16x64_bf16 v[108:111], v[96:99], v[168:175], v17
    s_waitcnt lgkmcnt(0)
    s_barrier
    v_smfmac_f32_16x16x64_bf16 v[112:115], v[88:91], v[32:39], v17
    ds_read_b64_tr_b16 v[40:41], v27 offset:4096
    ds_read_b64_tr_b16 v[42:43], v27 offset:4160
    ds_read_b64_tr_b16 v[44:45], v27 offset:4608
    ds_read_b64_tr_b16 v[46:47], v27 offset:4672
    ds_read_b64_tr_b16 v[48:49], v27 offset:5120
    ds_read_b64_tr_b16 v[50:51], v27 offset:5184
    ds_read_b64_tr_b16 v[52:53], v27 offset:5632
    ds_read_b64_tr_b16 v[54:55], v27 offset:5696
    v_add_f32 v56, v104, v105
    v_add_f32 v57, v108, v109
    v_max_f32 v60, v56, v57
    s_nop 1
    v_max_f32_dpp v60, v60, v60 row_ror:8 row_mask:0xf bank_mask:0xf
    s_nop 1
    v_max_f32_dpp v60, v60, v60 row_ror:4 row_mask:0xf bank_mask:0xf
    s_waitcnt lgkmcnt(4)
    v_smfmac_f32_16x16x64_bf16 v[112:115], v[92:95], v[40:47], v17
    v_max_f32_dpp v60, v60, v60 row_ror:2 row_mask:0xf bank_mask:0xf
    s_waitcnt lgkmcnt(0)
    v_smfmac_f32_16x16x64_bf16 v[112:115], v[96:99], v[48:55], v17
    v_max_f32_dpp v60, v60, v60 row_ror:1 row_mask:0xf bank_mask:0xf
    v_mul_f32 v60, s40, v60
    v_fma_f32 v56, v56, s40, -v60
    v_fma_f32 v57, v57, s40, -v60
    v_exp_f32 v56, v56
    v_exp_f32 v57, v57
    s_nop 0
    v_add_f32 v62, v56, v57
    v_add_f32 v64, v112, v113
    v_mul_f32 v64, s40, v64
    v_max_f32 v68, v64, v60
    v_add_f32_dpp v62, v62, v62 row_ror:8 row_mask:0xf bank_mask:0xf
    s_nop 0
    v_max_f32_dpp v68, v68, v68 row_ror:4 row_mask:0xf bank_mask:0xf
    s_nop 1
    v_max_f32_dpp v68, v68, v68 row_ror:2 row_mask:0xf bank_mask:0xf
    s_nop 1
    v_max_f32_dpp v68, v68, v68 row_ror:1 row_mask:0xf bank_mask:0xf
    v_sub_f32 v66, v60, v68
    v_sub_f32 v64, v64, v68
    v_exp_f32 v66, v66
    v_exp_f32 v64, v64
    v_mul_f32 v56, v56, v66
    v_fma_f32 v62, v62, v66, v64
    v_mul_f32 v57, v57, v66
    s_nop 0
    v_add_f32_dpp v62, v62, v62 row_ror:4 row_mask:0xf bank_mask:0xf
    v_mov_b32_dpp v65, v64 quad_perm:[1,0,3,2] row_mask:0xf bank_mask:0xf
    s_nop 0
    v_add_f32_dpp v62, v62, v62 row_ror:2 row_mask:0xf bank_mask:0xf
    s_nop 1
    v_add_f32_dpp v62, v62, v62 row_ror:1 row_mask:0xf bank_mask:0xf
    v_rcp_f32 v62, v62
    s_nop 0
    v_mul_f32 v56, v56, v62
    v_mul_f32 v57, v57, v62
    v_cvt_pk_bf16_f32 v70, v56, v57
    v_mul_f32 v64, v64, v62
    v_mul_f32 v65, v65, v62
    buffer_store_dword v70, v30, s[8:11], s58 offen
    s_mov_b64 exec, s[38:39]
    v_cvt_pk_bf16_f32 v64, v64, v65
    buffer_store_dword v64, v31, s[8:11], s58 offen
    s_mov_b64 exec, -1
    s_add_u32 s50, s34, 2
    s_cmp_gt_u32 s50, 64
    s_cbranch_scc1 AKN_11
    s_cmp_ge_u32 s41, s50
    s_cbranch_scc1 FWD_13
    s_branch FW_12_go
FW_12:
    s_sleep 1
    s_sub_u32 s33, s33, 1
    s_cbranch_scc1 EXIT
FW_12_go:
    buffer_load_dword v4, v10, s[8:11], 0 offen sc1
    s_waitcnt vmcnt(0)
    v_cmp_gt_u32 vcc, s50, v4
    s_cbranch_vccnz FW_12
    s_mov_b32 s41, s50
    s_add_u32 s4, s50, 1
    v_cmp_gt_u32 vcc, s4, v4
    s_cbranch_vccnz FWD_13
    s_mov_b32 s41, s4
    s_add_u32 s4, s50, 3
    v_cmp_gt_u32 vcc, s4, v4
    s_cbranch_vccnz FWD_13
    s_mov_b32 s41, s4
    s_add_u32 s4, s50, 8
    v_cmp_gt_u32 vcc, s4, v4
    s_cbranch_vccnz FWD_13
    s_mov_b32 s41, s4
    s_add_u32 s4, s50, 20
    v_cmp_gt_u32 vcc, s4, v4
    s_cbranch_vccnz FWD_13
    s_mov_b32 s41, s4
FWD_13:
    s_add_u32 s49, s45, 1179648
    s_add_u32 s48, s49, 393216
    buffer_load_dwordx4 v[128:131], v28, s[8:11], s48 offen offset:0 sc1
    buffer_load_dwordx4 v[152:155], v29, s[8:11], s48 offen offset:0 sc1
    buffer_load_dwordx4 v[132:135], v28, s[8:11], s48 offen offset:2048 sc1
    buffer_load_dwordx4 v[156:159], v29, s[8:11], s48 offen offset:2048 sc1
    s_add_u32 s48, s48, 4096
    buffer_load_dwordx4 v[136:139], v28, s[8:11], s48 offen offset:0 sc1
    buffer_load_dwordx4 v[160:163], v29, s[8:11], s48 offen offset:0 sc1
    buffer_load_dwordx4 v[140:143], v28, s[8:11], s48 offen offset:2048 sc1
    buffer_load_dwordx4 v[164:167], v29, s[8:11], s48 offen offset:2048 sc1
    s_add_u32 s48, s48, 4096
    buffer_load_dwordx4 v[144:147], v28, s[8:11], s48 offen offset:0 sc1
    buffer_load_dwordx4 v[168:171], v29, s[8:11], s48 offen offset:0 sc1
    buffer_load_dwordx4 v[148:151], v28, s[8:11], s48 offen offset:2048 sc1
    buffer_load_dwordx4 v[172:175], v29, s[8:11], s48 offen offset:2048 sc1
AKN_11:
    s_add_u32 s45, s45, 1179648
    s_add_u32 s44, s44, 81920
    s_add_u32 s34, s34, 1
    s_cmp_lt_u32 s34, 64
    s_cbranch_scc1 A_LOOP
    s_branch A_END
.p2align 6
A_LOOP_1:
    ds_read_b128 v[72:75], v25 offset:0
    ds_read_b128 v[76:79], v25 offset:1024
    ds_read_b128 v[80:83], v25 offset:2048
    ds_read_b128 v[84:87], v25 offset:3072
    ds_read_b128 v[88:91], v25 offset:4096
    ds_read_b128 v[92:95], v25 offset:5120
    ds_read_b128 v[96:99], v25 offset:6144
    ds_read_b128 v[100:103], v25 offset:7168
    v_mov_b32 v104, 0
    v_mov_b32 v105, 0
    v_mov_b32 v106, 0
    v_mov_b32 v107, 0
    v_mov_b32 v108, 0
    v_mov_b32 v109, 0
    v_mov_b32 v110, 0
    v_mov_b32 v111, 0
    v_mov_b32 v112, 0
    v_mov_b32 v113, 0
    v_mov_b32 v114, 0
    v_mov_b32 v115, 0
    v_mov_b32 v116, 0
    v_mov_b32 v117, 0
    v_mov_b32 v118, 0
    v_mov_b32 v119, 0
    v_mov_b32 v120, 0
    v_mov_b32 v121, 0
    v_mov_b32 v122, 0
    v_mov_b32 v123, 0
    v_mov_b32 v124, 0
    v_mov_b32 v125, 0
    v_mov_b32 v126, 0
    v_mov_b32 v127, 0
    s_add_u32 s55, s34, 0
    s_and_b32 s55, s55, 3
    s_mul_i32 s55, s55, 10240
    s_add_u32 s55, s55, s57
    s_add_u32 s58, s34, 0
    s_and_b32 s58, s58, 3
    s_mul_i32 s58, s58, 5120
    s_add_u32 s58, s58, s57
    s_waitcnt lgkmcnt(0)
    s_add_u32 s51, s45, s42
QP_14:
    buffer_load_dwordx4 v[32:35], v12, s[8:11], s55 offen offset:0 sc1
    buffer_load_dwordx4 v[36:39], v12, s[8:11], s55 offen offset:1024 sc1
    buffer_load_dwordx4 v[40:43], v12, s[8:11], s55 offen offset:2048 sc1
    s_sub_u32 s33, s33, 1
    s_cbranch_scc1 EXIT
    s_waitcnt vmcnt(0)
    v_max3_u32 v4, v32, v36, v40
    v_cmp_eq_u32 vcc, -1, v4
    s_cbranch_vccnz QP_14
    v_smfmac_f32_16x16x64_bf16 v[104:107], v[32:35], a[0:7], v17
    ds_write_b128 v15, v[32:35] offset:0
    v_max3_u32 v4, v33, v34, v35
    v_smfmac_f32_16x16x64_bf16 v[108:111], v[32:35], v[72:79], v17
    ds_write_b128 v15, v[36:39] offset:1024
    v_max3_u32 v4, v4, v37, v38
    v_smfmac_f32_16x16x64_bf16 v[112:115], v[32:35], v[80:87], v17
    ds_write_b128 v15, v[40:43] offset:2048
    v_max3_u32 v4, v4, v39, v41
    v_smfmac_f32_16x16x64_bf16 v[116:119], v[32:35], a[8:15], v17
    ds_read_b128 v[72:75], v25 offset:8192
    v_max3_u32 v4, v4, v42, v43
    v_smfmac_f32_16x16x64_bf16 v[120:123], v[32:35], a[16:23], v17
    ds_read_b128 v[76:79], v25 offset:9216
    v_cmp_eq_u32 vcc, -1, v4
    v_smfmac_f32_16x16x64_bf16 v[124:127], v[32:35], v[88:95], v17
    ds_read_b128 v[80:83], v25 offset:10240
    v_smfmac_f32_16x16x64_bf16 v[104:107], v[36:39], a[24:31], v17
    ds_read_b128 v[84:87], v25 offset:11264
    v_smfmac_f32_16x16x64_bf16 v[108:111], v[36:39], a[32:39], v17
    ds_read_b128 v[88:91], v25 offset:12288
    v_smfmac_f32_16x16x64_bf16 v[112:115], v[36:39], a[40:47], v17
    s_cbranch_vccnz A_LOOP_1
    s_waitcnt lgkmcnt(5)
    s_barrier
    ds_read_b128 v[44:47], v18
    v_smfmac_f32_16x16x64_bf16 v[116:119], v[36:39], a[48:55], v17
    ds_read_b128 v[48:51], v19
    v_smfmac_f32_16x16x64_bf16 v[120:123], v[36:39], a[56:63], v17
    ds_read_b128 v[52:55], v20
    v_smfmac_f32_16x16x64_bf16 v[124:127], v[36:39], v[96:103], v17
    ds_read_b128 v[56:59], v21
    v_smfmac_f32_16x16x64_bf16 v[104:107], v[40:43], a[64:71], v17
    ds_read_b128 v[60:63], v22
    v_smfmac_f32_16x16x64_bf16 v[108:111], v[40:43], a[72:79], v17
    ds_read_b128 v[64:67], v23
    v_smfmac_f32_16x16x64_bf16 v[112:115], v[40:43], a[80:87], v17
    ds_read_b128 v[68:71], v24
    s_waitcnt lgkmcnt(10)
    v_smfmac_f32_16x16x64_bf16 v[116:119], v[40:43], v[72:79], v17
    ds_read_b128 v[92:95], v25 offset:13312
    v_smfmac_f32_16x16x64_bf16 v[120:123], v[40:43], a[88:95], v17
    ds_read_b128 v[96:99], v25 offset:14336
    v_smfmac_f32_16x16x64_bf16 v[124:127], v[40:43], a[96:103], v17
    ds_read_b128 v[100:103], v25 offset:15360
    s_waitcnt lgkmcnt(9)
    v_smfmac_f32_16x16x64_bf16 v[104:107], v[44:47], v[80:87], v17
    ds_read_b128 v[72:75], v25 offset:16384
    s_waitcnt lgkmcnt(9)
    v_smfmac_f32_16x16x64_bf16 v[104:107], v[48:51], a[104:111], v17
    ds_read_b128 v[76:79], v25 offset:17408
    s_waitcnt lgkmcnt(9)
    v_smfmac_f32_16x16x64_bf16 v[104:107], v[52:55], a[112:119], v17
    ds_read_b128 v[80:83], v25 offset:18432
    s_waitcnt lgkmcnt(5)
    v_smfmac_f32_16x16x64_bf16 v[104:107], v[56:59], v[88:95], v17
    ds_read_b128 v[84:87], v25 offset:19456
    v_smfmac_f32_16x16x64_bf16 v[104:107], v[60:63], a[120:127], v17
    ds_read_b128 v[88:91], v25 offset:20480
    s_waitcnt lgkmcnt(5)
    v_smfmac_f32_16x16x64_bf16 v[104:107], v[64:67], v[96:103], v17
    ds_read_b128 v[92:95], v25 offset:21504
    v_smfmac_f32_16x16x64_bf16 v[104:107], v[68:71], a[128:135], v17
    ds_read_b128 v[96:99], v25 offset:22528
    s_waitcnt lgkmcnt(5)
    v_smfmac_f32_16x16x64_bf16 v[108:111], v[44:47], v[72:79], v17
    ds_read_b128 v[100:103], v25 offset:23552
    v_smfmac_f32_16x16x64_bf16 v[108:111], v[48:51], a[136:143], v17
    ds_read_b128 v[72:75], v25 offset:24576
    s_waitcnt lgkmcnt(5)
    v_smfmac_f32_16x16x64_bf16 v[108:111], v[52:55], v[80:87], v17
    ds_read_b128 v[76:79], v25 offset:25600
    v_add_f32 v104, v104, v105
    v_smfmac_f32_16x16x64_bf16 v[108:111], v[56:59], a[144:151], v17
    ds_read_b128 v[80:83], v25 offset:26624
    s_waitcnt lgkmcnt(5)
    v_add_f32 v106, v106, v107
    v_smfmac_f32_16x16x64_bf16 v[108:111], v[60:63], v[88:95], v17
    ds_read_b128 v[84:87], v25 offset:27648
    v_cvt_pk_bf16_f32 v105, v104, v106
    v_smfmac_f32_16x16x64_bf16 v[108:111], v[64:67], a[152:159], v17
    ds_write_b16 v16, v105 offset:0
    v_smfmac_f32_16x16x64_bf16 v[108:111], v[68:71], a[160:167], v17
    ds_write_b16_d16_hi v16, v105 offset:4
    s_waitcnt lgkmcnt(4)
    v_smfmac_f32_16x16x64_bf16 v[112:115], v[44:47], a[168:175], v17
    ds_read_b128 v[88:91], v25 offset:28672
    v_mov_b32 v104, 0
    v_smfmac_f32_16x16x64_bf16 v[112:115], v[48:51], v[96:103], v17
    ds_read_b128 v[92:95], v25 offset:29696
    v_mov_b32 v105, 0
    v_smfmac_f32_16x16x64_bf16 v[112:115], v[52:55], a[176:183], v17
    ds_read_b128 v[96:99], v25 offset:30720
    v_add_f32 v108, v108, v109
    v_smfmac_f32_16x16x64_bf16 v[112:115], v[56:59], v[72:79], v17
    ds_read_b128 v[100:103], v25 offset:31744
    v_add_f32 v110, v110, v111
    v_smfmac_f32_16x16x64_bf16 v[112:115], v[60:63], a[184:191], v17
    ds_read_b128 v[72:75], v25 offset:32768
    v_cvt_pk_bf16_f32 v109, v108, v110
    v_smfmac_f32_16x16x64_bf16 v[112:115], v[64:67], a[192:199], v17
    ds_write_b16 v16, v109 offset:1024
    s_waitcnt lgkmcnt(8)
    v_mov_b32 v106, 0
    v_smfmac_f32_16x16x64_bf16 v[112:115], v[68:71], v[80:87], v17
    ds_write_b16_d16_hi v16, v109 offset:1028
    v_mov_b32 v107, 0
    v_smfmac_f32_16x16x64_bf16 v[116:119], v[44:47], a[200:207], v17
    ds_read_b128 v[76:79], v25 offset:33792
    v_mov_b32 v108, 0
    v_smfmac_f32_16x16x64_bf16 v[116:119], v[48:51], a[208:215], v17
    ds_read_b128 v[80:83], v25 offset:34816
    s_waitcnt lgkmcnt(7)
    v_mov_b32 v109, 0
    v_smfmac_f32_16x16x64_bf16 v[116:119], v[52:55], v[88:95], v17
    ds_read_b128 v[84:87], v25 offset:35840
    v_add_f32 v112, v112, v113
    v_smfmac_f32_16x16x64_bf16 v[116:119], v[56:59], a[216:223], v17
    s_waitcnt lgkmcnt(6)
    v_add_f32 v114, v114, v115
    v_smfmac_f32_16x16x64_bf16 v[116:119], v[60:63], v[96:103], v17
    v_cvt_pk_bf16_f32 v113, v112, v114
    v_smfmac_f32_16x16x64_bf16 v[116:119], v[64:67], a[224:231], v17
    ds_write_b16 v16, v113 offset:2048
    s_waitcnt lgkmcnt(3)
    v_mov_b32 v110, 0
    v_smfmac_f32_16x16x64_bf16 v[116:119], v[68:71], v[72:79], v17
    ds_write_b16_d16_hi v16, v113 offset:2052
    v_mov_b32 v111, 0
    v_smfmac_f32_16x16x64_bf16 v[120:123], v[44:47], a[232:239], v17
    s_waitcnt lgkmcnt(2)
    v_smfmac_f32_16x16x64_bf16 v[120:123], v[48:51], v[80:87], v17
    v_mov_b32 v112, 0
    v_smfmac_f32_16x16x64_bf16 v[120:123], v[52:55], a[240:247], v17
    s_waitcnt lgkmcnt(0)
    s_barrier
    ds_read_b64_tr_b16 v[88:89], v3 offset:0
    v_smfmac_f32_16x16x64_bf16 v[120:123], v[56:59], a[248:255], v17
    ds_read_b64_tr_b16 v[90:91], v3 offset:128
    v_add_f32 v116, v116, v117
    v_smfmac_f32_16x16x64_bf16 v[120:123], v[60:63], v[176:183], v17
    ds_read_b64_tr_b16 v[92:93], v3 offset:1024
    v_add_f32 v118, v118, v119
    v_smfmac_f32_16x16x64_bf16 v[120:123], v[64:67], v[184:191], v17
    ds_read_b64_tr_b16 v[94:95], v3 offset:1152
    v_cvt_pk_bf16_f32 v117, v116, v118
    v_smfmac_f32_16x16x64_bf16 v[120:123], v[68:71], v[192:199], v17
    ds_write_b32 v26, v117 offset:3072
    v_mov_b32 v113, 0
    v_smfmac_f32_16x16x64_bf16 v[124:127], v[44:47], v[200:207], v17
    ds_read_b64_tr_b16 v[96:97], v3 offset:2048
    v_mov_b32 v114, 0
    v_smfmac_f32_16x16x64_bf16 v[124:127], v[48:51], v[208:215], v17
    ds_read_b64_tr_b16 v[98:99], v3 offset:2176
    v_mov_b32 v115, 0
    v_smfmac_f32_16x16x64_bf16 v[124:127], v[52:55], v[216:223], v17
    v_add_f32 v120, v120, v121
    v_smfmac_f32_16x16x64_bf16 v[124:127], v[56:59], v[224:231], v17
    s_waitcnt lgkmcnt(2)
    s_barrier
    ds_read_b64_tr_b16 v[32:33], v27 offset:3072
    v_add_f32 v122, v122, v123
    v_smfmac_f32_16x16x64_bf16 v[124:127], v[60:63], v[232:239], v17
    ds_read_b64_tr_b16 v[34:35], v27 offset:3136
    v_cvt_pk_bf16_f32 v121, v120, v122
    v_smfmac_f32_16x16x64_bf16 v[124:127], v[64:67], v[240:247], v17
    ds_write_b32 v26, v121 offset:4096
    v_smfmac_f32_16x16x64_bf16 v[124:127], v[68:71], v[248:255], v17
    ds_read_b64_tr_b16 v[36:37], v27 offset:3584
    s_waitcnt lgkmcnt(4)
    v_smfmac_f32_16x16x64_bf16 v[104:107], v[88:91], v[128:135], v17
    ds_read_b64_tr_b16 v[38:39], v27 offset:3648
    v_smfmac_f32_16x16x64_bf16 v[104:107], v[92:95], v[136:143], v17
    s_nop 2
    v_add_f32 v124, v124, v125
    v_add_f32 v126, v126, v127
    v_cvt_pk_bf16_f32 v125, v124, v126
    v_smfmac_f32_16x16x64_bf16 v[104:107], v[96:99], v[144:151], v17
    ds_write_b32 v26, v125 offset:5120
    v_smfmac_f32_16x16x64_bf16 v[108:111], v[88:91], v[152:159], v17
    v_smfmac_f32_16x16x64_bf16 v[108:111], v[92:95], v[160:167], v17
    v_smfmac_f32_16x16x64_bf16 v[108:111], v[96:99], v[168:175], v17
    s_waitcnt lgkmcnt(0)
    s_barrier
    v_smfmac_f32_16x16x64_bf16 v[112:115], v[88:91], v[32:39], v17
    ds_read_b64_tr_b16 v[40:41], v27 offset:4096
    ds_read_b64_tr_b16 v[42:43], v27 offset:4160
    ds_read_b64_tr_b16 v[44:45], v27 offset:4608
    ds_read_b64_tr_b16 v[46:47], v27 offset:4672
    ds_read_b64_tr_b16 v[48:49], v27 offset:5120
    ds_read_b64_tr_b16 v[50:51], v27 offset:5184
    ds_read_b64_tr_b16 v[52:53], v27 offset:5632
    ds_read_b64_tr_b16 v[54:55], v27 offset:5696
    v_add_f32 v56, v106, v107
    v_add_f32 v57, v110, v111
    v_max_f32 v60, v56, v57
    s_nop 1
    v_max_f32_dpp v60, v60, v60 row_ror:8 row_mask:0xf bank_mask:0xf
    s_nop 1
    v_max_f32_dpp v60, v60, v60 row_ror:4 row_mask:0xf bank_mask:0xf
    s_waitcnt lgkmcnt(4)
    v_smfmac_f32_16x16x64_bf16 v[112:115], v[92:95], v[40:47], v17
    v_max_f32_dpp v60, v60, v60 row_ror:2 row_mask:0xf bank_mask:0xf
    s_waitcnt lgkmcnt(0)
    v_smfmac_f32_16x16x64_bf16 v[112:115], v[96:99], v[48:55], v17
    v_max_f32_dpp v60, v60, v60 row_ror:1 row_mask:0xf bank_mask:0xf
    v_mul_f32 v60, s40, v60
    v_fma_f32 v56, v56, s40, -v60
    v_fma_f32 v57, v57, s40, -v60
    v_exp_f32 v56, v56
    v_exp_f32 v57, v57
    s_nop 0
    v_add_f32 v62, v56, v57
    v_add_f32 v64, v114, v115
    v_mul_f32 v64, s40, v64
    v_max_f32 v68, v64, v60
    v_add_f32_dpp v62, v62, v62 row_ror:8 row_mask:0xf bank_mask:0xf
    s_nop 0
    v_max_f32_dpp v68, v68, v68 row_ror:4 row_mask:0xf bank_mask:0xf
    s_nop 1
    v_max_f32_dpp v68, v68, v68 row_ror:2 row_mask:0xf bank_mask:0xf
    s_nop 1
    v_max_f32_dpp v68, v68, v68 row_ror:1 row_mask:0xf bank_mask:0xf
    v_sub_f32 v66, v60, v68
    v_sub_f32 v64, v64, v68
    v_exp_f32 v66, v66
    v_exp_f32 v64, v64
    v_mul_f32 v56, v56, v66
    v_fma_f32 v62, v62, v66, v64
    v_mul_f32 v57, v57, v66
    s_nop 0
    v_add_f32_dpp v62, v62, v62 row_ror:4 row_mask:0xf bank_mask:0xf
    v_mov_b32_dpp v65, v64 quad_perm:[1,0,3,2] row_mask:0xf bank_mask:0xf
    s_nop 0
    v_add_f32_dpp v62, v62, v62 row_ror:2 row_mask:0xf bank_mask:0xf
    s_nop 1
    v_add_f32_dpp v62, v62, v62 row_ror:1 row_mask:0xf bank_mask:0xf
    v_rcp_f32 v62, v62
    s_nop 0
    v_mul_f32 v56, v56, v62
    v_mul_f32 v57, v57, v62
    v_cvt_pk_bf16_f32 v70, v56, v57
    v_mul_f32 v64, v64, v62
    v_mul_f32 v65, v65, v62
    buffer_store_dword v70, v30, s[8:11], s58 offen
    s_mov_b64 exec, s[38:39]
    v_cvt_pk_bf16_f32 v64, v64, v65
    buffer_store_dword v64, v31, s[8:11], s58 offen
    s_mov_b64 exec, -1
    s_add_u32 s50, s34, 2
    s_cmp_gt_u32 s50, 64
    s_cbranch_scc1 AKN_15
    s_cmp_ge_u32 s41, s50
    s_cbranch_scc1 FWD_17
    s_branch FW_16_go
FW_16:
    s_sleep 1
    s_sub_u32 s33, s33, 1
    s_cbranch_scc1 EXIT
FW_16_go:
    buffer_load_dword v4, v10, s[8:11], 0 offen sc1
    s_waitcnt vmcnt(0)
    v_cmp_gt_u32 vcc, s50, v4
    s_cbranch_vccnz FW_16
    s_mov_b32 s41, s50
    s_add_u32 s4, s50, 1
    v_cmp_gt_u32 vcc, s4, v4
    s_cbranch_vccnz FWD_17
    s_mov_b32 s41, s4
    s_add_u32 s4, s50, 3
    v_cmp_gt_u32 vcc, s4, v4
    s_cbranch_vccnz FWD_17
    s_mov_b32 s41, s4
    s_add_u32 s4, s50, 8
    v_cmp_gt_u32 vcc, s4, v4
    s_cbranch_vccnz FWD_17
    s_mov_b32 s41, s4
    s_add_u32 s4, s50, 20
    v_cmp_gt_u32 vcc, s4, v4
    s_cbranch_vccnz FWD_17
    s_mov_b32 s41, s4
FWD_17:
    s_add_u32 s49, s45, 1179648
    s_add_u32 s48, s49, 393216
    buffer_load_dwordx4 v[128:131], v28, s[8:11], s48 offen offset:0 sc1
    buffer_load_dwordx4 v[152:155], v29, s[8:11], s48 offen offset:0 sc1
    buffer_load_dwordx4 v[132:135], v28, s[8:11], s48 offen offset:2048 sc1
    buffer_load_dwordx4 v[156:159], v29, s[8:11], s48 offen offset:2048 sc1
    s_add_u32 s48, s48, 4096
    buffer_load_dwordx4 v[136:139], v28, s[8:11], s48 offen offset:0 sc1
    buffer_load_dwordx4 v[160:163], v29, s[8:11], s48 offen offset:0 sc1
    buffer_load_dwordx4 v[140:143], v28, s[8:11], s48 offen offset:2048 sc1
    buffer_load_dwordx4 v[164:167], v29, s[8:11], s48 offen offset:2048 sc1
    s_add_u32 s48, s48, 4096
    buffer_load_dwordx4 v[144:147], v28, s[8:11], s48 offen offset:0 sc1
    buffer_load_dwordx4 v[168:171], v29, s[8:11], s48 offen offset:0 sc1
    buffer_load_dwordx4 v[148:151], v28, s[8:11], s48 offen offset:2048 sc1
    buffer_load_dwordx4 v[172:175], v29, s[8:11], s48 offen offset:2048 sc1
AKN_15:
    s_add_u32 s45, s45, 1179648
    s_add_u32 s44, s44, 81920
    s_add_u32 s34, s34, 1
    s_cmp_lt_u32 s34, 64
    s_cbranch_scc1 A_LOOP_1
    s_branch A_END
.p2align 6
A_LOOP_S:
    ds_read_b128 v[72:75], v25 offset:0
    ds_read_b128 v[76:79], v25 offset:1024
    ds_read_b128 v[80:83], v25 offset:2048
    ds_read_b128 v[84:87], v25 offset:3072
    ds_read_b128 v[88:91], v25 offset:4096
    ds_read_b128 v[92:95], v25 offset:5120
    ds_read_b128 v[96:99], v25 offset:6144
    ds_read_b128 v[100:103], v25 offset:7168
    v_mov_b32 v104, 0
    v_mov_b32 v105, 0
    v_mov_b32 v106, 0
    v_mov_b32 v107, 0
    v_mov_b32 v108, 0
    v_mov_b32 v109, 0
    v_mov_b32 v110, 0
    v_mov_b32 v111, 0
    v_mov_b32 v112, 0
    v_mov_b32 v113, 0
    v_mov_b32 v114, 0
    v_mov_b32 v115, 0
    v_mov_b32 v116, 0
    v_mov_b32 v117, 0
    v_mov_b32 v118, 0
    v_mov_b32 v119, 0
    v_mov_b32 v120, 0
    v_mov_b32 v121, 0
    v_mov_b32 v122, 0
    v_mov_b32 v123, 0
    v_mov_b32 v124, 0
    v_mov_b32 v125, 0
    v_mov_b32 v126, 0
    v_mov_b32 v127, 0
    s_add_u32 s55, s34, 0
    s_and_b32 s55, s55, 3
    s_mul_i32 s55, s55, 10240
    s_add_u32 s55, s55, s57
    s_add_u32 s58, s34, 0
    s_and_b32 s58, s58, 3
    s_mul_i32 s58, s58, 5120
    s_add_u32 s58, s58, s57
    s_waitcnt lgkmcnt(0)
    s_add_u32 s51, s45, s42
QP_18:
    buffer_load_dwordx4 v[32:35], v12, s[8:11], s55 offen offset:0 sc1
    buffer_load_dwordx4 v[36:39], v12, s[8:11], s55 offen offset:1024 sc1
    buffer_load_dwordx4 v[40:43], v12, s[8:11], s55 offen offset:2048 sc1
    s_sub_u32 s33, s33, 1
    s_cbranch_scc1 EXIT
    s_waitcnt vmcnt(0)
    v_max3_u32 v4, v32, v36, v40
    v_cmp_eq_u32 vcc, -1, v4
    s_cbranch_vccnz QP_18
    v_smfmac_f32_16x16x64_bf16 v[104:107], v[32:35], a[0:7], v17
    ds_write_b128 v15, v[32:35] offset:0
    v_max3_u32 v4, v33, v34, v35
    v_smfmac_f32_16x16x64_bf16 v[108:111], v[32:35], v[72:79], v17
    ds_write_b128 v15, v[36:39] offset:1024
    v_max3_u32 v4, v4, v37, v38
    v_smfmac_f32_16x16x64_bf16 v[112:115], v[32:35], v[80:87], v17
    ds_write_b128 v15, v[40:43] offset:2048
    v_max3_u32 v4, v4, v39, v41
    v_smfmac_f32_16x16x64_bf16 v[116:119], v[32:35], a[8:15], v17
    ds_read_b128 v[72:75], v25 offset:8192
    v_max3_u32 v4, v4, v42, v43
    v_smfmac_f32_16x16x64_bf16 v[120:123], v[32:35], a[16:23], v17
    ds_read_b128 v[76:79], v25 offset:9216
    v_cmp_eq_u32 vcc, -1, v4
    v_smfmac_f32_16x16x64_bf16 v[124:127], v[32:35], v[88:95], v17
    ds_read_b128 v[80:83], v25 offset:10240
    v_smfmac_f32_16x16x64_bf16 v[104:107], v[36:39], a[24:31], v17
    ds_read_b128 v[84:87], v25 offset:11264
    v_smfmac_f32_16x16x64_bf16 v[108:111], v[36:39], a[32:39], v17
    ds_read_b128 v[88:91], v25 offset:12288
    v_smfmac_f32_16x16x64_bf16 v[112:115], v[36:39], a[40:47], v17
    s_cbranch_vccnz A_LOOP_S
    s_waitcnt lgkmcnt(5)
    s_barrier
    ds_read_b128 v[44:47], v18
    v_smfmac_f32_16x16x64_bf16 v[116:119], v[36:39], a[48:55], v17
    ds_read_b128 v[48:51], v19
    v_smfmac_f32_16x16x64_bf16 v[120:123], v[36:39], a[56:63], v17
    ds_read_b128 v[52:55], v20
    v_smfmac_f32_16x16x64_bf16 v[124:127], v[36:39], v[96:103], v17
    ds_read_b128 v[56:59], v21
    v_smfmac_f32_16x16x64_bf16 v[104:107], v[40:43], a[64:71], v17
    ds_read_b128 v[60:63], v22
    v_smfmac_f32_16x16x64_bf16 v[108:111], v[40:43], a[72:79], v17
    ds_read_b128 v[64:67], v23
    v_smfmac_f32_16x16x64_bf16 v[112:115], v[40:43], a[80:87], v17
    ds_read_b128 v[68:71], v24
    s_waitcnt lgkmcnt(10)
    v_smfmac_f32_16x16x64_bf16 v[116:119], v[40:43], v[72:79], v17
    ds_read_b128 v[92:95], v25 offset:13312
    v_smfmac_f32_16x16x64_bf16 v[120:123], v[40:43], a[88:95], v17
    ds_read_b128 v[96:99], v25 offset:14336
    v_smfmac_f32_16x16x64_bf16 v[124:127], v[40:43], a[96:103], v17
    ds_read_b128 v[100:103], v25 offset:15360
    s_waitcnt lgkmcnt(9)
    v_smfmac_f32_16x16x64_bf16 v[104:107], v[44:47], v[80:87], v17
    ds_read_b128 v[72:75], v25 offset:16384
    s_waitcnt lgkmcnt(9)
    v_smfmac_f32_16x16x64_bf16 v[104:107], v[48:51], a[104:111], v17
    ds_read_b128 v[76:79], v25 offset:17408
    s_waitcnt lgkmcnt(9)
    v_smfmac_f32_16x16x64_bf16 v[104:107], v[52:55], a[112:119], v17
    ds_read_b128 v[80:83], v25 offset:18432
    s_waitcnt lgkmcnt(5)
    v_smfmac_f32_16x16x64_bf16 v[104:107], v[56:59], v[88:95], v17
    ds_read_b128 v[84:87], v25 offset:19456
    v_smfmac_f32_16x16x64_bf16 v[104:107], v[60:63], a[120:127], v17
    ds_read_b128 v[88:91], v25 offset:20480
    s_waitcnt lgkmcnt(5)
    v_smfmac_f32_16x16x64_bf16 v[104:107], v[64:67], v[96:103], v17
    ds_read_b128 v[92:95], v25 offset:21504
    v_smfmac_f32_16x16x64_bf16 v[104:107], v[68:71], a[128:135], v17
    ds_read_b128 v[96:99], v25 offset:22528
    s_waitcnt lgkmcnt(5)
    v_smfmac_f32_16x16x64_bf16 v[108:111], v[44:47], v[72:79], v17
    ds_read_b128 v[100:103], v25 offset:23552
    v_smfmac_f32_16x16x64_bf16 v[108:111], v[48:51], a[136:143], v17
    ds_read_b128 v[72:75], v25 offset:24576
    s_waitcnt lgkmcnt(5)
    v_smfmac_f32_16x16x64_bf16 v[108:111], v[52:55], v[80:87], v17
    ds_read_b128 v[76:79], v25 offset:25600
    v_add_f32 v104, v104, v105
    v_smfmac_f32_16x16x64_bf16 v[108:111], v[56:59], a[144:151], v17
    ds_read_b128 v[80:83], v25 offset:26624
    s_waitcnt lgkmcnt(5)
    v_add_f32 v106, v106, v107
    v_smfmac_f32_16x16x64_bf16 v[108:111], v[60:63], v[88:95], v17
    ds_read_b128 v[84:87], v25 offset:27648
    v_cvt_pk_bf16_f32 v105, v104, v106
    v_smfmac_f32_16x16x64_bf16 v[108:111], v[64:67], a[152:159], v17
    ds_write_b16 v16, v105 offset:0
    v_smfmac_f32_16x16x64_bf16 v[108:111], v[68:71], a[160:167], v17
    ds_write_b16_d16_hi v16, v105 offset:4
    s_waitcnt lgkmcnt(4)
    v_smfmac_f32_16x16x64_bf16 v[112:115], v[44:47], a[168:175], v17
    ds_read_b128 v[88:91], v25 offset:28672
    v_mov_b32 v104, 0
    v_smfmac_f32_16x16x64_bf16 v[112:115], v[48:51], v[96:103], v17
    ds_read_b128 v[92:95], v25 offset:29696
    v_mov_b32 v105, 0
    v_smfmac_f32_16x16x64_bf16 v[112:115], v[52:55], a[176:183], v17
    ds_read_b128 v[96:99], v25 offset:30720
    v_add_f32 v108, v108, v109
    v_smfmac_f32_16x16x64_bf16 v[112:115], v[56:59], v[72:79], v17
    ds_read_b128 v[100:103], v25 offset:31744
    v_add_f32 v110, v110, v111
    v_smfmac_f32_16x16x64_bf16 v[112:115], v[60:63], a[184:191], v17
    ds_read_b128 v[72:75], v25 offset:32768
    v_cvt_pk_bf16_f32 v109, v108, v110
    v_smfmac_f32_16x16x64_bf16 v[112:115], v[64:67], a[192:199], v17
    ds_write_b16 v16, v109 offset:1024
    s_waitcnt lgkmcnt(8)
    v_mov_b32 v106, 0
    v_smfmac_f32_16x16x64_bf16 v[112:115], v[68:71], v[80:87], v17
    ds_write_b16_d16_hi v16, v109 offset:1028
    v_mov_b32 v107, 0
    v_smfmac_f32_16x16x64_bf16 v[116:119], v[44:47], a[200:207], v17
    ds_read_b128 v[76:79], v25 offset:33792
    v_mov_b32 v108, 0
    v_smfmac_f32_16x16x64_bf16 v[116:119], v[48:51], a[208:215], v17
    ds_read_b128 v[80:83], v25 offset:34816
    s_waitcnt lgkmcnt(7)
    v_mov_b32 v109, 0
    v_smfmac_f32_16x16x64_bf16 v[116:119], v[52:55], v[88:95], v17
    ds_read_b128 v[84:87], v25 offset:35840
    v_add_f32 v112, v112, v113
    v_smfmac_f32_16x16x64_bf16 v[116:119], v[56:59], a[216:223], v17
    s_waitcnt lgkmcnt(6)
    v_add_f32 v114, v114, v115
    v_smfmac_f32_16x16x64_bf16 v[116:119], v[60:63], v[96:103], v17
    v_cvt_pk_bf16_f32 v113, v112, v114
    v_smfmac_f32_16x16x64_bf16 v[116:119], v[64:67], a[224:231], v17
    ds_write_b16 v16, v113 offset:2048
    s_waitcnt lgkmcnt(3)
    v_mov_b32 v110, 0
    v_smfmac_f32_16x16x64_bf16 v[116:119], v[68:71], v[72:79], v17
    ds_write_b16_d16_hi v16, v113 offset:2052
    v_mov_b32 v111, 0
    v_smfmac_f32_16x16x64_bf16 v[120:123], v[44:47], a[232:239], v17
    s_waitcnt lgkmcnt(2)
    v_smfmac_f32_16x16x64_bf16 v[120:123], v[48:51], v[80:87], v17
    v_mov_b32 v112, 0
    v_smfmac_f32_16x16x64_bf16 v[120:123], v[52:55], a[240:247], v17
    s_waitcnt lgkmcnt(0)
    s_barrier
    ds_read_b64_tr_b16 v[88:89], v3 offset:0
    v_smfmac_f32_16x16x64_bf16 v[120:123], v[56:59], a[248:255], v17
    ds_read_b64_tr_b16 v[90:91], v3 offset:128
    v_add_f32 v116, v116, v117
    v_smfmac_f32_16x16x64_bf16 v[120:123], v[60:63], v[176:183], v17
    ds_read_b64_tr_b16 v[92:93], v3 offset:1024
    v_add_f32 v118, v118, v119
    v_smfmac_f32_16x16x64_bf16 v[120:123], v[64:67], v[184:191], v17
    ds_read_b64_tr_b16 v[94:95], v3 offset:1152
    v_cvt_pk_bf16_f32 v117, v116, v118
    v_smfmac_f32_16x16x64_bf16 v[120:123], v[68:71], v[192:199], v17
    ds_write_b32 v26, v117 offset:3072
    v_mov_b32 v113, 0
    v_smfmac_f32_16x16x64_bf16 v[124:127], v[44:47], v[200:207], v17
    ds_read_b64_tr_b16 v[96:97], v3 offset:2048
    v_mov_b32 v114, 0
    v_smfmac_f32_16x16x64_bf16 v[124:127], v[48:51], v[208:215], v17
    ds_read_b64_tr_b16 v[98:99], v3 offset:2176
    v_mov_b32 v115, 0
    v_smfmac_f32_16x16x64_bf16 v[124:127], v[52:55], v[216:223], v17
    v_add_f32 v120, v120, v121
    v_smfmac_f32_16x16x64_bf16 v[124:127], v[56:59], v[224:231], v17
    s_waitcnt lgkmcnt(2)
    s_barrier
    ds_read_b64_tr_b16 v[32:33], v27 offset:3072
    v_add_f32 v122, v122, v123
    v_smfmac_f32_16x16x64_bf16 v[124:127], v[60:63], v[232:239], v17
    ds_read_b64_tr_b16 v[34:35], v27 offset:3136
    v_cvt_pk_bf16_f32 v121, v120, v122
    v_smfmac_f32_16x16x64_bf16 v[124:127], v[64:67], v[240:247], v17
    ds_write_b32 v26, v121 offset:4096
    v_smfmac_f32_16x16x64_bf16 v[124:127], v[68:71], v[248:255], v17
    ds_read_b64_tr_b16 v[36:37], v27 offset:3584
    s_waitcnt lgkmcnt(4)
    v_smfmac_f32_16x16x64_bf16 v[104:107], v[88:91], v[128:135], v17
    ds_read_b64_tr_b16 v[38:39], v27 offset:3648
    v_smfmac_f32_16x16x64_bf16 v[104:107], v[92:95], v[136:143], v17
    s_nop 2
    v_add_f32 v124, v124, v125
    v_add_f32 v126, v126, v127
    v_cvt_pk_bf16_f32 v125, v124, v126
    v_smfmac_f32_16x16x64_bf16 v[104:107], v[96:99], v[144:151], v17
    ds_write_b32 v26, v125 offset:5120
    v_smfmac_f32_16x16x64_bf16 v[108:111], v[88:91], v[152:159], v17
    v_smfmac_f32_16x16x64_bf16 v[108:111], v[92:95], v[160:167], v17
    v_smfmac_f32_16x16x64_bf16 v[108:111], v[96:99], v[168:175], v17
    s_waitcnt lgkmcnt(0)
    s_barrier
    v_smfmac_f32_16x16x64_bf16 v[112:115], v[88:91], v[32:39], v17
    ds_read_b64_tr_b16 v[40:41], v27 offset:4096
    ds_read_b64_tr_b16 v[42:43], v27 offset:4160
    ds_read_b64_tr_b16 v[44:45], v27 offset:4608
    ds_read_b64_tr_b16 v[46:47], v27 offset:4672
    ds_read_b64_tr_b16 v[48:49], v27 offset:5120
    ds_read_b64_tr_b16 v[50:51], v27 offset:5184
    ds_read_b64_tr_b16 v[52:53], v27 offset:5632
    ds_read_b64_tr_b16 v[54:55], v27 offset:5696
    v_add_f32 v56, v104, v105
    v_add_f32 v58, v106, v107
    v_add_f32 v57, v108, v109
    v_add_f32 v59, v110, v111
    v_cndmask_b32 v56, v56, v58, s[36:37]
    v_cndmask_b32 v57, v57, v59, s[36:37]
    v_max_f32 v60, v56, v57
    s_waitcnt lgkmcnt(4)
    v_smfmac_f32_16x16x64_bf16 v[112:115], v[92:95], v[40:47], v17
    v_max_f32_dpp v60, v60, v60 row_ror:8 row_mask:0xf bank_mask:0xf
    s_waitcnt lgkmcnt(0)
    v_smfmac_f32_16x16x64_bf16 v[112:115], v[96:99], v[48:55], v17
    v_max_f32_dpp v60, v60, v60 row_ror:4 row_mask:0xf bank_mask:0xf
    s_nop 1
    v_max_f32_dpp v60, v60, v60 row_ror:2 row_mask:0xf bank_mask:0xf
    s_nop 1
    v_max_f32_dpp v60, v60, v60 row_ror:1 row_mask:0xf bank_mask:0xf
    v_mul_f32 v60, s40, v60
    v_add_f32 v64, v112, v113
    v_add_f32 v65, v114, v115
    v_fma_f32 v56, v56, s40, -v60
    v_cndmask_b32 v64, v64, v65, s[36:37]
    v_fma_f32 v57, v57, s40, -v60
    v_exp_f32 v56, v56
    v_exp_f32 v57, v57
    s_nop 0
    v_add_f32 v62, v56, v57
    v_mul_f32 v64, s40, v64
    v_max_f32 v68, v64, v60
    v_add_f32_dpp v62, v62, v62 row_ror:8 row_mask:0xf bank_mask:0xf
    s_nop 0
    v_max_f32_dpp v68, v68, v68 row_ror:4 row_mask:0xf bank_mask:0xf
    s_nop 1
    v_max_f32_dpp v68, v68, v68 row_ror:2 row_mask:0xf bank_mask:0xf
    s_nop 1
    v_max_f32_dpp v68, v68, v68 row_ror:1 row_mask:0xf bank_mask:0xf
    v_sub_f32 v66, v60, v68
    v_sub_f32 v64, v64, v68
    v_exp_f32 v66, v66
    v_exp_f32 v64, v64
    v_mul_f32 v56, v56, v66
    v_fma_f32 v62, v62, v66, v64
    v_mul_f32 v57, v57, v66
    s_nop 0
    v_add_f32_dpp v62, v62, v62 row_ror:4 row_mask:0xf bank_mask:0xf
    v_mov_b32_dpp v65, v64 quad_perm:[1,0,3,2] row_mask:0xf bank_mask:0xf
    s_nop 0
    v_add_f32_dpp v62, v62, v62 row_ror:2 row_mask:0xf bank_mask:0xf
    s_nop 1
    v_add_f32_dpp v62, v62, v62 row_ror:1 row_mask:0xf bank_mask:0xf
    v_rcp_f32 v62, v62
    s_nop 0
    v_mul_f32 v56, v56, v62
    v_mul_f32 v57, v57, v62
    v_cvt_pk_bf16_f32 v70, v56, v57
    v_mul_f32 v64, v64, v62
    v_mul_f32 v65, v65, v62
    buffer_store_dword v70, v30, s[8:11], s58 offen sc1
    s_mov_b64 exec, s[38:39]
    v_cvt_pk_bf16_f32 v64, v64, v65
    buffer_store_dword v64, v31, s[8:11], s58 offen sc1
    s_mov_b64 exec, -1
    s_add_u32 s50, s34, 2
    s_cmp_gt_u32 s50, 64
    s_cbranch_scc1 AKN_19
    s_cmp_ge_u32 s41, s50
    s_cbranch_scc1 FWD_21
    s_branch FW_20_go
FW_20:
    s_sleep 1
    s_sub_u32 s33, s33, 1
    s_cbranch_scc1 EXIT
FW_20_go:
    buffer_load_dword v4, v10, s[8:11], 0 offen sc1
    s_waitcnt vmcnt(0)
    v_cmp_gt_u32 vcc, s50, v4
    s_cbranch_vccnz FW_20
    s_mov_b32 s41, s50
    s_add_u32 s4, s50, 1
    v_cmp_gt_u32 vcc, s4, v4
    s_cbranch_vccnz FWD_21
    s_mov_b32 s41, s4
    s_add_u32 s4, s50, 3
    v_cmp_gt_u32 vcc, s4, v4
    s_cbranch_vccnz FWD_21
    s_mov_b32 s41, s4
    s_add_u32 s4, s50, 8
    v_cmp_gt_u32 vcc, s4, v4
    s_cbranch_vccnz FWD_21
    s_mov_b32 s41, s4
    s_add_u32 s4, s50, 20
    v_cmp_gt_u32 vcc, s4, v4
    s_cbranch_vccnz FWD_21
    s_mov_b32 s41, s4
FWD_21:
    s_add_u32 s49, s45, 1179648
    s_add_u32 s48, s49, 393216
    buffer_load_dwordx4 v[128:131], v28, s[8:11], s48 offen offset:0 sc1
    buffer_load_dwordx4 v[152:155], v29, s[8:11], s48 offen offset:0 sc1
    buffer_load_dwordx4 v[132:135], v28, s[8:11], s48 offen offset:2048 sc1
    buffer_load_dwordx4 v[156:159], v29, s[8:11], s48 offen offset:2048 sc1
    s_add_u32 s48, s48, 4096
    buffer_load_dwordx4 v[136:139], v28, s[8:11], s48 offen offset:0 sc1
    buffer_load_dwordx4 v[160:163], v29, s[8:11], s48 offen offset:0 sc1
    buffer_load_dwordx4 v[140:143], v28, s[8:11], s48 offen offset:2048 sc1
    buffer_load_dwordx4 v[164:167], v29, s[8:11], s48 offen offset:2048 sc1
    s_add_u32 s48, s48, 4096
    buffer_load_dwordx4 v[144:147], v28, s[8:11], s48 offen offset:0 sc1
    buffer_load_dwordx4 v[168:171], v29, s[8:11], s48 offen offset:0 sc1
    buffer_load_dwordx4 v[148:151], v28, s[8:11], s48 offen offset:2048 sc1
    buffer_load_dwordx4 v[172:175], v29, s[8:11], s48 offen offset:2048 sc1
AKN_19:
    s_add_u32 s45, s45, 1179648
    s_add_u32 s44, s44, 81920
    s_add_u32 s34, s34, 1
    s_cmp_lt_u32 s34, 64
    s_cbranch_scc1 A_LOOP_S
    s_branch A_END
.p2align 6
A_OTHER:
    ds_read_b128 v[72:75], v25 offset:0
    ds_read_b128 v[76:79], v25 offset:1024
    ds_read_b128 v[80:83], v25 offset:2048
    ds_read_b128 v[84:87], v25 offset:3072
    ds_read_b128 v[88:91], v25 offset:4096
    ds_read_b128 v[92:95], v25 offset:5120
    ds_read_b128 v[96:99], v25 offset:6144
    ds_read_b128 v[100:103], v25 offset:7168
    v_mov_b32 v104, 0
    v_mov_b32 v105, 0
    v_mov_b32 v106, 0
    v_mov_b32 v107, 0
    v_mov_b32 v108, 0
    v_mov_b32 v109, 0
    v_mov_b32 v110, 0
    v_mov_b32 v111, 0
    v_mov_b32 v112, 0
    v_mov_b32 v113, 0
    v_mov_b32 v114, 0
    v_mov_b32 v115, 0
    v_mov_b32 v116, 0
    v_mov_b32 v117, 0
    v_mov_b32 v118, 0
    v_mov_b32 v119, 0
    v_mov_b32 v120, 0
    v_mov_b32 v121, 0
    v_mov_b32 v122, 0
    v_mov_b32 v123, 0
    v_mov_b32 v124, 0
    v_mov_b32 v125, 0
    v_mov_b32 v126, 0
    v_mov_b32 v127, 0
    s_add_u32 s55, s34, 0
    s_and_b32 s55, s55, 3
    s_mul_i32 s55, s55, 10240
    s_add_u32 s55, s55, s57
    s_add_u32 s58, s34, 0
    s_and_b32 s58, s58, 3
    s_mul_i32 s58, s58, 5120
    s_add_u32 s58, s58, s57
    s_waitcnt lgkmcnt(0)
    s_add_u32 s51, s45, s42
QP_22:
    buffer_load_dwordx4 v[32:35], v12, s[8:11], s55 offen offset:0 sc1
    buffer_load_dwordx4 v[36:39], v12, s[8:11], s55 offen offset:1024 sc1
    buffer_load_dwordx4 v[40:43], v12, s[8:11], s55 offen offset:2048 sc1
    s_sub_u32 s33, s33, 1
    s_cbranch_scc1 EXIT
    s_waitcnt vmcnt(0)
    v_max3_u32 v4, v32, v36, v40
    v_cmp_eq_u32 vcc, -1, v4
    s_cbranch_vccnz QP_22
    v_smfmac_f32_16x16x64_bf16 v[104:107], v[32:35], a[0:7], v17
    ds_write_b128 v15, v[36:39] offset:1024
    v_max3_u32 v4, v33, v34, v35
    v_smfmac_f32_16x16x64_bf16 v[108:111], v[32:35], v[72:79], v17
    ds_write_b128 v15, v[40:43] offset:2048
    v_max3_u32 v4, v4, v37, v38
    v_smfmac_f32_16x16x64_bf16 v[112:115], v[32:35], v[80:87], v17
    ds_read_b128 v[72:75], v25 offset:8192
    v_max3_u32 v4, v4, v39, v41
    v_smfmac_f32_16x16x64_bf16 v[116:119], v[32:35], a[8:15], v17
    ds_read_b128 v[76:79], v25 offset:9216
    v_max3_u32 v4, v4, v42, v43
    v_smfmac_f32_16x16x64_bf16 v[120:123], v[32:35], a[16:23], v17
    ds_read_b128 v[80:83], v25 offset:10240
    v_cmp_eq_u32 vcc, -1, v4
    v_smfmac_f32_16x16x64_bf16 v[124:127], v[32:35], v[88:95], v17
    ds_read_b128 v[84:87], v25 offset:11264
    v_smfmac_f32_16x16x64_bf16 v[104:107], v[36:39], a[24:31], v17
    ds_read_b128 v[88:91], v25 offset:12288
    v_smfmac_f32_16x16x64_bf16 v[108:111], v[36:39], a[32:39], v17
    ds_read_b128 v[92:95], v25 offset:13312
    v_smfmac_f32_16x16x64_bf16 v[112:115], v[36:39], a[40:47], v17
    s_cbranch_vccnz A_OTHER
    s_waitcnt lgkmcnt(6)
    s_barrier
    ds_read_b128 v[44:47], v18
    v_smfmac_f32_16x16x64_bf16 v[116:119], v[36:39], a[48:55], v17
    ds_read_b128 v[48:51], v19
    v_smfmac_f32_16x16x64_bf16 v[120:123], v[36:39], a[56:63], v17
    ds_read_b128 v[52:55], v20
    v_smfmac_f32_16x16x64_bf16 v[124:127], v[36:39], v[96:103], v17
    ds_read_b128 v[56:59], v21
    v_smfmac_f32_16x16x64_bf16 v[104:107], v[40:43], a[64:71], v17
    ds_read_b128 v[60:63], v22
    v_smfmac_f32_16x16x64_bf16 v[108:111], v[40:43], a[72:79], v17
    ds_read_b128 v[64:67], v23
    v_smfmac_f32_16x16x64_bf16 v[112:115], v[40:43], a[80:87], v17
    ds_read_b128 v[68:71], v24
    s_waitcnt lgkmcnt(11)
    v_smfmac_f32_16x16x64_bf16 v[116:119], v[40:43], v[72:79], v17
    ds_read_b128 v[96:99], v25 offset:14336
    v_smfmac_f32_16x16x64_bf16 v[120:123], v[40:43], a[88:95], v17
    ds_read_b128 v[100:103], v25 offset:15360
    v_smfmac_f32_16x16x64_bf16 v[124:127], v[40:43], a[96:103], v17
    ds_read_b128 v[72:75], v25 offset:16384
    s_waitcnt lgkmcnt(9)
    v_smfmac_f32_16x16x64_bf16 v[104:107], v[44:47], v[80:87], v17
    ds_read_b128 v[76:79], v25 offset:17408
    s_waitcnt lgkmcnt(9)
    v_smfmac_f32_16x16x64_bf16 v[104:107], v[48:51], a[104:111], v17
    ds_read_b128 v[80:83], v25 offset:18432
    s_waitcnt lgkmcnt(9)
    v_smfmac_f32_16x16x64_bf16 v[104:107], v[52:55], a[112:119], v17
    ds_read_b128 v[84:87], v25 offset:19456
    s_waitcnt lgkmcnt(9)
    v_smfmac_f32_16x16x64_bf16 v[104:107], v[56:59], v[88:95], v17
    ds_read_b128 v[88:91], v25 offset:20480
    s_waitcnt lgkmcnt(9)
    v_smfmac_f32_16x16x64_bf16 v[104:107], v[60:63], a[120:127], v17
    ds_read_b128 v[92:95], v25 offset:21504
    s_waitcnt lgkmcnt(6)
    v_smfmac_f32_16x16x64_bf16 v[104:107], v[64:67], v[96:103], v17
    ds_read_b128 v[96:99], v25 offset:22528
    v_smfmac_f32_16x16x64_bf16 v[104:107], v[68:71], a[128:135], v17
    ds_read_b128 v[100:103], v25 offset:23552
    s_waitcnt lgkmcnt(6)
    v_smfmac_f32_16x16x64_bf16 v[108:111], v[44:47], v[72:79], v17
    ds_read_b128 v[72:75], v25 offset:24576
    v_smfmac_f32_16x16x64_bf16 v[108:111], v[48:51], a[136:143], v17
    ds_read_b128 v[76:79], v25 offset:25600
    s_waitcnt lgkmcnt(4)
    v_smfmac_f32_16x16x64_bf16 v[108:111], v[52:55], v[80:87], v17
    ds_read_b128 v[80:83], v25 offset:26624
    v_add_f32 v104, v104, v105
    v_smfmac_f32_16x16x64_bf16 v[108:111], v[56:59], a[144:151], v17
    ds_read_b128 v[84:87], v25 offset:27648
    v_add_f32 v106, v106, v107
    v_smfmac_f32_16x16x64_bf16 v[108:111], v[60:63], v[88:95], v17
    ds_read_b128 v[88:91], v25 offset:28672
    v_cvt_pk_bf16_f32 v105, v104, v106
    v_smfmac_f32_16x16x64_bf16 v[108:111], v[64:67], a[152:159], v17
    ds_write_b16 v16, v105 offset:0
    v_smfmac_f32_16x16x64_bf16 v[108:111], v[68:71], a[160:167], v17
    ds_write_b16_d16_hi v16, v105 offset:4
    v_smfmac_f32_16x16x64_bf16 v[112:115], v[44:47], a[168:175], v17
    ds_read_b128 v[92:95], v25 offset:29696
    s_waitcnt lgkmcnt(8)
    v_smfmac_f32_16x16x64_bf16 v[112:115], v[48:51], v[96:103], v17
    s_add_u32 s48, s45, 0
    buffer_load_dwordx4 v[32:35], v3, s[8:11], s48 offen offset:0 sc1
    ds_read_b128 v[96:99], v25 offset:30720
    s_waitcnt lgkmcnt(7)
    v_smfmac_f32_16x16x64_bf16 v[112:115], v[52:55], a[176:183], v17
    ds_read_b128 v[100:103], v25 offset:31744
    v_add_f32 v108, v108, v109
    v_smfmac_f32_16x16x64_bf16 v[112:115], v[56:59], v[72:79], v17
    ds_read_b128 v[72:75], v25 offset:32768
    v_add_f32 v110, v110, v111
    v_smfmac_f32_16x16x64_bf16 v[112:115], v[60:63], a[184:191], v17
    buffer_load_dwordx4 v[36:39], v3, s[8:11], s48 offen offset:2048 sc1
    ds_read_b128 v[76:79], v25 offset:33792
    v_cvt_pk_bf16_f32 v109, v108, v110
    v_smfmac_f32_16x16x64_bf16 v[112:115], v[64:67], a[192:199], v17
    ds_write_b16 v16, v109 offset:1024
    s_waitcnt lgkmcnt(9)
    v_smfmac_f32_16x16x64_bf16 v[112:115], v[68:71], v[80:87], v17
    ds_write_b16_d16_hi v16, v109 offset:1028
    v_smfmac_f32_16x16x64_bf16 v[116:119], v[44:47], a[200:207], v17
    s_add_u32 s48, s45, 4096
    buffer_load_dwordx4 v[40:43], v3, s[8:11], s48 offen offset:0 sc1
    ds_read_b128 v[80:83], v25 offset:34816
    v_smfmac_f32_16x16x64_bf16 v[116:119], v[48:51], a[208:215], v17
    buffer_load_dwordx4 v[104:107], v3, s[8:11], s48 offen offset:2048 sc1
    ds_read_b128 v[84:87], v25 offset:35840
    s_waitcnt lgkmcnt(6)
    v_smfmac_f32_16x16x64_bf16 v[116:119], v[52:55], v[88:95], v17
    v_add_f32 v112, v112, v113
    v_smfmac_f32_16x16x64_bf16 v[116:119], v[56:59], a[216:223], v17
    v_add_f32 v114, v114, v115
    v_smfmac_f32_16x16x64_bf16 v[116:119], v[60:63], v[96:103], v17
    v_cvt_pk_bf16_f32 v113, v112, v114
    v_smfmac_f32_16x16x64_bf16 v[116:119], v[64:67], a[224:231], v17
    s_add_u32 s48, s45, 8192
    buffer_load_dwordx4 v[108:111], v3, s[8:11], s48 offen offset:0 sc1
    ds_write_b16 v16, v113 offset:2048
    s_waitcnt lgkmcnt(5)
    v_smfmac_f32_16x16x64_bf16 v[116:119], v[68:71], v[72:79], v17
    ds_write_b16_d16_hi v16, v113 offset:2052
    v_smfmac_f32_16x16x64_bf16 v[120:123], v[44:47], a[232:239], v17
    s_waitcnt lgkmcnt(2)
    v_smfmac_f32_16x16x64_bf16 v[120:123], v[48:51], v[80:87], v17
    buffer_load_dwordx4 v[112:115], v3, s[8:11], s48 offen offset:2048 sc1
    v_smfmac_f32_16x16x64_bf16 v[120:123], v[52:55], a[240:247], v17
    s_waitcnt lgkmcnt(0)
    s_barrier
    v_smfmac_f32_16x16x64_bf16 v[120:123], v[56:59], a[248:255], v17
    v_add_f32 v116, v116, v117
    v_smfmac_f32_16x16x64_bf16 v[120:123], v[60:63], v[176:183], v17
    v_add_f32 v118, v118, v119
    v_smfmac_f32_16x16x64_bf16 v[120:123], v[64:67], v[184:191], v17
    v_cvt_pk_bf16_f32 v117, v116, v118
    v_smfmac_f32_16x16x64_bf16 v[120:123], v[68:71], v[192:199], v17
    ds_write_b32 v26, v117 offset:3072
    v_smfmac_f32_16x16x64_bf16 v[124:127], v[44:47], v[200:207], v17
    v_smfmac_f32_16x16x64_bf16 v[124:127], v[48:51], v[208:215], v17
    v_smfmac_f32_16x16x64_bf16 v[124:127], v[52:55], v[216:223], v17
    s_nop 3
    v_add_f32 v120, v120, v121
    v_smfmac_f32_16x16x64_bf16 v[124:127], v[56:59], v[224:231], v17
    s_waitcnt lgkmcnt(0)
    s_barrier
    v_add_f32 v122, v122, v123
    v_smfmac_f32_16x16x64_bf16 v[124:127], v[60:63], v[232:239], v17
    v_cvt_pk_bf16_f32 v121, v120, v122
    v_smfmac_f32_16x16x64_bf16 v[124:127], v[64:67], v[240:247], v17
    ds_write_b32 v26, v121 offset:4096
    v_smfmac_f32_16x16x64_bf16 v[124:127], v[68:71], v[248:255], v17
    s_nop 7
    v_add_f32 v124, v124, v125
    v_add_f32 v126, v126, v127
    v_cvt_pk_bf16_f32 v125, v124, v126
    ds_write_b32 v26, v125 offset:5120
    s_waitcnt lgkmcnt(0)
    s_barrier
    s_add_u32 s50, s34, 1
    s_cmp_ge_u32 s59, s50
    s_cbranch_scc1 AQ_23
    v_subrev_u32 v71, 4096, v10
    s_cmp_ge_u32 s59, s50
    s_cbranch_scc1 FWD_25
    s_branch FW_24_go
FW_24:
    s_sleep 2
    s_sub_u32 s33, s33, 1
    s_cbranch_scc1 EXIT
FW_24_go:
    buffer_load_dword v4, v71, s[8:11], 0 offen sc1
    s_waitcnt vmcnt(0)
    v_cmp_gt_u32 vcc, s50, v4
    s_cbranch_vccnz FW_24
    s_mov_b32 s59, s50
    s_add_u32 s4, s50, 1
    v_cmp_gt_u32 vcc, s4, v4
    s_cbranch_vccnz FWD_25
    s_mov_b32 s59, s4
    s_add_u32 s4, s50, 3
    v_cmp_gt_u32 vcc, s4, v4
    s_cbranch_vccnz FWD_25
    s_mov_b32 s59, s4
    s_add_u32 s4, s50, 8
    v_cmp_gt_u32 vcc, s4, v4
    s_cbranch_vccnz FWD_25
    s_mov_b32 s59, s4
    s_add_u32 s4, s50, 20
    v_cmp_gt_u32 vcc, s4, v4
    s_cbranch_vccnz FWD_25
    s_mov_b32 s59, s4
FWD_25:
    s_add_u32 s48, s45, 0
    buffer_load_dwordx4 v[32:35], v3, s[8:11], s48 offen offset:0 sc1
    buffer_load_dwordx4 v[36:39], v3, s[8:11], s48 offen offset:2048 sc1
    s_add_u32 s48, s45, 4096
    buffer_load_dwordx4 v[40:43], v3, s[8:11], s48 offen offset:0 sc1
    buffer_load_dwordx4 v[104:107], v3, s[8:11], s48 offen offset:2048 sc1
    s_add_u32 s48, s45, 8192
    buffer_load_dwordx4 v[108:111], v3, s[8:11], s48 offen offset:0 sc1
    buffer_load_dwordx4 v[112:115], v3, s[8:11], s48 offen offset:2048 sc1
AQ_23:
    v_mov_b32 v4, s34
    s_waitcnt vmcnt(6)
    s_mov_b64 exec, 1
    buffer_store_dword v4, off, s[8:11], s43 sc1
    s_mov_b64 exec, -1
    ds_read_b64_tr_b16 v[72:73], v27 offset:3072
    ds_read_b64_tr_b16 v[74:75], v27 offset:3136
    ds_read_b64_tr_b16 v[76:77], v27 offset:3584
    ds_read_b64_tr_b16 v[78:79], v27 offset:3648
    ds_read_b64_tr_b16 v[80:81], v27 offset:4096
    ds_read_b64_tr_b16 v[82:83], v27 offset:4160
    ds_read_b64_tr_b16 v[84:85], v27 offset:4608
    ds_read_b64_tr_b16 v[86:87], v27 offset:4672
    ds_read_b64_tr_b16 v[88:89], v27 offset:5120
    ds_read_b64_tr_b16 v[90:91], v27 offset:5184
    ds_read_b64_tr_b16 v[92:93], v27 offset:5632
    ds_read_b64_tr_b16 v[94:95], v27 offset:5696
    s_waitcnt vmcnt(1) lgkmcnt(0)
    v_mfma_f32_16x16x32_bf16 v[116:119], v[128:131], v[32:35], 0
    v_mfma_f32_16x16x32_bf16 v[120:123], v[152:155], v[32:35], 0
    v_mfma_f32_16x16x32_bf16 v[124:127], v[72:75], v[32:35], 0
    v_mfma_f32_16x16x32_bf16 v[116:119], v[132:135], v[36:39], v[116:119]
    v_mfma_f32_16x16x32_bf16 v[120:123], v[156:159], v[36:39], v[120:123]
    v_mfma_f32_16x16x32_bf16 v[124:127], v[76:79], v[36:39], v[124:127]
    v_mfma_f32_16x16x32_bf16 v[116:119], v[136:139], v[40:43], v[116:119]
    v_mfma_f32_16x16x32_bf16 v[120:123], v[160:163], v[40:43], v[120:123]
    v_mfma_f32_16x16x32_bf16 v[124:127], v[80:83], v[40:43], v[124:127]
    v_mfma_f32_16x16x32_bf16 v[116:119], v[140:143], v[104:107], v[116:119]
    v_mfma_f32_16x16x32_bf16 v[120:123], v[164:167], v[104:107], v[120:123]
    v_mfma_f32_16x16x32_bf16 v[124:127], v[84:87], v[104:107], v[124:127]
    v_mfma_f32_16x16x32_bf16 v[116:119], v[144:147], v[108:111], v[116:119]
    v_mfma_f32_16x16x32_bf16 v[120:123], v[168:171], v[108:111], v[120:123]
    v_mfma_f32_16x16x32_bf16 v[124:127], v[88:91], v[108:111], v[124:127]
    v_mfma_f32_16x16x32_bf16 v[116:119], v[148:151], v[112:115], v[116:119]
    v_mfma_f32_16x16x32_bf16 v[120:123], v[172:175], v[112:115], v[120:123]
    v_mfma_f32_16x16x32_bf16 v[124:127], v[92:95], v[112:115], v[124:127]
    s_add_u32 s50, s34, 2
    s_cmp_gt_u32 s50, 64
    s_cbranch_scc1 AKN_26
    s_cmp_ge_u32 s41, s50
    s_cbranch_scc1 FWD_28
    s_branch FW_27_go
FW_27:
    s_sleep 1
    s_sub_u32 s33, s33, 1
    s_cbranch_scc1 EXIT
FW_27_go:
    buffer_load_dword v4, v10, s[8:11], 0 offen sc1
    s_waitcnt vmcnt(0)
    v_cmp_gt_u32 vcc, s50, v4
    s_cbranch_vccnz FW_27
    s_mov_b32 s41, s50
    s_add_u32 s4, s50, 1
    v_cmp_gt_u32 vcc, s4, v4
    s_cbranch_vccnz FWD_28
    s_mov_b32 s41, s4
    s_add_u32 s4, s50, 3
    v_cmp_gt_u32 vcc, s4, v4
    s_cbranch_vccnz FWD_28
    s_mov_b32 s41, s4
    s_add_u32 s4, s50, 8
    v_cmp_gt_u32 vcc, s4, v4
    s_cbranch_vccnz FWD_28
    s_mov_b32 s41, s4
    s_add_u32 s4, s50, 20
    v_cmp_gt_u32 vcc, s4, v4
    s_cbranch_vccnz FWD_28
    s_mov_b32 s41, s4
FWD_28:
    s_add_u32 s49, s45, 1179648
    s_add_u32 s48, s49, 393216
    buffer_load_dwordx4 v[128:131], v28, s[8:11], s48 offen offset:0 sc1
    buffer_load_dwordx4 v[152:155], v29, s[8:11], s48 offen offset:0 sc1
    buffer_load_dwordx4 v[132:135], v28, s[8:11], s48 offen offset:2048 sc1
    buffer_load_dwordx4 v[156:159], v29, s[8:11], s48 offen offset:2048 sc1
    s_add_u32 s48, s48, 4096
    buffer_load_dwordx4 v[136:139], v28, s[8:11], s48 offen offset:0 sc1
    buffer_load_dwordx4 v[160:163], v29, s[8:11], s48 offen offset:0 sc1
    buffer_load_dwordx4 v[140:143], v28, s[8:11], s48 offen offset:2048 sc1
    buffer_load_dwordx4 v[164:167], v29, s[8:11], s48 offen offset:2048 sc1
    s_add_u32 s48, s48, 4096
    buffer_load_dwordx4 v[144:147], v28, s[8:11], s48 offen offset:0 sc1
    buffer_load_dwordx4 v[168:171], v29, s[8:11], s48 offen offset:0 sc1
    buffer_load_dwordx4 v[148:151], v28, s[8:11], s48 offen offset:2048 sc1
    buffer_load_dwordx4 v[172:175], v29, s[8:11], s48 offen offset:2048 sc1
AKN_26:
    v_mov_b32 v65, 0xf149f2ca
    v_cmp_gt_i32 vcc, 0, v11
    s_nop 1
    v_cndmask_b32 v116, v116, v65, vcc
    v_cmp_gt_i32 vcc, 1, v11
    s_nop 1
    v_cndmask_b32 v117, v117, v65, vcc
    v_cmp_gt_i32 vcc, 2, v11
    s_nop 1
    v_cndmask_b32 v118, v118, v65, vcc
    v_cmp_gt_i32 vcc, 3, v11
    s_nop 1
    v_cndmask_b32 v119, v119, v65, vcc
    v_cmp_gt_i32 vcc, 4, v11
    s_nop 1
    v_cndmask_b32 v120, v120, v65, vcc
    v_cmp_gt_i32 vcc, 5, v11
    s_nop 1
    v_cndmask_b32 v121, v121, v65, vcc
    v_cmp_gt_i32 vcc, 6, v11
    s_nop 1
    v_cndmask_b32 v122, v122, v65, vcc
    v_cmp_gt_i32 vcc, 7, v11
    s_nop 1
    v_cndmask_b32 v123, v123, v65, vcc
    v_max3_f32 v62, v116, v117, v118
    v_max3_f32 v62, v62, v119, v120
    v_max3_f32 v62, v62, v121, v122
    v_max3_f32 v62, v62, v123, v124
    v_max3_f32 v62, v62, v125, v126
    v_max_f32 v62, v62, v127
    v_mov_b32 v63, v62
    s_nop 1
    v_permlane16_swap_b32 v62, v63
    v_max_f32 v62, v62, v63
    v_mov_b32 v63, v62
    s_nop 1
    v_permlane32_swap_b32 v62, v63
    v_max_f32 v62, v62, v63
    v_mul_f32 v62, s40, v62
    v_fma_f32 v116, v116, s40, -v62
    v_fma_f32 v117, v117, s40, -v62
    v_fma_f32 v118, v118, s40, -v62
    v_fma_f32 v119, v119, s40, -v62
    v_fma_f32 v120, v120, s40, -v62
    v_fma_f32 v121, v121, s40, -v62
    v_fma_f32 v122, v122, s40, -v62
    v_fma_f32 v123, v123, s40, -v62
    v_fma_f32 v124, v124, s40, -v62
    v_fma_f32 v125, v125, s40, -v62
    v_fma_f32 v126, v126, s40, -v62
    v_fma_f32 v127, v127, s40, -v62
    v_exp_f32 v116, v116
    v_exp_f32 v117, v117
    v_exp_f32 v118, v118
    v_exp_f32 v119, v119
    v_exp_f32 v120, v120
    v_exp_f32 v121, v121
    v_exp_f32 v122, v122
    v_exp_f32 v123, v123
    v_exp_f32 v124, v124
    v_exp_f32 v125, v125
    v_exp_f32 v126, v126
    v_exp_f32 v127, v127
    v_add_f32 v64, v124, v125
    v_add_f32 v64, v64, v126
    v_add_f32 v64, v64, v127
    v_mul_f32 v64, 0.5, v64
    v_add_f32 v64, v64, v116
    v_add_f32 v64, v64, v117
    v_add_f32 v64, v64, v118
    v_add_f32 v64, v64, v119
    v_add_f32 v64, v64, v120
    v_add_f32 v64, v64, v121
    v_add_f32 v64, v64, v122
    v_add_f32 v64, v64, v123
    v_mov_b32 v63, v64
    s_nop 1
    v_permlane16_swap_b32 v64, v63
    v_add_f32 v64, v64, v63
    v_mov_b32 v63, v64
    s_nop 1
    v_permlane32_swap_b32 v64, v63
    v_add_f32 v64, v64, v63
    v_rcp_f32 v64, v64
    s_nop 0
    v_mul_f32 v116, v116, v64
    v_mul_f32 v117, v117, v64
    v_mul_f32 v118, v118, v64
    v_mul_f32 v119, v119, v64
    v_mul_f32 v120, v120, v64
    v_mul_f32 v121, v121, v64
    v_mul_f32 v122, v122, v64
    v_mul_f32 v123, v123, v64
    v_mul_f32 v124, v124, v64
    v_mul_f32 v125, v125, v64
    v_mul_f32 v126, v126, v64
    v_mul_f32 v127, v127, v64
    v_cvt_pk_bf16_f32 v56, v116, v120
    v_cvt_pk_bf16_f32 v57, v117, v121
    v_cvt_pk_bf16_f32 v58, v118, v122
    v_cvt_pk_bf16_f32 v59, v119, v123
    v_cvt_pk_bf16_f32 v60, v124, v125
    v_cvt_pk_bf16_f32 v61, v126, v127
    buffer_store_dwordx4 v[56:59], v30, s[8:11], s44 offen sc1
    s_mov_b32 exec_hi, 0
    buffer_store_dwordx2 v[60:61], v31, s[8:11], s44 offen sc1
    s_mov_b32 exec_hi, -1
    s_mov_b32 s60, s44
    s_cmp_lg_u32 s34, 62
    s_cbranch_scc1 A_NFE
    v_mov_b32 v4, 63
    s_waitcnt vmcnt(0)
    s_mov_b64 exec, 1
    buffer_store_dword v4, off, s[8:11], s43 sc1
    s_mov_b64 exec, -1
A_NFE:
    s_add_u32 s45, s45, 1179648
    s_add_u32 s44, s44, 81920
    s_add_u32 s34, s34, 1
    s_cmp_lt_u32 s34, 64
    s_cbranch_scc1 A_OTHER
    s_waitcnt vmcnt(0)
    v_mov_b32 v4, s34
    s_mov_b64 exec, 1
    buffer_store_dword v4, off, s[8:11], s43 sc1
A_END:
    s_endpgm
.p2align 6
ROLE_R:
    s_load_dwordx2 s[40:41], s[0:1], 8
    s_and_b32 s56, s52, 3
    s_waitcnt lgkmcnt(0)
    s_mov_b32 s16, s40
    s_mov_b32 s17, s41
    s_mov_b32 s18, 10240
    s_mov_b32 s19, 0x20000
    s_and_b32 s35, s2, 0xfc
    s_add_u32 s35, s35, s32
    s_lshl_b32 s57, s56, 16
    s_add_u32 s57, s57, 2097152
    v_mov_b32 v8, -1
    v_mov_b32 v9, -1
    v_mov_b32 v10, -1
    v_mov_b32 v11, -1
    v_lshlrev_b32 v6, 4, v0
    v_lshlrev_b32 v3, 4, v2
    v_lshrrev_b32 v12, 3, v2
    v_mul_u32_u24 v12, 1280, v12
    v_and_b32 v13, 7, v2
    v_lshl_add_u32 v12, v13, 1, v12
    s_lshr_b32 s46, s35, 1
    s_lshl_b32 s46, s46, 6
    s_and_b32 s47, s35, 1
    s_lshl_b32 s47, s47, 4
    s_add_u32 s46, s46, s47
    buffer_load_ushort v16, v12, s[16:19], s46 offen
    buffer_load_ushort v17, v12, s[16:19], s46 offen offset:32
    s_lshl_b32 s46, s2, 12
R_FILL:
    buffer_store_dwordx4 v[8:11], v6, s[8:11], s46 offen sc1
    s_add_u32 s46, s46, 163840
    s_cmp_lt_u32 s46, 655360
    s_cbranch_scc1 R_FILL
    s_lshl_b32 s46, s2, 12
    s_add_u32 s46, s46, 2359296
R_FILL2:
    buffer_store_dwordx4 v[8:11], v6, s[8:11], s46 offen sc1
    s_add_u32 s46, s46, 163840
    s_cmp_lt_u32 s46, 3407872
    s_cbranch_scc1 R_FILL2
    s_mul_i32 s46, s2, 40960
    s_add_u32 s46, s46, 83918848
    buffer_store_dwordx4 v[8:11], v6, s[8:11], s46 offen sc1
    s_add_u32 s46, s46, 4096
    buffer_store_dwordx4 v[8:11], v6, s[8:11], s46 offen sc1
    s_lshl_b32 s38, s35, 8
    s_add_u32 s38, s38, s57
    s_lshl_b32 s37, s35, 7
    s_add_u32 s37, s37, s57
    s_add_u32 s37, s37, 40960
    s_mov_b64 exec, 0xffff
    s_add_u32 s46, s38, 10240
    buffer_store_dwordx4 v[8:11], v3, s[8:11], s46 offen sc1
    s_add_u32 s46, s38, 20480
    buffer_store_dwordx4 v[8:11], v3, s[8:11], s46 offen sc1
    s_add_u32 s46, s38, 30720
    buffer_store_dwordx4 v[8:11], v3, s[8:11], s46 offen sc1
    s_mov_b64 exec, -1
    s_waitcnt vmcnt(0)
    v_lshl_or_b32 v16, v17, 16, v16
    v_min_u32 v16, -2, v16
    v_lshlrev_b32 v17, 2, v2
    buffer_store_dword v16, v17, s[8:11], s38 offen sc1
    s_mov_b64 exec, 0xff
    s_add_u32 s46, s37, 0
    buffer_store_dwordx4 v[8:11], v3, s[8:11], s46 offen sc1
    s_add_u32 s46, s37, 5120
    buffer_store_dwordx4 v[8:11], v3, s[8:11], s46 offen sc1
    s_add_u32 s46, s37, 10240
    buffer_store_dwordx4 v[8:11], v3, s[8:11], s46 offen sc1
    s_add_u32 s46, s37, 15360
    buffer_store_dwordx4 v[8:11], v3, s[8:11], s46 offen sc1
    s_mov_b64 exec, -1
    s_cmp_ge_u32 s2, 16
    s_cbranch_scc1 R_I4
    v_mov_b32 v20, 0
    v_mov_b32 v21, 0
    v_mov_b32 v22, 0
    v_mov_b32 v23, 0
    s_lshl_b32 s46, s2, 12
    s_add_u32 s46, s46, 4194304
    buffer_store_dwordx4 v[20:23], v6, s[8:11], s46 offen sc1
R_I4:
    s_nop 1
    v_mov_b32 v20, 0
    ds_write_b32 v3, v20
    s_waitcnt vmcnt(0) lgkmcnt(0)
    s_barrier
    s_cmp_lg_u32 s32, 0
    s_cbranch_scc1 R_I5
    v_mov_b32 v4, 1
    s_mov_b64 exec, 1
    buffer_atomic_add v4, off, s[12:15], s95 sc1
    s_mov_b64 exec, -1
R_I5:
    s_cmp_ge_u32 s32, 4
    s_cbranch_scc1 EXIT
    s_and_b32 s61, s32, 1
    s_and_b32 s35, s2, 0xfc
    s_lshl_b32 s46, s61, 1
    s_add_u32 s35, s35, s46
    s_lshl_b32 s38, s35, 8
    s_add_u32 s38, s38, s57
    s_lshl_b32 s37, s35, 7
    s_add_u32 s37, s37, s57
    s_add_u32 s37, s37, 40960
    v_lshrrev_b32 v12, 5, v2
    v_mul_u32_u24 v12, 640, v12
    v_bfe_u32 v13, v2, 3, 1
    v_lshl_add_u32 v12, v13, 8, v12
    v_bfe_u32 v13, v2, 4, 1
    v_lshl_add_u32 v12, v13, 7, v12
    v_and_b32 v13, 7, v2
    v_lshl_add_u32 v12, v13, 4, v12
    v_lshrrev_b32 v13, 4, v2
    v_mul_u32_u24 v13, 1280, v13
    v_and_b32 v14, 15, v2
    v_lshl_add_u32 v13, v14, 3, v13
    v_add_u32 v13, 512, v13
    s_mul_i32 s46, s35, 205
    s_lshr_b32 s46, s46, 11
    s_lshl_b32 s46, s46, 12
    s_lshl_b32 s47, s56, 7
    s_add_u32 s46, s46, s47
    s_add_u32 s46, s46, 4206592
    v_and_b32 v14, 7, v2
    v_lshl_add_u32 v14, v14, 9, s46
    s_lshl_b32 s46, s56, 10
    v_lshl_add_u32 v15, v2, 4, s46
    v_xor_b32 v16, 1024, v15
    v_xor_b32 v18, 2048, v15
    v_xor_b32 v19, 3072, v15
    v_and_b32 v28, 8, v2
    v_lshlrev_b32 v28, 5, v28
    v_lshrrev_b32 v17, 4, v2
    v_lshl_add_u32 v28, v17, 5, v28
    v_and_b32 v17, 7, v2
    v_lshl_add_u32 v28, v17, 2, v28
    v_and_b32 v17, 1, v2
    v_cmp_ne_u32 s[58:59], 0, v17
    v_mov_b32 v17, 0x4444
    v_mov_b32 v29, 0xeeee
    v_cndmask_b32 v17, v17, v29, s[58:59]
    s_mul_i32 s44, s35, 40960
    s_lshl_b32 s46, s56, 10
    s_add_u32 s44, s44, s46
    s_add_u32 s44, s44, 83886080
    s_lshl_b32 s45, s35, 11
    s_lshl_b32 s46, s56, 18
    s_add_u32 s45, s45, s46
    s_add_u32 s45, s45, 2359296
    s_add_u32 s43, s45, 245760
    s_add_u32 s36, s57, 40960
    s_mov_b32 s42, s45
    s_mul_i32 s60, s56, -768
    s_add_u32 s60, s60, 4293361664
    v_lshrrev_b32 v7, 4, v2
    v_lshlrev_b32 v7, 10, v7
    v_and_b32 v30, 15, v2
    v_lshl_add_u32 v7, v30, 4, v7
    v_lshrrev_b32 v5, 4, v2
    v_lshlrev_b32 v5, 8, v5
    v_lshl_add_u32 v5, v30, 3, v5
    s_lshl_b32 s46, s61, 4
    v_mov_b32 v29, s46
    s_lshl_b32 s46, s61, 12
    s_add_u32 s46, s46, 1024
    v_add_u32 v6, s46, v3
    s_mov_b32 s41, 0
    s_mov_b32 s34, 0
WST_29:
    s_sleep 120
WST_29_go:
    buffer_load_dwordx2 v[20:21], off, s[12:15], s95 sc1
    v_and_b32 v22, 7, v2
    v_lshlrev_b32 v22, 3, v22
    buffer_load_dwordx2 v[22:23], v22, s[12:15], 0 offen offset:128 sc1
WST_29_chk:
    s_sub_u32 s33, s33, 1
    s_cbranch_scc1 EXIT
    s_waitcnt vmcnt(0)
    s_cmp_eq_u32 s54, 0
    s_cbranch_scc1 WST_29_v
    v_not_b32 v22, v22
    v_xor_b32 v23, 8192, v23
    v_or_b32 v22, v22, v23
    v_cmp_ne_u32 vcc, 0, v22
    s_cbranch_vccz WST_29_v
    v_xor_b32 v23, 8192, v23
    v_lshrrev_b32 v23, 8, v23
    s_nop 1
    v_add_u32_dpp v23, v23, v23 row_ror:4 row_mask:0xf bank_mask:0xf
    s_nop 1
    v_add_u32_dpp v23, v23, v23 row_ror:2 row_mask:0xf bank_mask:0xf
    s_nop 1
    v_add_u32_dpp v23, v23, v23 row_ror:1 row_mask:0xf bank_mask:0xf
    s_nop 0
    v_readfirstlane_b32 s4, v23
    s_nop 0
    s_cmp_lt_u32 s4, 256
    s_cbranch_scc1 WST_29
    s_branch RESTART
WST_29_v:
    v_readfirstlane_b32 s4, v20
    v_readfirstlane_b32 s5, v21
    s_cmp_lt_u32 s4, 40
    s_cbranch_scc1 WST_29
    s_bitcmp1_b32 s5, 1
    s_cbranch_scc0 WST_29
    s_and_b32 s53, s5, 1
    s_lshl_b32 s53, s53, 13
    s_lshr_b32 s39, s2, 2
    s_lshl_b32 s39, s39, 14
    s_lshl_b32 s46, s61, 12
    s_add_u32 s39, s39, s46
    s_add_u32 s39, s39, s53
    s_cmp_eq_u32 s54, 0
    s_cbranch_scc1 R_GO_S
R_GO:
    s_cmp_lt_u32 s32, 2
    s_cbranch_scc1 R_LOOP
R_HK:
    s_add_u32 s50, s34, 2
    s_cmp_ge_u32 s41, s50
    s_cbranch_scc1 FWD_31
    s_branch FW_30_go
FW_30:
    s_sleep 2
    s_sub_u32 s33, s33, 1
    s_cbranch_scc1 EXIT
FW_30_go:
    buffer_load_dword v4, v14, s[8:11], 0 offen sc1
    s_waitcnt vmcnt(0)
    v_cmp_gt_u32 vcc, s50, v4
    s_cbranch_vccnz FW_30
    s_mov_b32 s41, s50
    s_add_u32 s4, s50, 1
    v_cmp_gt_u32 vcc, s4, v4
    s_cbranch_vccnz FWD_31
    s_mov_b32 s41, s4
    s_add_u32 s4, s50, 3
    v_cmp_gt_u32 vcc, s4, v4
    s_cbranch_vccnz FWD_31
    s_mov_b32 s41, s4
    s_add_u32 s4, s50, 8
    v_cmp_gt_u32 vcc, s4, v4
    s_cbranch_vccnz FWD_31
    s_mov_b32 s41, s4
    s_add_u32 s4, s50, 20
    v_cmp_gt_u32 vcc, s4, v4
    s_cbranch_vccnz FWD_31
    s_mov_b32 s41, s4
FWD_31:
    s_barrier
    s_add_u32 s44, s44, 1638400
    s_mov_b32 s42, s45
    s_add_u32 s45, s45, 81920
    s_cmp_eq_u32 s45, s43
    s_cselect_b32 s46, 245760, 0
    s_sub_u32 s45, s45, s46
    s_add_u32 s34, s34, 1
    s_cmp_lt_u32 s34, 63
    buffer_load_dwordx4 v[64:67], v3, s[8:11], s42 offen offset:0 sc1
    buffer_load_dwordx4 v[68:71], v3, s[8:11], s42 offen offset:1024 sc1
    buffer_load_dwordx4 v[104:107], v3, s[8:11], s42 offen offset:2048 sc1
    buffer_load_dwordx4 v[108:111], v3, s[8:11], s42 offen offset:3072 sc1
    s_add_u32 s46, s34, 3
    s_and_b32 s46, s46, 3
    s_mul_i32 s46, s46, 10240
    s_add_u32 s46, s46, s38
    s_add_u32 s47, s34, 2
    s_and_b32 s47, s47, 3
    s_mul_i32 s47, s47, 5120
    s_add_u32 s47, s47, s37
    s_add_u32 s48, s34, 2
    s_and_b32 s48, s48, 3
    s_mul_i32 s48, s48, 163840
    s_add_u32 s48, s48, s39
    s_waitcnt vmcnt(0)
    buffer_store_dwordx4 v[8:11], v15, s[8:11], s48 offen sc1
    s_mov_b32 exec_hi, 0
    s_mov_b32 exec_lo, 0xffffffff
    buffer_store_dwordx4 v[8:11], v3, s[8:11], s46 offen
    s_mov_b32 exec_lo, 0xffff
    buffer_store_dwordx4 v[8:11], v3, s[8:11], s47 offen
    s_mov_b64 exec, -1
    s_add_u32 s46, s44, s60
    s_add_u32 s47, s46, 0
    buffer_store_dwordx4 v[64:67], v7, s[8:11], s47 offen sc1
    s_add_u32 s47, s46, 4096
    buffer_store_dwordx4 v[68:71], v7, s[8:11], s47 offen sc1
    s_add_u32 s47, s46, 40960
    buffer_store_dwordx4 v[104:107], v7, s[8:11], s47 offen sc1
    s_add_u32 s47, s46, 45056
    buffer_store_dwordx4 v[108:111], v7, s[8:11], s47 offen sc1
    buffer_store_dwordx4 v[8:11], v3, s[8:11], s42 offen offset:0
    buffer_store_dwordx4 v[8:11], v3, s[8:11], s42 offen offset:1024
    buffer_store_dwordx4 v[8:11], v3, s[8:11], s42 offen offset:2048
    buffer_store_dwordx4 v[8:11], v3, s[8:11], s42 offen offset:3072
    s_waitcnt vmcnt(0)
    s_cmp_lt_u32 s34, 63
    s_cbranch_scc1 R_HK
    s_endpgm
.p2align 6
R_LOOP:
    s_add_u32 s50, s34, 1
    s_cmp_ge_u32 s41, s50
    s_cbranch_scc1 FWD_33
    s_branch FW_32_go
FW_32:
    s_sleep 3
    s_sub_u32 s33, s33, 1
    s_cbranch_scc1 EXIT
FW_32_go:
    buffer_load_dword v4, v14, s[8:11], 0 offen sc1
    s_waitcnt vmcnt(0)
    v_cmp_gt_u32 vcc, s50, v4
    s_cbranch_vccnz FW_32
    s_mov_b32 s41, s50
    s_add_u32 s4, s50, 1
    v_cmp_gt_u32 vcc, s4, v4
    s_cbranch_vccnz FWD_33
    s_mov_b32 s41, s4
    s_add_u32 s4, s50, 3
    v_cmp_gt_u32 vcc, s4, v4
    s_cbranch_vccnz FWD_33
    s_mov_b32 s41, s4
    s_add_u32 s4, s50, 8
    v_cmp_gt_u32 vcc, s4, v4
    s_cbranch_vccnz FWD_33
    s_mov_b32 s41, s4
    s_add_u32 s4, s50, 20
    v_cmp_gt_u32 vcc, s4, v4
    s_cbranch_vccnz FWD_33
    s_mov_b32 s41, s4
FWD_33:
    s_movk_i32 s41, 128
    s_add_u32 s48, s44, 0
    buffer_load_dwordx4 v[32:35], v3, s[8:11], s48 offen sc1
    s_add_u32 s48, s44, 4096
    buffer_load_dwordx4 v[36:39], v3, s[8:11], s48 offen sc1
    s_add_u32 s48, s44, 8192
    buffer_load_dwordx4 v[40:43], v3, s[8:11], s48 offen sc1
    s_add_u32 s48, s44, 12288
    buffer_load_dwordx4 v[44:47], v3, s[8:11], s48 offen sc1
    s_add_u32 s48, s44, 16384
    buffer_load_dwordx4 v[48:51], v3, s[8:11], s48 offen sc1
    s_add_u32 s48, s44, 20480
    buffer_load_dwordx4 v[52:55], v3, s[8:11], s48 offen sc1
    s_add_u32 s48, s44, 24576
    buffer_load_dwordx4 v[56:59], v3, s[8:11], s48 offen sc1
    s_add_u32 s48, s44, 28672
    buffer_load_dwordx4 v[60:63], v3, s[8:11], s48 offen sc1
    s_add_u32 s48, s44, 40960
    buffer_load_dwordx4 v[72:75], v3, s[8:11], s48 offen sc1
    s_add_u32 s48, s44, 45056
    buffer_load_dwordx4 v[76:79], v3, s[8:11], s48 offen sc1
    s_add_u32 s48, s44, 49152
    buffer_load_dwordx4 v[80:83], v3, s[8:11], s48 offen sc1
    s_add_u32 s48, s44, 53248
    buffer_load_dwordx4 v[84:87], v3, s[8:11], s48 offen sc1
    s_add_u32 s48, s44, 57344
    buffer_load_dwordx4 v[88:91], v3, s[8:11], s48 offen sc1
    s_add_u32 s48, s44, 61440
    buffer_load_dwordx4 v[92:95], v3, s[8:11], s48 offen sc1
    s_add_u32 s48, s44, 65536
    buffer_load_dwordx4 v[96:99], v3, s[8:11], s48 offen sc1
    s_add_u32 s48, s44, 69632
    buffer_load_dwordx4 v[100:103], v3, s[8:11], s48 offen sc1
    s_add_u32 s55, s34, 0
    s_and_b32 s55, s55, 3
    s_mul_i32 s55, s55, 5120
    s_add_u32 s55, s55, s36
    s_add_u32 s49, s34, 1
    s_and_b32 s49, s49, 3
    s_mul_i32 s49, s49, 10240
    s_add_u32 s49, s49, s38
    s_add_u32 s51, s34, 0
    s_and_b32 s51, s51, 3
    s_mul_i32 s51, s51, 163840
    s_add_u32 s51, s51, s39
R_UP:
    buffer_load_dwordx4 v[64:67], v3, s[8:11], s45 offen offset:0 sc1
    buffer_load_dwordx4 v[68:71], v3, s[8:11], s45 offen offset:1024 sc1
    buffer_load_dwordx4 v[104:107], v3, s[8:11], s45 offen offset:2048 sc1
    buffer_load_dwordx4 v[108:111], v3, s[8:11], s45 offen offset:3072 sc1
    s_sub_u32 s33, s33, 1
    s_cbranch_scc1 EXIT
    s_waitcnt vmcnt(2)
    v_max_u32 v30, v64, v68
    s_waitcnt vmcnt(0)
    v_max3_u32 v30, v30, v104, v108
    v_cmp_eq_u32 vcc, -1, v30
    s_cbranch_vccnz R_UP
R_PP:
    buffer_load_dwordx4 v[112:115], v12, s[8:11], s55 offen offset:0 sc1
    buffer_load_dwordx4 v[116:119], v12, s[8:11], s55 offen offset:1280 sc1
    buffer_load_dwordx4 v[120:123], v12, s[8:11], s55 offen offset:2560 sc1
    buffer_load_dwordx4 v[124:127], v12, s[8:11], s55 offen offset:3840 sc1
    buffer_load_dwordx2 v[128:129], v13, s[8:11], s55 offen sc1
    buffer_load_dwordx2 v[130:131], v13, s[8:11], s55 offen offset:640 sc1
    s_sub_u32 s33, s33, 1
    s_cbranch_scc1 EXIT
    v_max3_u32 v30, v65, v66, v67
    v_max3_u32 v30, v30, v69, v70
    v_max3_u32 v30, v30, v71, v105
    v_max3_u32 v30, v30, v106, v107
    v_max3_u32 v30, v30, v109, v110
    v_max_u32 v30, v30, v111
    v_cmp_eq_u32 vcc, -1, v30
    s_cbranch_vccnz R_UP
    v_mov_b32 v132, 0
    v_mov_b32 v133, 0
    v_mov_b32 v134, 0
    v_mov_b32 v135, 0
    v_mov_b32 v136, 0
    v_mov_b32 v137, 0
    v_mov_b32 v138, 0
    v_mov_b32 v139, 0
    s_waitcnt vmcnt(5)
    v_smfmac_f32_16x16x64_bf16 v[132:135], v[112:115], v[32:39], v17
    v_max3_u32 v4, v112, v113, v114
    v_smfmac_f32_16x16x64_bf16 v[136:139], v[112:115], v[72:79], v17
    v_max_u32 v4, v4, v115
    s_waitcnt vmcnt(4)
    v_smfmac_f32_16x16x64_bf16 v[132:135], v[116:119], v[40:47], v17
    v_max3_u32 v4, v4, v116, v117
    v_smfmac_f32_16x16x64_bf16 v[136:139], v[116:119], v[80:87], v17
    v_max3_u32 v4, v4, v118, v119
    s_waitcnt vmcnt(3)
    v_smfmac_f32_16x16x64_bf16 v[132:135], v[120:123], v[48:55], v17
    v_max3_u32 v4, v4, v120, v121
    v_smfmac_f32_16x16x64_bf16 v[136:139], v[120:123], v[88:95], v17
    v_max3_u32 v4, v4, v122, v123
    s_waitcnt vmcnt(2)
    v_smfmac_f32_16x16x64_bf16 v[132:135], v[124:127], v[56:63], v17
    v_max3_u32 v4, v4, v124, v125
    v_smfmac_f32_16x16x64_bf16 v[136:139], v[124:127], v[96:103], v17
    v_max3_u32 v4, v4, v126, v127
    s_waitcnt vmcnt(0)
    v_smfmac_f32_16x16x64_bf16 v[132:135], v[128:131], v[64:71], v17
    v_max3_u32 v4, v4, v128, v129
    v_smfmac_f32_16x16x64_bf16 v[136:139], v[128:131], v[104:111], v17
    v_max3_u32 v4, v4, v130, v131
    v_cmp_eq_u32 vcc, -1, v4
    s_cbranch_vccnz R_PP
    s_nop 2
    v_add_f32 v152, v132, v133
    v_add_f32 v153, v134, v135
    v_add_f32 v154, v136, v137
    v_add_f32 v155, v138, v139
    buffer_store_dwordx4 v[152:155], v15, s[8:11], s51 offen sc1
    s_waitcnt vmcnt(0)
R_PE:
    buffer_load_dwordx4 v[180:183], v16, s[8:11], s51 offen sc1
    buffer_load_dwordx4 v[184:187], v18, s[8:11], s51 offen sc1
    buffer_load_dwordx4 v[188:191], v19, s[8:11], s51 offen sc1
    s_sub_u32 s33, s33, 1
    s_cbranch_scc1 EXIT
    s_waitcnt vmcnt(2)
    v_max3_u32 v4, v180, v181, v182
    v_add_f32 v192, v152, v180
    v_add_f32 v193, v153, v181
    v_add_f32 v194, v154, v182
    v_add_f32 v195, v155, v183
    s_waitcnt vmcnt(1)
    v_max3_u32 v4, v4, v183, v184
    v_max3_u32 v4, v4, v185, v186
    s_waitcnt vmcnt(0)
    v_max3_u32 v4, v4, v187, v188
    v_max3_u32 v4, v4, v189, v190
    v_max_u32 v4, v4, v191
    v_add_f32 v184, v184, v188
    v_add_f32 v185, v185, v189
    v_add_f32 v186, v186, v190
    v_add_f32 v187, v187, v191
    v_cmp_eq_u32 vcc, -1, v4
    v_add_f32 v192, v192, v184
    v_add_f32 v193, v193, v185
    v_add_f32 v194, v194, v186
    v_add_f32 v195, v195, v187
    v_cvt_pk_bf16_f32 v192, v192, v194
    v_cvt_pk_bf16_f32 v193, v193, v195
    s_cbranch_vccnz R_PE
    buffer_store_dword v192, v28, s[8:11], s49 offen offset:0
    buffer_store_dword v193, v28, s[8:11], s49 offen offset:128
    s_waitcnt lgkmcnt(0)
    s_barrier
    s_add_u32 s44, s44, 1638400
    s_mov_b32 s42, s45
    s_add_u32 s45, s45, 81920
    s_cmp_eq_u32 s45, s43
    s_cselect_b32 s46, 245760, 0
    s_sub_u32 s45, s45, s46
    s_add_u32 s34, s34, 1
    s_cmp_lt_u32 s34, 63
    s_cbranch_scc1 R_LOOP
    s_endpgm
R_GO_S:
    s_cmp_lt_u32 s32, 2
    s_cbranch_scc1 R_LOOP_S
R_HK_S:
    s_add_u32 s50, s34, 2
    s_cmp_ge_u32 s41, s50
    s_cbranch_scc1 FWD_35
    s_branch FW_34_go
FW_34:
    s_sleep 2
    s_sub_u32 s33, s33, 1
    s_cbranch_scc1 EXIT
FW_34_go:
    buffer_load_dword v4, v14, s[8:11], 0 offen sc1
    s_waitcnt vmcnt(0)
    v_cmp_gt_u32 vcc, s50, v4
    s_cbranch_vccnz FW_34
    s_mov_b32 s41, s50
    s_add_u32 s4, s50, 1
    v_cmp_gt_u32 vcc, s4, v4
    s_cbranch_vccnz FWD_35
    s_mov_b32 s41, s4
    s_add_u32 s4, s50, 3
    v_cmp_gt_u32 vcc, s4, v4
    s_cbranch_vccnz FWD_35
    s_mov_b32 s41, s4
    s_add_u32 s4, s50, 8
    v_cmp_gt_u32 vcc, s4, v4
    s_cbranch_vccnz FWD_35
    s_mov_b32 s41, s4
    s_add_u32 s4, s50, 20
    v_cmp_gt_u32 vcc, s4, v4
    s_cbranch_vccnz FWD_35
    s_mov_b32 s41, s4
FWD_35:
    s_barrier
    s_add_u32 s44, s44, 1638400
    s_mov_b32 s42, s45
    s_add_u32 s45, s45, 81920
    s_cmp_eq_u32 s45, s43
    s_cselect_b32 s46, 245760, 0
    s_sub_u32 s45, s45, s46
    s_add_u32 s34, s34, 1
    s_cmp_lt_u32 s34, 63
    buffer_load_dwordx4 v[64:67], v3, s[8:11], s42 offen offset:0 sc1
    buffer_load_dwordx4 v[68:71], v3, s[8:11], s42 offen offset:1024 sc1
    buffer_load_dwordx4 v[104:107], v3, s[8:11], s42 offen offset:2048 sc1
    buffer_load_dwordx4 v[108:111], v3, s[8:11], s42 offen offset:3072 sc1
    s_add_u32 s46, s34, 3
    s_and_b32 s46, s46, 3
    s_mul_i32 s46, s46, 10240
    s_add_u32 s46, s46, s38
    s_add_u32 s47, s34, 2
    s_and_b32 s47, s47, 3
    s_mul_i32 s47, s47, 5120
    s_add_u32 s47, s47, s37
    s_add_u32 s48, s34, 2
    s_and_b32 s48, s48, 3
    s_mul_i32 s48, s48, 163840
    s_add_u32 s48, s48, s39
    s_waitcnt vmcnt(0)
    buffer_store_dwordx4 v[8:11], v15, s[8:11], s48 offen sc1
    s_mov_b32 exec_hi, 0
    s_mov_b32 exec_lo, 0xffffffff
    buffer_store_dwordx4 v[8:11], v3, s[8:11], s46 offen sc1
    s_mov_b32 exec_lo, 0xffff
    buffer_store_dwordx4 v[8:11], v3, s[8:11], s47 offen sc1
    s_mov_b64 exec, -1
    s_add_u32 s46, s44, s60
    s_add_u32 s47, s46, 0
    buffer_store_dwordx4 v[64:67], v7, s[8:11], s47 offen sc1
    s_add_u32 s47, s46, 4096
    buffer_store_dwordx4 v[68:71], v7, s[8:11], s47 offen sc1
    s_add_u32 s47, s46, 40960
    buffer_store_dwordx4 v[104:107], v7, s[8:11], s47 offen sc1
    s_add_u32 s47, s46, 45056
    buffer_store_dwordx4 v[108:111], v7, s[8:11], s47 offen sc1
    buffer_store_dwordx4 v[8:11], v3, s[8:11], s42 offen offset:0 sc1
    buffer_store_dwordx4 v[8:11], v3, s[8:11], s42 offen offset:1024 sc1
    buffer_store_dwordx4 v[8:11], v3, s[8:11], s42 offen offset:2048 sc1
    buffer_store_dwordx4 v[8:11], v3, s[8:11], s42 offen offset:3072 sc1
    s_waitcnt vmcnt(0)
    s_cmp_lt_u32 s34, 63
    s_cbranch_scc1 R_HK_S
    s_endpgm
.p2align 6
R_LOOP_S:
    s_add_u32 s50, s34, 1
    s_cmp_ge_u32 s41, s50
    s_cbranch_scc1 FWD_37
    s_branch FW_36_go
FW_36:
    s_sleep 3
    s_sub_u32 s33, s33, 1
    s_cbranch_scc1 EXIT
FW_36_go:
    buffer_load_dword v4, v14, s[8:11], 0 offen sc1
    s_waitcnt vmcnt(0)
    v_cmp_gt_u32 vcc, s50, v4
    s_cbranch_vccnz FW_36
    s_mov_b32 s41, s50
    s_add_u32 s4, s50, 1
    v_cmp_gt_u32 vcc, s4, v4
    s_cbranch_vccnz FWD_37
    s_mov_b32 s41, s4
    s_add_u32 s4, s50, 3
    v_cmp_gt_u32 vcc, s4, v4
    s_cbranch_vccnz FWD_37
    s_mov_b32 s41, s4
    s_add_u32 s4, s50, 8
    v_cmp_gt_u32 vcc, s4, v4
    s_cbranch_vccnz FWD_37
    s_mov_b32 s41, s4
    s_add_u32 s4, s50, 20
    v_cmp_gt_u32 vcc, s4, v4
    s_cbranch_vccnz FWD_37
    s_mov_b32 s41, s4
FWD_37:
    s_movk_i32 s41, 128
    s_add_u32 s48, s44, 0
    buffer_load_dwordx4 v[32:35], v3, s[8:11], s48 offen sc1
    s_add_u32 s48, s44, 4096
    buffer_load_dwordx4 v[36:39], v3, s[8:11], s48 offen sc1
    s_add_u32 s48, s44, 8192
    buffer_load_dwordx4 v[40:43], v3, s[8:11], s48 offen sc1
    s_add_u32 s48, s44, 12288
    buffer_load_dwordx4 v[44:47], v3, s[8:11], s48 offen sc1
    s_add_u32 s48, s44, 16384
    buffer_load_dwordx4 v[48:51], v3, s[8:11], s48 offen sc1
    s_add_u32 s48, s44, 20480
    buffer_load_dwordx4 v[52:55], v3, s[8:11], s48 offen sc1
    s_add_u32 s48, s44, 24576
    buffer_load_dwordx4 v[56:59], v3, s[8:11], s48 offen sc1
    s_add_u32 s48, s44, 28672
    buffer_load_dwordx4 v[60:63], v3, s[8:11], s48 offen sc1
    s_add_u32 s48, s44, 40960
    buffer_load_dwordx4 v[72:75], v3, s[8:11], s48 offen sc1
    s_add_u32 s48, s44, 45056
    buffer_load_dwordx4 v[76:79], v3, s[8:11], s48 offen sc1
    s_add_u32 s48, s44, 49152
    buffer_load_dwordx4 v[80:83], v3, s[8:11], s48 offen sc1
    s_add_u32 s48, s44, 53248
    buffer_load_dwordx4 v[84:87], v3, s[8:11], s48 offen sc1
    s_add_u32 s48, s44, 57344
    buffer_load_dwordx4 v[88:91], v3, s[8:11], s48 offen sc1
    s_add_u32 s48, s44, 61440
    buffer_load_dwordx4 v[92:95], v3, s[8:11], s48 offen sc1
    s_add_u32 s48, s44, 65536
    buffer_load_dwordx4 v[96:99], v3, s[8:11], s48 offen sc1
    s_add_u32 s48, s44, 69632
    buffer_load_dwordx4 v[100:103], v3, s[8:11], s48 offen sc1
    s_add_u32 s55, s34, 0
    s_and_b32 s55, s55, 3
    s_mul_i32 s55, s55, 5120
    s_add_u32 s55, s55, s36
    s_add_u32 s49, s34, 1
    s_and_b32 s49, s49, 3
    s_mul_i32 s49, s49, 10240
    s_add_u32 s49, s49, s38
    s_add_u32 s51, s34, 0
    s_and_b32 s51, s51, 3
    s_mul_i32 s51, s51, 163840
    s_add_u32 s51, s51, s39
R_UP_S:
    buffer_load_dwordx4 v[64:67], v3, s[8:11], s45 offen offset:0 sc1
    buffer_load_dwordx4 v[68:71], v3, s[8:11], s45 offen offset:1024 sc1
    buffer_load_dwordx4 v[104:107], v3, s[8:11], s45 offen offset:2048 sc1
    buffer_load_dwordx4 v[108:111], v3, s[8:11], s45 offen offset:3072 sc1
    s_sub_u32 s33, s33, 1
    s_cbranch_scc1 EXIT
    s_waitcnt vmcnt(2)
    v_max_u32 v30, v64, v68
    s_waitcnt vmcnt(0)
    v_max3_u32 v30, v30, v104, v108
    v_cmp_eq_u32 vcc, -1, v30
    s_cbranch_vccnz R_UP_S
R_PP_S:
    buffer_load_dwordx4 v[112:115], v12, s[8:11], s55 offen offset:0 sc1
    buffer_load_dwordx4 v[116:119], v12, s[8:11], s55 offen offset:1280 sc1
    buffer_load_dwordx4 v[120:123], v12, s[8:11], s55 offen offset:2560 sc1
    buffer_load_dwordx4 v[124:127], v12, s[8:11], s55 offen offset:3840 sc1
    buffer_load_dwordx2 v[128:129], v13, s[8:11], s55 offen sc1
    buffer_load_dwordx2 v[130:131], v13, s[8:11], s55 offen offset:640 sc1
    s_sub_u32 s33, s33, 1
    s_cbranch_scc1 EXIT
    v_max3_u32 v30, v65, v66, v67
    v_max3_u32 v30, v30, v69, v70
    v_max3_u32 v30, v30, v71, v105
    v_max3_u32 v30, v30, v106, v107
    v_max3_u32 v30, v30, v109, v110
    v_max_u32 v30, v30, v111
    v_cmp_eq_u32 vcc, -1, v30
    s_cbranch_vccnz R_UP_S
    v_mov_b32 v132, 0
    v_mov_b32 v133, 0
    v_mov_b32 v134, 0
    v_mov_b32 v135, 0
    v_mov_b32 v136, 0
    v_mov_b32 v137, 0
    v_mov_b32 v138, 0
    v_mov_b32 v139, 0
    s_waitcnt vmcnt(5)
    v_smfmac_f32_16x16x64_bf16 v[132:135], v[112:115], v[32:39], v17
    v_max3_u32 v4, v112, v113, v114
    v_smfmac_f32_16x16x64_bf16 v[136:139], v[112:115], v[72:79], v17
    v_max_u32 v4, v4, v115
    s_waitcnt vmcnt(4)
    v_smfmac_f32_16x16x64_bf16 v[132:135], v[116:119], v[40:47], v17
    v_max3_u32 v4, v4, v116, v117
    v_smfmac_f32_16x16x64_bf16 v[136:139], v[116:119], v[80:87], v17
    v_max3_u32 v4, v4, v118, v119
    s_waitcnt vmcnt(3)
    v_smfmac_f32_16x16x64_bf16 v[132:135], v[120:123], v[48:55], v17
    v_max3_u32 v4, v4, v120, v121
    v_smfmac_f32_16x16x64_bf16 v[136:139], v[120:123], v[88:95], v17
    v_max3_u32 v4, v4, v122, v123
    s_waitcnt vmcnt(2)
    v_smfmac_f32_16x16x64_bf16 v[132:135], v[124:127], v[56:63], v17
    v_max3_u32 v4, v4, v124, v125
    v_smfmac_f32_16x16x64_bf16 v[136:139], v[124:127], v[96:103], v17
    v_max3_u32 v4, v4, v126, v127
    s_waitcnt vmcnt(0)
    v_smfmac_f32_16x16x64_bf16 v[132:135], v[128:131], v[64:71], v17
    v_max3_u32 v4, v4, v128, v129
    v_smfmac_f32_16x16x64_bf16 v[136:139], v[128:131], v[104:111], v17
    v_max3_u32 v4, v4, v130, v131
    v_cmp_eq_u32 vcc, -1, v4
    s_cbranch_vccnz R_PP_S
    s_nop 2
    v_add_f32 v152, v132, v133
    v_add_f32 v153, v134, v135
    v_add_f32 v154, v136, v137
    v_add_f32 v155, v138, v139
    buffer_store_dwordx4 v[152:155], v15, s[8:11], s51 offen sc1
    s_waitcnt vmcnt(0)
R_PE_S:
    buffer_load_dwordx4 v[180:183], v16, s[8:11], s51 offen sc1
    buffer_load_dwordx4 v[184:187], v18, s[8:11], s51 offen sc1
    buffer_load_dwordx4 v[188:191], v19, s[8:11], s51 offen sc1
    s_sub_u32 s33, s33, 1
    s_cbranch_scc1 EXIT
    s_waitcnt vmcnt(2)
    v_max3_u32 v4, v180, v181, v182
    v_add_f32 v192, v152, v180
    v_add_f32 v193, v153, v181
    v_add_f32 v194, v154, v182
    v_add_f32 v195, v155, v183
    s_waitcnt vmcnt(1)
    v_max3_u32 v4, v4, v183, v184
    v_max3_u32 v4, v4, v185, v186
    s_waitcnt vmcnt(0)
    v_max3_u32 v4, v4, v187, v188
    v_max3_u32 v4, v4, v189, v190
    v_max_u32 v4, v4, v191
    v_add_f32 v184, v184, v188
    v_add_f32 v185, v185, v189
    v_add_f32 v186, v186, v190
    v_add_f32 v187, v187, v191
    v_cmp_eq_u32 vcc, -1, v4
    v_add_f32 v192, v192, v184
    v_add_f32 v193, v193, v185
    v_add_f32 v194, v194, v186
    v_add_f32 v195, v195, v187
    v_cvt_pk_bf16_f32 v192, v192, v194
    v_cvt_pk_bf16_f32 v193, v193, v195
    s_cbranch_vccnz R_PE_S
    buffer_store_dword v192, v28, s[8:11], s49 offen offset:0 sc1
    buffer_store_dword v193, v28, s[8:11], s49 offen offset:128 sc1
    s_waitcnt lgkmcnt(0)
    s_barrier
    s_add_u32 s44, s44, 1638400
    s_mov_b32 s42, s45
    s_add_u32 s45, s45, 81920
    s_cmp_eq_u32 s45, s43
    s_cselect_b32 s46, 245760, 0
    s_sub_u32 s45, s45, s46
    s_add_u32 s34, s34, 1
    s_cmp_lt_u32 s34, 63
    s_cbranch_scc1 R_LOOP_S
    s_endpgm
.p2align 6
ROLE_T:
    s_cmp_lg_u32 s32, 0
    s_cbranch_scc1 T_W
    s_cmp_ge_u32 s2, 1
    s_cbranch_scc1 T_W
    v_mov_b32 v5, 0
    s_mov_b64 exec, 1
    s_mov_b32 s46, 0x1E0000
    v_mov_b32 v4, -1
    s_mov_b32 s40, -1
    s_mov_b32 s41, -1
    s_mov_b32 s38, 0
T_P:
    s_add_u32 s47, s46, 0
    s_memtime s[42:43]
    s_waitcnt lgkmcnt(0)
    buffer_store_dword v4, v5, s[8:11], s47 offen sc1
    s_waitcnt vmcnt(0)
    s_memtime s[44:45]
    s_waitcnt lgkmcnt(0)
    s_sub_u32 s44, s44, s42
    s_min_u32 s40, s40, s44
    s_add_u32 s47, s46, 8192
    s_memtime s[42:43]
    s_waitcnt lgkmcnt(0)
    buffer_store_dword v4, v5, s[8:11], s47 offen sc1
    s_waitcnt vmcnt(0)
    s_memtime s[44:45]
    s_waitcnt lgkmcnt(0)
    s_sub_u32 s44, s44, s42
    s_min_u32 s41, s41, s44
    s_add_u32 s47, s46, 16384
    s_memtime s[42:43]
    s_waitcnt lgkmcnt(0)
    buffer_store_dword v4, v5, s[8:11], s47 offen sc1
    s_waitcnt vmcnt(0)
    s_memtime s[44:45]
    s_waitcnt lgkmcnt(0)
    s_sub_u32 s44, s44, s42
    s_min_u32 s40, s40, s44
    s_add_u32 s47, s46, 24576
    s_memtime s[42:43]
    s_waitcnt lgkmcnt(0)
    buffer_store_dword v4, v5, s[8:11], s47 offen sc1
    s_waitcnt vmcnt(0)
    s_memtime s[44:45]
    s_waitcnt lgkmcnt(0)
    s_sub_u32 s44, s44, s42
    s_min_u32 s41, s41, s44
    s_add_u32 s47, s46, 32768
    s_memtime s[42:43]
    s_waitcnt lgkmcnt(0)
    buffer_store_dword v4, v5, s[8:11], s47 offen sc1
    s_waitcnt vmcnt(0)
    s_memtime s[44:45]
    s_waitcnt lgkmcnt(0)
    s_sub_u32 s44, s44, s42
    s_min_u32 s40, s40, s44
    s_add_u32 s47, s46, 40960
    s_memtime s[42:43]
    s_waitcnt lgkmcnt(0)
    buffer_store_dword v4, v5, s[8:11], s47 offen sc1
    s_waitcnt vmcnt(0)
    s_memtime s[44:45]
    s_waitcnt lgkmcnt(0)
    s_sub_u32 s44, s44, s42
    s_min_u32 s41, s41, s44
    s_add_u32 s47, s46, 49152
    s_memtime s[42:43]
    s_waitcnt lgkmcnt(0)
    buffer_store_dword v4, v5, s[8:11], s47 offen sc1
    s_waitcnt vmcnt(0)
    s_memtime s[44:45]
    s_waitcnt lgkmcnt(0)
    s_sub_u32 s44, s44, s42
    s_min_u32 s40, s40, s44
    s_add_u32 s47, s46, 57344
    s_memtime s[42:43]
    s_waitcnt lgkmcnt(0)
    buffer_store_dword v4, v5, s[8:11], s47 offen sc1
    s_waitcnt vmcnt(0)
    s_memtime s[44:45]
    s_waitcnt lgkmcnt(0)
    s_sub_u32 s44, s44, s42
    s_min_u32 s41, s41, s44
    s_add_u32 s38, s38, 1
    s_cmp_lt_u32 s38, 2
    s_cbranch_scc1 T_P
    s_sub_i32 s39, s40, s41
    s_abs_i32 s39, s39
    s_cmp_ge_u32 s39, 120
    s_cbranch_scc1 T_D
    s_cmp_lt_u32 s38, 5
    s_cbranch_scc1 T_P
T_D:
    s_cmp_lt_u32 s41, s40
    s_cselect_b32 s44, 3, 2
    v_mov_b32 v4, s44
    buffer_store_dword v4, v5, s[12:15], s95 offen offset:4 sc1
T_W:
    s_mov_b64 exec, -1
    s_barrier
WST_38:
    s_sleep 120
WST_38_go:
    buffer_load_dwordx2 v[8:9], off, s[12:15], s95 sc1
    v_and_b32 v10, 7, v2
    v_lshlrev_b32 v10, 3, v10
    buffer_load_dwordx2 v[10:11], v10, s[12:15], 0 offen offset:128 sc1
WST_38_chk:
    s_sub_u32 s33, s33, 1
    s_cbranch_scc1 EXIT
    s_waitcnt vmcnt(0)
    s_cmp_eq_u32 s54, 0
    s_cbranch_scc1 WST_38_v
    v_not_b32 v10, v10
    v_xor_b32 v11, 8192, v11
    v_or_b32 v10, v10, v11
    v_cmp_ne_u32 vcc, 0, v10
    s_cbranch_vccz WST_38_v
    v_xor_b32 v11, 8192, v11
    v_lshrrev_b32 v11, 8, v11
    s_nop 1
    v_add_u32_dpp v11, v11, v11 row_ror:4 row_mask:0xf bank_mask:0xf
    s_nop 1
    v_add_u32_dpp v11, v11, v11 row_ror:2 row_mask:0xf bank_mask:0xf
    s_nop 1
    v_add_u32_dpp v11, v11, v11 row_ror:1 row_mask:0xf bank_mask:0xf
    s_nop 0
    v_readfirstlane_b32 s4, v11
    s_nop 0
    s_cmp_lt_u32 s4, 256
    s_cbranch_scc1 WST_38
    s_branch RESTART
WST_38_v:
    v_readfirstlane_b32 s4, v8
    v_readfirstlane_b32 s5, v9
    s_cmp_lt_u32 s4, 40
    s_cbranch_scc1 WST_38
    s_endpgm
.p2align 6
ROLE_H:
    s_load_dwordx2 s[4:5], s[0:1], 0
    s_waitcnt lgkmcnt(0)
    s_mov_b32 s24, s4
    s_mov_b32 s25, s5
    s_mov_b32 s26, 2621440
    s_mov_b32 s27, 0x20000
    s_lshl_b32 s4, s2, 2
    s_add_u32 s4, s4, s32
    v_mul_u32_u24 v30, 5, v2
    v_lshlrev_b32 v31, 12, v2
    v_add_u32 v31, 0, v31
PFT_39:
    s_lshr_b32 s5, s4, 5
    s_lshl_b32 s5, s5, 18
    v_add_u32 v28, s4, v30
    v_and_b32 v28, 31, v28
    v_lshl_add_u32 v28, v28, 7, v31
    v_add_u32 v28, s5, v28
    buffer_load_dword v29, v28, s[24:27], 0 offen
    s_add_u32 s4, s4, 80
    s_waitcnt vmcnt(3)
    s_cmp_lt_u32 s4, 320
    s_cbranch_scc1 PFT_39
    s_load_dwordx2 s[4:5], s[0:1], 64
    s_waitcnt lgkmcnt(0)
    s_mov_b32 s24, s4
    s_mov_b32 s25, s5
    s_mov_b32 s26, 2457600
    s_mov_b32 s27, 0x20000
    s_lshl_b32 s4, s2, 2
    s_add_u32 s4, s4, s32
    v_mul_u32_u24 v30, 5, v2
    v_lshlrev_b32 v31, 12, v2
    v_add_u32 v31, 0, v31
PFT_40:
    s_lshr_b32 s5, s4, 5
    s_lshl_b32 s5, s5, 18
    v_add_u32 v28, s4, v30
    v_and_b32 v28, 31, v28
    v_lshl_add_u32 v28, v28, 7, v31
    v_add_u32 v28, s5, v28
    buffer_load_dword v29, v28, s[24:27], 0 offen
    s_add_u32 s4, s4, 80
    s_waitcnt vmcnt(3)
    s_cmp_lt_u32 s4, 320
    s_cbranch_scc1 PFT_40
    s_load_dwordx2 s[4:5], s[0:1], 56
    s_waitcnt lgkmcnt(0)
    s_mov_b32 s24, s4
    s_mov_b32 s25, s5
    s_mov_b32 s26, 2621440
    s_mov_b32 s27, 0x20000
    s_lshl_b32 s4, s2, 2
    s_add_u32 s4, s4, s32
    v_mul_u32_u24 v30, 5, v2
    v_lshlrev_b32 v31, 12, v2
    v_add_u32 v31, 0, v31
PFT_41:
    s_lshr_b32 s5, s4, 5
    s_lshl_b32 s5, s5, 18
    v_add_u32 v28, s4, v30
    v_and_b32 v28, 31, v28
    v_lshl_add_u32 v28, v28, 7, v31
    v_add_u32 v28, s5, v28
    buffer_load_dword v29, v28, s[24:27], 0 offen
    s_add_u32 s4, s4, 80
    s_waitcnt vmcnt(3)
    s_cmp_lt_u32 s4, 320
    s_cbranch_scc1 PFT_41
    s_load_dwordx2 s[4:5], s[0:1], 80
    s_waitcnt lgkmcnt(0)
    s_mov_b32 s24, s4
    s_mov_b32 s25, s5
    s_mov_b32 s26, 819200
    s_mov_b32 s27, 0x20000
    s_lshl_b32 s4, s2, 2
    s_add_u32 s4, s4, s32
    v_mul_u32_u24 v30, 5, v2
    v_lshlrev_b32 v31, 12, v2
    v_add_u32 v31, 0, v31
PFT_42:
    s_lshr_b32 s5, s4, 5
    s_lshl_b32 s5, s5, 18
    v_add_u32 v28, s4, v30
    v_and_b32 v28, 31, v28
    v_lshl_add_u32 v28, v28, 7, v31
    v_add_u32 v28, s5, v28
    buffer_load_dword v29, v28, s[24:27], 0 offen
    s_add_u32 s4, s4, 80
    s_waitcnt vmcnt(3)
    s_cmp_lt_u32 s4, 128
    s_cbranch_scc1 PFT_42
    s_waitcnt vmcnt(0)
    s_branch WST_43_go
WST_43:
    s_sleep 10
WST_43_go:
    buffer_load_dwordx2 v[8:9], off, s[12:15], s95 sc1
    v_and_b32 v10, 7, v2
    v_lshlrev_b32 v10, 3, v10
    buffer_load_dwordx2 v[10:11], v10, s[12:15], 0 offen offset:128 sc1
WST_43_chk:
    s_sub_u32 s33, s33, 1
    s_cbranch_scc1 EXIT
    s_waitcnt vmcnt(0)
    s_cmp_eq_u32 s54, 0
    s_cbranch_scc1 WST_43_v
    v_not_b32 v10, v10
    v_xor_b32 v11, 8192, v11
    v_or_b32 v10, v10, v11
    v_cmp_ne_u32 vcc, 0, v10
    s_cbranch_vccz WST_43_v
    v_xor_b32 v11, 8192, v11
    v_lshrrev_b32 v11, 8, v11
    s_nop 1
    v_add_u32_dpp v11, v11, v11 row_ror:4 row_mask:0xf bank_mask:0xf
    s_nop 1
    v_add_u32_dpp v11, v11, v11 row_ror:2 row_mask:0xf bank_mask:0xf
    s_nop 1
    v_add_u32_dpp v11, v11, v11 row_ror:1 row_mask:0xf bank_mask:0xf
    s_nop 0
    v_readfirstlane_b32 s4, v11
    s_nop 0
    s_cmp_lt_u32 s4, 256
    s_cbranch_scc1 WST_43
    s_branch RESTART
WST_43_v:
    v_readfirstlane_b32 s4, v8
    v_readfirstlane_b32 s5, v9
    s_cmp_lt_u32 s4, 40
    s_cbranch_scc1 WST_43
    s_cmp_eq_u32 s54, 0
    s_cbranch_scc1 EXIT
    s_and_b32 s56, s2, 3
    s_and_b32 s36, s2, 0xfc
    s_add_u32 s36, s36, s32
    s_cmp_ge_u32 s36, 16
    s_cbranch_scc1 EXIT
    s_lshl_b32 s57, s56, 16
    s_add_u32 s57, s57, 2097152
    s_lshl_b32 s46, s36, 9
    s_add_u32 s57, s57, s46
    v_lshlrev_b32 v3, 7, v2
    s_lshl_b32 s46, s36, 2
    s_add_u32 s46, s46, s56
    s_mul_i32 s44, s46, 12288
    s_add_u32 s44, s44, 9568256
    s_lshl_b32 s46, s56, 8
    s_add_u32 s46, s46, 4247552
    buffer_load_dword v4, off, s[8:11], s46 sc1
    s_waitcnt vmcnt(0)
    v_readfirstlane_b32 s34, v4
    s_nop 0
    s_add_u32 s34, s34, 1
    s_cmp_ge_u32 s34, 63
    s_cbranch_scc1 EXIT
    s_mul_i32 s46, s34, 1179648
    s_add_u32 s44, s44, s46
    s_movk_i32 s40, 300
H_LOOP:
    s_add_u32 s46, s34, 0
    s_and_b32 s46, s46, 3
    s_mul_i32 s46, s46, 10240
    s_add_u32 s46, s46, s57
H_W:
    s_sleep 3
    buffer_load_dword v4, off, s[8:11], s46 sc1
    s_sub_u32 s40, s40, 1
    s_cbranch_scc1 EXIT
    s_waitcnt vmcnt(0)
    v_cmp_eq_u32 vcc, -1, v4
    s_cbranch_vccnz H_W
    buffer_load_dword v5, v3, s[8:11], s44 offen sc1
    s_add_u32 s46, s44, 4096
    buffer_load_dword v5, v3, s[8:11], s46 offen sc1
    s_add_u32 s44, s44, 1179648
    s_add_u32 s34, s34, 1
    s_movk_i32 s40, 40
    s_cmp_lt_u32 s34, 63
    s_cbranch_scc1 H_LOOP
    s_endpgm
.p2align 6
ROLE_O:
    s_load_dwordx2 s[40:41], s[0:1], 88
    s_waitcnt lgkmcnt(0)
    s_mov_b32 s28, s40
    s_mov_b32 s29, s41
    s_mov_b32 s30, 5242880
    s_mov_b32 s31, 0x20000
    s_mul_i32 s34, s2, 205
    s_lshr_b32 s34, s34, 11
    s_mul_i32 s36, s34, 10
    s_sub_u32 s36, s2, s36
    s_cmp_ge_u32 s34, 3
    s_cselect_b32 s46, 12, 0
    s_add_u32 s34, s34, s46
    s_waitcnt vmcnt(0) lgkmcnt(0)
    s_barrier
    v_lshlrev_b32 v3, 4, v2
    v_and_b32 v12, 7, v2
    v_lshlrev_b32 v12, 7, v12
    v_bfe_u32 v13, v2, 3, 2
    v_lshl_add_u32 v12, v13, 12, v12
    s_lshl_b32 s46, s32, 10
    s_add_u32 s46, s46, 4206592
    v_add_u32 v12, s46, v12
    s_lshl_b32 s46, s32, 11
    s_add_u32 s46, s46, 4247552
    v_and_b32 v13, 15, v2
    v_lshl_add_u32 v13, v13, 7, s46
    v_lshrrev_b32 v14, 4, v2
    v_mul_u32_u24 v14, 2560, v14
    v_and_b32 v15, 15, v2
    v_lshl_add_u32 v14, v15, 4, v14
    v_add_u32 v14, 2048, v14
    s_lshl_b32 s46, s32, 13
    v_add_u32 v15, s46, v3
    s_lshl_b32 s46, s32, 11
    v_add_u32 v16, s46, v3
    v_and_b32 v17, 31, v2
    v_mul_u32_u24 v17, 2560, v17
    v_lshrrev_b32 v18, 5, v2
    v_lshl_add_u32 v17, v18, 4, v17
    s_lshl_b32 s46, s36, 7
    s_lshl_b32 s47, s32, 5
    s_add_u32 s46, s46, s47
    v_add_u32 v17, s46, v17
    s_mul_i32 s44, s36, 163840
    s_add_u32 s44, s44, 83886080
    s_mul_i32 s45, s32, 20480
    s_add_u32 s45, s45, 190382080
    s_mov_b32 s41, 0
    s_mov_b32 s42, 0
    s_lshl_b32 s46, s32, 11
    s_add_u32 s46, s46, 32768
    v_add_u32 v6, s46, v3
    s_lshl_b32 s46, s32, 11
    s_add_u32 s46, s46, 73728
    v_add_u32 v7, s46, v3
    s_lshl_b32 s46, s32, 11
    s_add_u32 s46, s46, 114688
    v_add_u32 v8, s46, v3
    s_lshl_b32 s46, s32, 11
    s_add_u32 s46, s46, 155648
    v_add_u32 v9, s46, v3
    s_mov_b32 s37, 2
    s_mov_b64 s[58:59], -1
    s_mov_b64 s[60:61], -1
O_LOOP:
    s_add_u32 s50, s34, 1
    s_cmp_ge_u32 s41, s50
    s_cbranch_scc1 FWD_45
    s_branch FW_44_go
FW_44:
    s_sleep 8
    s_sub_u32 s33, s33, 1
    s_cbranch_scc1 EXIT
FW_44_go:
    buffer_load_dword v4, v12, s[8:11], 0 offen sc1
    s_waitcnt vmcnt(0)
    v_cmp_gt_u32 vcc, s50, v4
    s_cbranch_vccnz FW_44
    s_mov_b32 s41, s50
    s_add_u32 s4, s50, 1
    v_cmp_gt_u32 vcc, s4, v4
    s_cbranch_vccnz FWD_45
    s_mov_b32 s41, s4
    s_add_u32 s4, s50, 3
    v_cmp_gt_u32 vcc, s4, v4
    s_cbranch_vccnz FWD_45
    s_mov_b32 s41, s4
    s_add_u32 s4, s50, 8
    v_cmp_gt_u32 vcc, s4, v4
    s_cbranch_vccnz FWD_45
    s_mov_b32 s41, s4
    s_add_u32 s4, s50, 20
    v_cmp_gt_u32 vcc, s4, v4
    s_cbranch_vccnz FWD_45
    s_mov_b32 s41, s4
FWD_45:
    s_mul_i32 s48, s34, 1638400
    s_add_u32 s48, s48, s44
    s_lshl_b32 s46, s32, 13
    s_add_u32 s46, s46, s48
    buffer_load_dwordx4 a[0:3], v3, s[8:11], s46 offen offset:0 sc1
    buffer_load_dwordx4 a[4:7], v3, s[8:11], s46 offen offset:1024 sc1
    buffer_load_dwordx4 a[8:11], v3, s[8:11], s46 offen offset:2048 sc1
    buffer_load_dwordx4 a[12:15], v3, s[8:11], s46 offen offset:3072 sc1
    s_add_u32 s46, s46, 4096
    buffer_load_dwordx4 a[16:19], v3, s[8:11], s46 offen offset:0 sc1
    buffer_load_dwordx4 a[20:23], v3, s[8:11], s46 offen offset:1024 sc1
    buffer_load_dwordx4 a[24:27], v3, s[8:11], s46 offen offset:2048 sc1
    buffer_load_dwordx4 a[28:31], v3, s[8:11], s46 offen offset:3072 sc1
    s_add_u32 s46, s46, 36864
    buffer_load_dwordx4 a[32:35], v3, s[8:11], s46 offen offset:0 sc1
    buffer_load_dwordx4 a[36:39], v3, s[8:11], s46 offen offset:1024 sc1
    buffer_load_dwordx4 a[40:43], v3, s[8:11], s46 offen offset:2048 sc1
    buffer_load_dwordx4 a[44:47], v3, s[8:11], s46 offen offset:3072 sc1
    s_add_u32 s46, s46, 4096
    buffer_load_dwordx4 a[48:51], v3, s[8:11], s46 offen offset:0 sc1
    buffer_load_dwordx4 a[52:55], v3, s[8:11], s46 offen offset:1024 sc1
    buffer_load_dwordx4 a[56:59], v3, s[8:11], s46 offen offset:2048 sc1
    buffer_load_dwordx4 a[60:63], v3, s[8:11], s46 offen offset:3072 sc1
    s_add_u32 s46, s46, 36864
    buffer_load_dwordx4 a[64:67], v3, s[8:11], s46 offen offset:0 sc1
    buffer_load_dwordx4 a[68:71], v3, s[8:11], s46 offen offset:1024 sc1
    buffer_load_dwordx4 a[72:75], v3, s[8:11], s46 offen offset:2048 sc1
    buffer_load_dwordx4 a[76:79], v3, s[8:11], s46 offen offset:3072 sc1
    s_add_u32 s46, s46, 4096
    buffer_load_dwordx4 a[80:83], v3, s[8:11], s46 offen offset:0 sc1
    buffer_load_dwordx4 a[84:87], v3, s[8:11], s46 offen offset:1024 sc1
    buffer_load_dwordx4 a[88:91], v3, s[8:11], s46 offen offset:2048 sc1
    buffer_load_dwordx4 a[92:95], v3, s[8:11], s46 offen offset:3072 sc1
    s_add_u32 s46, s46, 36864
    buffer_load_dwordx4 a[96:99], v3, s[8:11], s46 offen offset:0 sc1
    buffer_load_dwordx4 a[100:103], v3, s[8:11], s46 offen offset:1024 sc1
    buffer_load_dwordx4 a[104:107], v3, s[8:11], s46 offen offset:2048 sc1
    buffer_load_dwordx4 a[108:111], v3, s[8:11], s46 offen offset:3072 sc1
    s_add_u32 s46, s46, 4096
    buffer_load_dwordx4 a[112:115], v3, s[8:11], s46 offen offset:0 sc1
    buffer_load_dwordx4 a[116:119], v3, s[8:11], s46 offen offset:1024 sc1
    buffer_load_dwordx4 a[120:123], v3, s[8:11], s46 offen offset:2048 sc1
    buffer_load_dwordx4 a[124:127], v3, s[8:11], s46 offen offset:3072 sc1
    s_add_u32 s46, s46, 36864
    s_min_u32 s51, s50, 62
    s_cmp_ge_u32 s42, s51
    s_cbranch_scc1 FWD_47
    s_branch FW_46_go
FW_46:
    s_sleep 24
    s_sub_u32 s33, s33, 1
    s_cbranch_scc1 EXIT
FW_46_go:
    buffer_load_dword v4, v13, s[8:11], 0 offen sc1
    s_waitcnt vmcnt(0)
    v_cmp_gt_u32 vcc, s51, v4
    s_cbranch_vccnz FW_46
    s_mov_b32 s42, s51
    s_add_u32 s4, s51, 1
    v_cmp_gt_u32 vcc, s4, v4
    s_cbranch_vccnz FWD_47
    s_mov_b32 s42, s4
    s_add_u32 s4, s51, 3
    v_cmp_gt_u32 vcc, s4, v4
    s_cbranch_vccnz FWD_47
    s_mov_b32 s42, s4
    s_add_u32 s4, s51, 8
    v_cmp_gt_u32 vcc, s4, v4
    s_cbranch_vccnz FWD_47
    s_mov_b32 s42, s4
    s_add_u32 s4, s51, 20
    v_cmp_gt_u32 vcc, s4, v4
    s_cbranch_vccnz FWD_47
    s_mov_b32 s42, s4
FWD_47:
    s_branch PL_48_g
PL_48:
    s_sleep 8
PL_48_g:
    buffer_load_dwordx4 v[32:35], v6, s[8:11], s48 offen offset:0 sc1
    buffer_load_dwordx4 v[36:39], v6, s[8:11], s48 offen offset:1024 sc1
    buffer_load_dwordx4 v[40:43], v7, s[8:11], s48 offen offset:0 sc1
    buffer_load_dwordx4 v[44:47], v7, s[8:11], s48 offen offset:1024 sc1
    buffer_load_dwordx4 v[48:51], v8, s[8:11], s48 offen offset:0 sc1
    buffer_load_dwordx4 v[52:55], v8, s[8:11], s48 offen offset:1024 sc1
    buffer_load_dwordx4 v[56:59], v9, s[8:11], s48 offen offset:0 sc1
    buffer_load_dwordx4 v[60:63], v9, s[8:11], s48 offen offset:1024 sc1
    s_sub_u32 s33, s33, 1
    s_cbranch_scc1 EXIT
    s_waitcnt vmcnt(7)
    v_max3_u32 v4, v32, v33, v34
    s_waitcnt vmcnt(6)
    v_max3_u32 v4, v4, v35, v36
    v_max3_u32 v4, v4, v37, v38
    s_waitcnt vmcnt(5)
    v_max3_u32 v4, v4, v39, v40
    v_max3_u32 v4, v4, v41, v42
    s_waitcnt vmcnt(4)
    v_max3_u32 v4, v4, v43, v44
    v_max3_u32 v4, v4, v45, v46
    s_waitcnt vmcnt(3)
    v_max3_u32 v4, v4, v47, v48
    v_max3_u32 v4, v4, v49, v50
    s_waitcnt vmcnt(2)
    v_max3_u32 v4, v4, v51, v52
    v_max3_u32 v4, v4, v53, v54
    s_waitcnt vmcnt(1)
    v_max3_u32 v4, v4, v55, v56
    v_max3_u32 v4, v4, v57, v58
    s_waitcnt vmcnt(0)
    v_max3_u32 v4, v4, v59, v60
    v_max3_u32 v4, v4, v61, v62
    v_max_u32 v4, v4, v63
    v_cmp_eq_u32 vcc, -1, v4
    s_cbranch_vccnz PL_48
    s_cmp_ge_u32 s42, s50
    s_cbranch_scc1 FWD_50
    s_branch FW_49_go
FW_49:
    s_sleep 2
    s_sub_u32 s33, s33, 1
    s_cbranch_scc1 EXIT
FW_49_go:
    buffer_load_dword v4, v13, s[8:11], 0 offen sc1
    s_waitcnt vmcnt(0)
    v_cmp_gt_u32 vcc, s50, v4
    s_cbranch_vccnz FW_49
    s_mov_b32 s42, s50
    s_add_u32 s4, s50, 1
    v_cmp_gt_u32 vcc, s4, v4
    s_cbranch_vccnz FWD_50
    s_mov_b32 s42, s4
    s_add_u32 s4, s50, 3
    v_cmp_gt_u32 vcc, s4, v4
    s_cbranch_vccnz FWD_50
    s_mov_b32 s42, s4
    s_add_u32 s4, s50, 8
    v_cmp_gt_u32 vcc, s4, v4
    s_cbranch_vccnz FWD_50
    s_mov_b32 s42, s4
    s_add_u32 s4, s50, 20
    v_cmp_gt_u32 vcc, s4, v4
    s_cbranch_vccnz FWD_50
    s_mov_b32 s42, s4
FWD_50:
    s_mul_i32 s49, s34, 81920
    s_add_u32 s49, s49, s45
    s_add_u32 s47, s49, 10240
    s_mov_b64 exec, s[58:59]
    s_cmp_eq_u32 s37, 0
    s_cbranch_scc1 O_SL0
    buffer_load_dwordx4 v[128:131], v14, s[8:11], s49 offen offset:0 sc1
    buffer_load_dwordx4 v[136:139], v14, s[8:11], s47 offen offset:0 sc1
    s_add_u32 s46, s49, 0
    buffer_load_dwordx4 v[64:67], v3, s[8:11], s46 offen offset:0 sc1
    s_add_u32 s46, s49, 2560
    buffer_load_dwordx4 v[72:75], v3, s[8:11], s46 offen offset:0 sc1
    s_add_u32 s46, s49, 5120
    buffer_load_dwordx4 v[80:83], v3, s[8:11], s46 offen offset:0 sc1
    s_add_u32 s46, s49, 7680
    buffer_load_dwordx4 v[88:91], v3, s[8:11], s46 offen offset:0 sc1
    s_add_u32 s46, s49, 10240
    buffer_load_dwordx4 v[96:99], v3, s[8:11], s46 offen offset:0 sc1
    s_add_u32 s46, s49, 12800
    buffer_load_dwordx4 v[104:107], v3, s[8:11], s46 offen offset:0 sc1
    s_add_u32 s46, s49, 15360
    buffer_load_dwordx4 v[112:115], v3, s[8:11], s46 offen offset:0 sc1
    s_add_u32 s46, s49, 17920
    buffer_load_dwordx4 v[120:123], v3, s[8:11], s46 offen offset:0 sc1
O_SL0:
    s_cmp_eq_u32 s37, 1
    s_cbranch_scc1 O_SL1
    buffer_load_dwordx4 v[132:135], v14, s[8:11], s49 offen offset:256 sc1
    buffer_load_dwordx4 v[140:143], v14, s[8:11], s47 offen offset:256 sc1
    s_add_u32 s46, s49, 0
    buffer_load_dwordx4 v[68:71], v3, s[8:11], s46 offen offset:1024 sc1
    s_add_u32 s46, s49, 2560
    buffer_load_dwordx4 v[76:79], v3, s[8:11], s46 offen offset:1024 sc1
    s_add_u32 s46, s49, 5120
    buffer_load_dwordx4 v[84:87], v3, s[8:11], s46 offen offset:1024 sc1
    s_add_u32 s46, s49, 7680
    buffer_load_dwordx4 v[92:95], v3, s[8:11], s46 offen offset:1024 sc1
    s_add_u32 s46, s49, 10240
    buffer_load_dwordx4 v[100:103], v3, s[8:11], s46 offen offset:1024 sc1
    s_add_u32 s46, s49, 12800
    buffer_load_dwordx4 v[108:111], v3, s[8:11], s46 offen offset:1024 sc1
    s_add_u32 s46, s49, 15360
    buffer_load_dwordx4 v[116:119], v3, s[8:11], s46 offen offset:1024 sc1
    s_add_u32 s46, s49, 17920
    buffer_load_dwordx4 v[124:127], v3, s[8:11], s46 offen offset:1024 sc1
O_SL1:
    s_mov_b64 exec, -1
    s_cmp_lg_u32 s37, 1
    s_cbranch_scc1 O_NW
    s_waitcnt vmcnt(0)
O_NW:
    s_cmp_eq_u32 s37, 0
    s_cbranch_scc1 O_SM0
    s_waitcnt vmcnt(19)
    v_mfma_f32_16x16x32_bf16 v[144:147], v[32:35], v[128:131], 0
    v_mfma_f32_16x16x32_bf16 v[152:155], v[40:43], v[128:131], 0
    v_mfma_f32_16x16x32_bf16 v[160:163], v[48:51], v[128:131], 0
    v_mfma_f32_16x16x32_bf16 v[168:171], v[56:59], v[128:131], 0
    s_waitcnt vmcnt(18)
    v_mfma_f32_16x16x32_bf16 v[144:147], v[36:39], v[136:139], v[144:147]
    v_mfma_f32_16x16x32_bf16 v[152:155], v[44:47], v[136:139], v[152:155]
    v_mfma_f32_16x16x32_bf16 v[160:163], v[52:55], v[136:139], v[160:163]
    v_mfma_f32_16x16x32_bf16 v[168:171], v[60:63], v[136:139], v[168:171]
    s_waitcnt vmcnt(17)
    v_mfma_f32_16x16x32_bf16 v[144:147], a[0:3], v[64:67], v[144:147]
    v_mfma_f32_16x16x32_bf16 v[152:155], a[32:35], v[64:67], v[152:155]
    v_mfma_f32_16x16x32_bf16 v[160:163], a[64:67], v[64:67], v[160:163]
    v_mfma_f32_16x16x32_bf16 v[168:171], a[96:99], v[64:67], v[168:171]
    s_waitcnt vmcnt(16)
    v_mfma_f32_16x16x32_bf16 v[144:147], a[4:7], v[72:75], v[144:147]
    v_mfma_f32_16x16x32_bf16 v[152:155], a[36:39], v[72:75], v[152:155]
    v_mfma_f32_16x16x32_bf16 v[160:163], a[68:71], v[72:75], v[160:163]
    v_mfma_f32_16x16x32_bf16 v[168:171], a[100:103], v[72:75], v[168:171]
    s_waitcnt vmcnt(15)
    v_mfma_f32_16x16x32_bf16 v[144:147], a[8:11], v[80:83], v[144:147]
    v_mfma_f32_16x16x32_bf16 v[152:155], a[40:43], v[80:83], v[152:155]
    v_mfma_f32_16x16x32_bf16 v[160:163], a[72:75], v[80:83], v[160:163]
    v_mfma_f32_16x16x32_bf16 v[168:171], a[104:107], v[80:83], v[168:171]
    s_waitcnt vmcnt(14)
    v_mfma_f32_16x16x32_bf16 v[144:147], a[12:15], v[88:91], v[144:147]
    v_mfma_f32_16x16x32_bf16 v[152:155], a[44:47], v[88:91], v[152:155]
    v_mfma_f32_16x16x32_bf16 v[160:163], a[76:79], v[88:91], v[160:163]
    v_mfma_f32_16x16x32_bf16 v[168:171], a[108:111], v[88:91], v[168:171]
    s_waitcnt vmcnt(13)
    v_mfma_f32_16x16x32_bf16 v[144:147], a[16:19], v[96:99], v[144:147]
    v_mfma_f32_16x16x32_bf16 v[152:155], a[48:51], v[96:99], v[152:155]
    v_mfma_f32_16x16x32_bf16 v[160:163], a[80:83], v[96:99], v[160:163]
    v_mfma_f32_16x16x32_bf16 v[168:171], a[112:115], v[96:99], v[168:171]
    s_waitcnt vmcnt(12)
    v_mfma_f32_16x16x32_bf16 v[144:147], a[20:23], v[104:107], v[144:147]
    v_mfma_f32_16x16x32_bf16 v[152:155], a[52:55], v[104:107], v[152:155]
    v_mfma_f32_16x16x32_bf16 v[160:163], a[84:87], v[104:107], v[160:163]
    v_mfma_f32_16x16x32_bf16 v[168:171], a[116:119], v[104:107], v[168:171]
    s_waitcnt vmcnt(11)
    v_mfma_f32_16x16x32_bf16 v[144:147], a[24:27], v[112:115], v[144:147]
    v_mfma_f32_16x16x32_bf16 v[152:155], a[56:59], v[112:115], v[152:155]
    v_mfma_f32_16x16x32_bf16 v[160:163], a[88:91], v[112:115], v[160:163]
    v_mfma_f32_16x16x32_bf16 v[168:171], a[120:123], v[112:115], v[168:171]
    s_waitcnt vmcnt(10)
    v_mfma_f32_16x16x32_bf16 v[144:147], a[28:31], v[120:123], v[144:147]
    v_mfma_f32_16x16x32_bf16 v[152:155], a[60:63], v[120:123], v[152:155]
    v_mfma_f32_16x16x32_bf16 v[160:163], a[92:95], v[120:123], v[160:163]
    v_mfma_f32_16x16x32_bf16 v[168:171], a[124:127], v[120:123], v[168:171]
O_SM0:
    s_cmp_eq_u32 s37, 1
    s_nop 2
    s_cbranch_scc1 O_SM1
    s_waitcnt vmcnt(9)
    v_mfma_f32_16x16x32_bf16 v[148:151], v[32:35], v[132:135], 0
    v_mfma_f32_16x16x32_bf16 v[156:159], v[40:43], v[132:135], 0
    v_mfma_f32_16x16x32_bf16 v[164:167], v[48:51], v[132:135], 0
    v_mfma_f32_16x16x32_bf16 v[172:175], v[56:59], v[132:135], 0
    s_waitcnt vmcnt(8)
    v_mfma_f32_16x16x32_bf16 v[148:151], v[36:39], v[140:143], v[148:151]
    v_mfma_f32_16x16x32_bf16 v[156:159], v[44:47], v[140:143], v[156:159]
    v_mfma_f32_16x16x32_bf16 v[164:167], v[52:55], v[140:143], v[164:167]
    v_mfma_f32_16x16x32_bf16 v[172:175], v[60:63], v[140:143], v[172:175]
    s_waitcnt vmcnt(7)
    v_mfma_f32_16x16x32_bf16 v[148:151], a[0:3], v[68:71], v[148:151]
    v_mfma_f32_16x16x32_bf16 v[156:159], a[32:35], v[68:71], v[156:159]
    v_mfma_f32_16x16x32_bf16 v[164:167], a[64:67], v[68:71], v[164:167]
    v_mfma_f32_16x16x32_bf16 v[172:175], a[96:99], v[68:71], v[172:175]
    s_waitcnt vmcnt(6)
    v_mfma_f32_16x16x32_bf16 v[148:151], a[4:7], v[76:79], v[148:151]
    v_mfma_f32_16x16x32_bf16 v[156:159], a[36:39], v[76:79], v[156:159]
    v_mfma_f32_16x16x32_bf16 v[164:167], a[68:71], v[76:79], v[164:167]
    v_mfma_f32_16x16x32_bf16 v[172:175], a[100:103], v[76:79], v[172:175]
    s_waitcnt vmcnt(5)
    v_mfma_f32_16x16x32_bf16 v[148:151], a[8:11], v[84:87], v[148:151]
    v_mfma_f32_16x16x32_bf16 v[156:159], a[40:43], v[84:87], v[156:159]
    v_mfma_f32_16x16x32_bf16 v[164:167], a[72:75], v[84:87], v[164:167]
    v_mfma_f32_16x16x32_bf16 v[172:175], a[104:107], v[84:87], v[172:175]
    s_waitcnt vmcnt(4)
    v_mfma_f32_16x16x32_bf16 v[148:151], a[12:15], v[92:95], v[148:151]
    v_mfma_f32_16x16x32_bf16 v[156:159], a[44:47], v[92:95], v[156:159]
    v_mfma_f32_16x16x32_bf16 v[164:167], a[76:79], v[92:95], v[164:167]
    v_mfma_f32_16x16x32_bf16 v[172:175], a[108:111], v[92:95], v[172:175]
    s_waitcnt vmcnt(3)
    v_mfma_f32_16x16x32_bf16 v[148:151], a[16:19], v[100:103], v[148:151]
    v_mfma_f32_16x16x32_bf16 v[156:159], a[48:51], v[100:103], v[156:159]
    v_mfma_f32_16x16x32_bf16 v[164:167], a[80:83], v[100:103], v[164:167]
    v_mfma_f32_16x16x32_bf16 v[172:175], a[112:115], v[100:103], v[172:175]
    s_waitcnt vmcnt(2)
    v_mfma_f32_16x16x32_bf16 v[148:151], a[20:23], v[108:111], v[148:151]
    v_mfma_f32_16x16x32_bf16 v[156:159], a[52:55], v[108:111], v[156:159]
    v_mfma_f32_16x16x32_bf16 v[164:167], a[84:87], v[108:111], v[164:167]
    v_mfma_f32_16x16x32_bf16 v[172:175], a[116:119], v[108:111], v[172:175]
    s_waitcnt vmcnt(1)
    v_mfma_f32_16x16x32_bf16 v[148:151], a[24:27], v[116:119], v[148:151]
    v_mfma_f32_16x16x32_bf16 v[156:159], a[56:59], v[116:119], v[156:159]
    v_mfma_f32_16x16x32_bf16 v[164:167], a[88:91], v[116:119], v[164:167]
    v_mfma_f32_16x16x32_bf16 v[172:175], a[120:123], v[116:119], v[172:175]
    s_waitcnt vmcnt(0)
    v_mfma_f32_16x16x32_bf16 v[148:151], a[28:31], v[124:127], v[148:151]
    v_mfma_f32_16x16x32_bf16 v[156:159], a[60:63], v[124:127], v[156:159]
    v_mfma_f32_16x16x32_bf16 v[164:167], a[92:95], v[124:127], v[164:167]
    v_mfma_f32_16x16x32_bf16 v[172:175], a[124:127], v[124:127], v[172:175]
O_SM1:
    ds_write_b128 v15, v[144:147] offset:0
    s_nop 3
    ds_write_b128 v15, v[148:151] offset:1024
    ds_write_b128 v15, v[152:155] offset:2048
    ds_write_b128 v15, v[156:159] offset:3072
    ds_write_b128 v15, v[160:163] offset:4096
    ds_write_b128 v15, v[164:167] offset:5120
    ds_write_b128 v15, v[168:171] offset:6144
    ds_write_b128 v15, v[172:175] offset:7168
    s_waitcnt lgkmcnt(0)
    s_barrier
    ds_read_b128 v[176:179], v16 offset:0
    ds_read_b128 v[180:183], v16 offset:1024
    ds_read_b128 v[184:187], v16 offset:8192
    ds_read_b128 v[188:191], v16 offset:9216
    ds_read_b128 v[192:195], v16 offset:16384
    ds_read_b128 v[196:199], v16 offset:17408
    ds_read_b128 v[200:203], v16 offset:24576
    ds_read_b128 v[204:207], v16 offset:25600
    s_waitcnt lgkmcnt(0)
    s_barrier
    v_add_f32 v176, v176, v184
    v_add_f32 v177, v177, v185
    v_add_f32 v178, v178, v186
    v_add_f32 v179, v179, v187
    v_add_f32 v180, v180, v188
    v_add_f32 v181, v181, v189
    v_add_f32 v182, v182, v190
    v_add_f32 v183, v183, v191
    v_add_f32 v176, v176, v192
    v_add_f32 v177, v177, v193
    v_add_f32 v178, v178, v194
    v_add_f32 v179, v179, v195
    v_add_f32 v180, v180, v196
    v_add_f32 v181, v181, v197
    v_add_f32 v182, v182, v198
    v_add_f32 v183, v183, v199
    v_add_f32 v176, v176, v200
    v_add_f32 v177, v177, v201
    v_add_f32 v178, v178, v202
    v_add_f32 v179, v179, v203
    v_add_f32 v180, v180, v204
    v_add_f32 v181, v181, v205
    v_add_f32 v182, v182, v206
    v_add_f32 v183, v183, v207
    v_cvt_pk_bf16_f32 v184, v176, v177
    v_cvt_pk_bf16_f32 v185, v178, v179
    v_cvt_pk_bf16_f32 v186, v180, v181
    v_cvt_pk_bf16_f32 v187, v182, v183
    s_mul_i32 s46, s34, 81920
    v_permlane16_swap_b32 v184, v186
    v_permlane16_swap_b32 v185, v187
    s_mov_b64 exec, s[60:61]
    buffer_store_dwordx4 v[184:187], v17, s[28:31], s46 offen nt
    s_mov_b64 exec, -1
    s_cmp_lt_u32 s34, 12
    s_cselect_b32 s46, 3, 6
    s_add_u32 s34, s34, s46
    s_cmp_lt_u32 s34, 63
    s_cbranch_scc1 O_LOOP
    s_sub_u32 s46, s34, 63
    s_cmp_ge_u32 s46, 4
    s_cbranch_scc1 O_END
    s_mov_b32 s34, 63
    s_lshr_b32 s37, s46, 1
    s_xor_b32 s37, s37, 1
    s_and_b32 s47, s46, 1
    s_lshl_b32 s47, s47, 3
    s_lshl_b32 s58, 0x00ff00ff, s47
    s_mov_b32 s59, s58
    s_lshl_b32 s46, s46, 3
    s_lshl_b32 s60, 0xff, s46
    s_mov_b32 s61, s60
    s_branch O_LOOP
O_END:
    s_endpgm
EXIT:
    s_endpgm
.p2align 6
ROLE_U:
    s_load_dwordx4 s[40:43], s[0:1], 32
    s_mul_i32 s37, s2, 384
    s_waitcnt lgkmcnt(0)
    s_mov_b32 s16, s40
    s_mov_b32 s17, s41
    s_mov_b32 s18, 7864320
    s_mov_b32 s19, 0x20000
    s_mov_b32 s20, s42
    s_mov_b32 s21, s43
    s_mov_b32 s22, 7864320
    s_mov_b32 s23, 0x20000
    s_and_b32 s56, s52, 3
    s_lshl_b32 s35, s32, 1
    s_add_u32 s35, s35, 1
    s_cmp_eq_u32 s32, 0
    s_cselect_b32 s35, 0, s35
    s_mul_i32 s39, s32, 6144
    s_movk_i32 s46, 2731
    s_mul_i32 s47, s32, 384
    v_add_u32 v15, s47, v2
    v_add_u32 v15, 0, v15
    v_mul_lo_u32 v16, v15, s46
    v_lshrrev_b32 v16, 16, v16
    v_mul_u32_u24 v17, 24, v16
    v_sub_u32 v17, v15, v17
    v_bfe_u32 v18, v16, 4, 1
    v_lshlrev_b32 v18, 2, v18
    v_bfe_u32 v19, v16, 2, 1
    v_lshl_add_u32 v18, v19, 1, v18
    v_xor_b32 v17, v17, v18
    v_mul_u32_u24 v16, 12288, v16
    v_lshl_add_u32 v16, v17, 4, v16
    v_add_u32 v6, s37, v16
    v_add_u32 v15, s47, v2
    v_add_u32 v15, 64, v15
    v_mul_lo_u32 v16, v15, s46
    v_lshrrev_b32 v16, 16, v16
    v_mul_u32_u24 v17, 24, v16
    v_sub_u32 v17, v15, v17
    v_bfe_u32 v18, v16, 4, 1
    v_lshlrev_b32 v18, 2, v18
    v_bfe_u32 v19, v16, 2, 1
    v_lshl_add_u32 v18, v19, 1, v18
    v_xor_b32 v17, v17, v18
    v_mul_u32_u24 v16, 12288, v16
    v_lshl_add_u32 v16, v17, 4, v16
    v_add_u32 v7, s37, v16
    v_add_u32 v15, s47, v2
    v_add_u32 v15, 128, v15
    v_mul_lo_u32 v16, v15, s46
    v_lshrrev_b32 v16, 16, v16
    v_mul_u32_u24 v17, 24, v16
    v_sub_u32 v17, v15, v17
    v_bfe_u32 v18, v16, 4, 1
    v_lshlrev_b32 v18, 2, v18
    v_bfe_u32 v19, v16, 2, 1
    v_lshl_add_u32 v18, v19, 1, v18
    v_xor_b32 v17, v17, v18
    v_mul_u32_u24 v16, 12288, v16
    v_lshl_add_u32 v16, v17, 4, v16
    v_add_u32 v8, s37, v16
    v_add_u32 v15, s47, v2
    v_add_u32 v15, 192, v15
    v_mul_lo_u32 v16, v15, s46
    v_lshrrev_b32 v16, 16, v16
    v_mul_u32_u24 v17, 24, v16
    v_sub_u32 v17, v15, v17
    v_bfe_u32 v18, v16, 4, 1
    v_lshlrev_b32 v18, 2, v18
    v_bfe_u32 v19, v16, 2, 1
    v_lshl_add_u32 v18, v19, 1, v18
    v_xor_b32 v17, v17, v18
    v_mul_u32_u24 v16, 12288, v16
    v_lshl_add_u32 v16, v17, 4, v16
    v_add_u32 v9, s37, v16
    v_add_u32 v15, s47, v2
    v_add_u32 v15, 256, v15
    v_mul_lo_u32 v16, v15, s46
    v_lshrrev_b32 v16, 16, v16
    v_mul_u32_u24 v17, 24, v16
    v_sub_u32 v17, v15, v17
    v_bfe_u32 v18, v16, 4, 1
    v_lshlrev_b32 v18, 2, v18
    v_bfe_u32 v19, v16, 2, 1
    v_lshl_add_u32 v18, v19, 1, v18
    v_xor_b32 v17, v17, v18
    v_mul_u32_u24 v16, 12288, v16
    v_lshl_add_u32 v16, v17, 4, v16
    v_add_u32 v10, s37, v16
    v_add_u32 v15, s47, v2
    v_add_u32 v15, 320, v15
    v_mul_lo_u32 v16, v15, s46
    v_lshrrev_b32 v16, 16, v16
    v_mul_u32_u24 v17, 24, v16
    v_sub_u32 v17, v15, v17
    v_bfe_u32 v18, v16, 4, 1
    v_lshlrev_b32 v18, 2, v18
    v_bfe_u32 v19, v16, 2, 1
    v_lshl_add_u32 v18, v19, 1, v18
    v_xor_b32 v17, v17, v18
    v_mul_u32_u24 v16, 12288, v16
    v_lshl_add_u32 v16, v17, 4, v16
    v_add_u32 v11, s37, v16
    v_lshrrev_b32 v15, 5, v2
    v_lshlrev_b32 v15, 3, v15
    v_bfe_u32 v16, v2, 4, 1
    v_lshl_add_u32 v15, v16, 1, v15
    v_bfe_u32 v16, v2, 3, 1
    v_lshl_add_u32 v15, v16, 2, v15
    v_lshlrev_b32 v18, 1, v16
    v_bfe_u32 v16, v2, 2, 1
    v_lshl_add_u32 v15, v16, 4, v15
    v_lshl_add_u32 v18, v16, 2, v18
    v_mul_u32_u24 v15, 384, v15
    v_and_b32 v16, 3, v2
    v_lshl_add_u32 v15, v16, 3, v15
    s_mul_i32 s46, s32, 2
    s_add_u32 s46, s46, 0
    v_xor_b32 v16, s46, v18
    v_lshl_add_u32 v12, v16, 4, v15
    s_mul_i32 s46, s32, 2
    s_add_u32 s46, s46, 8
    v_xor_b32 v16, s46, v18
    v_lshl_add_u32 v13, v16, 4, v15
    s_mul_i32 s46, s32, 2
    s_add_u32 s46, s46, 16
    v_xor_b32 v16, s46, v18
    v_lshl_add_u32 v14, v16, 4, v15
    s_cmp_eq_u32 s32, 1
    s_cbranch_scc1 U_L1
    s_cmp_eq_u32 s32, 2
    s_cbranch_scc1 U_L2
    s_cmp_eq_u32 s32, 3
    s_cbranch_scc1 U_L3
    s_mov_b32 s46, 0
    s_add_u32 m0, s39, 0
    s_nop 0
    buffer_load_dwordx4 v6, s[16:19], s46 offen  lds
    s_add_u32 m0, s39, 1024
    s_nop 0
    buffer_load_dwordx4 v7, s[16:19], s46 offen  lds
    s_add_u32 m0, s39, 2048
    s_nop 0
    buffer_load_dwordx4 v8, s[16:19], s46 offen  lds
    s_add_u32 m0, s39, 3072
    s_nop 0
    buffer_load_dwordx4 v9, s[16:19], s46 offen  lds
    s_add_u32 m0, s39, 4096
    s_nop 0
    buffer_load_dwordx4 v10, s[16:19], s46 offen  lds
    s_add_u32 m0, s39, 5120
    s_nop 0
    buffer_load_dwordx4 v11, s[16:19], s46 offen  lds
    s_mov_b32 s46, 786432
    s_add_u32 m0, s39, 24576
    s_nop 0
    buffer_load_dwordx4 v6, s[16:19], s46 offen  lds
    s_add_u32 m0, s39, 25600
    s_nop 0
    buffer_load_dwordx4 v7, s[16:19], s46 offen  lds
    s_add_u32 m0, s39, 26624
    s_nop 0
    buffer_load_dwordx4 v8, s[16:19], s46 offen  lds
    s_add_u32 m0, s39, 27648
    s_nop 0
    buffer_load_dwordx4 v9, s[16:19], s46 offen  lds
    s_add_u32 m0, s39, 28672
    s_nop 0
    buffer_load_dwordx4 v10, s[16:19], s46 offen  lds
    s_add_u32 m0, s39, 29696
    s_nop 0
    buffer_load_dwordx4 v11, s[16:19], s46 offen  lds
    s_mov_b32 s46, 1572864
    s_add_u32 m0, s39, 49152
    s_nop 0
    buffer_load_dwordx4 v6, s[16:19], s46 offen  lds
    s_add_u32 m0, s39, 50176
    s_nop 0
    buffer_load_dwordx4 v7, s[16:19], s46 offen  lds
    s_add_u32 m0, s39, 51200
    s_nop 0
    buffer_load_dwordx4 v8, s[16:19], s46 offen  lds
    s_add_u32 m0, s39, 52224
    s_nop 0
    buffer_load_dwordx4 v9, s[16:19], s46 offen  lds
    s_add_u32 m0, s39, 53248
    s_nop 0
    buffer_load_dwordx4 v10, s[16:19], s46 offen  lds
    s_add_u32 m0, s39, 54272
    s_nop 0
    buffer_load_dwordx4 v11, s[16:19], s46 offen  lds
    s_mov_b32 s46, 2359296
    s_add_u32 m0, s39, 73728
    s_nop 0
    buffer_load_dwordx4 v6, s[16:19], s46 offen  lds
    s_add_u32 m0, s39, 74752
    s_nop 0
    buffer_load_dwordx4 v7, s[16:19], s46 offen  lds
    s_add_u32 m0, s39, 75776
    s_nop 0
    buffer_load_dwordx4 v8, s[16:19], s46 offen  lds
    s_add_u32 m0, s39, 76800
    s_nop 0
    buffer_load_dwordx4 v9, s[16:19], s46 offen  lds
    s_add_u32 m0, s39, 77824
    s_nop 0
    buffer_load_dwordx4 v10, s[16:19], s46 offen  lds
    s_add_u32 m0, s39, 78848
    s_nop 0
    buffer_load_dwordx4 v11, s[16:19], s46 offen  lds
    s_mov_b32 s46, 3145728
    s_add_u32 m0, s39, 98304
    s_nop 0
    buffer_load_dwordx4 v6, s[16:19], s46 offen  lds
    s_add_u32 m0, s39, 99328
    s_nop 0
    buffer_load_dwordx4 v7, s[16:19], s46 offen  lds
    s_add_u32 m0, s39, 100352
    s_nop 0
    buffer_load_dwordx4 v8, s[16:19], s46 offen  lds
    s_add_u32 m0, s39, 101376
    s_nop 0
    buffer_load_dwordx4 v9, s[16:19], s46 offen  lds
    s_add_u32 m0, s39, 102400
    s_nop 0
    buffer_load_dwordx4 v10, s[16:19], s46 offen  lds
    s_add_u32 m0, s39, 103424
    s_nop 0
    buffer_load_dwordx4 v11, s[16:19], s46 offen  lds
    s_waitcnt vmcnt(24)
    s_barrier
    ds_read_b64_tr_b16 v[32:33], v12 offset:0
    ds_read_b64_tr_b16 v[34:35], v12 offset:384
    ds_read_b64_tr_b16 v[36:37], v12 offset:12288
    ds_read_b64_tr_b16 v[38:39], v12 offset:12672
    ds_read_b64_tr_b16 a[0:1], v13 offset:0
    ds_read_b64_tr_b16 a[2:3], v13 offset:384
    ds_read_b64_tr_b16 a[4:5], v13 offset:12288
    ds_read_b64_tr_b16 a[6:7], v13 offset:12672
    ds_read_b64_tr_b16 a[8:9], v14 offset:0
    ds_read_b64_tr_b16 a[10:11], v14 offset:384
    ds_read_b64_tr_b16 a[12:13], v14 offset:12288
    ds_read_b64_tr_b16 a[14:15], v14 offset:12672
    s_mov_b32 s46, 3932160
    s_add_u32 m0, s39, 122880
    s_nop 0
    buffer_load_dwordx4 v6, s[16:19], s46 offen  lds
    s_add_u32 m0, s39, 123904
    s_nop 0
    buffer_load_dwordx4 v7, s[16:19], s46 offen  lds
    s_add_u32 m0, s39, 124928
    s_nop 0
    buffer_load_dwordx4 v8, s[16:19], s46 offen  lds
    s_add_u32 m0, s39, 125952
    s_nop 0
    buffer_load_dwordx4 v9, s[16:19], s46 offen  lds
    s_add_u32 m0, s39, 126976
    s_nop 0
    buffer_load_dwordx4 v10, s[16:19], s46 offen  lds
    s_add_u32 m0, s39, 128000
    s_nop 0
    buffer_load_dwordx4 v11, s[16:19], s46 offen  lds
    s_waitcnt lgkmcnt(0)
    s_waitcnt vmcnt(24)
    s_barrier
    ds_read_b64_tr_b16 a[16:17], v12 offset:24576
    ds_read_b64_tr_b16 a[18:19], v12 offset:24960
    ds_read_b64_tr_b16 a[20:21], v12 offset:36864
    ds_read_b64_tr_b16 a[22:23], v12 offset:37248
    ds_read_b64_tr_b16 a[24:25], v13 offset:24576
    ds_read_b64_tr_b16 a[26:27], v13 offset:24960
    ds_read_b64_tr_b16 a[28:29], v13 offset:36864
    ds_read_b64_tr_b16 a[30:31], v13 offset:37248
    ds_read_b64_tr_b16 a[32:33], v14 offset:24576
    ds_read_b64_tr_b16 a[34:35], v14 offset:24960
    ds_read_b64_tr_b16 a[36:37], v14 offset:36864
    ds_read_b64_tr_b16 a[38:39], v14 offset:37248
    s_mov_b32 s46, 4718592
    s_add_u32 m0, s39, 0
    s_nop 0
    buffer_load_dwordx4 v6, s[16:19], s46 offen  lds
    s_add_u32 m0, s39, 1024
    s_nop 0
    buffer_load_dwordx4 v7, s[16:19], s46 offen  lds
    s_add_u32 m0, s39, 2048
    s_nop 0
    buffer_load_dwordx4 v8, s[16:19], s46 offen  lds
    s_add_u32 m0, s39, 3072
    s_nop 0
    buffer_load_dwordx4 v9, s[16:19], s46 offen  lds
    s_add_u32 m0, s39, 4096
    s_nop 0
    buffer_load_dwordx4 v10, s[16:19], s46 offen  lds
    s_add_u32 m0, s39, 5120
    s_nop 0
    buffer_load_dwordx4 v11, s[16:19], s46 offen  lds
    s_waitcnt lgkmcnt(0)
    v_add_u32 v12, 49152, v12
    v_add_u32 v13, 49152, v13
    v_add_u32 v14, 49152, v14
    s_waitcnt vmcnt(24)
    s_barrier
    ds_read_b64_tr_b16 a[40:41], v12 offset:0
    ds_read_b64_tr_b16 a[42:43], v12 offset:384
    ds_read_b64_tr_b16 a[44:45], v12 offset:12288
    ds_read_b64_tr_b16 a[46:47], v12 offset:12672
    ds_read_b64_tr_b16 a[48:49], v13 offset:0
    ds_read_b64_tr_b16 a[50:51], v13 offset:384
    ds_read_b64_tr_b16 a[52:53], v13 offset:12288
    ds_read_b64_tr_b16 a[54:55], v13 offset:12672
    ds_read_b64_tr_b16 v[40:41], v14 offset:0
    ds_read_b64_tr_b16 v[42:43], v14 offset:384
    ds_read_b64_tr_b16 v[44:45], v14 offset:12288
    ds_read_b64_tr_b16 v[46:47], v14 offset:12672
    s_mov_b32 s46, 5505024
    s_add_u32 m0, s39, 24576
    s_nop 0
    buffer_load_dwordx4 v6, s[16:19], s46 offen  lds
    s_add_u32 m0, s39, 25600
    s_nop 0
    buffer_load_dwordx4 v7, s[16:19], s46 offen  lds
    s_add_u32 m0, s39, 26624
    s_nop 0
    buffer_load_dwordx4 v8, s[16:19], s46 offen  lds
    s_add_u32 m0, s39, 27648
    s_nop 0
    buffer_load_dwordx4 v9, s[16:19], s46 offen  lds
    s_add_u32 m0, s39, 28672
    s_nop 0
    buffer_load_dwordx4 v10, s[16:19], s46 offen  lds
    s_add_u32 m0, s39, 29696
    s_nop 0
    buffer_load_dwordx4 v11, s[16:19], s46 offen  lds
    s_waitcnt lgkmcnt(0)
    s_waitcnt vmcnt(24)
    s_barrier
    ds_read_b64_tr_b16 v[48:49], v12 offset:24576
    ds_read_b64_tr_b16 v[50:51], v12 offset:24960
    ds_read_b64_tr_b16 v[52:53], v12 offset:36864
    ds_read_b64_tr_b16 v[54:55], v12 offset:37248
    ds_read_b64_tr_b16 v[64:65], v13 offset:24576
    ds_read_b64_tr_b16 v[66:67], v13 offset:24960
    ds_read_b64_tr_b16 v[68:69], v13 offset:36864
    ds_read_b64_tr_b16 v[70:71], v13 offset:37248
    ds_read_b64_tr_b16 v[80:81], v14 offset:24576
    ds_read_b64_tr_b16 v[82:83], v14 offset:24960
    ds_read_b64_tr_b16 v[84:85], v14 offset:36864
    ds_read_b64_tr_b16 v[86:87], v14 offset:37248
    s_mov_b32 s46, 6291456
    s_add_u32 m0, s39, 49152
    s_nop 0
    buffer_load_dwordx4 v6, s[16:19], s46 offen  lds
    s_add_u32 m0, s39, 50176
    s_nop 0
    buffer_load_dwordx4 v7, s[16:19], s46 offen  lds
    s_add_u32 m0, s39, 51200
    s_nop 0
    buffer_load_dwordx4 v8, s[16:19], s46 offen  lds
    s_add_u32 m0, s39, 52224
    s_nop 0
    buffer_load_dwordx4 v9, s[16:19], s46 offen  lds
    s_add_u32 m0, s39, 53248
    s_nop 0
    buffer_load_dwordx4 v10, s[16:19], s46 offen  lds
    s_add_u32 m0, s39, 54272
    s_nop 0
    buffer_load_dwordx4 v11, s[16:19], s46 offen  lds
    s_waitcnt lgkmcnt(0)
    v_add_u32 v12, 49152, v12
    v_add_u32 v13, 49152, v13
    v_add_u32 v14, 49152, v14
    s_waitcnt vmcnt(24)
    s_barrier
    ds_read_b64_tr_b16 v[56:57], v12 offset:0
    ds_read_b64_tr_b16 v[58:59], v12 offset:384
    ds_read_b64_tr_b16 v[60:61], v12 offset:12288
    ds_read_b64_tr_b16 v[62:63], v12 offset:12672
    ds_read_b64_tr_b16 a[96:97], v13 offset:0
    ds_read_b64_tr_b16 a[98:99], v13 offset:384
    ds_read_b64_tr_b16 a[100:101], v13 offset:12288
    ds_read_b64_tr_b16 a[102:103], v13 offset:12672
    ds_read_b64_tr_b16 a[136:137], v14 offset:0
    ds_read_b64_tr_b16 a[138:139], v14 offset:384
    ds_read_b64_tr_b16 a[140:141], v14 offset:12288
    ds_read_b64_tr_b16 a[142:143], v14 offset:12672
    s_mov_b32 s46, 7077888
    s_add_u32 m0, s39, 73728
    s_nop 0
    buffer_load_dwordx4 v6, s[16:19], s46 offen  lds
    s_add_u32 m0, s39, 74752
    s_nop 0
    buffer_load_dwordx4 v7, s[16:19], s46 offen  lds
    s_add_u32 m0, s39, 75776
    s_nop 0
    buffer_load_dwordx4 v8, s[16:19], s46 offen  lds
    s_add_u32 m0, s39, 76800
    s_nop 0
    buffer_load_dwordx4 v9, s[16:19], s46 offen  lds
    s_add_u32 m0, s39, 77824
    s_nop 0
    buffer_load_dwordx4 v10, s[16:19], s46 offen  lds
    s_add_u32 m0, s39, 78848
    s_nop 0
    buffer_load_dwordx4 v11, s[16:19], s46 offen  lds
    s_waitcnt lgkmcnt(0)
    s_waitcnt vmcnt(24)
    s_barrier
    ds_read_b64_tr_b16 a[56:57], v12 offset:24576
    ds_read_b64_tr_b16 a[58:59], v12 offset:24960
    ds_read_b64_tr_b16 a[60:61], v12 offset:36864
    ds_read_b64_tr_b16 a[62:63], v12 offset:37248
    ds_read_b64_tr_b16 a[104:105], v13 offset:24576
    ds_read_b64_tr_b16 a[106:107], v13 offset:24960
    ds_read_b64_tr_b16 a[108:109], v13 offset:36864
    ds_read_b64_tr_b16 a[110:111], v13 offset:37248
    ds_read_b64_tr_b16 a[144:145], v14 offset:24576
    ds_read_b64_tr_b16 a[146:147], v14 offset:24960
    ds_read_b64_tr_b16 a[148:149], v14 offset:36864
    ds_read_b64_tr_b16 a[150:151], v14 offset:37248
    s_waitcnt lgkmcnt(0)
    v_add_u32 v12, 4294868992, v12
    v_add_u32 v13, 4294868992, v13
    v_add_u32 v14, 4294868992, v14
    s_waitcnt vmcnt(18)
    s_barrier
    ds_read_b64_tr_b16 a[64:65], v12 offset:0
    ds_read_b64_tr_b16 a[66:67], v12 offset:384
    ds_read_b64_tr_b16 a[68:69], v12 offset:12288
    ds_read_b64_tr_b16 a[70:71], v12 offset:12672
    ds_read_b64_tr_b16 v[72:73], v13 offset:0
    ds_read_b64_tr_b16 v[74:75], v13 offset:384
    ds_read_b64_tr_b16 v[76:77], v13 offset:12288
    ds_read_b64_tr_b16 v[78:79], v13 offset:12672
    ds_read_b64_tr_b16 a[152:153], v14 offset:0
    ds_read_b64_tr_b16 a[154:155], v14 offset:384
    ds_read_b64_tr_b16 a[156:157], v14 offset:12288
    ds_read_b64_tr_b16 a[158:159], v14 offset:12672
    s_waitcnt lgkmcnt(0)
    s_waitcnt vmcnt(12)
    s_barrier
    ds_read_b64_tr_b16 a[72:73], v12 offset:24576
    ds_read_b64_tr_b16 a[74:75], v12 offset:24960
    ds_read_b64_tr_b16 a[76:77], v12 offset:36864
    ds_read_b64_tr_b16 a[78:79], v12 offset:37248
    ds_read_b64_tr_b16 a[112:113], v13 offset:24576
    ds_read_b64_tr_b16 a[114:115], v13 offset:24960
    ds_read_b64_tr_b16 a[116:117], v13 offset:36864
    ds_read_b64_tr_b16 a[118:119], v13 offset:37248
    ds_read_b64_tr_b16 v[88:89], v14 offset:24576
    ds_read_b64_tr_b16 v[90:91], v14 offset:24960
    ds_read_b64_tr_b16 v[92:93], v14 offset:36864
    ds_read_b64_tr_b16 v[94:95], v14 offset:37248
    s_waitcnt lgkmcnt(0)
    v_add_u32 v12, 49152, v12
    v_add_u32 v13, 49152, v13
    v_add_u32 v14, 49152, v14
    s_waitcnt vmcnt(6)
    s_barrier
    ds_read_b64_tr_b16 a[80:81], v12 offset:0
    ds_read_b64_tr_b16 a[82:83], v12 offset:384
    ds_read_b64_tr_b16 a[84:85], v12 offset:12288
    ds_read_b64_tr_b16 a[86:87], v12 offset:12672
    ds_read_b64_tr_b16 a[120:121], v13 offset:0
    ds_read_b64_tr_b16 a[122:123], v13 offset:384
    ds_read_b64_tr_b16 a[124:125], v13 offset:12288
    ds_read_b64_tr_b16 a[126:127], v13 offset:12672
    ds_read_b64_tr_b16 a[160:161], v14 offset:0
    ds_read_b64_tr_b16 a[162:163], v14 offset:384
    ds_read_b64_tr_b16 a[164:165], v14 offset:12288
    ds_read_b64_tr_b16 a[166:167], v14 offset:12672
    s_waitcnt lgkmcnt(0)
    s_waitcnt vmcnt(0)
    s_barrier
    ds_read_b64_tr_b16 a[88:89], v12 offset:24576
    ds_read_b64_tr_b16 a[90:91], v12 offset:24960
    ds_read_b64_tr_b16 a[92:93], v12 offset:36864
    ds_read_b64_tr_b16 a[94:95], v12 offset:37248
    ds_read_b64_tr_b16 a[128:129], v13 offset:24576
    ds_read_b64_tr_b16 a[130:131], v13 offset:24960
    ds_read_b64_tr_b16 a[132:133], v13 offset:36864
    ds_read_b64_tr_b16 a[134:135], v13 offset:37248
    ds_read_b64_tr_b16 a[168:169], v14 offset:24576
    ds_read_b64_tr_b16 a[170:171], v14 offset:24960
    ds_read_b64_tr_b16 a[172:173], v14 offset:36864
    ds_read_b64_tr_b16 a[174:175], v14 offset:37248
    s_waitcnt lgkmcnt(0)
    v_add_u32 v12, 49152, v12
    v_add_u32 v13, 49152, v13
    v_add_u32 v14, 49152, v14
    s_barrier
    s_branch U_LD
U_L1:
    s_mov_b32 s46, 0
    s_add_u32 m0, s39, 0
    s_nop 0
    buffer_load_dwordx4 v6, s[16:19], s46 offen  lds
    s_add_u32 m0, s39, 1024
    s_nop 0
    buffer_load_dwordx4 v7, s[16:19], s46 offen  lds
    s_add_u32 m0, s39, 2048
    s_nop 0
    buffer_load_dwordx4 v8, s[16:19], s46 offen  lds
    s_add_u32 m0, s39, 3072
    s_nop 0
    buffer_load_dwordx4 v9, s[16:19], s46 offen  lds
    s_add_u32 m0, s39, 4096
    s_nop 0
    buffer_load_dwordx4 v10, s[16:19], s46 offen  lds
    s_add_u32 m0, s39, 5120
    s_nop 0
    buffer_load_dwordx4 v11, s[16:19], s46 offen  lds
    s_mov_b32 s46, 786432
    s_add_u32 m0, s39, 24576
    s_nop 0
    buffer_load_dwordx4 v6, s[16:19], s46 offen  lds
    s_add_u32 m0, s39, 25600
    s_nop 0
    buffer_load_dwordx4 v7, s[16:19], s46 offen  lds
    s_add_u32 m0, s39, 26624
    s_nop 0
    buffer_load_dwordx4 v8, s[16:19], s46 offen  lds
    s_add_u32 m0, s39, 27648
    s_nop 0
    buffer_load_dwordx4 v9, s[16:19], s46 offen  lds
    s_add_u32 m0, s39, 28672
    s_nop 0
    buffer_load_dwordx4 v10, s[16:19], s46 offen  lds
    s_add_u32 m0, s39, 29696
    s_nop 0
    buffer_load_dwordx4 v11, s[16:19], s46 offen  lds
    s_mov_b32 s46, 1572864
    s_add_u32 m0, s39, 49152
    s_nop 0
    buffer_load_dwordx4 v6, s[16:19], s46 offen  lds
    s_add_u32 m0, s39, 50176
    s_nop 0
    buffer_load_dwordx4 v7, s[16:19], s46 offen  lds
    s_add_u32 m0, s39, 51200
    s_nop 0
    buffer_load_dwordx4 v8, s[16:19], s46 offen  lds
    s_add_u32 m0, s39, 52224
    s_nop 0
    buffer_load_dwordx4 v9, s[16:19], s46 offen  lds
    s_add_u32 m0, s39, 53248
    s_nop 0
    buffer_load_dwordx4 v10, s[16:19], s46 offen  lds
    s_add_u32 m0, s39, 54272
    s_nop 0
    buffer_load_dwordx4 v11, s[16:19], s46 offen  lds
    s_mov_b32 s46, 2359296
    s_add_u32 m0, s39, 73728
    s_nop 0
    buffer_load_dwordx4 v6, s[16:19], s46 offen  lds
    s_add_u32 m0, s39, 74752
    s_nop 0
    buffer_load_dwordx4 v7, s[16:19], s46 offen  lds
    s_add_u32 m0, s39, 75776
    s_nop 0
    buffer_load_dwordx4 v8, s[16:19], s46 offen  lds
    s_add_u32 m0, s39, 76800
    s_nop 0
    buffer_load_dwordx4 v9, s[16:19], s46 offen  lds
    s_add_u32 m0, s39, 77824
    s_nop 0
    buffer_load_dwordx4 v10, s[16:19], s46 offen  lds
    s_add_u32 m0, s39, 78848
    s_nop 0
    buffer_load_dwordx4 v11, s[16:19], s46 offen  lds
    s_mov_b32 s46, 3145728
    s_add_u32 m0, s39, 98304
    s_nop 0
    buffer_load_dwordx4 v6, s[16:19], s46 offen  lds
    s_add_u32 m0, s39, 99328
    s_nop 0
    buffer_load_dwordx4 v7, s[16:19], s46 offen  lds
    s_add_u32 m0, s39, 100352
    s_nop 0
    buffer_load_dwordx4 v8, s[16:19], s46 offen  lds
    s_add_u32 m0, s39, 101376
    s_nop 0
    buffer_load_dwordx4 v9, s[16:19], s46 offen  lds
    s_add_u32 m0, s39, 102400
    s_nop 0
    buffer_load_dwordx4 v10, s[16:19], s46 offen  lds
    s_add_u32 m0, s39, 103424
    s_nop 0
    buffer_load_dwordx4 v11, s[16:19], s46 offen  lds
    s_waitcnt vmcnt(24)
    s_barrier
    ds_read_b64_tr_b16 a[72:73], v12 offset:0
    ds_read_b64_tr_b16 a[74:75], v12 offset:384
    ds_read_b64_tr_b16 a[76:77], v12 offset:12288
    ds_read_b64_tr_b16 a[78:79], v12 offset:12672
    ds_read_b64_tr_b16 a[112:113], v13 offset:0
    ds_read_b64_tr_b16 a[114:115], v13 offset:384
    ds_read_b64_tr_b16 a[116:117], v13 offset:12288
    ds_read_b64_tr_b16 a[118:119], v13 offset:12672
    ds_read_b64_tr_b16 v[88:89], v14 offset:0
    ds_read_b64_tr_b16 v[90:91], v14 offset:384
    ds_read_b64_tr_b16 v[92:93], v14 offset:12288
    ds_read_b64_tr_b16 v[94:95], v14 offset:12672
    s_mov_b32 s46, 3932160
    s_add_u32 m0, s39, 122880
    s_nop 0
    buffer_load_dwordx4 v6, s[16:19], s46 offen  lds
    s_add_u32 m0, s39, 123904
    s_nop 0
    buffer_load_dwordx4 v7, s[16:19], s46 offen  lds
    s_add_u32 m0, s39, 124928
    s_nop 0
    buffer_load_dwordx4 v8, s[16:19], s46 offen  lds
    s_add_u32 m0, s39, 125952
    s_nop 0
    buffer_load_dwordx4 v9, s[16:19], s46 offen  lds
    s_add_u32 m0, s39, 126976
    s_nop 0
    buffer_load_dwordx4 v10, s[16:19], s46 offen  lds
    s_add_u32 m0, s39, 128000
    s_nop 0
    buffer_load_dwordx4 v11, s[16:19], s46 offen  lds
    s_waitcnt lgkmcnt(0)
    s_waitcnt vmcnt(24)
    s_barrier
    ds_read_b64_tr_b16 a[80:81], v12 offset:24576
    ds_read_b64_tr_b16 a[82:83], v12 offset:24960
    ds_read_b64_tr_b16 a[84:85], v12 offset:36864
    ds_read_b64_tr_b16 a[86:87], v12 offset:37248
    ds_read_b64_tr_b16 a[120:121], v13 offset:24576
    ds_read_b64_tr_b16 a[122:123], v13 offset:24960
    ds_read_b64_tr_b16 a[124:125], v13 offset:36864
    ds_read_b64_tr_b16 a[126:127], v13 offset:37248
    ds_read_b64_tr_b16 a[160:161], v14 offset:24576
    ds_read_b64_tr_b16 a[162:163], v14 offset:24960
    ds_read_b64_tr_b16 a[164:165], v14 offset:36864
    ds_read_b64_tr_b16 a[166:167], v14 offset:37248
    s_mov_b32 s46, 4718592
    s_add_u32 m0, s39, 0
    s_nop 0
    buffer_load_dwordx4 v6, s[16:19], s46 offen  lds
    s_add_u32 m0, s39, 1024
    s_nop 0
    buffer_load_dwordx4 v7, s[16:19], s46 offen  lds
    s_add_u32 m0, s39, 2048
    s_nop 0
    buffer_load_dwordx4 v8, s[16:19], s46 offen  lds
    s_add_u32 m0, s39, 3072
    s_nop 0
    buffer_load_dwordx4 v9, s[16:19], s46 offen  lds
    s_add_u32 m0, s39, 4096
    s_nop 0
    buffer_load_dwordx4 v10, s[16:19], s46 offen  lds
    s_add_u32 m0, s39, 5120
    s_nop 0
    buffer_load_dwordx4 v11, s[16:19], s46 offen  lds
    s_waitcnt lgkmcnt(0)
    v_add_u32 v12, 49152, v12
    v_add_u32 v13, 49152, v13
    v_add_u32 v14, 49152, v14
    s_waitcnt vmcnt(24)
    s_barrier
    ds_read_b64_tr_b16 a[88:89], v12 offset:0
    ds_read_b64_tr_b16 a[90:91], v12 offset:384
    ds_read_b64_tr_b16 a[92:93], v12 offset:12288
    ds_read_b64_tr_b16 a[94:95], v12 offset:12672
    ds_read_b64_tr_b16 a[128:129], v13 offset:0
    ds_read_b64_tr_b16 a[130:131], v13 offset:384
    ds_read_b64_tr_b16 a[132:133], v13 offset:12288
    ds_read_b64_tr_b16 a[134:135], v13 offset:12672
    ds_read_b64_tr_b16 a[168:169], v14 offset:0
    ds_read_b64_tr_b16 a[170:171], v14 offset:384
    ds_read_b64_tr_b16 a[172:173], v14 offset:12288
    ds_read_b64_tr_b16 a[174:175], v14 offset:12672
    s_mov_b32 s46, 5505024
    s_add_u32 m0, s39, 24576
    s_nop 0
    buffer_load_dwordx4 v6, s[16:19], s46 offen  lds
    s_add_u32 m0, s39, 25600
    s_nop 0
    buffer_load_dwordx4 v7, s[16:19], s46 offen  lds
    s_add_u32 m0, s39, 26624
    s_nop 0
    buffer_load_dwordx4 v8, s[16:19], s46 offen  lds
    s_add_u32 m0, s39, 27648
    s_nop 0
    buffer_load_dwordx4 v9, s[16:19], s46 offen  lds
    s_add_u32 m0, s39, 28672
    s_nop 0
    buffer_load_dwordx4 v10, s[16:19], s46 offen  lds
    s_add_u32 m0, s39, 29696
    s_nop 0
    buffer_load_dwordx4 v11, s[16:19], s46 offen  lds
    s_waitcnt lgkmcnt(0)
    s_waitcnt vmcnt(24)
    s_barrier
    ds_read_b64_tr_b16 v[32:33], v12 offset:24576
    ds_read_b64_tr_b16 v[34:35], v12 offset:24960
    ds_read_b64_tr_b16 v[36:37], v12 offset:36864
    ds_read_b64_tr_b16 v[38:39], v12 offset:37248
    ds_read_b64_tr_b16 a[0:1], v13 offset:24576
    ds_read_b64_tr_b16 a[2:3], v13 offset:24960
    ds_read_b64_tr_b16 a[4:5], v13 offset:36864
    ds_read_b64_tr_b16 a[6:7], v13 offset:37248
    ds_read_b64_tr_b16 a[8:9], v14 offset:24576
    ds_read_b64_tr_b16 a[10:11], v14 offset:24960
    ds_read_b64_tr_b16 a[12:13], v14 offset:36864
    ds_read_b64_tr_b16 a[14:15], v14 offset:37248
    s_mov_b32 s46, 6291456
    s_add_u32 m0, s39, 49152
    s_nop 0
    buffer_load_dwordx4 v6, s[16:19], s46 offen  lds
    s_add_u32 m0, s39, 50176
    s_nop 0
    buffer_load_dwordx4 v7, s[16:19], s46 offen  lds
    s_add_u32 m0, s39, 51200
    s_nop 0
    buffer_load_dwordx4 v8, s[16:19], s46 offen  lds
    s_add_u32 m0, s39, 52224
    s_nop 0
    buffer_load_dwordx4 v9, s[16:19], s46 offen  lds
    s_add_u32 m0, s39, 53248
    s_nop 0
    buffer_load_dwordx4 v10, s[16:19], s46 offen  lds
    s_add_u32 m0, s39, 54272
    s_nop 0
    buffer_load_dwordx4 v11, s[16:19], s46 offen  lds
    s_waitcnt lgkmcnt(0)
    v_add_u32 v12, 49152, v12
    v_add_u32 v13, 49152, v13
    v_add_u32 v14, 49152, v14
    s_waitcnt vmcnt(24)
    s_barrier
    ds_read_b64_tr_b16 a[16:17], v12 offset:0
    ds_read_b64_tr_b16 a[18:19], v12 offset:384
    ds_read_b64_tr_b16 a[20:21], v12 offset:12288
    ds_read_b64_tr_b16 a[22:23], v12 offset:12672
    ds_read_b64_tr_b16 a[24:25], v13 offset:0
    ds_read_b64_tr_b16 a[26:27], v13 offset:384
    ds_read_b64_tr_b16 a[28:29], v13 offset:12288
    ds_read_b64_tr_b16 a[30:31], v13 offset:12672
    ds_read_b64_tr_b16 a[32:33], v14 offset:0
    ds_read_b64_tr_b16 a[34:35], v14 offset:384
    ds_read_b64_tr_b16 a[36:37], v14 offset:12288
    ds_read_b64_tr_b16 a[38:39], v14 offset:12672
    s_mov_b32 s46, 7077888
    s_add_u32 m0, s39, 73728
    s_nop 0
    buffer_load_dwordx4 v6, s[16:19], s46 offen  lds
    s_add_u32 m0, s39, 74752
    s_nop 0
    buffer_load_dwordx4 v7, s[16:19], s46 offen  lds
    s_add_u32 m0, s39, 75776
    s_nop 0
    buffer_load_dwordx4 v8, s[16:19], s46 offen  lds
    s_add_u32 m0, s39, 76800
    s_nop 0
    buffer_load_dwordx4 v9, s[16:19], s46 offen  lds
    s_add_u32 m0, s39, 77824
    s_nop 0
    buffer_load_dwordx4 v10, s[16:19], s46 offen  lds
    s_add_u32 m0, s39, 78848
    s_nop 0
    buffer_load_dwordx4 v11, s[16:19], s46 offen  lds
    s_waitcnt lgkmcnt(0)
    s_waitcnt vmcnt(24)
    s_barrier
    ds_read_b64_tr_b16 a[40:41], v12 offset:24576
    ds_read_b64_tr_b16 a[42:43], v12 offset:24960
    ds_read_b64_tr_b16 a[44:45], v12 offset:36864
    ds_read_b64_tr_b16 a[46:47], v12 offset:37248
    ds_read_b64_tr_b16 a[48:49], v13 offset:24576
    ds_read_b64_tr_b16 a[50:51], v13 offset:24960
    ds_read_b64_tr_b16 a[52:53], v13 offset:36864
    ds_read_b64_tr_b16 a[54:55], v13 offset:37248
    ds_read_b64_tr_b16 v[40:41], v14 offset:24576
    ds_read_b64_tr_b16 v[42:43], v14 offset:24960
    ds_read_b64_tr_b16 v[44:45], v14 offset:36864
    ds_read_b64_tr_b16 v[46:47], v14 offset:37248
    s_waitcnt lgkmcnt(0)
    v_add_u32 v12, 4294868992, v12
    v_add_u32 v13, 4294868992, v13
    v_add_u32 v14, 4294868992, v14
    s_waitcnt vmcnt(18)
    s_barrier
    ds_read_b64_tr_b16 v[48:49], v12 offset:0
    ds_read_b64_tr_b16 v[50:51], v12 offset:384
    ds_read_b64_tr_b16 v[52:53], v12 offset:12288
    ds_read_b64_tr_b16 v[54:55], v12 offset:12672
    ds_read_b64_tr_b16 v[64:65], v13 offset:0
    ds_read_b64_tr_b16 v[66:67], v13 offset:384
    ds_read_b64_tr_b16 v[68:69], v13 offset:12288
    ds_read_b64_tr_b16 v[70:71], v13 offset:12672
    ds_read_b64_tr_b16 v[80:81], v14 offset:0
    ds_read_b64_tr_b16 v[82:83], v14 offset:384
    ds_read_b64_tr_b16 v[84:85], v14 offset:12288
    ds_read_b64_tr_b16 v[86:87], v14 offset:12672
    s_waitcnt lgkmcnt(0)
    s_waitcnt vmcnt(12)
    s_barrier
    ds_read_b64_tr_b16 v[56:57], v12 offset:24576
    ds_read_b64_tr_b16 v[58:59], v12 offset:24960
    ds_read_b64_tr_b16 v[60:61], v12 offset:36864
    ds_read_b64_tr_b16 v[62:63], v12 offset:37248
    ds_read_b64_tr_b16 a[96:97], v13 offset:24576
    ds_read_b64_tr_b16 a[98:99], v13 offset:24960
    ds_read_b64_tr_b16 a[100:101], v13 offset:36864
    ds_read_b64_tr_b16 a[102:103], v13 offset:37248
    ds_read_b64_tr_b16 a[136:137], v14 offset:24576
    ds_read_b64_tr_b16 a[138:139], v14 offset:24960
    ds_read_b64_tr_b16 a[140:141], v14 offset:36864
    ds_read_b64_tr_b16 a[142:143], v14 offset:37248
    s_waitcnt lgkmcnt(0)
    v_add_u32 v12, 49152, v12
    v_add_u32 v13, 49152, v13
    v_add_u32 v14, 49152, v14
    s_waitcnt vmcnt(6)
    s_barrier
    ds_read_b64_tr_b16 a[56:57], v12 offset:0
    ds_read_b64_tr_b16 a[58:59], v12 offset:384
    ds_read_b64_tr_b16 a[60:61], v12 offset:12288
    ds_read_b64_tr_b16 a[62:63], v12 offset:12672
    ds_read_b64_tr_b16 a[104:105], v13 offset:0
    ds_read_b64_tr_b16 a[106:107], v13 offset:384
    ds_read_b64_tr_b16 a[108:109], v13 offset:12288
    ds_read_b64_tr_b16 a[110:111], v13 offset:12672
    ds_read_b64_tr_b16 a[144:145], v14 offset:0
    ds_read_b64_tr_b16 a[146:147], v14 offset:384
    ds_read_b64_tr_b16 a[148:149], v14 offset:12288
    ds_read_b64_tr_b16 a[150:151], v14 offset:12672
    s_waitcnt lgkmcnt(0)
    s_waitcnt vmcnt(0)
    s_barrier
    ds_read_b64_tr_b16 a[64:65], v12 offset:24576
    ds_read_b64_tr_b16 a[66:67], v12 offset:24960
    ds_read_b64_tr_b16 a[68:69], v12 offset:36864
    ds_read_b64_tr_b16 a[70:71], v12 offset:37248
    ds_read_b64_tr_b16 v[72:73], v13 offset:24576
    ds_read_b64_tr_b16 v[74:75], v13 offset:24960
    ds_read_b64_tr_b16 v[76:77], v13 offset:36864
    ds_read_b64_tr_b16 v[78:79], v13 offset:37248
    ds_read_b64_tr_b16 a[152:153], v14 offset:24576
    ds_read_b64_tr_b16 a[154:155], v14 offset:24960
    ds_read_b64_tr_b16 a[156:157], v14 offset:36864
    ds_read_b64_tr_b16 a[158:159], v14 offset:37248
    s_waitcnt lgkmcnt(0)
    v_add_u32 v12, 49152, v12
    v_add_u32 v13, 49152, v13
    v_add_u32 v14, 49152, v14
    s_barrier
    s_branch U_LD
U_L2:
    s_mov_b32 s46, 0
    s_add_u32 m0, s39, 0
    s_nop 0
    buffer_load_dwordx4 v6, s[16:19], s46 offen  lds
    s_add_u32 m0, s39, 1024
    s_nop 0
    buffer_load_dwordx4 v7, s[16:19], s46 offen  lds
    s_add_u32 m0, s39, 2048
    s_nop 0
    buffer_load_dwordx4 v8, s[16:19], s46 offen  lds
    s_add_u32 m0, s39, 3072
    s_nop 0
    buffer_load_dwordx4 v9, s[16:19], s46 offen  lds
    s_add_u32 m0, s39, 4096
    s_nop 0
    buffer_load_dwordx4 v10, s[16:19], s46 offen  lds
    s_add_u32 m0, s39, 5120
    s_nop 0
    buffer_load_dwordx4 v11, s[16:19], s46 offen  lds
    s_mov_b32 s46, 786432
    s_add_u32 m0, s39, 24576
    s_nop 0
    buffer_load_dwordx4 v6, s[16:19], s46 offen  lds
    s_add_u32 m0, s39, 25600
    s_nop 0
    buffer_load_dwordx4 v7, s[16:19], s46 offen  lds
    s_add_u32 m0, s39, 26624
    s_nop 0
    buffer_load_dwordx4 v8, s[16:19], s46 offen  lds
    s_add_u32 m0, s39, 27648
    s_nop 0
    buffer_load_dwordx4 v9, s[16:19], s46 offen  lds
    s_add_u32 m0, s39, 28672
    s_nop 0
    buffer_load_dwordx4 v10, s[16:19], s46 offen  lds
    s_add_u32 m0, s39, 29696
    s_nop 0
    buffer_load_dwordx4 v11, s[16:19], s46 offen  lds
    s_mov_b32 s46, 1572864
    s_add_u32 m0, s39, 49152
    s_nop 0
    buffer_load_dwordx4 v6, s[16:19], s46 offen  lds
    s_add_u32 m0, s39, 50176
    s_nop 0
    buffer_load_dwordx4 v7, s[16:19], s46 offen  lds
    s_add_u32 m0, s39, 51200
    s_nop 0
    buffer_load_dwordx4 v8, s[16:19], s46 offen  lds
    s_add_u32 m0, s39, 52224
    s_nop 0
    buffer_load_dwordx4 v9, s[16:19], s46 offen  lds
    s_add_u32 m0, s39, 53248
    s_nop 0
    buffer_load_dwordx4 v10, s[16:19], s46 offen  lds
    s_add_u32 m0, s39, 54272
    s_nop 0
    buffer_load_dwordx4 v11, s[16:19], s46 offen  lds
    s_mov_b32 s46, 2359296
    s_add_u32 m0, s39, 73728
    s_nop 0
    buffer_load_dwordx4 v6, s[16:19], s46 offen  lds
    s_add_u32 m0, s39, 74752
    s_nop 0
    buffer_load_dwordx4 v7, s[16:19], s46 offen  lds
    s_add_u32 m0, s39, 75776
    s_nop 0
    buffer_load_dwordx4 v8, s[16:19], s46 offen  lds
    s_add_u32 m0, s39, 76800
    s_nop 0
    buffer_load_dwordx4 v9, s[16:19], s46 offen  lds
    s_add_u32 m0, s39, 77824
    s_nop 0
    buffer_load_dwordx4 v10, s[16:19], s46 offen  lds
    s_add_u32 m0, s39, 78848
    s_nop 0
    buffer_load_dwordx4 v11, s[16:19], s46 offen  lds
    s_mov_b32 s46, 3145728
    s_add_u32 m0, s39, 98304
    s_nop 0
    buffer_load_dwordx4 v6, s[16:19], s46 offen  lds
    s_add_u32 m0, s39, 99328
    s_nop 0
    buffer_load_dwordx4 v7, s[16:19], s46 offen  lds
    s_add_u32 m0, s39, 100352
    s_nop 0
    buffer_load_dwordx4 v8, s[16:19], s46 offen  lds
    s_add_u32 m0, s39, 101376
    s_nop 0
    buffer_load_dwordx4 v9, s[16:19], s46 offen  lds
    s_add_u32 m0, s39, 102400
    s_nop 0
    buffer_load_dwordx4 v10, s[16:19], s46 offen  lds
    s_add_u32 m0, s39, 103424
    s_nop 0
    buffer_load_dwordx4 v11, s[16:19], s46 offen  lds
    s_waitcnt vmcnt(24)
    s_barrier
    ds_read_b64_tr_b16 a[56:57], v12 offset:0
    ds_read_b64_tr_b16 a[58:59], v12 offset:384
    ds_read_b64_tr_b16 a[60:61], v12 offset:12288
    ds_read_b64_tr_b16 a[62:63], v12 offset:12672
    ds_read_b64_tr_b16 a[104:105], v13 offset:0
    ds_read_b64_tr_b16 a[106:107], v13 offset:384
    ds_read_b64_tr_b16 a[108:109], v13 offset:12288
    ds_read_b64_tr_b16 a[110:111], v13 offset:12672
    ds_read_b64_tr_b16 a[144:145], v14 offset:0
    ds_read_b64_tr_b16 a[146:147], v14 offset:384
    ds_read_b64_tr_b16 a[148:149], v14 offset:12288
    ds_read_b64_tr_b16 a[150:151], v14 offset:12672
    s_mov_b32 s46, 3932160
    s_add_u32 m0, s39, 122880
    s_nop 0
    buffer_load_dwordx4 v6, s[16:19], s46 offen  lds
    s_add_u32 m0, s39, 123904
    s_nop 0
    buffer_load_dwordx4 v7, s[16:19], s46 offen  lds
    s_add_u32 m0, s39, 124928
    s_nop 0
    buffer_load_dwordx4 v8, s[16:19], s46 offen  lds
    s_add_u32 m0, s39, 125952
    s_nop 0
    buffer_load_dwordx4 v9, s[16:19], s46 offen  lds
    s_add_u32 m0, s39, 126976
    s_nop 0
    buffer_load_dwordx4 v10, s[16:19], s46 offen  lds
    s_add_u32 m0, s39, 128000
    s_nop 0
    buffer_load_dwordx4 v11, s[16:19], s46 offen  lds
    s_waitcnt lgkmcnt(0)
    s_waitcnt vmcnt(24)
    s_barrier
    ds_read_b64_tr_b16 a[64:65], v12 offset:24576
    ds_read_b64_tr_b16 a[66:67], v12 offset:24960
    ds_read_b64_tr_b16 a[68:69], v12 offset:36864
    ds_read_b64_tr_b16 a[70:71], v12 offset:37248
    ds_read_b64_tr_b16 v[72:73], v13 offset:24576
    ds_read_b64_tr_b16 v[74:75], v13 offset:24960
    ds_read_b64_tr_b16 v[76:77], v13 offset:36864
    ds_read_b64_tr_b16 v[78:79], v13 offset:37248
    ds_read_b64_tr_b16 a[152:153], v14 offset:24576
    ds_read_b64_tr_b16 a[154:155], v14 offset:24960
    ds_read_b64_tr_b16 a[156:157], v14 offset:36864
    ds_read_b64_tr_b16 a[158:159], v14 offset:37248
    s_mov_b32 s46, 4718592
    s_add_u32 m0, s39, 0
    s_nop 0
    buffer_load_dwordx4 v6, s[16:19], s46 offen  lds
    s_add_u32 m0, s39, 1024
    s_nop 0
    buffer_load_dwordx4 v7, s[16:19], s46 offen  lds
    s_add_u32 m0, s39, 2048
    s_nop 0
    buffer_load_dwordx4 v8, s[16:19], s46 offen  lds
    s_add_u32 m0, s39, 3072
    s_nop 0
    buffer_load_dwordx4 v9, s[16:19], s46 offen  lds
    s_add_u32 m0, s39, 4096
    s_nop 0
    buffer_load_dwordx4 v10, s[16:19], s46 offen  lds
    s_add_u32 m0, s39, 5120
    s_nop 0
    buffer_load_dwordx4 v11, s[16:19], s46 offen  lds
    s_waitcnt lgkmcnt(0)
    v_add_u32 v12, 49152, v12
    v_add_u32 v13, 49152, v13
    v_add_u32 v14, 49152, v14
    s_waitcnt vmcnt(24)
    s_barrier
    ds_read_b64_tr_b16 a[72:73], v12 offset:0
    ds_read_b64_tr_b16 a[74:75], v12 offset:384
    ds_read_b64_tr_b16 a[76:77], v12 offset:12288
    ds_read_b64_tr_b16 a[78:79], v12 offset:12672
    ds_read_b64_tr_b16 a[112:113], v13 offset:0
    ds_read_b64_tr_b16 a[114:115], v13 offset:384
    ds_read_b64_tr_b16 a[116:117], v13 offset:12288
    ds_read_b64_tr_b16 a[118:119], v13 offset:12672
    ds_read_b64_tr_b16 v[88:89], v14 offset:0
    ds_read_b64_tr_b16 v[90:91], v14 offset:384
    ds_read_b64_tr_b16 v[92:93], v14 offset:12288
    ds_read_b64_tr_b16 v[94:95], v14 offset:12672
    s_mov_b32 s46, 5505024
    s_add_u32 m0, s39, 24576
    s_nop 0
    buffer_load_dwordx4 v6, s[16:19], s46 offen  lds
    s_add_u32 m0, s39, 25600
    s_nop 0
    buffer_load_dwordx4 v7, s[16:19], s46 offen  lds
    s_add_u32 m0, s39, 26624
    s_nop 0
    buffer_load_dwordx4 v8, s[16:19], s46 offen  lds
    s_add_u32 m0, s39, 27648
    s_nop 0
    buffer_load_dwordx4 v9, s[16:19], s46 offen  lds
    s_add_u32 m0, s39, 28672
    s_nop 0
    buffer_load_dwordx4 v10, s[16:19], s46 offen  lds
    s_add_u32 m0, s39, 29696
    s_nop 0
    buffer_load_dwordx4 v11, s[16:19], s46 offen  lds
    s_waitcnt lgkmcnt(0)
    s_waitcnt vmcnt(24)
    s_barrier
    ds_read_b64_tr_b16 a[80:81], v12 offset:24576
    ds_read_b64_tr_b16 a[82:83], v12 offset:24960
    ds_read_b64_tr_b16 a[84:85], v12 offset:36864
    ds_read_b64_tr_b16 a[86:87], v12 offset:37248
    ds_read_b64_tr_b16 a[120:121], v13 offset:24576
    ds_read_b64_tr_b16 a[122:123], v13 offset:24960
    ds_read_b64_tr_b16 a[124:125], v13 offset:36864
    ds_read_b64_tr_b16 a[126:127], v13 offset:37248
    ds_read_b64_tr_b16 a[160:161], v14 offset:24576
    ds_read_b64_tr_b16 a[162:163], v14 offset:24960
    ds_read_b64_tr_b16 a[164:165], v14 offset:36864
    ds_read_b64_tr_b16 a[166:167], v14 offset:37248
    s_mov_b32 s46, 6291456
    s_add_u32 m0, s39, 49152
    s_nop 0
    buffer_load_dwordx4 v6, s[16:19], s46 offen  lds
    s_add_u32 m0, s39, 50176
    s_nop 0
    buffer_load_dwordx4 v7, s[16:19], s46 offen  lds
    s_add_u32 m0, s39, 51200
    s_nop 0
    buffer_load_dwordx4 v8, s[16:19], s46 offen  lds
    s_add_u32 m0, s39, 52224
    s_nop 0
    buffer_load_dwordx4 v9, s[16:19], s46 offen  lds
    s_add_u32 m0, s39, 53248
    s_nop 0
    buffer_load_dwordx4 v10, s[16:19], s46 offen  lds
    s_add_u32 m0, s39, 54272
    s_nop 0
    buffer_load_dwordx4 v11, s[16:19], s46 offen  lds
    s_waitcnt lgkmcnt(0)
    v_add_u32 v12, 49152, v12
    v_add_u32 v13, 49152, v13
    v_add_u32 v14, 49152, v14
    s_waitcnt vmcnt(24)
    s_barrier
    ds_read_b64_tr_b16 a[88:89], v12 offset:0
    ds_read_b64_tr_b16 a[90:91], v12 offset:384
    ds_read_b64_tr_b16 a[92:93], v12 offset:12288
    ds_read_b64_tr_b16 a[94:95], v12 offset:12672
    ds_read_b64_tr_b16 a[128:129], v13 offset:0
    ds_read_b64_tr_b16 a[130:131], v13 offset:384
    ds_read_b64_tr_b16 a[132:133], v13 offset:12288
    ds_read_b64_tr_b16 a[134:135], v13 offset:12672
    ds_read_b64_tr_b16 a[168:169], v14 offset:0
    ds_read_b64_tr_b16 a[170:171], v14 offset:384
    ds_read_b64_tr_b16 a[172:173], v14 offset:12288
    ds_read_b64_tr_b16 a[174:175], v14 offset:12672
    s_mov_b32 s46, 7077888
    s_add_u32 m0, s39, 73728
    s_nop 0
    buffer_load_dwordx4 v6, s[16:19], s46 offen  lds
    s_add_u32 m0, s39, 74752
    s_nop 0
    buffer_load_dwordx4 v7, s[16:19], s46 offen  lds
    s_add_u32 m0, s39, 75776
    s_nop 0
    buffer_load_dwordx4 v8, s[16:19], s46 offen  lds
    s_add_u32 m0, s39, 76800
    s_nop 0
    buffer_load_dwordx4 v9, s[16:19], s46 offen  lds
    s_add_u32 m0, s39, 77824
    s_nop 0
    buffer_load_dwordx4 v10, s[16:19], s46 offen  lds
    s_add_u32 m0, s39, 78848
    s_nop 0
    buffer_load_dwordx4 v11, s[16:19], s46 offen  lds
    s_waitcnt lgkmcnt(0)
    s_waitcnt vmcnt(24)
    s_barrier
    ds_read_b64_tr_b16 v[32:33], v12 offset:24576
    ds_read_b64_tr_b16 v[34:35], v12 offset:24960
    ds_read_b64_tr_b16 v[36:37], v12 offset:36864
    ds_read_b64_tr_b16 v[38:39], v12 offset:37248
    ds_read_b64_tr_b16 a[0:1], v13 offset:24576
    ds_read_b64_tr_b16 a[2:3], v13 offset:24960
    ds_read_b64_tr_b16 a[4:5], v13 offset:36864
    ds_read_b64_tr_b16 a[6:7], v13 offset:37248
    ds_read_b64_tr_b16 a[8:9], v14 offset:24576
    ds_read_b64_tr_b16 a[10:11], v14 offset:24960
    ds_read_b64_tr_b16 a[12:13], v14 offset:36864
    ds_read_b64_tr_b16 a[14:15], v14 offset:37248
    s_waitcnt lgkmcnt(0)
    v_add_u32 v12, 4294868992, v12
    v_add_u32 v13, 4294868992, v13
    v_add_u32 v14, 4294868992, v14
    s_waitcnt vmcnt(18)
    s_barrier
    ds_read_b64_tr_b16 a[16:17], v12 offset:0
    ds_read_b64_tr_b16 a[18:19], v12 offset:384
    ds_read_b64_tr_b16 a[20:21], v12 offset:12288
    ds_read_b64_tr_b16 a[22:23], v12 offset:12672
    ds_read_b64_tr_b16 a[24:25], v13 offset:0
    ds_read_b64_tr_b16 a[26:27], v13 offset:384
    ds_read_b64_tr_b16 a[28:29], v13 offset:12288
    ds_read_b64_tr_b16 a[30:31], v13 offset:12672
    ds_read_b64_tr_b16 a[32:33], v14 offset:0
    ds_read_b64_tr_b16 a[34:35], v14 offset:384
    ds_read_b64_tr_b16 a[36:37], v14 offset:12288
    ds_read_b64_tr_b16 a[38:39], v14 offset:12672
    s_waitcnt lgkmcnt(0)
    s_waitcnt vmcnt(12)
    s_barrier
    ds_read_b64_tr_b16 a[40:41], v12 offset:24576
    ds_read_b64_tr_b16 a[42:43], v12 offset:24960
    ds_read_b64_tr_b16 a[44:45], v12 offset:36864
    ds_read_b64_tr_b16 a[46:47], v12 offset:37248
    ds_read_b64_tr_b16 a[48:49], v13 offset:24576
    ds_read_b64_tr_b16 a[50:51], v13 offset:24960
    ds_read_b64_tr_b16 a[52:53], v13 offset:36864
    ds_read_b64_tr_b16 a[54:55], v13 offset:37248
    ds_read_b64_tr_b16 v[40:41], v14 offset:24576
    ds_read_b64_tr_b16 v[42:43], v14 offset:24960
    ds_read_b64_tr_b16 v[44:45], v14 offset:36864
    ds_read_b64_tr_b16 v[46:47], v14 offset:37248
    s_waitcnt lgkmcnt(0)
    v_add_u32 v12, 49152, v12
    v_add_u32 v13, 49152, v13
    v_add_u32 v14, 49152, v14
    s_waitcnt vmcnt(6)
    s_barrier
    ds_read_b64_tr_b16 v[48:49], v12 offset:0
    ds_read_b64_tr_b16 v[50:51], v12 offset:384
    ds_read_b64_tr_b16 v[52:53], v12 offset:12288
    ds_read_b64_tr_b16 v[54:55], v12 offset:12672
    ds_read_b64_tr_b16 v[64:65], v13 offset:0
    ds_read_b64_tr_b16 v[66:67], v13 offset:384
    ds_read_b64_tr_b16 v[68:69], v13 offset:12288
    ds_read_b64_tr_b16 v[70:71], v13 offset:12672
    ds_read_b64_tr_b16 v[80:81], v14 offset:0
    ds_read_b64_tr_b16 v[82:83], v14 offset:384
    ds_read_b64_tr_b16 v[84:85], v14 offset:12288
    ds_read_b64_tr_b16 v[86:87], v14 offset:12672
    s_waitcnt lgkmcnt(0)
    s_waitcnt vmcnt(0)
    s_barrier
    ds_read_b64_tr_b16 v[56:57], v12 offset:24576
    ds_read_b64_tr_b16 v[58:59], v12 offset:24960
    ds_read_b64_tr_b16 v[60:61], v12 offset:36864
    ds_read_b64_tr_b16 v[62:63], v12 offset:37248
    ds_read_b64_tr_b16 a[96:97], v13 offset:24576
    ds_read_b64_tr_b16 a[98:99], v13 offset:24960
    ds_read_b64_tr_b16 a[100:101], v13 offset:36864
    ds_read_b64_tr_b16 a[102:103], v13 offset:37248
    ds_read_b64_tr_b16 a[136:137], v14 offset:24576
    ds_read_b64_tr_b16 a[138:139], v14 offset:24960
    ds_read_b64_tr_b16 a[140:141], v14 offset:36864
    ds_read_b64_tr_b16 a[142:143], v14 offset:37248
    s_waitcnt lgkmcnt(0)
    v_add_u32 v12, 49152, v12
    v_add_u32 v13, 49152, v13
    v_add_u32 v14, 49152, v14
    s_barrier
    s_branch U_LD
U_L3:
    s_mov_b32 s46, 0
    s_add_u32 m0, s39, 0
    s_nop 0
    buffer_load_dwordx4 v6, s[16:19], s46 offen  lds
    s_add_u32 m0, s39, 1024
    s_nop 0
    buffer_load_dwordx4 v7, s[16:19], s46 offen  lds
    s_add_u32 m0, s39, 2048
    s_nop 0
    buffer_load_dwordx4 v8, s[16:19], s46 offen  lds
    s_add_u32 m0, s39, 3072
    s_nop 0
    buffer_load_dwordx4 v9, s[16:19], s46 offen  lds
    s_add_u32 m0, s39, 4096
    s_nop 0
    buffer_load_dwordx4 v10, s[16:19], s46 offen  lds
    s_add_u32 m0, s39, 5120
    s_nop 0
    buffer_load_dwordx4 v11, s[16:19], s46 offen  lds
    s_mov_b32 s46, 786432
    s_add_u32 m0, s39, 24576
    s_nop 0
    buffer_load_dwordx4 v6, s[16:19], s46 offen  lds
    s_add_u32 m0, s39, 25600
    s_nop 0
    buffer_load_dwordx4 v7, s[16:19], s46 offen  lds
    s_add_u32 m0, s39, 26624
    s_nop 0
    buffer_load_dwordx4 v8, s[16:19], s46 offen  lds
    s_add_u32 m0, s39, 27648
    s_nop 0
    buffer_load_dwordx4 v9, s[16:19], s46 offen  lds
    s_add_u32 m0, s39, 28672
    s_nop 0
    buffer_load_dwordx4 v10, s[16:19], s46 offen  lds
    s_add_u32 m0, s39, 29696
    s_nop 0
    buffer_load_dwordx4 v11, s[16:19], s46 offen  lds
    s_mov_b32 s46, 1572864
    s_add_u32 m0, s39, 49152
    s_nop 0
    buffer_load_dwordx4 v6, s[16:19], s46 offen  lds
    s_add_u32 m0, s39, 50176
    s_nop 0
    buffer_load_dwordx4 v7, s[16:19], s46 offen  lds
    s_add_u32 m0, s39, 51200
    s_nop 0
    buffer_load_dwordx4 v8, s[16:19], s46 offen  lds
    s_add_u32 m0, s39, 52224
    s_nop 0
    buffer_load_dwordx4 v9, s[16:19], s46 offen  lds
    s_add_u32 m0, s39, 53248
    s_nop 0
    buffer_load_dwordx4 v10, s[16:19], s46 offen  lds
    s_add_u32 m0, s39, 54272
    s_nop 0
    buffer_load_dwordx4 v11, s[16:19], s46 offen  lds
    s_mov_b32 s46, 2359296
    s_add_u32 m0, s39, 73728
    s_nop 0
    buffer_load_dwordx4 v6, s[16:19], s46 offen  lds
    s_add_u32 m0, s39, 74752
    s_nop 0
    buffer_load_dwordx4 v7, s[16:19], s46 offen  lds
    s_add_u32 m0, s39, 75776
    s_nop 0
    buffer_load_dwordx4 v8, s[16:19], s46 offen  lds
    s_add_u32 m0, s39, 76800
    s_nop 0
    buffer_load_dwordx4 v9, s[16:19], s46 offen  lds
    s_add_u32 m0, s39, 77824
    s_nop 0
    buffer_load_dwordx4 v10, s[16:19], s46 offen  lds
    s_add_u32 m0, s39, 78848
    s_nop 0
    buffer_load_dwordx4 v11, s[16:19], s46 offen  lds
    s_mov_b32 s46, 3145728
    s_add_u32 m0, s39, 98304
    s_nop 0
    buffer_load_dwordx4 v6, s[16:19], s46 offen  lds
    s_add_u32 m0, s39, 99328
    s_nop 0
    buffer_load_dwordx4 v7, s[16:19], s46 offen  lds
    s_add_u32 m0, s39, 100352
    s_nop 0
    buffer_load_dwordx4 v8, s[16:19], s46 offen  lds
    s_add_u32 m0, s39, 101376
    s_nop 0
    buffer_load_dwordx4 v9, s[16:19], s46 offen  lds
    s_add_u32 m0, s39, 102400
    s_nop 0
    buffer_load_dwordx4 v10, s[16:19], s46 offen  lds
    s_add_u32 m0, s39, 103424
    s_nop 0
    buffer_load_dwordx4 v11, s[16:19], s46 offen  lds
    s_waitcnt vmcnt(24)
    s_barrier
    ds_read_b64_tr_b16 v[48:49], v12 offset:0
    ds_read_b64_tr_b16 v[50:51], v12 offset:384
    ds_read_b64_tr_b16 v[52:53], v12 offset:12288
    ds_read_b64_tr_b16 v[54:55], v12 offset:12672
    ds_read_b64_tr_b16 v[64:65], v13 offset:0
    ds_read_b64_tr_b16 v[66:67], v13 offset:384
    ds_read_b64_tr_b16 v[68:69], v13 offset:12288
    ds_read_b64_tr_b16 v[70:71], v13 offset:12672
    ds_read_b64_tr_b16 v[80:81], v14 offset:0
    ds_read_b64_tr_b16 v[82:83], v14 offset:384
    ds_read_b64_tr_b16 v[84:85], v14 offset:12288
    ds_read_b64_tr_b16 v[86:87], v14 offset:12672
    s_mov_b32 s46, 3932160
    s_add_u32 m0, s39, 122880
    s_nop 0
    buffer_load_dwordx4 v6, s[16:19], s46 offen  lds
    s_add_u32 m0, s39, 123904
    s_nop 0
    buffer_load_dwordx4 v7, s[16:19], s46 offen  lds
    s_add_u32 m0, s39, 124928
    s_nop 0
    buffer_load_dwordx4 v8, s[16:19], s46 offen  lds
    s_add_u32 m0, s39, 125952
    s_nop 0
    buffer_load_dwordx4 v9, s[16:19], s46 offen  lds
    s_add_u32 m0, s39, 126976
    s_nop 0
    buffer_load_dwordx4 v10, s[16:19], s46 offen  lds
    s_add_u32 m0, s39, 128000
    s_nop 0
    buffer_load_dwordx4 v11, s[16:19], s46 offen  lds
    s_waitcnt lgkmcnt(0)
    s_waitcnt vmcnt(24)
    s_barrier
    ds_read_b64_tr_b16 v[56:57], v12 offset:24576
    ds_read_b64_tr_b16 v[58:59], v12 offset:24960
    ds_read_b64_tr_b16 v[60:61], v12 offset:36864
    ds_read_b64_tr_b16 v[62:63], v12 offset:37248
    ds_read_b64_tr_b16 a[96:97], v13 offset:24576
    ds_read_b64_tr_b16 a[98:99], v13 offset:24960
    ds_read_b64_tr_b16 a[100:101], v13 offset:36864
    ds_read_b64_tr_b16 a[102:103], v13 offset:37248
    ds_read_b64_tr_b16 a[136:137], v14 offset:24576
    ds_read_b64_tr_b16 a[138:139], v14 offset:24960
    ds_read_b64_tr_b16 a[140:141], v14 offset:36864
    ds_read_b64_tr_b16 a[142:143], v14 offset:37248
    s_mov_b32 s46, 4718592
    s_add_u32 m0, s39, 0
    s_nop 0
    buffer_load_dwordx4 v6, s[16:19], s46 offen  lds
    s_add_u32 m0, s39, 1024
    s_nop 0
    buffer_load_dwordx4 v7, s[16:19], s46 offen  lds
    s_add_u32 m0, s39, 2048
    s_nop 0
    buffer_load_dwordx4 v8, s[16:19], s46 offen  lds
    s_add_u32 m0, s39, 3072
    s_nop 0
    buffer_load_dwordx4 v9, s[16:19], s46 offen  lds
    s_add_u32 m0, s39, 4096
    s_nop 0
    buffer_load_dwordx4 v10, s[16:19], s46 offen  lds
    s_add_u32 m0, s39, 5120
    s_nop 0
    buffer_load_dwordx4 v11, s[16:19], s46 offen  lds
    s_waitcnt lgkmcnt(0)
    v_add_u32 v12, 49152, v12
    v_add_u32 v13, 49152, v13
    v_add_u32 v14, 49152, v14
    s_waitcnt vmcnt(24)
    s_barrier
    ds_read_b64_tr_b16 a[56:57], v12 offset:0
    ds_read_b64_tr_b16 a[58:59], v12 offset:384
    ds_read_b64_tr_b16 a[60:61], v12 offset:12288
    ds_read_b64_tr_b16 a[62:63], v12 offset:12672
    ds_read_b64_tr_b16 a[104:105], v13 offset:0
    ds_read_b64_tr_b16 a[106:107], v13 offset:384
    ds_read_b64_tr_b16 a[108:109], v13 offset:12288
    ds_read_b64_tr_b16 a[110:111], v13 offset:12672
    ds_read_b64_tr_b16 a[144:145], v14 offset:0
    ds_read_b64_tr_b16 a[146:147], v14 offset:384
    ds_read_b64_tr_b16 a[148:149], v14 offset:12288
    ds_read_b64_tr_b16 a[150:151], v14 offset:12672
    s_mov_b32 s46, 5505024
    s_add_u32 m0, s39, 24576
    s_nop 0
    buffer_load_dwordx4 v6, s[16:19], s46 offen  lds
    s_add_u32 m0, s39, 25600
    s_nop 0
    buffer_load_dwordx4 v7, s[16:19], s46 offen  lds
    s_add_u32 m0, s39, 26624
    s_nop 0
    buffer_load_dwordx4 v8, s[16:19], s46 offen  lds
    s_add_u32 m0, s39, 27648
    s_nop 0
    buffer_load_dwordx4 v9, s[16:19], s46 offen  lds
    s_add_u32 m0, s39, 28672
    s_nop 0
    buffer_load_dwordx4 v10, s[16:19], s46 offen  lds
    s_add_u32 m0, s39, 29696
    s_nop 0
    buffer_load_dwordx4 v11, s[16:19], s46 offen  lds
    s_waitcnt lgkmcnt(0)
    s_waitcnt vmcnt(24)
    s_barrier
    ds_read_b64_tr_b16 a[64:65], v12 offset:24576
    ds_read_b64_tr_b16 a[66:67], v12 offset:24960
    ds_read_b64_tr_b16 a[68:69], v12 offset:36864
    ds_read_b64_tr_b16 a[70:71], v12 offset:37248
    ds_read_b64_tr_b16 v[72:73], v13 offset:24576
    ds_read_b64_tr_b16 v[74:75], v13 offset:24960
    ds_read_b64_tr_b16 v[76:77], v13 offset:36864
    ds_read_b64_tr_b16 v[78:79], v13 offset:37248
    ds_read_b64_tr_b16 a[152:153], v14 offset:24576
    ds_read_b64_tr_b16 a[154:155], v14 offset:24960
    ds_read_b64_tr_b16 a[156:157], v14 offset:36864
    ds_read_b64_tr_b16 a[158:159], v14 offset:37248
    s_mov_b32 s46, 6291456
    s_add_u32 m0, s39, 49152
    s_nop 0
    buffer_load_dwordx4 v6, s[16:19], s46 offen  lds
    s_add_u32 m0, s39, 50176
    s_nop 0
    buffer_load_dwordx4 v7, s[16:19], s46 offen  lds
    s_add_u32 m0, s39, 51200
    s_nop 0
    buffer_load_dwordx4 v8, s[16:19], s46 offen  lds
    s_add_u32 m0, s39, 52224
    s_nop 0
    buffer_load_dwordx4 v9, s[16:19], s46 offen  lds
    s_add_u32 m0, s39, 53248
    s_nop 0
    buffer_load_dwordx4 v10, s[16:19], s46 offen  lds
    s_add_u32 m0, s39, 54272
    s_nop 0
    buffer_load_dwordx4 v11, s[16:19], s46 offen  lds
    s_waitcnt lgkmcnt(0)
    v_add_u32 v12, 49152, v12
    v_add_u32 v13, 49152, v13
    v_add_u32 v14, 49152, v14
    s_waitcnt vmcnt(24)
    s_barrier
    ds_read_b64_tr_b16 a[72:73], v12 offset:0
    ds_read_b64_tr_b16 a[74:75], v12 offset:384
    ds_read_b64_tr_b16 a[76:77], v12 offset:12288
    ds_read_b64_tr_b16 a[78:79], v12 offset:12672
    ds_read_b64_tr_b16 a[112:113], v13 offset:0
    ds_read_b64_tr_b16 a[114:115], v13 offset:384
    ds_read_b64_tr_b16 a[116:117], v13 offset:12288
    ds_read_b64_tr_b16 a[118:119], v13 offset:12672
    ds_read_b64_tr_b16 v[88:89], v14 offset:0
    ds_read_b64_tr_b16 v[90:91], v14 offset:384
    ds_read_b64_tr_b16 v[92:93], v14 offset:12288
    ds_read_b64_tr_b16 v[94:95], v14 offset:12672
    s_mov_b32 s46, 7077888
    s_add_u32 m0, s39, 73728
    s_nop 0
    buffer_load_dwordx4 v6, s[16:19], s46 offen  lds
    s_add_u32 m0, s39, 74752
    s_nop 0
    buffer_load_dwordx4 v7, s[16:19], s46 offen  lds
    s_add_u32 m0, s39, 75776
    s_nop 0
    buffer_load_dwordx4 v8, s[16:19], s46 offen  lds
    s_add_u32 m0, s39, 76800
    s_nop 0
    buffer_load_dwordx4 v9, s[16:19], s46 offen  lds
    s_add_u32 m0, s39, 77824
    s_nop 0
    buffer_load_dwordx4 v10, s[16:19], s46 offen  lds
    s_add_u32 m0, s39, 78848
    s_nop 0
    buffer_load_dwordx4 v11, s[16:19], s46 offen  lds
    s_waitcnt lgkmcnt(0)
    s_waitcnt vmcnt(24)
    s_barrier
    ds_read_b64_tr_b16 a[80:81], v12 offset:24576
    ds_read_b64_tr_b16 a[82:83], v12 offset:24960
    ds_read_b64_tr_b16 a[84:85], v12 offset:36864
    ds_read_b64_tr_b16 a[86:87], v12 offset:37248
    ds_read_b64_tr_b16 a[120:121], v13 offset:24576
    ds_read_b64_tr_b16 a[122:123], v13 offset:24960
    ds_read_b64_tr_b16 a[124:125], v13 offset:36864
    ds_read_b64_tr_b16 a[126:127], v13 offset:37248
    ds_read_b64_tr_b16 a[160:161], v14 offset:24576
    ds_read_b64_tr_b16 a[162:163], v14 offset:24960
    ds_read_b64_tr_b16 a[164:165], v14 offset:36864
    ds_read_b64_tr_b16 a[166:167], v14 offset:37248
    s_waitcnt lgkmcnt(0)
    v_add_u32 v12, 4294868992, v12
    v_add_u32 v13, 4294868992, v13
    v_add_u32 v14, 4294868992, v14
    s_waitcnt vmcnt(18)
    s_barrier
    ds_read_b64_tr_b16 a[88:89], v12 offset:0
    ds_read_b64_tr_b16 a[90:91], v12 offset:384
    ds_read_b64_tr_b16 a[92:93], v12 offset:12288
    ds_read_b64_tr_b16 a[94:95], v12 offset:12672
    ds_read_b64_tr_b16 a[128:129], v13 offset:0
    ds_read_b64_tr_b16 a[130:131], v13 offset:384
    ds_read_b64_tr_b16 a[132:133], v13 offset:12288
    ds_read_b64_tr_b16 a[134:135], v13 offset:12672
    ds_read_b64_tr_b16 a[168:169], v14 offset:0
    ds_read_b64_tr_b16 a[170:171], v14 offset:384
    ds_read_b64_tr_b16 a[172:173], v14 offset:12288
    ds_read_b64_tr_b16 a[174:175], v14 offset:12672
    s_waitcnt lgkmcnt(0)
    s_waitcnt vmcnt(12)
    s_barrier
    ds_read_b64_tr_b16 v[32:33], v12 offset:24576
    ds_read_b64_tr_b16 v[34:35], v12 offset:24960
    ds_read_b64_tr_b16 v[36:37], v12 offset:36864
    ds_read_b64_tr_b16 v[38:39], v12 offset:37248
    ds_read_b64_tr_b16 a[0:1], v13 offset:24576
    ds_read_b64_tr_b16 a[2:3], v13 offset:24960
    ds_read_b64_tr_b16 a[4:5], v13 offset:36864
    ds_read_b64_tr_b16 a[6:7], v13 offset:37248
    ds_read_b64_tr_b16 a[8:9], v14 offset:24576
    ds_read_b64_tr_b16 a[10:11], v14 offset:24960
    ds_read_b64_tr_b16 a[12:13], v14 offset:36864
    ds_read_b64_tr_b16 a[14:15], v14 offset:37248
    s_waitcnt lgkmcnt(0)
    v_add_u32 v12, 49152, v12
    v_add_u32 v13, 49152, v13
    v_add_u32 v14, 49152, v14
    s_waitcnt vmcnt(6)
    s_barrier
    ds_read_b64_tr_b16 a[16:17], v12 offset:0
    ds_read_b64_tr_b16 a[18:19], v12 offset:384
    ds_read_b64_tr_b16 a[20:21], v12 offset:12288
    ds_read_b64_tr_b16 a[22:23], v12 offset:12672
    ds_read_b64_tr_b16 a[24:25], v13 offset:0
    ds_read_b64_tr_b16 a[26:27], v13 offset:384
    ds_read_b64_tr_b16 a[28:29], v13 offset:12288
    ds_read_b64_tr_b16 a[30:31], v13 offset:12672
    ds_read_b64_tr_b16 a[32:33], v14 offset:0
    ds_read_b64_tr_b16 a[34:35], v14 offset:384
    ds_read_b64_tr_b16 a[36:37], v14 offset:12288
    ds_read_b64_tr_b16 a[38:39], v14 offset:12672
    s_waitcnt lgkmcnt(0)
    s_waitcnt vmcnt(0)
    s_barrier
    ds_read_b64_tr_b16 a[40:41], v12 offset:24576
    ds_read_b64_tr_b16 a[42:43], v12 offset:24960
    ds_read_b64_tr_b16 a[44:45], v12 offset:36864
    ds_read_b64_tr_b16 a[46:47], v12 offset:37248
    ds_read_b64_tr_b16 a[48:49], v13 offset:24576
    ds_read_b64_tr_b16 a[50:51], v13 offset:24960
    ds_read_b64_tr_b16 a[52:53], v13 offset:36864
    ds_read_b64_tr_b16 a[54:55], v13 offset:37248
    ds_read_b64_tr_b16 v[40:41], v14 offset:24576
    ds_read_b64_tr_b16 v[42:43], v14 offset:24960
    ds_read_b64_tr_b16 v[44:45], v14 offset:36864
    ds_read_b64_tr_b16 v[46:47], v14 offset:37248
    s_waitcnt lgkmcnt(0)
    v_add_u32 v12, 49152, v12
    v_add_u32 v13, 49152, v13
    v_add_u32 v14, 49152, v14
    s_barrier
U_LD:
    s_mul_i32 s39, s32, 36864
    s_mul_i32 s39, s32, 36864
    s_mul_i32 s37, s2, 245760
    s_mul_i32 s36, s32, 320
    s_add_u32 s37, s37, s36
    s_movk_i32 s46, 3277
    v_add_u32 v10, 0, v2
    v_mul_lo_u32 v11, v10, s46
    v_lshrrev_b32 v11, 16, v11
    v_mul_u32_u24 v14, 20, v11
    v_sub_u32 v14, v10, v14
    v_mul_u32_u24 v11, 1280, v11
    v_lshl_add_u32 v11, v14, 4, v11
    v_add_u32 v6, s37, v11
    v_add_u32 v10, 64, v2
    v_mul_lo_u32 v11, v10, s46
    v_lshrrev_b32 v11, 16, v11
    v_mul_u32_u24 v14, 20, v11
    v_sub_u32 v14, v10, v14
    v_mul_u32_u24 v11, 1280, v11
    v_lshl_add_u32 v11, v14, 4, v11
    v_add_u32 v7, s37, v11
    v_add_u32 v10, 128, v2
    v_mul_lo_u32 v11, v10, s46
    v_lshrrev_b32 v11, 16, v11
    v_mul_u32_u24 v14, 20, v11
    v_sub_u32 v14, v10, v14
    v_mul_u32_u24 v11, 1280, v11
    v_lshl_add_u32 v11, v14, 4, v11
    v_add_u32 v8, s37, v11
    v_add_u32 v10, 192, v2
    v_mul_lo_u32 v11, v10, s46
    v_lshrrev_b32 v11, 16, v11
    v_mul_u32_u24 v14, 20, v11
    v_sub_u32 v14, v10, v14
    v_mul_u32_u24 v11, 1280, v11
    v_lshl_add_u32 v11, v14, 4, v11
    v_add_u32 v12, s37, v11
    v_add_u32 v10, 256, v2
    v_mul_lo_u32 v11, v10, s46
    v_lshrrev_b32 v11, 16, v11
    v_mul_u32_u24 v14, 20, v11
    v_sub_u32 v14, v10, v14
    v_mul_u32_u24 v11, 1280, v11
    v_lshl_add_u32 v11, v14, 4, v11
    v_add_u32 v13, s37, v11
    v_lshrrev_b32 v10, 4, v2
    v_lshlrev_b32 v10, 3, v10
    v_bfe_u32 v11, v2, 2, 2
    v_add_u32 v10, v10, v11
    v_mul_u32_u24 v10, 320, v10
    v_and_b32 v11, 3, v2
    v_lshl_add_u32 v10, v11, 3, v10
    v_add_u32 v9, s39, v10
    s_mov_b32 s46, 0
    s_mov_b32 s47, 20480
    s_add_u32 m0, s39, 0
    s_nop 0
    buffer_load_dwordx4 v6, s[20:23], s46 offen  lds
    s_add_u32 m0, s39, 1024
    s_nop 0
    buffer_load_dwordx4 v7, s[20:23], s46 offen  lds
    s_add_u32 m0, s39, 2048
    s_nop 0
    buffer_load_dwordx4 v8, s[20:23], s46 offen  lds
    s_add_u32 m0, s39, 3072
    s_nop 0
    buffer_load_dwordx4 v12, s[20:23], s46 offen  lds
    s_add_u32 m0, s39, 4096
    s_nop 0
    buffer_load_dwordx4 v13, s[20:23], s46 offen  lds
    s_add_u32 m0, s39, 5120
    s_nop 0
    buffer_load_dwordx4 v6, s[20:23], s47 offen  lds
    s_add_u32 m0, s39, 6144
    s_nop 0
    buffer_load_dwordx4 v7, s[20:23], s47 offen  lds
    s_add_u32 m0, s39, 7168
    s_nop 0
    buffer_load_dwordx4 v8, s[20:23], s47 offen  lds
    s_add_u32 m0, s39, 8192
    s_nop 0
    buffer_load_dwordx4 v12, s[20:23], s47 offen  lds
    s_add_u32 m0, s39, 9216
    s_nop 0
    buffer_load_dwordx4 v13, s[20:23], s47 offen  lds
    s_mov_b32 s46, 40960
    s_mov_b32 s47, 61440
    s_add_u32 m0, s39, 10240
    s_nop 0
    buffer_load_dwordx4 v6, s[20:23], s46 offen  lds
    s_add_u32 m0, s39, 11264
    s_nop 0
    buffer_load_dwordx4 v7, s[20:23], s46 offen  lds
    s_add_u32 m0, s39, 12288
    s_nop 0
    buffer_load_dwordx4 v8, s[20:23], s46 offen  lds
    s_add_u32 m0, s39, 13312
    s_nop 0
    buffer_load_dwordx4 v12, s[20:23], s46 offen  lds
    s_add_u32 m0, s39, 14336
    s_nop 0
    buffer_load_dwordx4 v13, s[20:23], s46 offen  lds
    s_add_u32 m0, s39, 15360
    s_nop 0
    buffer_load_dwordx4 v6, s[20:23], s47 offen  lds
    s_add_u32 m0, s39, 16384
    s_nop 0
    buffer_load_dwordx4 v7, s[20:23], s47 offen  lds
    s_add_u32 m0, s39, 17408
    s_nop 0
    buffer_load_dwordx4 v8, s[20:23], s47 offen  lds
    s_add_u32 m0, s39, 18432
    s_nop 0
    buffer_load_dwordx4 v12, s[20:23], s47 offen  lds
    s_add_u32 m0, s39, 19456
    s_nop 0
    buffer_load_dwordx4 v13, s[20:23], s47 offen  lds
    s_mov_b32 s46, 81920
    s_mov_b32 s47, 102400
    s_add_u32 m0, s39, 20480
    s_nop 0
    buffer_load_dwordx4 v6, s[20:23], s46 offen  lds
    s_add_u32 m0, s39, 21504
    s_nop 0
    buffer_load_dwordx4 v7, s[20:23], s46 offen  lds
    s_add_u32 m0, s39, 22528
    s_nop 0
    buffer_load_dwordx4 v8, s[20:23], s46 offen  lds
    s_add_u32 m0, s39, 23552
    s_nop 0
    buffer_load_dwordx4 v12, s[20:23], s46 offen  lds
    s_add_u32 m0, s39, 24576
    s_nop 0
    buffer_load_dwordx4 v13, s[20:23], s46 offen  lds
    s_add_u32 m0, s39, 25600
    s_nop 0
    buffer_load_dwordx4 v6, s[20:23], s47 offen  lds
    s_add_u32 m0, s39, 26624
    s_nop 0
    buffer_load_dwordx4 v7, s[20:23], s47 offen  lds
    s_add_u32 m0, s39, 27648
    s_nop 0
    buffer_load_dwordx4 v8, s[20:23], s47 offen  lds
    s_add_u32 m0, s39, 28672
    s_nop 0
    buffer_load_dwordx4 v12, s[20:23], s47 offen  lds
    s_add_u32 m0, s39, 29696
    s_nop 0
    buffer_load_dwordx4 v13, s[20:23], s47 offen  lds
    s_waitcnt vmcnt(20)
    ds_read_b64_tr_b16 a[176:177], v9 offset:0
    ds_read_b64_tr_b16 a[178:179], v9 offset:1280
    ds_read_b64_tr_b16 v[96:97], v9 offset:32
    ds_read_b64_tr_b16 v[98:99], v9 offset:1312
    ds_read_b64_tr_b16 a[184:185], v9 offset:64
    ds_read_b64_tr_b16 a[186:187], v9 offset:1344
    ds_read_b64_tr_b16 a[192:193], v9 offset:96
    ds_read_b64_tr_b16 a[194:195], v9 offset:1376
    ds_read_b64_tr_b16 a[200:201], v9 offset:128
    ds_read_b64_tr_b16 a[202:203], v9 offset:1408
    s_waitcnt lgkmcnt(4)
    ds_read_b64_tr_b16 v[104:105], v9 offset:160
    ds_read_b64_tr_b16 v[106:107], v9 offset:1440
    ds_read_b64_tr_b16 a[208:209], v9 offset:192
    ds_read_b64_tr_b16 a[210:211], v9 offset:1472
    ds_read_b64_tr_b16 a[216:217], v9 offset:224
    ds_read_b64_tr_b16 a[218:219], v9 offset:1504
    ds_read_b64_tr_b16 a[224:225], v9 offset:256
    ds_read_b64_tr_b16 a[226:227], v9 offset:1536
    ds_read_b64_tr_b16 a[232:233], v9 offset:288
    ds_read_b64_tr_b16 a[234:235], v9 offset:1568
    s_waitcnt lgkmcnt(0)
    s_mov_b32 s46, 122880
    s_mov_b32 s47, 143360
    s_add_u32 m0, s39, 0
    s_nop 0
    buffer_load_dwordx4 v6, s[20:23], s46 offen  lds
    s_add_u32 m0, s39, 1024
    s_nop 0
    buffer_load_dwordx4 v7, s[20:23], s46 offen  lds
    s_add_u32 m0, s39, 2048
    s_nop 0
    buffer_load_dwordx4 v8, s[20:23], s46 offen  lds
    s_add_u32 m0, s39, 3072
    s_nop 0
    buffer_load_dwordx4 v12, s[20:23], s46 offen  lds
    s_add_u32 m0, s39, 4096
    s_nop 0
    buffer_load_dwordx4 v13, s[20:23], s46 offen  lds
    s_add_u32 m0, s39, 5120
    s_nop 0
    buffer_load_dwordx4 v6, s[20:23], s47 offen  lds
    s_add_u32 m0, s39, 6144
    s_nop 0
    buffer_load_dwordx4 v7, s[20:23], s47 offen  lds
    s_add_u32 m0, s39, 7168
    s_nop 0
    buffer_load_dwordx4 v8, s[20:23], s47 offen  lds
    s_add_u32 m0, s39, 8192
    s_nop 0
    buffer_load_dwordx4 v12, s[20:23], s47 offen  lds
    s_add_u32 m0, s39, 9216
    s_nop 0
    buffer_load_dwordx4 v13, s[20:23], s47 offen  lds
    s_waitcnt vmcnt(20)
    ds_read_b64_tr_b16 a[180:181], v9 offset:10240
    ds_read_b64_tr_b16 a[182:183], v9 offset:11520
    ds_read_b64_tr_b16 v[100:101], v9 offset:10272
    ds_read_b64_tr_b16 v[102:103], v9 offset:11552
    ds_read_b64_tr_b16 a[188:189], v9 offset:10304
    ds_read_b64_tr_b16 a[190:191], v9 offset:11584
    ds_read_b64_tr_b16 a[196:197], v9 offset:10336
    ds_read_b64_tr_b16 a[198:199], v9 offset:11616
    ds_read_b64_tr_b16 a[204:205], v9 offset:10368
    ds_read_b64_tr_b16 a[206:207], v9 offset:11648
    s_waitcnt lgkmcnt(4)
    ds_read_b64_tr_b16 v[108:109], v9 offset:10400
    ds_read_b64_tr_b16 v[110:111], v9 offset:11680
    ds_read_b64_tr_b16 a[212:213], v9 offset:10432
    ds_read_b64_tr_b16 a[214:215], v9 offset:11712
    ds_read_b64_tr_b16 a[220:221], v9 offset:10464
    ds_read_b64_tr_b16 a[222:223], v9 offset:11744
    ds_read_b64_tr_b16 a[228:229], v9 offset:10496
    ds_read_b64_tr_b16 a[230:231], v9 offset:11776
    ds_read_b64_tr_b16 a[236:237], v9 offset:10528
    ds_read_b64_tr_b16 a[238:239], v9 offset:11808
    s_waitcnt lgkmcnt(0)
    s_mov_b32 s46, 163840
    s_mov_b32 s47, 184320
    s_add_u32 m0, s39, 10240
    s_nop 0
    buffer_load_dwordx4 v6, s[20:23], s46 offen  lds
    s_add_u32 m0, s39, 11264
    s_nop 0
    buffer_load_dwordx4 v7, s[20:23], s46 offen  lds
    s_add_u32 m0, s39, 12288
    s_nop 0
    buffer_load_dwordx4 v8, s[20:23], s46 offen  lds
    s_add_u32 m0, s39, 13312
    s_nop 0
    buffer_load_dwordx4 v12, s[20:23], s46 offen  lds
    s_add_u32 m0, s39, 14336
    s_nop 0
    buffer_load_dwordx4 v13, s[20:23], s46 offen  lds
    s_add_u32 m0, s39, 15360
    s_nop 0
    buffer_load_dwordx4 v6, s[20:23], s47 offen  lds
    s_add_u32 m0, s39, 16384
    s_nop 0
    buffer_load_dwordx4 v7, s[20:23], s47 offen  lds
    s_add_u32 m0, s39, 17408
    s_nop 0
    buffer_load_dwordx4 v8, s[20:23], s47 offen  lds
    s_add_u32 m0, s39, 18432
    s_nop 0
    buffer_load_dwordx4 v12, s[20:23], s47 offen  lds
    s_add_u32 m0, s39, 19456
    s_nop 0
    buffer_load_dwordx4 v13, s[20:23], s47 offen  lds
    s_waitcnt vmcnt(20)
    ds_read_b64_tr_b16 v[112:113], v9 offset:20480
    ds_read_b64_tr_b16 v[114:115], v9 offset:21760
    ds_read_b64_tr_b16 a[240:241], v9 offset:20512
    ds_read_b64_tr_b16 a[242:243], v9 offset:21792
    ds_read_b64_tr_b16 v[120:121], v9 offset:20544
    ds_read_b64_tr_b16 v[122:123], v9 offset:21824
    ds_read_b64_tr_b16 a[248:249], v9 offset:20576
    ds_read_b64_tr_b16 a[250:251], v9 offset:21856
    ds_read_b64_tr_b16 v[136:137], v9 offset:20608
    ds_read_b64_tr_b16 v[138:139], v9 offset:21888
    s_waitcnt lgkmcnt(4)
    ds_read_b64_tr_b16 v[144:145], v9 offset:20640
    ds_read_b64_tr_b16 v[146:147], v9 offset:21920
    ds_read_b64_tr_b16 v[152:153], v9 offset:20672
    ds_read_b64_tr_b16 v[154:155], v9 offset:21952
    ds_read_b64_tr_b16 v[160:161], v9 offset:20704
    ds_read_b64_tr_b16 v[162:163], v9 offset:21984
    ds_read_b64_tr_b16 v[168:169], v9 offset:20736
    ds_read_b64_tr_b16 v[170:171], v9 offset:22016
    ds_read_b64_tr_b16 v[240:241], v9 offset:20768
    ds_read_b64_tr_b16 v[242:243], v9 offset:22048
    s_waitcnt lgkmcnt(0)
    s_mov_b32 s46, 204800
    s_mov_b32 s47, 225280
    s_add_u32 m0, s39, 20480
    s_nop 0
    buffer_load_dwordx4 v6, s[20:23], s46 offen  lds
    s_add_u32 m0, s39, 21504
    s_nop 0
    buffer_load_dwordx4 v7, s[20:23], s46 offen  lds
    s_add_u32 m0, s39, 22528
    s_nop 0
    buffer_load_dwordx4 v8, s[20:23], s46 offen  lds
    s_add_u32 m0, s39, 23552
    s_nop 0
    buffer_load_dwordx4 v12, s[20:23], s46 offen  lds
    s_add_u32 m0, s39, 24576
    s_nop 0
    buffer_load_dwordx4 v13, s[20:23], s46 offen  lds
    s_add_u32 m0, s39, 25600
    s_nop 0
    buffer_load_dwordx4 v6, s[20:23], s47 offen  lds
    s_add_u32 m0, s39, 26624
    s_nop 0
    buffer_load_dwordx4 v7, s[20:23], s47 offen  lds
    s_add_u32 m0, s39, 27648
    s_nop 0
    buffer_load_dwordx4 v8, s[20:23], s47 offen  lds
    s_add_u32 m0, s39, 28672
    s_nop 0
    buffer_load_dwordx4 v12, s[20:23], s47 offen  lds
    s_add_u32 m0, s39, 29696
    s_nop 0
    buffer_load_dwordx4 v13, s[20:23], s47 offen  lds
    s_waitcnt vmcnt(20)
    ds_read_b64_tr_b16 v[116:117], v9 offset:0
    ds_read_b64_tr_b16 v[118:119], v9 offset:1280
    ds_read_b64_tr_b16 a[244:245], v9 offset:32
    ds_read_b64_tr_b16 a[246:247], v9 offset:1312
    ds_read_b64_tr_b16 v[124:125], v9 offset:64
    ds_read_b64_tr_b16 v[126:127], v9 offset:1344
    ds_read_b64_tr_b16 a[252:253], v9 offset:96
    ds_read_b64_tr_b16 a[254:255], v9 offset:1376
    ds_read_b64_tr_b16 v[140:141], v9 offset:128
    ds_read_b64_tr_b16 v[142:143], v9 offset:1408
    s_waitcnt lgkmcnt(4)
    ds_read_b64_tr_b16 v[148:149], v9 offset:160
    ds_read_b64_tr_b16 v[150:151], v9 offset:1440
    ds_read_b64_tr_b16 v[156:157], v9 offset:192
    ds_read_b64_tr_b16 v[158:159], v9 offset:1472
    ds_read_b64_tr_b16 v[164:165], v9 offset:224
    ds_read_b64_tr_b16 v[166:167], v9 offset:1504
    ds_read_b64_tr_b16 v[172:173], v9 offset:256
    ds_read_b64_tr_b16 v[174:175], v9 offset:1536
    ds_read_b64_tr_b16 v[244:245], v9 offset:288
    ds_read_b64_tr_b16 v[246:247], v9 offset:1568
    s_waitcnt lgkmcnt(0)
    s_waitcnt vmcnt(10)
    ds_read_b64_tr_b16 v[176:177], v9 offset:10240
    ds_read_b64_tr_b16 v[178:179], v9 offset:11520
    ds_read_b64_tr_b16 v[184:185], v9 offset:10272
    ds_read_b64_tr_b16 v[186:187], v9 offset:11552
    ds_read_b64_tr_b16 v[128:129], v9 offset:10304
    ds_read_b64_tr_b16 v[130:131], v9 offset:11584
    ds_read_b64_tr_b16 v[192:193], v9 offset:10336
    ds_read_b64_tr_b16 v[194:195], v9 offset:11616
    ds_read_b64_tr_b16 v[200:201], v9 offset:10368
    ds_read_b64_tr_b16 v[202:203], v9 offset:11648
    s_waitcnt lgkmcnt(4)
    ds_read_b64_tr_b16 v[208:209], v9 offset:10400
    ds_read_b64_tr_b16 v[210:211], v9 offset:11680
    ds_read_b64_tr_b16 v[216:217], v9 offset:10432
    ds_read_b64_tr_b16 v[218:219], v9 offset:11712
    ds_read_b64_tr_b16 v[224:225], v9 offset:10464
    ds_read_b64_tr_b16 v[226:227], v9 offset:11744
    ds_read_b64_tr_b16 v[232:233], v9 offset:10496
    ds_read_b64_tr_b16 v[234:235], v9 offset:11776
    ds_read_b64_tr_b16 v[248:249], v9 offset:10528
    ds_read_b64_tr_b16 v[250:251], v9 offset:11808
    s_waitcnt lgkmcnt(0)
    s_waitcnt vmcnt(0)
    ds_read_b64_tr_b16 v[180:181], v9 offset:20480
    ds_read_b64_tr_b16 v[182:183], v9 offset:21760
    ds_read_b64_tr_b16 v[188:189], v9 offset:20512
    ds_read_b64_tr_b16 v[190:191], v9 offset:21792
    ds_read_b64_tr_b16 v[132:133], v9 offset:20544
    ds_read_b64_tr_b16 v[134:135], v9 offset:21824
    ds_read_b64_tr_b16 v[196:197], v9 offset:20576
    ds_read_b64_tr_b16 v[198:199], v9 offset:21856
    ds_read_b64_tr_b16 v[204:205], v9 offset:20608
    ds_read_b64_tr_b16 v[206:207], v9 offset:21888
    s_waitcnt lgkmcnt(4)
    ds_read_b64_tr_b16 v[212:213], v9 offset:20640
    ds_read_b64_tr_b16 v[214:215], v9 offset:21920
    ds_read_b64_tr_b16 v[220:221], v9 offset:20672
    ds_read_b64_tr_b16 v[222:223], v9 offset:21952
    ds_read_b64_tr_b16 v[228:229], v9 offset:20704
    ds_read_b64_tr_b16 v[230:231], v9 offset:21984
    ds_read_b64_tr_b16 v[236:237], v9 offset:20736
    ds_read_b64_tr_b16 v[238:239], v9 offset:22016
    ds_read_b64_tr_b16 v[252:253], v9 offset:20768
    ds_read_b64_tr_b16 v[254:255], v9 offset:22048
    s_waitcnt lgkmcnt(0)
    buffer_load_dwordx2 v[28:29], off, s[12:15], s95 sc1
    v_and_b32 v30, 7, v2
    v_lshlrev_b32 v30, 3, v30
    buffer_load_dwordx2 v[30:31], v30, s[12:15], 0 offen offset:128 sc1
    s_lshl_b32 s47, s35, 10
    v_lshl_add_u32 v12, v2, 4, s47
    s_lshl_b32 s57, s56, 16
    s_add_u32 s57, s57, 2097152
    v_lshlrev_b32 v16, 4, v2
    v_add_u32 v25, s39, v16
    v_add_u32 v16, 147456, v16
    s_lshl_b32 s47, s35, 10
    v_add_u32 v15, s47, v16
    v_mov_b32 v17, 0x4444
    v_mov_b32 v10, 0xeeee
    v_and_b32 v11, 1, v2
    v_cmp_ne_u32 vcc, 0, v11
    s_nop 1
    v_cndmask_b32 v17, v17, v10, vcc
    s_add_u32 s46, s35, 3
    s_cmp_ge_u32 s46, 10
    s_cselect_b32 s47, 10, 0
    s_sub_u32 s46, s46, s47
    s_lshl_b32 s46, s46, 10
    v_add_u32 v18, s46, v16
    s_add_u32 s46, s35, 4
    s_cmp_ge_u32 s46, 10
    s_cselect_b32 s47, 10, 0
    s_sub_u32 s46, s46, s47
    s_lshl_b32 s46, s46, 10
    v_add_u32 v19, s46, v16
    s_add_u32 s46, s35, 5
    s_cmp_ge_u32 s46, 10
    s_cselect_b32 s47, 10, 0
    s_sub_u32 s46, s46, s47
    s_lshl_b32 s46, s46, 10
    v_add_u32 v20, s46, v16
    s_add_u32 s46, s35, 6
    s_cmp_ge_u32 s46, 10
    s_cselect_b32 s47, 10, 0
    s_sub_u32 s46, s46, s47
    s_lshl_b32 s46, s46, 10
    v_add_u32 v21, s46, v16
    s_add_u32 s46, s35, 7
    s_cmp_ge_u32 s46, 10
    s_cselect_b32 s47, 10, 0
    s_sub_u32 s46, s46, s47
    s_lshl_b32 s46, s46, 10
    v_add_u32 v22, s46, v16
    s_add_u32 s46, s35, 8
    s_cmp_ge_u32 s46, 10
    s_cselect_b32 s47, 10, 0
    s_sub_u32 s46, s46, s47
    s_lshl_b32 s46, s46, 10
    v_add_u32 v23, s46, v16
    s_add_u32 s46, s35, 9
    s_cmp_ge_u32 s46, 10
    s_cselect_b32 s47, 10, 0
    s_sub_u32 s46, s46, s47
    s_lshl_b32 s46, s46, 10
    v_add_u32 v24, s46, v16
    s_lshl_b32 s46, s32, 8
    s_add_u32 s46, s46, 157696
    v_bfe_u32 v10, v2, 2, 2
    v_lshlrev_b32 v10, 6, v10
    v_and_b32 v11, 1, v2
    v_lshl_add_u32 v10, v11, 5, v10
    v_and_b32 v11, 2, v2
    v_add_u32 v10, v10, v11
    v_lshrrev_b32 v11, 4, v2
    v_lshl_add_u32 v10, v11, 3, v10
    v_add_u32 v16, s46, v10
    v_and_b32 v10, 15, v2
    v_lshlrev_b32 v10, 4, v10
    v_lshl_add_u32 v10, v11, 2, v10
    v_add_u32 v26, s46, v10
    s_barrier
    ds_write_b128 v25, v[32:35] offset:0
    ds_write_b128 v25, v[36:39] offset:1024
    ds_write_b128 v25, v[40:43] offset:2048
    ds_write_b128 v25, v[44:47] offset:3072
    ds_write_b128 v25, v[48:51] offset:4096
    ds_write_b128 v25, v[52:55] offset:5120
    ds_write_b128 v25, v[56:59] offset:6144
    ds_write_b128 v25, v[60:63] offset:7168
    s_waitcnt lgkmcnt(0)
    ds_write_b128 v25, v[64:67] offset:8192
    ds_write_b128 v25, v[68:71] offset:9216
    ds_write_b128 v25, v[72:75] offset:10240
    ds_write_b128 v25, v[76:79] offset:11264
    ds_write_b128 v25, v[80:83] offset:12288
    ds_write_b128 v25, v[84:87] offset:13312
    ds_write_b128 v25, v[88:91] offset:14336
    ds_write_b128 v25, v[92:95] offset:15360
    s_waitcnt lgkmcnt(0)
    ds_write_b128 v25, v[96:99] offset:16384
    ds_write_b128 v25, v[100:103] offset:17408
    ds_write_b128 v25, v[104:107] offset:18432
    ds_write_b128 v25, v[108:111] offset:19456
    ds_write_b128 v25, v[112:115] offset:20480
    ds_write_b128 v25, v[116:119] offset:21504
    ds_write_b128 v25, v[120:123] offset:22528
    ds_write_b128 v25, v[124:127] offset:23552
    s_waitcnt lgkmcnt(0)
    ds_write_b128 v25, v[128:131] offset:24576
    ds_write_b128 v25, v[132:135] offset:25600
    ds_write_b128 v25, v[136:139] offset:26624
    ds_write_b128 v25, v[140:143] offset:27648
    ds_write_b128 v25, v[144:147] offset:28672
    ds_write_b128 v25, v[148:151] offset:29696
    ds_write_b128 v25, v[152:155] offset:30720
    ds_write_b128 v25, v[156:159] offset:31744
    s_waitcnt lgkmcnt(0)
    ds_write_b128 v25, v[160:163] offset:32768
    ds_write_b128 v25, v[164:167] offset:33792
    ds_write_b128 v25, v[168:171] offset:34816
    ds_write_b128 v25, v[172:175] offset:35840
    s_waitcnt lgkmcnt(0)
    s_branch WST_51_chk
WST_51:
    s_sleep 10
WST_51_go:
    buffer_load_dwordx2 v[28:29], off, s[12:15], s95 sc1
    v_and_b32 v30, 7, v2
    v_lshlrev_b32 v30, 3, v30
    buffer_load_dwordx2 v[30:31], v30, s[12:15], 0 offen offset:128 sc1
WST_51_chk:
    s_sub_u32 s33, s33, 1
    s_cbranch_scc1 EXIT
    s_waitcnt vmcnt(0)
    s_cmp_eq_u32 s54, 0
    s_cbranch_scc1 WST_51_v
    v_not_b32 v30, v30
    v_xor_b32 v31, 8192, v31
    v_or_b32 v30, v30, v31
    v_cmp_ne_u32 vcc, 0, v30
    s_cbranch_vccz WST_51_v
    v_xor_b32 v31, 8192, v31
    v_lshrrev_b32 v31, 8, v31
    s_nop 1
    v_add_u32_dpp v31, v31, v31 row_ror:4 row_mask:0xf bank_mask:0xf
    s_nop 1
    v_add_u32_dpp v31, v31, v31 row_ror:2 row_mask:0xf bank_mask:0xf
    s_nop 1
    v_add_u32_dpp v31, v31, v31 row_ror:1 row_mask:0xf bank_mask:0xf
    s_nop 0
    v_readfirstlane_b32 s4, v31
    s_nop 0
    s_cmp_lt_u32 s4, 256
    s_cbranch_scc1 WST_51
    s_branch RESTART
WST_51_v:
    v_readfirstlane_b32 s4, v28
    v_readfirstlane_b32 s5, v29
    s_cmp_lt_u32 s4, 40
    s_cbranch_scc1 WST_51
    s_bitcmp1_b32 s5, 1
    s_cbranch_scc0 WST_51
    s_and_b32 s53, s5, 1
    s_lshl_b32 s53, s53, 13
    v_lshrrev_b32 v10, 4, v2
    v_lshlrev_b32 v10, 3, v10
    v_bfe_u32 v11, v2, 2, 2
    v_add_u32 v10, v10, v11
    v_lshlrev_b32 v4, 5, v10
    v_and_b32 v11, 3, v2
    v_lshl_add_u32 v4, v11, 3, v4
    v_add_u32 v27, 157696, v4
    v_lshrrev_b32 v10, 4, v2
    v_lshlrev_b32 v30, 11, v10
    v_and_b32 v11, 15, v2
    v_lshl_add_u32 v30, v11, 4, v30
    v_lshrrev_b32 v10, 5, v2
    v_lshlrev_b32 v10, 3, v10
    v_lshl_add_u32 v11, v11, 4, v10
    v_bfe_u32 v10, v2, 4, 1
    v_lshl_add_u32 v28, v10, 11, v11
    v_mul_u32_u24 v10, 40960, v10
    v_add_u32 v29, v10, v11
    v_mov_b32 v168, -1
    v_mov_b32 v169, -1
    v_mov_b32 v170, -1
    v_mov_b32 v171, -1
    s_mul_i32 s44, s32, 409600
    s_lshl_b32 s46, s2, 8
    s_add_u32 s44, s44, s46
    s_add_u32 s44, s44, 83918848
    s_mov_b32 s36, -1
    s_mov_b32 s37, 0
    s_mov_b32 s34, 0
    s_mul_i32 s45, s32, 20480
    s_lshr_b32 s46, s2, 2
    s_lshl_b32 s46, s46, 8
    s_add_u32 s45, s45, s46
    s_lshl_b32 s46, s56, 18
    s_add_u32 s45, s45, s46
    s_add_u32 s45, s45, 2359296
    s_add_u32 s43, s45, 245760
    s_add_u32 s42, s45, 163840
    s_cmp_eq_u32 s54, 0
    s_cbranch_scc1 U_LOOP_S
.p2align 6
U_LOOP:
    ds_read_b128 v[72:75], v25 offset:0
    ds_read_b128 v[76:79], v25 offset:1024
    ds_read_b128 v[80:83], v25 offset:2048
    ds_read_b128 v[84:87], v25 offset:3072
    ds_read_b128 v[88:91], v25 offset:4096
    ds_read_b128 v[92:95], v25 offset:5120
    ds_read_b128 v[96:99], v25 offset:6144
    ds_read_b128 v[100:103], v25 offset:7168
    v_mov_b32 v104, 0
    v_mov_b32 v105, 0
    v_mov_b32 v106, 0
    v_mov_b32 v107, 0
    v_mov_b32 v108, 0
    v_mov_b32 v109, 0
    v_mov_b32 v110, 0
    v_mov_b32 v111, 0
    v_mov_b32 v112, 0
    v_mov_b32 v113, 0
    v_mov_b32 v114, 0
    v_mov_b32 v115, 0
    v_mov_b32 v128, 0
    v_mov_b32 v129, 0
    v_mov_b32 v130, 0
    v_mov_b32 v131, 0
    v_mov_b32 v132, 0
    v_mov_b32 v133, 0
    v_mov_b32 v134, 0
    v_mov_b32 v135, 0
    v_mov_b32 v136, 0
    v_mov_b32 v137, 0
    v_mov_b32 v138, 0
    v_mov_b32 v139, 0
    v_mov_b32 v140, 0
    v_mov_b32 v141, 0
    v_mov_b32 v142, 0
    v_mov_b32 v143, 0
    v_mov_b32 v144, 0
    v_mov_b32 v145, 0
    v_mov_b32 v146, 0
    v_mov_b32 v147, 0
    v_mov_b32 v148, 0
    v_mov_b32 v149, 0
    v_mov_b32 v150, 0
    v_mov_b32 v151, 0
    v_mov_b32 v152, 0
    v_mov_b32 v153, 0
    v_mov_b32 v154, 0
    v_mov_b32 v155, 0
    v_mov_b32 v156, 0
    v_mov_b32 v157, 0
    v_mov_b32 v158, 0
    v_mov_b32 v159, 0
    v_mov_b32 v160, 0
    v_mov_b32 v161, 0
    v_mov_b32 v162, 0
    v_mov_b32 v163, 0
    v_mov_b32 v164, 0
    v_mov_b32 v165, 0
    v_mov_b32 v166, 0
    v_mov_b32 v167, 0
    s_add_u32 s55, s34, 0
    s_and_b32 s55, s55, 3
    s_mul_i32 s55, s55, 10240
    s_add_u32 s55, s55, s57
    s_add_u32 s84, s45, 4096
    s_add_u32 s85, s45, 8192
    s_add_u32 s86, s45, 12288
    s_add_u32 s87, s45, 16384
    s_waitcnt lgkmcnt(0)
QP_52:
    buffer_load_dwordx4 v[32:35], v12, s[8:11], s55 offen offset:0 sc1
    buffer_load_dwordx4 v[36:39], v12, s[8:11], s55 offen offset:1024 sc1
    buffer_load_dwordx4 v[40:43], v12, s[8:11], s55 offen offset:2048 sc1
    s_sub_u32 s33, s33, 1
    s_cbranch_scc1 EXIT
    s_waitcnt vmcnt(0)
    v_max3_u32 v10, v32, v36, v40
    v_cmp_eq_u32 vcc, -1, v10
    s_cbranch_vccnz QP_52
    v_smfmac_f32_16x16x64_bf16 v[104:107], v[32:35], v[72:79], v17
    ds_write_b128 v15, v[32:35] offset:0
    v_max3_u32 v10, v33, v34, v35
    v_smfmac_f32_16x16x64_bf16 v[108:111], v[32:35], a[0:7], v17
    ds_write_b128 v15, v[36:39] offset:1024
    v_max3_u32 v10, v10, v37, v38
    v_smfmac_f32_16x16x64_bf16 v[112:115], v[32:35], a[8:15], v17
    ds_write_b128 v15, v[40:43] offset:2048
    v_max3_u32 v10, v10, v39, v41
    v_smfmac_f32_16x16x64_bf16 v[104:107], v[36:39], a[16:23], v17
    ds_read_b128 v[72:75], v25 offset:8192
    v_max3_u32 v10, v10, v42, v43
    v_cmp_eq_u32 vcc, -1, v10
    v_smfmac_f32_16x16x64_bf16 v[108:111], v[36:39], a[24:31], v17
    s_cbranch_vccnz U_LOOP
    s_waitcnt lgkmcnt(1)
    s_barrier
    ds_read_b128 v[44:47], v18
    v_smfmac_f32_16x16x64_bf16 v[112:115], v[36:39], a[32:39], v17
    ds_read_b128 v[48:51], v19
    v_smfmac_f32_16x16x64_bf16 v[104:107], v[40:43], a[40:47], v17
    ds_read_b128 v[52:55], v20
    v_smfmac_f32_16x16x64_bf16 v[108:111], v[40:43], a[48:55], v17
    ds_read_b128 v[56:59], v21
    v_smfmac_f32_16x16x64_bf16 v[112:115], v[40:43], v[80:87], v17
    ds_read_b128 v[60:63], v22
    s_waitcnt lgkmcnt(4)
    v_smfmac_f32_16x16x64_bf16 v[104:107], v[44:47], v[88:95], v17
    ds_read_b128 v[64:67], v23
    s_waitcnt lgkmcnt(4)
    v_smfmac_f32_16x16x64_bf16 v[104:107], v[48:51], v[96:103], v17
    ds_read_b128 v[68:71], v24
    s_waitcnt lgkmcnt(4)
    v_smfmac_f32_16x16x64_bf16 v[104:107], v[52:55], a[56:63], v17
    ds_read_b128 v[76:79], v25 offset:9216
    s_waitcnt lgkmcnt(4)
    v_smfmac_f32_16x16x64_bf16 v[104:107], v[56:59], a[64:71], v17
    ds_read_b128 v[80:83], v25 offset:10240
    s_waitcnt lgkmcnt(4)
    v_smfmac_f32_16x16x64_bf16 v[104:107], v[60:63], a[72:79], v17
    ds_read_b128 v[84:87], v25 offset:11264
    s_waitcnt lgkmcnt(4)
    v_smfmac_f32_16x16x64_bf16 v[104:107], v[64:67], a[80:87], v17
    ds_read_b128 v[88:91], v25 offset:12288
    s_waitcnt lgkmcnt(4)
    v_smfmac_f32_16x16x64_bf16 v[104:107], v[68:71], a[88:95], v17
    ds_read_b128 v[92:95], v25 offset:13312
    s_waitcnt lgkmcnt(4)
    v_smfmac_f32_16x16x64_bf16 v[108:111], v[44:47], v[72:79], v17
    ds_read_b128 v[96:99], v25 offset:14336
    v_smfmac_f32_16x16x64_bf16 v[108:111], v[48:51], a[96:103], v17
    ds_read_b128 v[100:103], v25 offset:15360
    s_waitcnt lgkmcnt(4)
    v_smfmac_f32_16x16x64_bf16 v[108:111], v[52:55], a[104:111], v17
    ds_read_b128 v[72:75], v25 offset:16384
    v_add_f32 v104, v104, v105
    v_smfmac_f32_16x16x64_bf16 v[108:111], v[56:59], v[80:87], v17
    ds_read_b128 v[76:79], v25 offset:17408
    v_add_f32 v106, v106, v107
    v_smfmac_f32_16x16x64_bf16 v[108:111], v[60:63], a[112:119], v17
    ds_read_b128 v[80:83], v25 offset:18432
    v_cvt_pk_bf16_f32 v105, v104, v106
    v_smfmac_f32_16x16x64_bf16 v[108:111], v[64:67], a[120:127], v17
    ds_write_b16 v16, v105 offset:0
    v_smfmac_f32_16x16x64_bf16 v[108:111], v[68:71], a[128:135], v17
    ds_write_b16_d16_hi v16, v105 offset:4
    s_waitcnt lgkmcnt(7)
    v_smfmac_f32_16x16x64_bf16 v[112:115], v[44:47], v[88:95], v17
    ds_read_b128 v[84:87], v25 offset:19456
    v_smfmac_f32_16x16x64_bf16 v[112:115], v[48:51], a[136:143], v17
    ds_read_b128 v[88:91], v25 offset:20480
    s_waitcnt lgkmcnt(7)
    v_smfmac_f32_16x16x64_bf16 v[112:115], v[52:55], a[144:151], v17
    s_waitcnt lgkmcnt(2)
    s_barrier
    ds_read_b64_tr_b16 v[116:117], v27 offset:0
    v_add_f32 v108, v108, v109
    v_smfmac_f32_16x16x64_bf16 v[112:115], v[56:59], a[152:159], v17
    ds_read_b64_tr_b16 v[118:119], v27 offset:128
    v_add_f32 v110, v110, v111
    v_smfmac_f32_16x16x64_bf16 v[112:115], v[60:63], v[96:103], v17
    ds_read_b128 v[92:95], v25 offset:21504
    v_cvt_pk_bf16_f32 v109, v108, v110
    v_smfmac_f32_16x16x64_bf16 v[112:115], v[64:67], a[160:167], v17
    ds_write_b16 v16, v109 offset:1024
    v_smfmac_f32_16x16x64_bf16 v[112:115], v[68:71], a[168:175], v17
    ds_write_b16_d16_hi v16, v109 offset:1028
    s_waitcnt lgkmcnt(3)
    v_smfmac_f32_16x16x64_bf16 v[128:131], v[116:119], a[176:183], v17
    ds_read_b128 v[96:99], v25 offset:22528
    v_smfmac_f32_16x16x64_bf16 v[132:135], v[116:119], v[72:79], v17
    ds_read_b128 v[100:103], v25 offset:23552
    s_nop 1
    v_add_f32 v112, v112, v113
    v_add_f32 v114, v114, v115
    v_smfmac_f32_16x16x64_bf16 v[136:139], v[116:119], a[184:191], v17
    s_waitcnt lgkmcnt(2)
    s_barrier
    ds_read_b64_tr_b16 v[120:121], v27 offset:1024
    v_cvt_pk_bf16_f32 v113, v112, v114
    v_smfmac_f32_16x16x64_bf16 v[140:143], v[116:119], a[192:199], v17
    ds_write_b16 v16, v113 offset:2048
    v_smfmac_f32_16x16x64_bf16 v[144:147], v[116:119], a[200:207], v17
    ds_write_b16_d16_hi v16, v113 offset:2052
    v_smfmac_f32_16x16x64_bf16 v[148:151], v[116:119], v[80:87], v17
    ds_read_b64_tr_b16 v[122:123], v27 offset:1152
    v_smfmac_f32_16x16x64_bf16 v[152:155], v[116:119], a[208:215], v17
    ds_read_b128 v[72:75], v25 offset:24576
    v_smfmac_f32_16x16x64_bf16 v[156:159], v[116:119], a[216:223], v17
    s_waitcnt lgkmcnt(2)
    s_barrier
    ds_read_b64_tr_b16 v[124:125], v27 offset:2048
    v_smfmac_f32_16x16x64_bf16 v[160:163], v[116:119], a[224:231], v17
    ds_read_b64_tr_b16 v[126:127], v27 offset:2176
    v_smfmac_f32_16x16x64_bf16 v[164:167], v[116:119], a[232:239], v17
    ds_read_b128 v[76:79], v25 offset:25600
    s_waitcnt lgkmcnt(4)
    v_smfmac_f32_16x16x64_bf16 v[128:131], v[120:123], v[88:95], v17
    ds_read_b128 v[80:83], v25 offset:26624
    v_smfmac_f32_16x16x64_bf16 v[132:135], v[120:123], a[240:247], v17
    ds_read_b128 v[84:87], v25 offset:27648
    v_smfmac_f32_16x16x64_bf16 v[136:139], v[120:123], v[96:103], v17
    ds_read_b128 v[88:91], v25 offset:28672
    v_smfmac_f32_16x16x64_bf16 v[140:143], v[120:123], a[248:255], v17
    ds_read_b128 v[92:95], v25 offset:29696
    s_waitcnt lgkmcnt(5)
    v_smfmac_f32_16x16x64_bf16 v[128:131], v[124:127], v[176:183], v17
    ds_read_b128 v[96:99], v25 offset:30720
    v_smfmac_f32_16x16x64_bf16 v[132:135], v[124:127], v[184:191], v17
    ds_read_b128 v[100:103], v25 offset:31744
    s_waitcnt lgkmcnt(6)
    v_smfmac_f32_16x16x64_bf16 v[136:139], v[124:127], v[72:79], v17
    ds_read_b128 v[72:75], v25 offset:32768
    v_smfmac_f32_16x16x64_bf16 v[140:143], v[124:127], v[192:199], v17
    ds_read_b128 v[76:79], v25 offset:33792
    s_waitcnt lgkmcnt(4)
    v_smfmac_f32_16x16x64_bf16 v[144:147], v[120:123], v[80:87], v17
    ds_read_b128 v[80:83], v25 offset:34816
    v_add_f32 v128, v128, v129
    v_add_f32 v130, v130, v131
    v_smfmac_f32_16x16x64_bf16 v[144:147], v[124:127], v[200:207], v17
    ds_read_b128 v[84:87], v25 offset:35840
    v_cvt_pk_bf16_f32 v32, v128, v130
    v_add_f32 v132, v132, v133
    v_smfmac_f32_16x16x64_bf16 v[148:151], v[120:123], v[88:95], v17
    v_add_f32 v134, v134, v135
    v_cvt_pk_bf16_f32 v33, v132, v134
    v_smfmac_f32_16x16x64_bf16 v[148:151], v[124:127], v[208:215], v17
    s_waitcnt lgkmcnt(4)
    v_add_f32 v136, v136, v137
    v_add_f32 v138, v138, v139
    v_smfmac_f32_16x16x64_bf16 v[152:155], v[120:123], v[96:103], v17
    v_permlane16_swap_b32 v32, v33
    v_cvt_pk_bf16_f32 v34, v136, v138
    v_smfmac_f32_16x16x64_bf16 v[152:155], v[124:127], v[216:223], v17
    buffer_store_dwordx2 v[32:33], v28, s[8:11], s45 offen
    s_waitcnt lgkmcnt(2)
    v_add_f32 v140, v140, v141
    v_add_f32 v142, v142, v143
    v_smfmac_f32_16x16x64_bf16 v[156:159], v[120:123], v[72:79], v17
    v_cvt_pk_bf16_f32 v35, v140, v142
    v_add_f32 v144, v144, v145
    v_smfmac_f32_16x16x64_bf16 v[156:159], v[124:127], v[224:231], v17
    s_waitcnt lgkmcnt(0)
    v_add_f32 v146, v146, v147
    v_permlane16_swap_b32 v34, v35
    v_smfmac_f32_16x16x64_bf16 v[160:163], v[120:123], v[80:87], v17
    v_cvt_pk_bf16_f32 v36, v144, v146
    v_smfmac_f32_16x16x64_bf16 v[160:163], v[124:127], v[232:239], v17
    buffer_store_dwordx2 v[34:35], v28, s[8:11], s84 offen
    v_add_f32 v148, v148, v149
    v_add_f32 v150, v150, v151
    v_smfmac_f32_16x16x64_bf16 v[164:167], v[120:123], v[240:247], v17
    v_cvt_pk_bf16_f32 v37, v148, v150
    v_add_f32 v152, v152, v153
    v_smfmac_f32_16x16x64_bf16 v[164:167], v[124:127], v[248:255], v17
    v_add_f32 v154, v154, v155
    v_permlane16_swap_b32 v36, v37
    v_cvt_pk_bf16_f32 v38, v152, v154
    buffer_store_dwordx2 v[36:37], v28, s[8:11], s85 offen
    v_add_f32 v156, v156, v157
    v_add_f32 v158, v158, v159
    v_cvt_pk_bf16_f32 v39, v156, v158
    v_add_f32 v160, v160, v161
    v_add_f32 v162, v162, v163
    v_permlane16_swap_b32 v38, v39
    v_cvt_pk_bf16_f32 v40, v160, v162
    buffer_store_dwordx2 v[38:39], v28, s[8:11], s86 offen
    v_add_f32 v164, v164, v165
    v_add_f32 v166, v166, v167
    v_cvt_pk_bf16_f32 v41, v164, v166
    s_nop 1
    v_permlane16_swap_b32 v40, v41
    buffer_store_dwordx2 v[40:41], v28, s[8:11], s87 offen
    s_mov_b32 s42, s45
    s_add_u32 s45, s45, 81920
    s_cmp_eq_u32 s45, s43
    s_cselect_b32 s46, 245760, 0
    s_sub_u32 s45, s45, s46
    s_add_u32 s44, s44, 1638400
    s_add_u32 s34, s34, 1
    s_cmp_lt_u32 s34, 64
    s_cbranch_scc1 U_LOOP
    s_add_u32 s47, s44, 4293328896
    buffer_store_dwordx2 v[32:33], v29, s[8:11], s47 offen sc1
    s_add_u32 s47, s44, 4293410816
    buffer_store_dwordx2 v[34:35], v29, s[8:11], s47 offen sc1
    s_add_u32 s47, s44, 4293492736
    buffer_store_dwordx2 v[36:37], v29, s[8:11], s47 offen sc1
    s_add_u32 s47, s44, 4293574656
    buffer_store_dwordx2 v[38:39], v29, s[8:11], s47 offen sc1
    s_add_u32 s47, s44, 4293656576
    buffer_store_dwordx2 v[40:41], v29, s[8:11], s47 offen sc1
    s_endpgm
.p2align 6
U_LOOP_S:
    ds_read_b128 v[72:75], v25 offset:0
    ds_read_b128 v[76:79], v25 offset:1024
    ds_read_b128 v[80:83], v25 offset:2048
    ds_read_b128 v[84:87], v25 offset:3072
    ds_read_b128 v[88:91], v25 offset:4096
    ds_read_b128 v[92:95], v25 offset:5120
    ds_read_b128 v[96:99], v25 offset:6144
    ds_read_b128 v[100:103], v25 offset:7168
    v_mov_b32 v104, 0
    v_mov_b32 v105, 0
    v_mov_b32 v106, 0
    v_mov_b32 v107, 0
    v_mov_b32 v108, 0
    v_mov_b32 v109, 0
    v_mov_b32 v110, 0
    v_mov_b32 v111, 0
    v_mov_b32 v112, 0
    v_mov_b32 v113, 0
    v_mov_b32 v114, 0
    v_mov_b32 v115, 0
    v_mov_b32 v128, 0
    v_mov_b32 v129, 0
    v_mov_b32 v130, 0
    v_mov_b32 v131, 0
    v_mov_b32 v132, 0
    v_mov_b32 v133, 0
    v_mov_b32 v134, 0
    v_mov_b32 v135, 0
    v_mov_b32 v136, 0
    v_mov_b32 v137, 0
    v_mov_b32 v138, 0
    v_mov_b32 v139, 0
    v_mov_b32 v140, 0
    v_mov_b32 v141, 0
    v_mov_b32 v142, 0
    v_mov_b32 v143, 0
    v_mov_b32 v144, 0
    v_mov_b32 v145, 0
    v_mov_b32 v146, 0
    v_mov_b32 v147, 0
    v_mov_b32 v148, 0
    v_mov_b32 v149, 0
    v_mov_b32 v150, 0
    v_mov_b32 v151, 0
    v_mov_b32 v152, 0
    v_mov_b32 v153, 0
    v_mov_b32 v154, 0
    v_mov_b32 v155, 0
    v_mov_b32 v156, 0
    v_mov_b32 v157, 0
    v_mov_b32 v158, 0
    v_mov_b32 v159, 0
    v_mov_b32 v160, 0
    v_mov_b32 v161, 0
    v_mov_b32 v162, 0
    v_mov_b32 v163, 0
    v_mov_b32 v164, 0
    v_mov_b32 v165, 0
    v_mov_b32 v166, 0
    v_mov_b32 v167, 0
    s_add_u32 s55, s34, 0
    s_and_b32 s55, s55, 3
    s_mul_i32 s55, s55, 10240
    s_add_u32 s55, s55, s57
    s_add_u32 s84, s45, 4096
    s_add_u32 s85, s45, 8192
    s_add_u32 s86, s45, 12288
    s_add_u32 s87, s45, 16384
    s_waitcnt lgkmcnt(0)
QP_53:
    buffer_load_dwordx4 v[32:35], v12, s[8:11], s55 offen offset:0 sc1
    buffer_load_dwordx4 v[36:39], v12, s[8:11], s55 offen offset:1024 sc1
    buffer_load_dwordx4 v[40:43], v12, s[8:11], s55 offen offset:2048 sc1
    s_sub_u32 s33, s33, 1
    s_cbranch_scc1 EXIT
    s_waitcnt vmcnt(0)
    v_max3_u32 v10, v32, v36, v40
    v_cmp_eq_u32 vcc, -1, v10
    s_cbranch_vccnz QP_53
    v_smfmac_f32_16x16x64_bf16 v[104:107], v[32:35], v[72:79], v17
    ds_write_b128 v15, v[32:35] offset:0
    v_max3_u32 v10, v33, v34, v35
    v_smfmac_f32_16x16x64_bf16 v[108:111], v[32:35], a[0:7], v17
    ds_write_b128 v15, v[36:39] offset:1024
    v_max3_u32 v10, v10, v37, v38
    v_smfmac_f32_16x16x64_bf16 v[112:115], v[32:35], a[8:15], v17
    ds_write_b128 v15, v[40:43] offset:2048
    v_max3_u32 v10, v10, v39, v41
    v_smfmac_f32_16x16x64_bf16 v[104:107], v[36:39], a[16:23], v17
    ds_read_b128 v[72:75], v25 offset:8192
    v_max3_u32 v10, v10, v42, v43
    v_cmp_eq_u32 vcc, -1, v10
    v_smfmac_f32_16x16x64_bf16 v[108:111], v[36:39], a[24:31], v17
    s_cbranch_vccnz U_LOOP_S
    s_waitcnt lgkmcnt(1)
    s_barrier
    ds_read_b128 v[44:47], v18
    v_smfmac_f32_16x16x64_bf16 v[112:115], v[36:39], a[32:39], v17
    ds_read_b128 v[48:51], v19
    v_smfmac_f32_16x16x64_bf16 v[104:107], v[40:43], a[40:47], v17
    ds_read_b128 v[52:55], v20
    v_smfmac_f32_16x16x64_bf16 v[108:111], v[40:43], a[48:55], v17
    ds_read_b128 v[56:59], v21
    v_smfmac_f32_16x16x64_bf16 v[112:115], v[40:43], v[80:87], v17
    ds_read_b128 v[60:63], v22
    s_waitcnt lgkmcnt(4)
    v_smfmac_f32_16x16x64_bf16 v[104:107], v[44:47], v[88:95], v17
    ds_read_b128 v[64:67], v23
    s_waitcnt lgkmcnt(4)
    v_smfmac_f32_16x16x64_bf16 v[104:107], v[48:51], v[96:103], v17
    ds_read_b128 v[68:71], v24
    s_waitcnt lgkmcnt(4)
    v_smfmac_f32_16x16x64_bf16 v[104:107], v[52:55], a[56:63], v17
    ds_read_b128 v[76:79], v25 offset:9216
    s_waitcnt lgkmcnt(4)
    v_smfmac_f32_16x16x64_bf16 v[104:107], v[56:59], a[64:71], v17
    ds_read_b128 v[80:83], v25 offset:10240
    s_waitcnt lgkmcnt(4)
    v_smfmac_f32_16x16x64_bf16 v[104:107], v[60:63], a[72:79], v17
    ds_read_b128 v[84:87], v25 offset:11264
    s_waitcnt lgkmcnt(4)
    v_smfmac_f32_16x16x64_bf16 v[104:107], v[64:67], a[80:87], v17
    ds_read_b128 v[88:91], v25 offset:12288
    s_waitcnt lgkmcnt(4)
    v_smfmac_f32_16x16x64_bf16 v[104:107], v[68:71], a[88:95], v17
    ds_read_b128 v[92:95], v25 offset:13312
    s_waitcnt lgkmcnt(4)
    v_smfmac_f32_16x16x64_bf16 v[108:111], v[44:47], v[72:79], v17
    ds_read_b128 v[96:99], v25 offset:14336
    v_smfmac_f32_16x16x64_bf16 v[108:111], v[48:51], a[96:103], v17
    ds_read_b128 v[100:103], v25 offset:15360
    s_waitcnt lgkmcnt(4)
    v_smfmac_f32_16x16x64_bf16 v[108:111], v[52:55], a[104:111], v17
    ds_read_b128 v[72:75], v25 offset:16384
    v_add_f32 v104, v104, v105
    v_smfmac_f32_16x16x64_bf16 v[108:111], v[56:59], v[80:87], v17
    ds_read_b128 v[76:79], v25 offset:17408
    v_add_f32 v106, v106, v107
    v_smfmac_f32_16x16x64_bf16 v[108:111], v[60:63], a[112:119], v17
    ds_read_b128 v[80:83], v25 offset:18432
    v_cvt_pk_bf16_f32 v105, v104, v106
    v_smfmac_f32_16x16x64_bf16 v[108:111], v[64:67], a[120:127], v17
    ds_write_b16 v16, v105 offset:0
    v_smfmac_f32_16x16x64_bf16 v[108:111], v[68:71], a[128:135], v17
    ds_write_b16_d16_hi v16, v105 offset:4
    s_waitcnt lgkmcnt(7)
    v_smfmac_f32_16x16x64_bf16 v[112:115], v[44:47], v[88:95], v17
    ds_read_b128 v[84:87], v25 offset:19456
    v_smfmac_f32_16x16x64_bf16 v[112:115], v[48:51], a[136:143], v17
    ds_read_b128 v[88:91], v25 offset:20480
    s_waitcnt lgkmcnt(7)
    v_smfmac_f32_16x16x64_bf16 v[112:115], v[52:55], a[144:151], v17
    s_waitcnt lgkmcnt(2)
    s_barrier
    ds_read_b64_tr_b16 v[116:117], v27 offset:0
    v_add_f32 v108, v108, v109
    v_smfmac_f32_16x16x64_bf16 v[112:115], v[56:59], a[152:159], v17
    ds_read_b64_tr_b16 v[118:119], v27 offset:128
    v_add_f32 v110, v110, v111
    v_smfmac_f32_16x16x64_bf16 v[112:115], v[60:63], v[96:103], v17
    ds_read_b128 v[92:95], v25 offset:21504
    v_cvt_pk_bf16_f32 v109, v108, v110
    v_smfmac_f32_16x16x64_bf16 v[112:115], v[64:67], a[160:167], v17
    ds_write_b16 v16, v109 offset:1024
    v_smfmac_f32_16x16x64_bf16 v[112:115], v[68:71], a[168:175], v17
    ds_write_b16_d16_hi v16, v109 offset:1028
    s_waitcnt lgkmcnt(3)
    v_smfmac_f32_16x16x64_bf16 v[128:131], v[116:119], a[176:183], v17
    ds_read_b128 v[96:99], v25 offset:22528
    v_smfmac_f32_16x16x64_bf16 v[132:135], v[116:119], v[72:79], v17
    ds_read_b128 v[100:103], v25 offset:23552
    s_nop 1
    v_add_f32 v112, v112, v113
    v_add_f32 v114, v114, v115
    v_smfmac_f32_16x16x64_bf16 v[136:139], v[116:119], a[184:191], v17
    s_waitcnt lgkmcnt(2)
    s_barrier
    ds_read_b64_tr_b16 v[120:121], v27 offset:1024
    v_cvt_pk_bf16_f32 v113, v112, v114
    v_smfmac_f32_16x16x64_bf16 v[140:143], v[116:119], a[192:199], v17
    ds_write_b16 v16, v113 offset:2048
    v_smfmac_f32_16x16x64_bf16 v[144:147], v[116:119], a[200:207], v17
    ds_write_b16_d16_hi v16, v113 offset:2052
    v_smfmac_f32_16x16x64_bf16 v[148:151], v[116:119], v[80:87], v17
    ds_read_b64_tr_b16 v[122:123], v27 offset:1152
    v_smfmac_f32_16x16x64_bf16 v[152:155], v[116:119], a[208:215], v17
    ds_read_b128 v[72:75], v25 offset:24576
    v_smfmac_f32_16x16x64_bf16 v[156:159], v[116:119], a[216:223], v17
    s_waitcnt lgkmcnt(2)
    s_barrier
    ds_read_b64_tr_b16 v[124:125], v27 offset:2048
    v_smfmac_f32_16x16x64_bf16 v[160:163], v[116:119], a[224:231], v17
    ds_read_b64_tr_b16 v[126:127], v27 offset:2176
    v_smfmac_f32_16x16x64_bf16 v[164:167], v[116:119], a[232:239], v17
    ds_read_b128 v[76:79], v25 offset:25600
    s_waitcnt lgkmcnt(4)
    v_smfmac_f32_16x16x64_bf16 v[128:131], v[120:123], v[88:95], v17
    ds_read_b128 v[80:83], v25 offset:26624
    v_smfmac_f32_16x16x64_bf16 v[132:135], v[120:123], a[240:247], v17
    ds_read_b128 v[84:87], v25 offset:27648
    v_smfmac_f32_16x16x64_bf16 v[136:139], v[120:123], v[96:103], v17
    ds_read_b128 v[88:91], v25 offset:28672
    v_smfmac_f32_16x16x64_bf16 v[140:143], v[120:123], a[248:255], v17
    ds_read_b128 v[92:95], v25 offset:29696
    s_waitcnt lgkmcnt(5)
    v_smfmac_f32_16x16x64_bf16 v[128:131], v[124:127], v[176:183], v17
    ds_read_b128 v[96:99], v25 offset:30720
    v_smfmac_f32_16x16x64_bf16 v[132:135], v[124:127], v[184:191], v17
    ds_read_b128 v[100:103], v25 offset:31744
    s_waitcnt lgkmcnt(6)
    v_smfmac_f32_16x16x64_bf16 v[136:139], v[124:127], v[72:79], v17
    ds_read_b128 v[72:75], v25 offset:32768
    v_smfmac_f32_16x16x64_bf16 v[140:143], v[124:127], v[192:199], v17
    ds_read_b128 v[76:79], v25 offset:33792
    s_waitcnt lgkmcnt(4)
    v_smfmac_f32_16x16x64_bf16 v[144:147], v[120:123], v[80:87], v17
    ds_read_b128 v[80:83], v25 offset:34816
    v_add_f32 v128, v128, v129
    v_add_f32 v130, v130, v131
    v_smfmac_f32_16x16x64_bf16 v[144:147], v[124:127], v[200:207], v17
    ds_read_b128 v[84:87], v25 offset:35840
    v_cvt_pk_bf16_f32 v32, v128, v130
    v_add_f32 v132, v132, v133
    v_smfmac_f32_16x16x64_bf16 v[148:151], v[120:123], v[88:95], v17
    v_add_f32 v134, v134, v135
    v_cvt_pk_bf16_f32 v33, v132, v134
    v_smfmac_f32_16x16x64_bf16 v[148:151], v[124:127], v[208:215], v17
    s_waitcnt lgkmcnt(4)
    v_add_f32 v136, v136, v137
    v_add_f32 v138, v138, v139
    v_smfmac_f32_16x16x64_bf16 v[152:155], v[120:123], v[96:103], v17
    v_permlane16_swap_b32 v32, v33
    v_cvt_pk_bf16_f32 v34, v136, v138
    v_smfmac_f32_16x16x64_bf16 v[152:155], v[124:127], v[216:223], v17
    buffer_store_dwordx2 v[32:33], v28, s[8:11], s45 offen sc1
    s_waitcnt lgkmcnt(2)
    v_add_f32 v140, v140, v141
    v_add_f32 v142, v142, v143
    v_smfmac_f32_16x16x64_bf16 v[156:159], v[120:123], v[72:79], v17
    v_cvt_pk_bf16_f32 v35, v140, v142
    v_add_f32 v144, v144, v145
    v_smfmac_f32_16x16x64_bf16 v[156:159], v[124:127], v[224:231], v17
    s_waitcnt lgkmcnt(0)
    v_add_f32 v146, v146, v147
    v_permlane16_swap_b32 v34, v35
    v_smfmac_f32_16x16x64_bf16 v[160:163], v[120:123], v[80:87], v17
    v_cvt_pk_bf16_f32 v36, v144, v146
    v_smfmac_f32_16x16x64_bf16 v[160:163], v[124:127], v[232:239], v17
    buffer_store_dwordx2 v[34:35], v28, s[8:11], s84 offen sc1
    v_add_f32 v148, v148, v149
    v_add_f32 v150, v150, v151
    v_smfmac_f32_16x16x64_bf16 v[164:167], v[120:123], v[240:247], v17
    v_cvt_pk_bf16_f32 v37, v148, v150
    v_add_f32 v152, v152, v153
    v_smfmac_f32_16x16x64_bf16 v[164:167], v[124:127], v[248:255], v17
    v_add_f32 v154, v154, v155
    v_permlane16_swap_b32 v36, v37
    v_cvt_pk_bf16_f32 v38, v152, v154
    buffer_store_dwordx2 v[36:37], v28, s[8:11], s85 offen sc1
    v_add_f32 v156, v156, v157
    v_add_f32 v158, v158, v159
    v_cvt_pk_bf16_f32 v39, v156, v158
    v_add_f32 v160, v160, v161
    v_add_f32 v162, v162, v163
    v_permlane16_swap_b32 v38, v39
    v_cvt_pk_bf16_f32 v40, v160, v162
    buffer_store_dwordx2 v[38:39], v28, s[8:11], s86 offen sc1
    v_add_f32 v164, v164, v165
    v_add_f32 v166, v166, v167
    v_cvt_pk_bf16_f32 v41, v164, v166
    s_nop 1
    v_permlane16_swap_b32 v40, v41
    buffer_store_dwordx2 v[40:41], v28, s[8:11], s87 offen sc1
    s_mov_b32 s42, s45
    s_add_u32 s45, s45, 81920
    s_cmp_eq_u32 s45, s43
    s_cselect_b32 s46, 245760, 0
    s_sub_u32 s45, s45, s46
    s_add_u32 s44, s44, 1638400
    s_add_u32 s34, s34, 1
    s_cmp_lt_u32 s34, 64
    s_cbranch_scc1 U_LOOP_S
    s_add_u32 s47, s44, 4293328896
    buffer_store_dwordx2 v[32:33], v29, s[8:11], s47 offen sc1
    s_add_u32 s47, s44, 4293410816
    buffer_store_dwordx2 v[34:35], v29, s[8:11], s47 offen sc1
    s_add_u32 s47, s44, 4293492736
    buffer_store_dwordx2 v[36:37], v29, s[8:11], s47 offen sc1
    s_add_u32 s47, s44, 4293574656
    buffer_store_dwordx2 v[38:39], v29, s[8:11], s47 offen sc1
    s_add_u32 s47, s44, 4293656576
    buffer_store_dwordx2 v[40:41], v29, s[8:11], s47 offen sc1
    s_endpgm
.p2align 6
ROLE_W:
    s_load_dwordx2 s[40:41], s[0:1], 40
    s_waitcnt lgkmcnt(0)
    s_mov_b32 s20, s40
    s_mov_b32 s21, s41
    s_mov_b32 s22, 7864320
    s_mov_b32 s23, 0x20000
    s_mul_i32 s39, s32, 36864
    s_mul_i32 s37, s2, 245760
    s_mul_i32 s36, s32, 320
    s_add_u32 s37, s37, s36
    s_movk_i32 s46, 3277
    v_add_u32 v10, 0, v2
    v_mul_lo_u32 v11, v10, s46
    v_lshrrev_b32 v11, 16, v11
    v_mul_u32_u24 v14, 20, v11
    v_sub_u32 v14, v10, v14
    v_mul_u32_u24 v11, 1280, v11
    v_lshl_add_u32 v11, v14, 4, v11
    v_add_u32 v6, s37, v11
    v_add_u32 v10, 64, v2
    v_mul_lo_u32 v11, v10, s46
    v_lshrrev_b32 v11, 16, v11
    v_mul_u32_u24 v14, 20, v11
    v_sub_u32 v14, v10, v14
    v_mul_u32_u24 v11, 1280, v11
    v_lshl_add_u32 v11, v14, 4, v11
    v_add_u32 v7, s37, v11
    v_add_u32 v10, 128, v2
    v_mul_lo_u32 v11, v10, s46
    v_lshrrev_b32 v11, 16, v11
    v_mul_u32_u24 v14, 20, v11
    v_sub_u32 v14, v10, v14
    v_mul_u32_u24 v11, 1280, v11
    v_lshl_add_u32 v11, v14, 4, v11
    v_add_u32 v8, s37, v11
    v_add_u32 v10, 192, v2
    v_mul_lo_u32 v11, v10, s46
    v_lshrrev_b32 v11, 16, v11
    v_mul_u32_u24 v14, 20, v11
    v_sub_u32 v14, v10, v14
    v_mul_u32_u24 v11, 1280, v11
    v_lshl_add_u32 v11, v14, 4, v11
    v_add_u32 v12, s37, v11
    v_add_u32 v10, 256, v2
    v_mul_lo_u32 v11, v10, s46
    v_lshrrev_b32 v11, 16, v11
    v_mul_u32_u24 v14, 20, v11
    v_sub_u32 v14, v10, v14
    v_mul_u32_u24 v11, 1280, v11
    v_lshl_add_u32 v11, v14, 4, v11
    v_add_u32 v13, s37, v11
    v_lshrrev_b32 v10, 4, v2
    v_lshlrev_b32 v10, 3, v10
    v_bfe_u32 v11, v2, 2, 2
    v_add_u32 v10, v10, v11
    v_mul_u32_u24 v10, 320, v10
    v_and_b32 v11, 3, v2
    v_lshl_add_u32 v10, v11, 3, v10
    v_add_u32 v9, s39, v10
    s_mov_b32 s46, 0
    s_mov_b32 s47, 20480
    s_add_u32 m0, s39, 0
    s_nop 0
    buffer_load_dwordx4 v6, s[20:23], s46 offen  lds
    s_add_u32 m0, s39, 1024
    s_nop 0
    buffer_load_dwordx4 v7, s[20:23], s46 offen  lds
    s_add_u32 m0, s39, 2048
    s_nop 0
    buffer_load_dwordx4 v8, s[20:23], s46 offen  lds
    s_add_u32 m0, s39, 3072
    s_nop 0
    buffer_load_dwordx4 v12, s[20:23], s46 offen  lds
    s_add_u32 m0, s39, 4096
    s_nop 0
    buffer_load_dwordx4 v13, s[20:23], s46 offen  lds
    s_add_u32 m0, s39, 5120
    s_nop 0
    buffer_load_dwordx4 v6, s[20:23], s47 offen  lds
    s_add_u32 m0, s39, 6144
    s_nop 0
    buffer_load_dwordx4 v7, s[20:23], s47 offen  lds
    s_add_u32 m0, s39, 7168
    s_nop 0
    buffer_load_dwordx4 v8, s[20:23], s47 offen  lds
    s_add_u32 m0, s39, 8192
    s_nop 0
    buffer_load_dwordx4 v12, s[20:23], s47 offen  lds
    s_add_u32 m0, s39, 9216
    s_nop 0
    buffer_load_dwordx4 v13, s[20:23], s47 offen  lds
    s_mov_b32 s46, 40960
    s_mov_b32 s47, 61440
    s_add_u32 m0, s39, 10240
    s_nop 0
    buffer_load_dwordx4 v6, s[20:23], s46 offen  lds
    s_add_u32 m0, s39, 11264
    s_nop 0
    buffer_load_dwordx4 v7, s[20:23], s46 offen  lds
    s_add_u32 m0, s39, 12288
    s_nop 0
    buffer_load_dwordx4 v8, s[20:23], s46 offen  lds
    s_add_u32 m0, s39, 13312
    s_nop 0
    buffer_load_dwordx4 v12, s[20:23], s46 offen  lds
    s_add_u32 m0, s39, 14336
    s_nop 0
    buffer_load_dwordx4 v13, s[20:23], s46 offen  lds
    s_add_u32 m0, s39, 15360
    s_nop 0
    buffer_load_dwordx4 v6, s[20:23], s47 offen  lds
    s_add_u32 m0, s39, 16384
    s_nop 0
    buffer_load_dwordx4 v7, s[20:23], s47 offen  lds
    s_add_u32 m0, s39, 17408
    s_nop 0
    buffer_load_dwordx4 v8, s[20:23], s47 offen  lds
    s_add_u32 m0, s39, 18432
    s_nop 0
    buffer_load_dwordx4 v12, s[20:23], s47 offen  lds
    s_add_u32 m0, s39, 19456
    s_nop 0
    buffer_load_dwordx4 v13, s[20:23], s47 offen  lds
    s_mov_b32 s46, 81920
    s_mov_b32 s47, 102400
    s_add_u32 m0, s39, 20480
    s_nop 0
    buffer_load_dwordx4 v6, s[20:23], s46 offen  lds
    s_add_u32 m0, s39, 21504
    s_nop 0
    buffer_load_dwordx4 v7, s[20:23], s46 offen  lds
    s_add_u32 m0, s39, 22528
    s_nop 0
    buffer_load_dwordx4 v8, s[20:23], s46 offen  lds
    s_add_u32 m0, s39, 23552
    s_nop 0
    buffer_load_dwordx4 v12, s[20:23], s46 offen  lds
    s_add_u32 m0, s39, 24576
    s_nop 0
    buffer_load_dwordx4 v13, s[20:23], s46 offen  lds
    s_add_u32 m0, s39, 25600
    s_nop 0
    buffer_load_dwordx4 v6, s[20:23], s47 offen  lds
    s_add_u32 m0, s39, 26624
    s_nop 0
    buffer_load_dwordx4 v7, s[20:23], s47 offen  lds
    s_add_u32 m0, s39, 27648
    s_nop 0
    buffer_load_dwordx4 v8, s[20:23], s47 offen  lds
    s_add_u32 m0, s39, 28672
    s_nop 0
    buffer_load_dwordx4 v12, s[20:23], s47 offen  lds
    s_add_u32 m0, s39, 29696
    s_nop 0
    buffer_load_dwordx4 v13, s[20:23], s47 offen  lds
    s_waitcnt vmcnt(20)
    ds_read_b64_tr_b16 a[0:1], v9 offset:0
    ds_read_b64_tr_b16 a[2:3], v9 offset:1280
    ds_read_b64_tr_b16 a[24:25], v9 offset:32
    ds_read_b64_tr_b16 a[26:27], v9 offset:1312
    ds_read_b64_tr_b16 a[48:49], v9 offset:64
    ds_read_b64_tr_b16 a[50:51], v9 offset:1344
    ds_read_b64_tr_b16 a[72:73], v9 offset:96
    ds_read_b64_tr_b16 a[74:75], v9 offset:1376
    ds_read_b64_tr_b16 a[96:97], v9 offset:128
    ds_read_b64_tr_b16 a[98:99], v9 offset:1408
    s_waitcnt lgkmcnt(4)
    ds_read_b64_tr_b16 a[120:121], v9 offset:160
    ds_read_b64_tr_b16 a[122:123], v9 offset:1440
    ds_read_b64_tr_b16 a[144:145], v9 offset:192
    ds_read_b64_tr_b16 a[146:147], v9 offset:1472
    ds_read_b64_tr_b16 a[168:169], v9 offset:224
    ds_read_b64_tr_b16 a[170:171], v9 offset:1504
    ds_read_b64_tr_b16 a[192:193], v9 offset:256
    ds_read_b64_tr_b16 a[194:195], v9 offset:1536
    ds_read_b64_tr_b16 a[216:217], v9 offset:288
    ds_read_b64_tr_b16 a[218:219], v9 offset:1568
    s_waitcnt lgkmcnt(0)
    s_mov_b32 s46, 122880
    s_mov_b32 s47, 143360
    s_add_u32 m0, s39, 0
    s_nop 0
    buffer_load_dwordx4 v6, s[20:23], s46 offen  lds
    s_add_u32 m0, s39, 1024
    s_nop 0
    buffer_load_dwordx4 v7, s[20:23], s46 offen  lds
    s_add_u32 m0, s39, 2048
    s_nop 0
    buffer_load_dwordx4 v8, s[20:23], s46 offen  lds
    s_add_u32 m0, s39, 3072
    s_nop 0
    buffer_load_dwordx4 v12, s[20:23], s46 offen  lds
    s_add_u32 m0, s39, 4096
    s_nop 0
    buffer_load_dwordx4 v13, s[20:23], s46 offen  lds
    s_add_u32 m0, s39, 5120
    s_nop 0
    buffer_load_dwordx4 v6, s[20:23], s47 offen  lds
    s_add_u32 m0, s39, 6144
    s_nop 0
    buffer_load_dwordx4 v7, s[20:23], s47 offen  lds
    s_add_u32 m0, s39, 7168
    s_nop 0
    buffer_load_dwordx4 v8, s[20:23], s47 offen  lds
    s_add_u32 m0, s39, 8192
    s_nop 0
    buffer_load_dwordx4 v12, s[20:23], s47 offen  lds
    s_add_u32 m0, s39, 9216
    s_nop 0
    buffer_load_dwordx4 v13, s[20:23], s47 offen  lds
    s_waitcnt vmcnt(20)
    ds_read_b64_tr_b16 a[4:5], v9 offset:10240
    ds_read_b64_tr_b16 a[6:7], v9 offset:11520
    ds_read_b64_tr_b16 a[28:29], v9 offset:10272
    ds_read_b64_tr_b16 a[30:31], v9 offset:11552
    ds_read_b64_tr_b16 a[52:53], v9 offset:10304
    ds_read_b64_tr_b16 a[54:55], v9 offset:11584
    ds_read_b64_tr_b16 a[76:77], v9 offset:10336
    ds_read_b64_tr_b16 a[78:79], v9 offset:11616
    ds_read_b64_tr_b16 a[100:101], v9 offset:10368
    ds_read_b64_tr_b16 a[102:103], v9 offset:11648
    s_waitcnt lgkmcnt(4)
    ds_read_b64_tr_b16 a[124:125], v9 offset:10400
    ds_read_b64_tr_b16 a[126:127], v9 offset:11680
    ds_read_b64_tr_b16 a[148:149], v9 offset:10432
    ds_read_b64_tr_b16 a[150:151], v9 offset:11712
    ds_read_b64_tr_b16 a[172:173], v9 offset:10464
    ds_read_b64_tr_b16 a[174:175], v9 offset:11744
    ds_read_b64_tr_b16 a[196:197], v9 offset:10496
    ds_read_b64_tr_b16 a[198:199], v9 offset:11776
    ds_read_b64_tr_b16 a[220:221], v9 offset:10528
    ds_read_b64_tr_b16 a[222:223], v9 offset:11808
    s_waitcnt lgkmcnt(0)
    s_mov_b32 s46, 163840
    s_mov_b32 s47, 184320
    s_add_u32 m0, s39, 10240
    s_nop 0
    buffer_load_dwordx4 v6, s[20:23], s46 offen  lds
    s_add_u32 m0, s39, 11264
    s_nop 0
    buffer_load_dwordx4 v7, s[20:23], s46 offen  lds
    s_add_u32 m0, s39, 12288
    s_nop 0
    buffer_load_dwordx4 v8, s[20:23], s46 offen  lds
    s_add_u32 m0, s39, 13312
    s_nop 0
    buffer_load_dwordx4 v12, s[20:23], s46 offen  lds
    s_add_u32 m0, s39, 14336
    s_nop 0
    buffer_load_dwordx4 v13, s[20:23], s46 offen  lds
    s_add_u32 m0, s39, 15360
    s_nop 0
    buffer_load_dwordx4 v6, s[20:23], s47 offen  lds
    s_add_u32 m0, s39, 16384
    s_nop 0
    buffer_load_dwordx4 v7, s[20:23], s47 offen  lds
    s_add_u32 m0, s39, 17408
    s_nop 0
    buffer_load_dwordx4 v8, s[20:23], s47 offen  lds
    s_add_u32 m0, s39, 18432
    s_nop 0
    buffer_load_dwordx4 v12, s[20:23], s47 offen  lds
    s_add_u32 m0, s39, 19456
    s_nop 0
    buffer_load_dwordx4 v13, s[20:23], s47 offen  lds
    s_waitcnt vmcnt(20)
    ds_read_b64_tr_b16 a[8:9], v9 offset:20480
    ds_read_b64_tr_b16 a[10:11], v9 offset:21760
    ds_read_b64_tr_b16 a[32:33], v9 offset:20512
    ds_read_b64_tr_b16 a[34:35], v9 offset:21792
    ds_read_b64_tr_b16 a[56:57], v9 offset:20544
    ds_read_b64_tr_b16 a[58:59], v9 offset:21824
    ds_read_b64_tr_b16 a[80:81], v9 offset:20576
    ds_read_b64_tr_b16 a[82:83], v9 offset:21856
    ds_read_b64_tr_b16 a[104:105], v9 offset:20608
    ds_read_b64_tr_b16 a[106:107], v9 offset:21888
    s_waitcnt lgkmcnt(4)
    ds_read_b64_tr_b16 a[128:129], v9 offset:20640
    ds_read_b64_tr_b16 a[130:131], v9 offset:21920
    ds_read_b64_tr_b16 a[152:153], v9 offset:20672
    ds_read_b64_tr_b16 a[154:155], v9 offset:21952
    ds_read_b64_tr_b16 a[176:177], v9 offset:20704
    ds_read_b64_tr_b16 a[178:179], v9 offset:21984
    ds_read_b64_tr_b16 a[200:201], v9 offset:20736
    ds_read_b64_tr_b16 a[202:203], v9 offset:22016
    ds_read_b64_tr_b16 a[224:225], v9 offset:20768
    ds_read_b64_tr_b16 a[226:227], v9 offset:22048
    s_waitcnt lgkmcnt(0)
    s_mov_b32 s46, 204800
    s_mov_b32 s47, 225280
    s_add_u32 m0, s39, 20480
    s_nop 0
    buffer_load_dwordx4 v6, s[20:23], s46 offen  lds
    s_add_u32 m0, s39, 21504
    s_nop 0
    buffer_load_dwordx4 v7, s[20:23], s46 offen  lds
    s_add_u32 m0, s39, 22528
    s_nop 0
    buffer_load_dwordx4 v8, s[20:23], s46 offen  lds
    s_add_u32 m0, s39, 23552
    s_nop 0
    buffer_load_dwordx4 v12, s[20:23], s46 offen  lds
    s_add_u32 m0, s39, 24576
    s_nop 0
    buffer_load_dwordx4 v13, s[20:23], s46 offen  lds
    s_add_u32 m0, s39, 25600
    s_nop 0
    buffer_load_dwordx4 v6, s[20:23], s47 offen  lds
    s_add_u32 m0, s39, 26624
    s_nop 0
    buffer_load_dwordx4 v7, s[20:23], s47 offen  lds
    s_add_u32 m0, s39, 27648
    s_nop 0
    buffer_load_dwordx4 v8, s[20:23], s47 offen  lds
    s_add_u32 m0, s39, 28672
    s_nop 0
    buffer_load_dwordx4 v12, s[20:23], s47 offen  lds
    s_add_u32 m0, s39, 29696
    s_nop 0
    buffer_load_dwordx4 v13, s[20:23], s47 offen  lds
    s_waitcnt vmcnt(20)
    ds_read_b64_tr_b16 a[12:13], v9 offset:0
    ds_read_b64_tr_b16 a[14:15], v9 offset:1280
    ds_read_b64_tr_b16 a[36:37], v9 offset:32
    ds_read_b64_tr_b16 a[38:39], v9 offset:1312
    ds_read_b64_tr_b16 a[60:61], v9 offset:64
    ds_read_b64_tr_b16 a[62:63], v9 offset:1344
    ds_read_b64_tr_b16 a[84:85], v9 offset:96
    ds_read_b64_tr_b16 a[86:87], v9 offset:1376
    ds_read_b64_tr_b16 a[108:109], v9 offset:128
    ds_read_b64_tr_b16 a[110:111], v9 offset:1408
    s_waitcnt lgkmcnt(4)
    ds_read_b64_tr_b16 a[132:133], v9 offset:160
    ds_read_b64_tr_b16 a[134:135], v9 offset:1440
    ds_read_b64_tr_b16 a[156:157], v9 offset:192
    ds_read_b64_tr_b16 a[158:159], v9 offset:1472
    ds_read_b64_tr_b16 a[180:181], v9 offset:224
    ds_read_b64_tr_b16 a[182:183], v9 offset:1504
    ds_read_b64_tr_b16 a[204:205], v9 offset:256
    ds_read_b64_tr_b16 a[206:207], v9 offset:1536
    ds_read_b64_tr_b16 a[228:229], v9 offset:288
    ds_read_b64_tr_b16 a[230:231], v9 offset:1568
    s_waitcnt lgkmcnt(0)
    s_waitcnt vmcnt(10)
    ds_read_b64_tr_b16 a[16:17], v9 offset:10240
    ds_read_b64_tr_b16 a[18:19], v9 offset:11520
    ds_read_b64_tr_b16 a[40:41], v9 offset:10272
    ds_read_b64_tr_b16 a[42:43], v9 offset:11552
    ds_read_b64_tr_b16 a[64:65], v9 offset:10304
    ds_read_b64_tr_b16 a[66:67], v9 offset:11584
    ds_read_b64_tr_b16 a[88:89], v9 offset:10336
    ds_read_b64_tr_b16 a[90:91], v9 offset:11616
    ds_read_b64_tr_b16 a[112:113], v9 offset:10368
    ds_read_b64_tr_b16 a[114:115], v9 offset:11648
    s_waitcnt lgkmcnt(4)
    ds_read_b64_tr_b16 a[136:137], v9 offset:10400
    ds_read_b64_tr_b16 a[138:139], v9 offset:11680
    ds_read_b64_tr_b16 a[160:161], v9 offset:10432
    ds_read_b64_tr_b16 a[162:163], v9 offset:11712
    ds_read_b64_tr_b16 a[184:185], v9 offset:10464
    ds_read_b64_tr_b16 a[186:187], v9 offset:11744
    ds_read_b64_tr_b16 a[208:209], v9 offset:10496
    ds_read_b64_tr_b16 a[210:211], v9 offset:11776
    ds_read_b64_tr_b16 a[232:233], v9 offset:10528
    ds_read_b64_tr_b16 a[234:235], v9 offset:11808
    s_waitcnt lgkmcnt(0)
    s_waitcnt vmcnt(0)
    ds_read_b64_tr_b16 a[20:21], v9 offset:20480
    ds_read_b64_tr_b16 a[22:23], v9 offset:21760
    ds_read_b64_tr_b16 a[44:45], v9 offset:20512
    ds_read_b64_tr_b16 a[46:47], v9 offset:21792
    ds_read_b64_tr_b16 a[68:69], v9 offset:20544
    ds_read_b64_tr_b16 a[70:71], v9 offset:21824
    ds_read_b64_tr_b16 a[92:93], v9 offset:20576
    ds_read_b64_tr_b16 a[94:95], v9 offset:21856
    ds_read_b64_tr_b16 a[116:117], v9 offset:20608
    ds_read_b64_tr_b16 a[118:119], v9 offset:21888
    s_waitcnt lgkmcnt(4)
    ds_read_b64_tr_b16 a[140:141], v9 offset:20640
    ds_read_b64_tr_b16 a[142:143], v9 offset:21920
    ds_read_b64_tr_b16 a[164:165], v9 offset:20672
    ds_read_b64_tr_b16 a[166:167], v9 offset:21952
    ds_read_b64_tr_b16 a[188:189], v9 offset:20704
    ds_read_b64_tr_b16 a[190:191], v9 offset:21984
    ds_read_b64_tr_b16 a[212:213], v9 offset:20736
    ds_read_b64_tr_b16 a[214:215], v9 offset:22016
    ds_read_b64_tr_b16 a[236:237], v9 offset:20768
    ds_read_b64_tr_b16 a[238:239], v9 offset:22048
    s_waitcnt lgkmcnt(0)
    s_barrier
    v_lshrrev_b32 v10, 4, v2
    v_lshlrev_b32 v10, 9, v10
    v_and_b32 v11, 15, v2
    v_lshl_add_u32 v28, v11, 4, v10
    s_mul_i32 s39, s32, 3072
    v_lshlrev_b32 v29, 4, v2
    v_add_u32 v29, s39, v29
    v_lshlrev_b32 v30, 4, v2
    s_add_u32 s46, s2, 64
    s_lshl_b32 s46, s46, 7
    s_add_u32 s46, s46, 4194304
    v_mov_b32 v31, s46
    v_mov_b32 v5, 0
    s_mul_i32 s38, s32, 409600
    s_lshl_b32 s46, s2, 10
    s_add_u32 s38, s38, s46
    s_add_u32 s38, s38, 83886080
    s_add_u32 s45, s2, 64
    s_mul_i32 s45, s45, 12288
    s_add_u32 s45, s45, 8388608
    s_lshl_b32 s43, s32, 5
    s_add_u32 s43, s43, s2
    s_lshl_b32 s43, s43, 7
    s_add_u32 s43, s43, 4206592
    s_mov_b32 s41, 0
    s_mov_b32 s42, 0
    s_lshl_b32 s46, s32, 2
    s_add_u32 s46, s46, 32768
    v_mov_b32 v11, s46
    v_lshrrev_b32 v16, 4, v2
    v_mul_u32_u24 v16, 40960, v16
    v_and_b32 v17, 15, v2
    v_lshl_add_u32 v16, v17, 4, v16
    v_mov_b32 v152, -1
    v_mov_b32 v153, -1
    v_mov_b32 v154, -1
    v_mov_b32 v155, -1
    s_mul_i32 s40, s2, -768
    s_add_u32 s40, s40, 1671168
    s_mov_b32 s34, 0
    s_branch WST_54_go
WST_54:
    s_sleep 10
WST_54_go:
    buffer_load_dwordx2 v[12:13], off, s[12:15], s95 sc1
    v_and_b32 v14, 7, v2
    v_lshlrev_b32 v14, 3, v14
    buffer_load_dwordx2 v[14:15], v14, s[12:15], 0 offen offset:128 sc1
WST_54_chk:
    s_sub_u32 s33, s33, 1
    s_cbranch_scc1 EXIT
    s_waitcnt vmcnt(0)
    s_cmp_eq_u32 s54, 0
    s_cbranch_scc1 WST_54_v
    v_not_b32 v14, v14
    v_xor_b32 v15, 8192, v15
    v_or_b32 v14, v14, v15
    v_cmp_ne_u32 vcc, 0, v14
    s_cbranch_vccz WST_54_v
    v_xor_b32 v15, 8192, v15
    v_lshrrev_b32 v15, 8, v15
    s_nop 1
    v_add_u32_dpp v15, v15, v15 row_ror:4 row_mask:0xf bank_mask:0xf
    s_nop 1
    v_add_u32_dpp v15, v15, v15 row_ror:2 row_mask:0xf bank_mask:0xf
    s_nop 1
    v_add_u32_dpp v15, v15, v15 row_ror:1 row_mask:0xf bank_mask:0xf
    s_nop 0
    v_readfirstlane_b32 s4, v15
    s_nop 0
    s_cmp_lt_u32 s4, 256
    s_cbranch_scc1 WST_54
    s_branch RESTART
WST_54_v:
    v_readfirstlane_b32 s4, v12
    v_readfirstlane_b32 s5, v13
    s_cmp_lt_u32 s4, 40
    s_cbranch_scc1 WST_54
    s_add_u32 s37, s38, 104857600
W_LOOP:
    s_cmp_lg_u32 s42, 0
    s_cbranch_scc1 WH_55
    v_cvt_pk_bf16_f32 v148, v136, v140
    v_cvt_pk_bf16_f32 v149, v137, v141
    v_cvt_pk_bf16_f32 v150, v138, v142
    v_cvt_pk_bf16_f32 v151, v139, v143
    buffer_store_dwordx4 v[148:151], v30, s[8:11], s37 offen sc1
    s_add_u32 s50, s34, 1
    s_mov_b32 s51, s41
    s_cmp_ge_u32 s41, s50
    s_cbranch_scc1 WH_55_k
    s_waitcnt vmcnt(0)
    v_mov_b32 v4, s34
    s_mov_b64 exec, 1
    buffer_store_dword v4, v5, s[8:11], s43 offen sc1
    s_mov_b64 exec, -1
    s_cmp_ge_u32 s51, s50
    s_cbranch_scc1 FWD_57
    s_branch FW_56_go
FW_56:
    s_sleep 1
    s_sub_u32 s33, s33, 1
    s_cbranch_scc1 EXIT
FW_56_go:
    buffer_load_dword v10, v31, s[8:11], 0 offen sc1
    s_waitcnt vmcnt(0)
    v_cmp_gt_u32 vcc, s50, v10
    s_cbranch_vccnz FW_56
    s_mov_b32 s51, s50
    s_add_u32 s4, s50, 1
    v_cmp_gt_u32 vcc, s4, v10
    s_cbranch_vccnz FWD_57
    s_mov_b32 s51, s4
    s_add_u32 s4, s50, 3
    v_cmp_gt_u32 vcc, s4, v10
    s_cbranch_vccnz FWD_57
    s_mov_b32 s51, s4
    s_add_u32 s4, s50, 8
    v_cmp_gt_u32 vcc, s4, v10
    s_cbranch_vccnz FWD_57
    s_mov_b32 s51, s4
    s_add_u32 s4, s50, 20
    v_cmp_gt_u32 vcc, s4, v10
    s_cbranch_vccnz FWD_57
    s_mov_b32 s51, s4
FWD_57:
WH_55_k:
    s_waitcnt lgkmcnt(0)
    s_barrier
    s_add_u32 m0, s39, 0
    s_nop 0
    buffer_load_dwordx4 v29, s[8:11], s45 offen sc1 lds
    buffer_load_dwordx4 v29, s[8:11], s45 offen offset:1024 sc1 lds
    buffer_load_dwordx4 v29, s[8:11], s45 offen offset:2048 sc1 lds
    buffer_load_dword v10, v31, s[8:11], 0 offen sc1
    s_waitcnt vmcnt(4)
    v_mov_b32 v4, s34
    s_mov_b64 exec, 1
    buffer_store_dword v4, v5, s[8:11], s43 offen sc1
    s_mov_b64 exec, -1
    s_waitcnt vmcnt(1)
    ds_write_b32 v11, v10 offset:128
    s_waitcnt lgkmcnt(0)
    s_barrier
    ds_read_b32 v12, v5 offset:32896
    s_waitcnt lgkmcnt(0)
    v_readfirstlane_b32 s41, v12
    ds_read_b128 v[32:35], v28 offset:0
    ds_read_b128 v[36:39], v28 offset:256
    ds_read_b128 v[40:43], v28 offset:2048
    ds_read_b128 v[44:47], v28 offset:2304
    ds_read_b128 v[48:51], v28 offset:4096
    ds_read_b128 v[52:55], v28 offset:4352
    ds_read_b128 v[56:59], v28 offset:6144
    ds_read_b128 v[60:63], v28 offset:6400
    ds_read_b128 v[64:67], v28 offset:8192
    ds_read_b128 v[68:71], v28 offset:8448
    ds_read_b128 v[72:75], v28 offset:10240
    ds_read_b128 v[76:79], v28 offset:10496
    s_waitcnt lgkmcnt(0)
WH_55:
    v_mfma_f32_16x16x32_bf16 v[128:131], v[32:35], a[0:3], 0
    s_add_u32 s50, s34, 2
    s_cmp_ge_u32 s41, s50
    s_cselect_b32 s42, 1, 0
    v_mfma_f32_16x16x32_bf16 v[132:135], v[36:39], a[0:3], 0
    s_cmp_lt_u32 s34, 63
    s_cselect_b32 s46, 1179648, 0
    s_add_u32 s45, s45, s46
    v_mfma_f32_16x16x32_bf16 v[128:131], v[40:43], a[4:7], v[128:131]
    s_add_u32 m0, s39, 12288
    s_nop 0
    buffer_load_dwordx4 v29, s[8:11], s45 offen sc1 lds
    v_mfma_f32_16x16x32_bf16 v[132:135], v[44:47], a[4:7], v[132:135]
    buffer_load_dwordx4 v29, s[8:11], s45 offen offset:1024 sc1 lds
    v_mfma_f32_16x16x32_bf16 v[128:131], v[48:51], a[8:11], v[128:131]
    buffer_load_dwordx4 v29, s[8:11], s45 offen offset:2048 sc1 lds
    v_mfma_f32_16x16x32_bf16 v[132:135], v[52:55], a[8:11], v[132:135]
    s_mov_b32 s48, s38
    s_add_u32 s47, s38, s40
    v_mfma_f32_16x16x32_bf16 v[128:131], v[56:59], a[12:15], v[128:131]
    v_cvt_pk_bf16_f32 v148, v136, v140
    v_mfma_f32_16x16x32_bf16 v[132:135], v[60:63], a[12:15], v[132:135]
    v_cvt_pk_bf16_f32 v149, v137, v141
    v_mfma_f32_16x16x32_bf16 v[128:131], v[64:67], a[16:19], v[128:131]
    v_cvt_pk_bf16_f32 v150, v138, v142
    v_mfma_f32_16x16x32_bf16 v[132:135], v[68:71], a[16:19], v[132:135]
    v_cvt_pk_bf16_f32 v151, v139, v143
    v_mfma_f32_16x16x32_bf16 v[128:131], v[72:75], a[20:23], v[128:131]
    buffer_store_dwordx4 v[148:151], v30, s[8:11], s37 offen sc1
    v_mfma_f32_16x16x32_bf16 v[132:135], v[76:79], a[20:23], v[132:135]
    s_add_u32 s37, s38, 368640
    v_mfma_f32_16x16x32_bf16 v[136:139], v[32:35], a[24:27], 0
    buffer_load_dword v10, v31, s[8:11], 0 offen sc1
    v_mfma_f32_16x16x32_bf16 v[140:143], v[36:39], a[24:27], 0
    v_mov_b32 v4, s34
    v_mfma_f32_16x16x32_bf16 v[136:139], v[40:43], a[28:31], v[136:139]
    buffer_store_dwordx4 v[152:155], v16, s[8:11], s47 offen sc1
    v_mfma_f32_16x16x32_bf16 v[140:143], v[44:47], a[28:31], v[140:143]
    s_add_u32 s47, s47, 163840
    buffer_store_dwordx4 v[152:155], v16, s[8:11], s47 offen sc1
    v_mfma_f32_16x16x32_bf16 v[136:139], v[48:51], a[32:35], v[136:139]
    s_add_u32 s47, s47, 81920
    buffer_store_dwordx4 v[152:155], v16, s[8:11], s47 offen sc1
    v_mfma_f32_16x16x32_bf16 v[140:143], v[52:55], a[32:35], v[140:143]
    v_mfma_f32_16x16x32_bf16 v[136:139], v[56:59], a[36:39], v[136:139]
    v_mfma_f32_16x16x32_bf16 v[140:143], v[60:63], a[36:39], v[140:143]
    v_cvt_pk_bf16_f32 v144, v128, v132
    v_mfma_f32_16x16x32_bf16 v[136:139], v[64:67], a[40:43], v[136:139]
    v_cvt_pk_bf16_f32 v145, v129, v133
    v_mfma_f32_16x16x32_bf16 v[140:143], v[68:71], a[40:43], v[140:143]
    v_cvt_pk_bf16_f32 v146, v130, v134
    v_mfma_f32_16x16x32_bf16 v[136:139], v[72:75], a[44:47], v[136:139]
    v_cvt_pk_bf16_f32 v147, v131, v135
    v_mfma_f32_16x16x32_bf16 v[140:143], v[76:79], a[44:47], v[140:143]
    buffer_store_dwordx4 v[144:147], v30, s[8:11], s48 offen sc1
    s_add_u32 s48, s48, 40960
    v_mfma_f32_16x16x32_bf16 v[128:131], v[32:35], a[48:51], 0
    v_mfma_f32_16x16x32_bf16 v[132:135], v[36:39], a[48:51], 0
    v_mfma_f32_16x16x32_bf16 v[128:131], v[40:43], a[52:55], v[128:131]
    v_mfma_f32_16x16x32_bf16 v[132:135], v[44:47], a[52:55], v[132:135]
    v_mfma_f32_16x16x32_bf16 v[128:131], v[48:51], a[56:59], v[128:131]
    v_mfma_f32_16x16x32_bf16 v[132:135], v[52:55], a[56:59], v[132:135]
    v_mfma_f32_16x16x32_bf16 v[128:131], v[56:59], a[60:63], v[128:131]
    v_mfma_f32_16x16x32_bf16 v[132:135], v[60:63], a[60:63], v[132:135]
    v_cvt_pk_bf16_f32 v148, v136, v140
    v_mfma_f32_16x16x32_bf16 v[128:131], v[64:67], a[64:67], v[128:131]
    v_cvt_pk_bf16_f32 v149, v137, v141
    v_mfma_f32_16x16x32_bf16 v[132:135], v[68:71], a[64:67], v[132:135]
    v_cvt_pk_bf16_f32 v150, v138, v142
    v_mfma_f32_16x16x32_bf16 v[128:131], v[72:75], a[68:71], v[128:131]
    v_cvt_pk_bf16_f32 v151, v139, v143
    v_mfma_f32_16x16x32_bf16 v[132:135], v[76:79], a[68:71], v[132:135]
    buffer_store_dwordx4 v[148:151], v30, s[8:11], s48 offen sc1
    s_add_u32 s48, s48, 40960
    v_mfma_f32_16x16x32_bf16 v[136:139], v[32:35], a[72:75], 0
    v_mfma_f32_16x16x32_bf16 v[140:143], v[36:39], a[72:75], 0
    v_mfma_f32_16x16x32_bf16 v[136:139], v[40:43], a[76:79], v[136:139]
    v_mfma_f32_16x16x32_bf16 v[140:143], v[44:47], a[76:79], v[140:143]
    v_mfma_f32_16x16x32_bf16 v[136:139], v[48:51], a[80:83], v[136:139]
    v_mfma_f32_16x16x32_bf16 v[140:143], v[52:55], a[80:83], v[140:143]
    v_mfma_f32_16x16x32_bf16 v[136:139], v[56:59], a[84:87], v[136:139]
    v_mfma_f32_16x16x32_bf16 v[140:143], v[60:63], a[84:87], v[140:143]
    v_cvt_pk_bf16_f32 v144, v128, v132
    v_mfma_f32_16x16x32_bf16 v[136:139], v[64:67], a[88:91], v[136:139]
    v_cvt_pk_bf16_f32 v145, v129, v133
    v_mfma_f32_16x16x32_bf16 v[140:143], v[68:71], a[88:91], v[140:143]
    v_cvt_pk_bf16_f32 v146, v130, v134
    v_mfma_f32_16x16x32_bf16 v[136:139], v[72:75], a[92:95], v[136:139]
    v_cvt_pk_bf16_f32 v147, v131, v135
    v_mfma_f32_16x16x32_bf16 v[140:143], v[76:79], a[92:95], v[140:143]
    buffer_store_dwordx4 v[144:147], v30, s[8:11], s48 offen sc1
    s_add_u32 s48, s48, 40960
    v_mfma_f32_16x16x32_bf16 v[128:131], v[32:35], a[96:99], 0
    v_mfma_f32_16x16x32_bf16 v[132:135], v[36:39], a[96:99], 0
    v_mfma_f32_16x16x32_bf16 v[128:131], v[40:43], a[100:103], v[128:131]
    v_mfma_f32_16x16x32_bf16 v[132:135], v[44:47], a[100:103], v[132:135]
    v_mfma_f32_16x16x32_bf16 v[128:131], v[48:51], a[104:107], v[128:131]
    v_mfma_f32_16x16x32_bf16 v[132:135], v[52:55], a[104:107], v[132:135]
    v_mfma_f32_16x16x32_bf16 v[128:131], v[56:59], a[108:111], v[128:131]
    v_mfma_f32_16x16x32_bf16 v[132:135], v[60:63], a[108:111], v[132:135]
    v_cvt_pk_bf16_f32 v148, v136, v140
    v_mfma_f32_16x16x32_bf16 v[128:131], v[64:67], a[112:115], v[128:131]
    v_cvt_pk_bf16_f32 v149, v137, v141
    v_mfma_f32_16x16x32_bf16 v[132:135], v[68:71], a[112:115], v[132:135]
    v_cvt_pk_bf16_f32 v150, v138, v142
    v_mfma_f32_16x16x32_bf16 v[128:131], v[72:75], a[116:119], v[128:131]
    v_cvt_pk_bf16_f32 v151, v139, v143
    v_mfma_f32_16x16x32_bf16 v[132:135], v[76:79], a[116:119], v[132:135]
    buffer_store_dwordx4 v[148:151], v30, s[8:11], s48 offen sc1
    s_add_u32 s48, s48, 40960
    v_mfma_f32_16x16x32_bf16 v[136:139], v[32:35], a[120:123], 0
    v_mfma_f32_16x16x32_bf16 v[140:143], v[36:39], a[120:123], 0
    v_mfma_f32_16x16x32_bf16 v[136:139], v[40:43], a[124:127], v[136:139]
    v_mfma_f32_16x16x32_bf16 v[140:143], v[44:47], a[124:127], v[140:143]
    v_mfma_f32_16x16x32_bf16 v[136:139], v[48:51], a[128:131], v[136:139]
    v_mfma_f32_16x16x32_bf16 v[140:143], v[52:55], a[128:131], v[140:143]
    v_mfma_f32_16x16x32_bf16 v[136:139], v[56:59], a[132:135], v[136:139]
    v_mfma_f32_16x16x32_bf16 v[140:143], v[60:63], a[132:135], v[140:143]
    v_cvt_pk_bf16_f32 v144, v128, v132
    v_mfma_f32_16x16x32_bf16 v[136:139], v[64:67], a[136:139], v[136:139]
    v_cvt_pk_bf16_f32 v145, v129, v133
    v_mfma_f32_16x16x32_bf16 v[140:143], v[68:71], a[136:139], v[140:143]
    v_cvt_pk_bf16_f32 v146, v130, v134
    v_mfma_f32_16x16x32_bf16 v[136:139], v[72:75], a[140:143], v[136:139]
    v_cvt_pk_bf16_f32 v147, v131, v135
    v_mfma_f32_16x16x32_bf16 v[140:143], v[76:79], a[140:143], v[140:143]
    buffer_store_dwordx4 v[144:147], v30, s[8:11], s48 offen sc1
    s_add_u32 s48, s48, 40960
    v_mfma_f32_16x16x32_bf16 v[128:131], v[32:35], a[144:147], 0
    v_mfma_f32_16x16x32_bf16 v[132:135], v[36:39], a[144:147], 0
    v_mfma_f32_16x16x32_bf16 v[128:131], v[40:43], a[148:151], v[128:131]
    v_mfma_f32_16x16x32_bf16 v[132:135], v[44:47], a[148:151], v[132:135]
    v_mfma_f32_16x16x32_bf16 v[128:131], v[48:51], a[152:155], v[128:131]
    v_mfma_f32_16x16x32_bf16 v[132:135], v[52:55], a[152:155], v[132:135]
    v_mfma_f32_16x16x32_bf16 v[128:131], v[56:59], a[156:159], v[128:131]
    v_mfma_f32_16x16x32_bf16 v[132:135], v[60:63], a[156:159], v[132:135]
    v_cvt_pk_bf16_f32 v148, v136, v140
    v_mfma_f32_16x16x32_bf16 v[128:131], v[64:67], a[160:163], v[128:131]
    v_cvt_pk_bf16_f32 v149, v137, v141
    v_mfma_f32_16x16x32_bf16 v[132:135], v[68:71], a[160:163], v[132:135]
    v_cvt_pk_bf16_f32 v150, v138, v142
    v_mfma_f32_16x16x32_bf16 v[128:131], v[72:75], a[164:167], v[128:131]
    v_cvt_pk_bf16_f32 v151, v139, v143
    v_mfma_f32_16x16x32_bf16 v[132:135], v[76:79], a[164:167], v[132:135]
    buffer_store_dwordx4 v[148:151], v30, s[8:11], s48 offen sc1
    s_add_u32 s48, s48, 40960
    v_mfma_f32_16x16x32_bf16 v[136:139], v[32:35], a[168:171], 0
    s_waitcnt vmcnt(6)
    ds_write_b32 v11, v10 offset:0
    v_mfma_f32_16x16x32_bf16 v[140:143], v[36:39], a[168:171], 0
    s_mov_b64 exec, 1
    buffer_store_dword v4, v5, s[8:11], s43 offen sc1
    s_mov_b64 exec, -1
    v_mfma_f32_16x16x32_bf16 v[136:139], v[40:43], a[172:175], v[136:139]
    v_mfma_f32_16x16x32_bf16 v[140:143], v[44:47], a[172:175], v[140:143]
    v_mfma_f32_16x16x32_bf16 v[136:139], v[48:51], a[176:179], v[136:139]
    v_mfma_f32_16x16x32_bf16 v[140:143], v[52:55], a[176:179], v[140:143]
    v_mfma_f32_16x16x32_bf16 v[136:139], v[56:59], a[180:183], v[136:139]
    s_waitcnt lgkmcnt(0)
    s_barrier
    v_mfma_f32_16x16x32_bf16 v[140:143], v[60:63], a[180:183], v[140:143]
    v_cvt_pk_bf16_f32 v144, v128, v132
    v_mfma_f32_16x16x32_bf16 v[136:139], v[64:67], a[184:187], v[136:139]
    v_cvt_pk_bf16_f32 v145, v129, v133
    v_mfma_f32_16x16x32_bf16 v[140:143], v[68:71], a[184:187], v[140:143]
    v_cvt_pk_bf16_f32 v146, v130, v134
    v_mfma_f32_16x16x32_bf16 v[136:139], v[72:75], a[188:191], v[136:139]
    v_cvt_pk_bf16_f32 v147, v131, v135
    v_mfma_f32_16x16x32_bf16 v[140:143], v[76:79], a[188:191], v[140:143]
    buffer_store_dwordx4 v[144:147], v30, s[8:11], s48 offen sc1
    s_add_u32 s48, s48, 40960
    v_mfma_f32_16x16x32_bf16 v[128:131], v[32:35], a[192:195], 0
    ds_read_b32 v12, v5 offset:32768
    v_mfma_f32_16x16x32_bf16 v[132:135], v[36:39], a[192:195], 0
    ds_read_b128 v[80:83], v28 offset:12288
    v_mfma_f32_16x16x32_bf16 v[128:131], v[40:43], a[196:199], v[128:131]
    ds_read_b128 v[84:87], v28 offset:12544
    v_mfma_f32_16x16x32_bf16 v[132:135], v[44:47], a[196:199], v[132:135]
    ds_read_b128 v[88:91], v28 offset:14336
    v_mfma_f32_16x16x32_bf16 v[128:131], v[48:51], a[200:203], v[128:131]
    ds_read_b128 v[92:95], v28 offset:14592
    v_mfma_f32_16x16x32_bf16 v[132:135], v[52:55], a[200:203], v[132:135]
    ds_read_b128 v[96:99], v28 offset:16384
    v_mfma_f32_16x16x32_bf16 v[128:131], v[56:59], a[204:207], v[128:131]
    ds_read_b128 v[100:103], v28 offset:16640
    v_mfma_f32_16x16x32_bf16 v[132:135], v[60:63], a[204:207], v[132:135]
    v_cvt_pk_bf16_f32 v148, v136, v140
    v_mfma_f32_16x16x32_bf16 v[128:131], v[64:67], a[208:211], v[128:131]
    v_cvt_pk_bf16_f32 v149, v137, v141
    v_mfma_f32_16x16x32_bf16 v[132:135], v[68:71], a[208:211], v[132:135]
    v_cvt_pk_bf16_f32 v150, v138, v142
    v_mfma_f32_16x16x32_bf16 v[128:131], v[72:75], a[212:215], v[128:131]
    v_cvt_pk_bf16_f32 v151, v139, v143
    v_mfma_f32_16x16x32_bf16 v[132:135], v[76:79], a[212:215], v[132:135]
    buffer_store_dwordx4 v[148:151], v30, s[8:11], s48 offen sc1
    s_add_u32 s48, s48, 40960
    v_mfma_f32_16x16x32_bf16 v[136:139], v[32:35], a[216:219], 0
    ds_read_b128 v[104:107], v28 offset:18432
    v_mfma_f32_16x16x32_bf16 v[140:143], v[36:39], a[216:219], 0
    ds_read_b128 v[108:111], v28 offset:18688
    v_mfma_f32_16x16x32_bf16 v[136:139], v[40:43], a[220:223], v[136:139]
    ds_read_b128 v[112:115], v28 offset:20480
    v_mfma_f32_16x16x32_bf16 v[140:143], v[44:47], a[220:223], v[140:143]
    ds_read_b128 v[116:119], v28 offset:20736
    v_mfma_f32_16x16x32_bf16 v[136:139], v[48:51], a[224:227], v[136:139]
    ds_read_b128 v[120:123], v28 offset:22528
    v_mfma_f32_16x16x32_bf16 v[140:143], v[52:55], a[224:227], v[140:143]
    ds_read_b128 v[124:127], v28 offset:22784
    v_mfma_f32_16x16x32_bf16 v[136:139], v[56:59], a[228:231], v[136:139]
    s_waitcnt lgkmcnt(12)
    v_readfirstlane_b32 s41, v12
    v_mfma_f32_16x16x32_bf16 v[140:143], v[60:63], a[228:231], v[140:143]
    v_cvt_pk_bf16_f32 v144, v128, v132
    v_mfma_f32_16x16x32_bf16 v[136:139], v[64:67], a[232:235], v[136:139]
    v_cvt_pk_bf16_f32 v145, v129, v133
    v_mfma_f32_16x16x32_bf16 v[140:143], v[68:71], a[232:235], v[140:143]
    v_cvt_pk_bf16_f32 v146, v130, v134
    v_mfma_f32_16x16x32_bf16 v[136:139], v[72:75], a[236:239], v[136:139]
    v_cvt_pk_bf16_f32 v147, v131, v135
    v_mfma_f32_16x16x32_bf16 v[140:143], v[76:79], a[236:239], v[140:143]
    buffer_store_dwordx4 v[144:147], v30, s[8:11], s48 offen sc1
    s_add_u32 s48, s48, 40960
    s_add_u32 s38, s38, 1638400
    s_add_u32 s34, s34, 1
    s_waitcnt lgkmcnt(0)
    s_cmp_gt_u32 s34, 3
    s_cbranch_scc1 WE_58
    s_cmp_eq_u32 s42, 0
    s_cbranch_scc1 WE_58
    v_cvt_pk_bf16_f32 v148, v136, v140
    v_cvt_pk_bf16_f32 v149, v137, v141
    v_cvt_pk_bf16_f32 v150, v138, v142
    v_cvt_pk_bf16_f32 v151, v139, v143
    buffer_store_dwordx4 v[148:151], v30, s[8:11], s37 offen sc1
    s_waitcnt vmcnt(0)
    v_mov_b32 v4, s34
    s_mov_b64 exec, 1
    buffer_store_dword v4, v5, s[8:11], s43 offen sc1
    s_mov_b64 exec, -1
WE_58:
    s_cmp_lg_u32 s42, 0
    s_cbranch_scc1 WH_59
    v_cvt_pk_bf16_f32 v148, v136, v140
    v_cvt_pk_bf16_f32 v149, v137, v141
    v_cvt_pk_bf16_f32 v150, v138, v142
    v_cvt_pk_bf16_f32 v151, v139, v143
    buffer_store_dwordx4 v[148:151], v30, s[8:11], s37 offen sc1
    s_add_u32 s50, s34, 1
    s_mov_b32 s51, s41
    s_cmp_ge_u32 s41, s50
    s_cbranch_scc1 WH_59_k
    s_waitcnt vmcnt(0)
    v_mov_b32 v4, s34
    s_mov_b64 exec, 1
    buffer_store_dword v4, v5, s[8:11], s43 offen sc1
    s_mov_b64 exec, -1
    s_cmp_ge_u32 s51, s50
    s_cbranch_scc1 FWD_61
    s_branch FW_60_go
FW_60:
    s_sleep 1
    s_sub_u32 s33, s33, 1
    s_cbranch_scc1 EXIT
FW_60_go:
    buffer_load_dword v10, v31, s[8:11], 0 offen sc1
    s_waitcnt vmcnt(0)
    v_cmp_gt_u32 vcc, s50, v10
    s_cbranch_vccnz FW_60
    s_mov_b32 s51, s50
    s_add_u32 s4, s50, 1
    v_cmp_gt_u32 vcc, s4, v10
    s_cbranch_vccnz FWD_61
    s_mov_b32 s51, s4
    s_add_u32 s4, s50, 3
    v_cmp_gt_u32 vcc, s4, v10
    s_cbranch_vccnz FWD_61
    s_mov_b32 s51, s4
    s_add_u32 s4, s50, 8
    v_cmp_gt_u32 vcc, s4, v10
    s_cbranch_vccnz FWD_61
    s_mov_b32 s51, s4
    s_add_u32 s4, s50, 20
    v_cmp_gt_u32 vcc, s4, v10
    s_cbranch_vccnz FWD_61
    s_mov_b32 s51, s4
FWD_61:
WH_59_k:
    s_waitcnt lgkmcnt(0)
    s_barrier
    s_add_u32 m0, s39, 12288
    s_nop 0
    buffer_load_dwordx4 v29, s[8:11], s45 offen sc1 lds
    buffer_load_dwordx4 v29, s[8:11], s45 offen offset:1024 sc1 lds
    buffer_load_dwordx4 v29, s[8:11], s45 offen offset:2048 sc1 lds
    buffer_load_dword v10, v31, s[8:11], 0 offen sc1
    s_waitcnt vmcnt(4)
    v_mov_b32 v4, s34
    s_mov_b64 exec, 1
    buffer_store_dword v4, v5, s[8:11], s43 offen sc1
    s_mov_b64 exec, -1
    s_waitcnt vmcnt(1)
    ds_write_b32 v11, v10 offset:128
    s_waitcnt lgkmcnt(0)
    s_barrier
    ds_read_b32 v12, v5 offset:32896
    s_waitcnt lgkmcnt(0)
    v_readfirstlane_b32 s41, v12
    ds_read_b128 v[80:83], v28 offset:12288
    ds_read_b128 v[84:87], v28 offset:12544
    ds_read_b128 v[88:91], v28 offset:14336
    ds_read_b128 v[92:95], v28 offset:14592
    ds_read_b128 v[96:99], v28 offset:16384
    ds_read_b128 v[100:103], v28 offset:16640
    ds_read_b128 v[104:107], v28 offset:18432
    ds_read_b128 v[108:111], v28 offset:18688
    ds_read_b128 v[112:115], v28 offset:20480
    ds_read_b128 v[116:119], v28 offset:20736
    ds_read_b128 v[120:123], v28 offset:22528
    ds_read_b128 v[124:127], v28 offset:22784
    s_waitcnt lgkmcnt(0)
WH_59:
    v_mfma_f32_16x16x32_bf16 v[128:131], v[80:83], a[0:3], 0
    s_add_u32 s50, s34, 2
    s_cmp_ge_u32 s41, s50
    s_cselect_b32 s42, 1, 0
    v_mfma_f32_16x16x32_bf16 v[132:135], v[84:87], a[0:3], 0
    s_cmp_lt_u32 s34, 63
    s_cselect_b32 s46, 1179648, 0
    s_add_u32 s45, s45, s46
    v_mfma_f32_16x16x32_bf16 v[128:131], v[88:91], a[4:7], v[128:131]
    s_add_u32 m0, s39, 0
    s_nop 0
    buffer_load_dwordx4 v29, s[8:11], s45 offen sc1 lds
    v_mfma_f32_16x16x32_bf16 v[132:135], v[92:95], a[4:7], v[132:135]
    buffer_load_dwordx4 v29, s[8:11], s45 offen offset:1024 sc1 lds
    v_mfma_f32_16x16x32_bf16 v[128:131], v[96:99], a[8:11], v[128:131]
    buffer_load_dwordx4 v29, s[8:11], s45 offen offset:2048 sc1 lds
    v_mfma_f32_16x16x32_bf16 v[132:135], v[100:103], a[8:11], v[132:135]
    s_mov_b32 s48, s38
    s_add_u32 s47, s38, s40
    v_mfma_f32_16x16x32_bf16 v[128:131], v[104:107], a[12:15], v[128:131]
    v_cvt_pk_bf16_f32 v148, v136, v140
    v_mfma_f32_16x16x32_bf16 v[132:135], v[108:111], a[12:15], v[132:135]
    v_cvt_pk_bf16_f32 v149, v137, v141
    v_mfma_f32_16x16x32_bf16 v[128:131], v[112:115], a[16:19], v[128:131]
    v_cvt_pk_bf16_f32 v150, v138, v142
    v_mfma_f32_16x16x32_bf16 v[132:135], v[116:119], a[16:19], v[132:135]
    v_cvt_pk_bf16_f32 v151, v139, v143
    v_mfma_f32_16x16x32_bf16 v[128:131], v[120:123], a[20:23], v[128:131]
    buffer_store_dwordx4 v[148:151], v30, s[8:11], s37 offen sc1
    v_mfma_f32_16x16x32_bf16 v[132:135], v[124:127], a[20:23], v[132:135]
    s_add_u32 s37, s38, 368640
    v_mfma_f32_16x16x32_bf16 v[136:139], v[80:83], a[24:27], 0
    buffer_load_dword v10, v31, s[8:11], 0 offen sc1
    v_mfma_f32_16x16x32_bf16 v[140:143], v[84:87], a[24:27], 0
    v_mov_b32 v4, s34
    v_mfma_f32_16x16x32_bf16 v[136:139], v[88:91], a[28:31], v[136:139]
    buffer_store_dwordx4 v[152:155], v16, s[8:11], s47 offen sc1
    v_mfma_f32_16x16x32_bf16 v[140:143], v[92:95], a[28:31], v[140:143]
    s_add_u32 s47, s47, 163840
    buffer_store_dwordx4 v[152:155], v16, s[8:11], s47 offen sc1
    v_mfma_f32_16x16x32_bf16 v[136:139], v[96:99], a[32:35], v[136:139]
    s_add_u32 s47, s47, 81920
    buffer_store_dwordx4 v[152:155], v16, s[8:11], s47 offen sc1
    v_mfma_f32_16x16x32_bf16 v[140:143], v[100:103], a[32:35], v[140:143]
    v_mfma_f32_16x16x32_bf16 v[136:139], v[104:107], a[36:39], v[136:139]
    v_mfma_f32_16x16x32_bf16 v[140:143], v[108:111], a[36:39], v[140:143]
    v_cvt_pk_bf16_f32 v144, v128, v132
    v_mfma_f32_16x16x32_bf16 v[136:139], v[112:115], a[40:43], v[136:139]
    v_cvt_pk_bf16_f32 v145, v129, v133
    v_mfma_f32_16x16x32_bf16 v[140:143], v[116:119], a[40:43], v[140:143]
    v_cvt_pk_bf16_f32 v146, v130, v134
    v_mfma_f32_16x16x32_bf16 v[136:139], v[120:123], a[44:47], v[136:139]
    v_cvt_pk_bf16_f32 v147, v131, v135
    v_mfma_f32_16x16x32_bf16 v[140:143], v[124:127], a[44:47], v[140:143]
    buffer_store_dwordx4 v[144:147], v30, s[8:11], s48 offen sc1
    s_add_u32 s48, s48, 40960
    v_mfma_f32_16x16x32_bf16 v[128:131], v[80:83], a[48:51], 0
    v_mfma_f32_16x16x32_bf16 v[132:135], v[84:87], a[48:51], 0
    v_mfma_f32_16x16x32_bf16 v[128:131], v[88:91], a[52:55], v[128:131]
    v_mfma_f32_16x16x32_bf16 v[132:135], v[92:95], a[52:55], v[132:135]
    v_mfma_f32_16x16x32_bf16 v[128:131], v[96:99], a[56:59], v[128:131]
    v_mfma_f32_16x16x32_bf16 v[132:135], v[100:103], a[56:59], v[132:135]
    v_mfma_f32_16x16x32_bf16 v[128:131], v[104:107], a[60:63], v[128:131]
    v_mfma_f32_16x16x32_bf16 v[132:135], v[108:111], a[60:63], v[132:135]
    v_cvt_pk_bf16_f32 v148, v136, v140
    v_mfma_f32_16x16x32_bf16 v[128:131], v[112:115], a[64:67], v[128:131]
    v_cvt_pk_bf16_f32 v149, v137, v141
    v_mfma_f32_16x16x32_bf16 v[132:135], v[116:119], a[64:67], v[132:135]
    v_cvt_pk_bf16_f32 v150, v138, v142
    v_mfma_f32_16x16x32_bf16 v[128:131], v[120:123], a[68:71], v[128:131]
    v_cvt_pk_bf16_f32 v151, v139, v143
    v_mfma_f32_16x16x32_bf16 v[132:135], v[124:127], a[68:71], v[132:135]
    buffer_store_dwordx4 v[148:151], v30, s[8:11], s48 offen sc1
    s_add_u32 s48, s48, 40960
    v_mfma_f32_16x16x32_bf16 v[136:139], v[80:83], a[72:75], 0
    v_mfma_f32_16x16x32_bf16 v[140:143], v[84:87], a[72:75], 0
    v_mfma_f32_16x16x32_bf16 v[136:139], v[88:91], a[76:79], v[136:139]
    v_mfma_f32_16x16x32_bf16 v[140:143], v[92:95], a[76:79], v[140:143]
    v_mfma_f32_16x16x32_bf16 v[136:139], v[96:99], a[80:83], v[136:139]
    v_mfma_f32_16x16x32_bf16 v[140:143], v[100:103], a[80:83], v[140:143]
    v_mfma_f32_16x16x32_bf16 v[136:139], v[104:107], a[84:87], v[136:139]
    v_mfma_f32_16x16x32_bf16 v[140:143], v[108:111], a[84:87], v[140:143]
    v_cvt_pk_bf16_f32 v144, v128, v132
    v_mfma_f32_16x16x32_bf16 v[136:139], v[112:115], a[88:91], v[136:139]
    v_cvt_pk_bf16_f32 v145, v129, v133
    v_mfma_f32_16x16x32_bf16 v[140:143], v[116:119], a[88:91], v[140:143]
    v_cvt_pk_bf16_f32 v146, v130, v134
    v_mfma_f32_16x16x32_bf16 v[136:139], v[120:123], a[92:95], v[136:139]
    v_cvt_pk_bf16_f32 v147, v131, v135
    v_mfma_f32_16x16x32_bf16 v[140:143], v[124:127], a[92:95], v[140:143]
    buffer_store_dwordx4 v[144:147], v30, s[8:11], s48 offen sc1
    s_add_u32 s48, s48, 40960
    v_mfma_f32_16x16x32_bf16 v[128:131], v[80:83], a[96:99], 0
    v_mfma_f32_16x16x32_bf16 v[132:135], v[84:87], a[96:99], 0
    v_mfma_f32_16x16x32_bf16 v[128:131], v[88:91], a[100:103], v[128:131]
    v_mfma_f32_16x16x32_bf16 v[132:135], v[92:95], a[100:103], v[132:135]
    v_mfma_f32_16x16x32_bf16 v[128:131], v[96:99], a[104:107], v[128:131]
    v_mfma_f32_16x16x32_bf16 v[132:135], v[100:103], a[104:107], v[132:135]
    v_mfma_f32_16x16x32_bf16 v[128:131], v[104:107], a[108:111], v[128:131]
    v_mfma_f32_16x16x32_bf16 v[132:135], v[108:111], a[108:111], v[132:135]
    v_cvt_pk_bf16_f32 v148, v136, v140
    v_mfma_f32_16x16x32_bf16 v[128:131], v[112:115], a[112:115], v[128:131]
    v_cvt_pk_bf16_f32 v149, v137, v141
    v_mfma_f32_16x16x32_bf16 v[132:135], v[116:119], a[112:115], v[132:135]
    v_cvt_pk_bf16_f32 v150, v138, v142
    v_mfma_f32_16x16x32_bf16 v[128:131], v[120:123], a[116:119], v[128:131]
    v_cvt_pk_bf16_f32 v151, v139, v143
    v_mfma_f32_16x16x32_bf16 v[132:135], v[124:127], a[116:119], v[132:135]
    buffer_store_dwordx4 v[148:151], v30, s[8:11], s48 offen sc1
    s_add_u32 s48, s48, 40960
    v_mfma_f32_16x16x32_bf16 v[136:139], v[80:83], a[120:123], 0
    v_mfma_f32_16x16x32_bf16 v[140:143], v[84:87], a[120:123], 0
    v_mfma_f32_16x16x32_bf16 v[136:139], v[88:91], a[124:127], v[136:139]
    v_mfma_f32_16x16x32_bf16 v[140:143], v[92:95], a[124:127], v[140:143]
    v_mfma_f32_16x16x32_bf16 v[136:139], v[96:99], a[128:131], v[136:139]
    v_mfma_f32_16x16x32_bf16 v[140:143], v[100:103], a[128:131], v[140:143]
    v_mfma_f32_16x16x32_bf16 v[136:139], v[104:107], a[132:135], v[136:139]
    v_mfma_f32_16x16x32_bf16 v[140:143], v[108:111], a[132:135], v[140:143]
    v_cvt_pk_bf16_f32 v144, v128, v132
    v_mfma_f32_16x16x32_bf16 v[136:139], v[112:115], a[136:139], v[136:139]
    v_cvt_pk_bf16_f32 v145, v129, v133
    v_mfma_f32_16x16x32_bf16 v[140:143], v[116:119], a[136:139], v[140:143]
    v_cvt_pk_bf16_f32 v146, v130, v134
    v_mfma_f32_16x16x32_bf16 v[136:139], v[120:123], a[140:143], v[136:139]
    v_cvt_pk_bf16_f32 v147, v131, v135
    v_mfma_f32_16x16x32_bf16 v[140:143], v[124:127], a[140:143], v[140:143]
    buffer_store_dwordx4 v[144:147], v30, s[8:11], s48 offen sc1
    s_add_u32 s48, s48, 40960
    v_mfma_f32_16x16x32_bf16 v[128:131], v[80:83], a[144:147], 0
    v_mfma_f32_16x16x32_bf16 v[132:135], v[84:87], a[144:147], 0
    v_mfma_f32_16x16x32_bf16 v[128:131], v[88:91], a[148:151], v[128:131]
    v_mfma_f32_16x16x32_bf16 v[132:135], v[92:95], a[148:151], v[132:135]
    v_mfma_f32_16x16x32_bf16 v[128:131], v[96:99], a[152:155], v[128:131]
    v_mfma_f32_16x16x32_bf16 v[132:135], v[100:103], a[152:155], v[132:135]
    v_mfma_f32_16x16x32_bf16 v[128:131], v[104:107], a[156:159], v[128:131]
    v_mfma_f32_16x16x32_bf16 v[132:135], v[108:111], a[156:159], v[132:135]
    v_cvt_pk_bf16_f32 v148, v136, v140
    v_mfma_f32_16x16x32_bf16 v[128:131], v[112:115], a[160:163], v[128:131]
    v_cvt_pk_bf16_f32 v149, v137, v141
    v_mfma_f32_16x16x32_bf16 v[132:135], v[116:119], a[160:163], v[132:135]
    v_cvt_pk_bf16_f32 v150, v138, v142
    v_mfma_f32_16x16x32_bf16 v[128:131], v[120:123], a[164:167], v[128:131]
    v_cvt_pk_bf16_f32 v151, v139, v143
    v_mfma_f32_16x16x32_bf16 v[132:135], v[124:127], a[164:167], v[132:135]
    buffer_store_dwordx4 v[148:151], v30, s[8:11], s48 offen sc1
    s_add_u32 s48, s48, 40960
    v_mfma_f32_16x16x32_bf16 v[136:139], v[80:83], a[168:171], 0
    s_waitcnt vmcnt(6)
    ds_write_b32 v11, v10 offset:64
    v_mfma_f32_16x16x32_bf16 v[140:143], v[84:87], a[168:171], 0
    s_mov_b64 exec, 1
    buffer_store_dword v4, v5, s[8:11], s43 offen sc1
    s_mov_b64 exec, -1
    v_mfma_f32_16x16x32_bf16 v[136:139], v[88:91], a[172:175], v[136:139]
    v_mfma_f32_16x16x32_bf16 v[140:143], v[92:95], a[172:175], v[140:143]
    v_mfma_f32_16x16x32_bf16 v[136:139], v[96:99], a[176:179], v[136:139]
    v_mfma_f32_16x16x32_bf16 v[140:143], v[100:103], a[176:179], v[140:143]
    v_mfma_f32_16x16x32_bf16 v[136:139], v[104:107], a[180:183], v[136:139]
    s_waitcnt lgkmcnt(0)
    s_barrier
    v_mfma_f32_16x16x32_bf16 v[140:143], v[108:111], a[180:183], v[140:143]
    v_cvt_pk_bf16_f32 v144, v128, v132
    v_mfma_f32_16x16x32_bf16 v[136:139], v[112:115], a[184:187], v[136:139]
    v_cvt_pk_bf16_f32 v145, v129, v133
    v_mfma_f32_16x16x32_bf16 v[140:143], v[116:119], a[184:187], v[140:143]
    v_cvt_pk_bf16_f32 v146, v130, v134
    v_mfma_f32_16x16x32_bf16 v[136:139], v[120:123], a[188:191], v[136:139]
    v_cvt_pk_bf16_f32 v147, v131, v135
    v_mfma_f32_16x16x32_bf16 v[140:143], v[124:127], a[188:191], v[140:143]
    buffer_store_dwordx4 v[144:147], v30, s[8:11], s48 offen sc1
    s_add_u32 s48, s48, 40960
    v_mfma_f32_16x16x32_bf16 v[128:131], v[80:83], a[192:195], 0
    ds_read_b32 v12, v5 offset:32832
    v_mfma_f32_16x16x32_bf16 v[132:135], v[84:87], a[192:195], 0
    ds_read_b128 v[32:35], v28 offset:0
    v_mfma_f32_16x16x32_bf16 v[128:131], v[88:91], a[196:199], v[128:131]
    ds_read_b128 v[36:39], v28 offset:256
    v_mfma_f32_16x16x32_bf16 v[132:135], v[92:95], a[196:199], v[132:135]
    ds_read_b128 v[40:43], v28 offset:2048
    v_mfma_f32_16x16x32_bf16 v[128:131], v[96:99], a[200:203], v[128:131]
    ds_read_b128 v[44:47], v28 offset:2304
    v_mfma_f32_16x16x32_bf16 v[132:135], v[100:103], a[200:203], v[132:135]
    ds_read_b128 v[48:51], v28 offset:4096
    v_mfma_f32_16x16x32_bf16 v[128:131], v[104:107], a[204:207], v[128:131]
    ds_read_b128 v[52:55], v28 offset:4352
    v_mfma_f32_16x16x32_bf16 v[132:135], v[108:111], a[204:207], v[132:135]
    v_cvt_pk_bf16_f32 v148, v136, v140
    v_mfma_f32_16x16x32_bf16 v[128:131], v[112:115], a[208:211], v[128:131]
    v_cvt_pk_bf16_f32 v149, v137, v141
    v_mfma_f32_16x16x32_bf16 v[132:135], v[116:119], a[208:211], v[132:135]
    v_cvt_pk_bf16_f32 v150, v138, v142
    v_mfma_f32_16x16x32_bf16 v[128:131], v[120:123], a[212:215], v[128:131]
    v_cvt_pk_bf16_f32 v151, v139, v143
    v_mfma_f32_16x16x32_bf16 v[132:135], v[124:127], a[212:215], v[132:135]
    buffer_store_dwordx4 v[148:151], v30, s[8:11], s48 offen sc1
    s_add_u32 s48, s48, 40960
    v_mfma_f32_16x16x32_bf16 v[136:139], v[80:83], a[216:219], 0
    ds_read_b128 v[56:59], v28 offset:6144
    v_mfma_f32_16x16x32_bf16 v[140:143], v[84:87], a[216:219], 0
    ds_read_b128 v[60:63], v28 offset:6400
    v_mfma_f32_16x16x32_bf16 v[136:139], v[88:91], a[220:223], v[136:139]
    ds_read_b128 v[64:67], v28 offset:8192
    v_mfma_f32_16x16x32_bf16 v[140:143], v[92:95], a[220:223], v[140:143]
    ds_read_b128 v[68:71], v28 offset:8448
    v_mfma_f32_16x16x32_bf16 v[136:139], v[96:99], a[224:227], v[136:139]
    ds_read_b128 v[72:75], v28 offset:10240
    v_mfma_f32_16x16x32_bf16 v[140:143], v[100:103], a[224:227], v[140:143]
    ds_read_b128 v[76:79], v28 offset:10496
    v_mfma_f32_16x16x32_bf16 v[136:139], v[104:107], a[228:231], v[136:139]
    s_waitcnt lgkmcnt(12)
    v_readfirstlane_b32 s41, v12
    v_mfma_f32_16x16x32_bf16 v[140:143], v[108:111], a[228:231], v[140:143]
    v_cvt_pk_bf16_f32 v144, v128, v132
    v_mfma_f32_16x16x32_bf16 v[136:139], v[112:115], a[232:235], v[136:139]
    v_cvt_pk_bf16_f32 v145, v129, v133
    v_mfma_f32_16x16x32_bf16 v[140:143], v[116:119], a[232:235], v[140:143]
    v_cvt_pk_bf16_f32 v146, v130, v134
    v_mfma_f32_16x16x32_bf16 v[136:139], v[120:123], a[236:239], v[136:139]
    v_cvt_pk_bf16_f32 v147, v131, v135
    v_mfma_f32_16x16x32_bf16 v[140:143], v[124:127], a[236:239], v[140:143]
    buffer_store_dwordx4 v[144:147], v30, s[8:11], s48 offen sc1
    s_add_u32 s48, s48, 40960
    s_add_u32 s38, s38, 1638400
    s_add_u32 s34, s34, 1
    s_waitcnt lgkmcnt(0)
    s_cmp_gt_u32 s34, 3
    s_cbranch_scc1 WE_62
    s_cmp_eq_u32 s42, 0
    s_cbranch_scc1 WE_62
    v_cvt_pk_bf16_f32 v148, v136, v140
    v_cvt_pk_bf16_f32 v149, v137, v141
    v_cvt_pk_bf16_f32 v150, v138, v142
    v_cvt_pk_bf16_f32 v151, v139, v143
    buffer_store_dwordx4 v[148:151], v30, s[8:11], s37 offen sc1
    s_waitcnt vmcnt(0)
    v_mov_b32 v4, s34
    s_mov_b64 exec, 1
    buffer_store_dword v4, v5, s[8:11], s43 offen sc1
    s_mov_b64 exec, -1
WE_62:
    s_cmp_lt_u32 s34, 64
    s_cbranch_scc1 W_LOOP
    v_cvt_pk_bf16_f32 v148, v136, v140
    v_cvt_pk_bf16_f32 v149, v137, v141
    v_cvt_pk_bf16_f32 v150, v138, v142
    v_cvt_pk_bf16_f32 v151, v139, v143
    buffer_store_dwordx4 v[148:151], v30, s[8:11], s37 offen sc1
    s_waitcnt vmcnt(0)
    s_movk_i32 s46, 128
    v_mov_b32 v4, s46
    s_mov_b64 exec, 1
    buffer_store_dword v4, v5, s[8:11], s43 offen sc1
    s_mov_b64 exec, -1
    s_add_u32 s2, s2, 30
    s_add_u32 s52, s2, 256
    s_cmp_lt_u32 s2, 60
    s_cbranch_scc1 ROLE_O
    s_endpgm
.p2align 6
ROLE_P:
    s_lshr_b32 s3, s2, 5
    s_load_dwordx2 s[4:5], s[0:1], 0
    s_load_dwordx4 s[40:43], s[0:1], 16
    s_load_dwordx2 s[44:45], s[0:1], 32
    s_and_b32 s36, s2, 31
    s_mul_i32 s37, s36, 384
    s_waitcnt lgkmcnt(0)
    s_cmp_eq_u32 s3, 1
    s_cselect_b32 s40, s42, s40
    s_cselect_b32 s41, s43, s41
    s_cmp_eq_u32 s3, 2
    s_cselect_b32 s40, s44, s40
    s_cselect_b32 s41, s45, s41
    s_mov_b32 s16, s4
    s_mov_b32 s17, s5
    s_mov_b32 s18, 2621440
    s_mov_b32 s19, 0x20000
    s_mov_b32 s20, s40
    s_mov_b32 s21, s41
    s_mov_b32 s22, 7864320
    s_mov_b32 s23, 0x20000
    s_lshl_b32 s46, s32, 3
    v_lshrrev_b32 v6, 3, v2
    v_add_u32 v6, s46, v6
    v_bfe_u32 v7, v6, 1, 3
    v_and_b32 v9, 7, v2
    v_xor_b32 v7, v7, v9
    v_bfe_u32 v8, v6, 2, 2
    v_lshlrev_b32 v8, 3, v8
    v_bfe_u32 v9, v6, 4, 1
    v_lshl_add_u32 v8, v9, 2, v8
    v_and_b32 v9, 3, v6
    v_add_u32 v8, v8, v9
    s_cmp_ge_u32 s2, 32
    s_cselect_b64 vcc, -1, 0
    v_cndmask_b32 v6, v6, v8, vcc
    v_mul_u32_u24 v6, 1280, v6
    v_lshl_add_u32 v6, v7, 4, v6
    v_mov_b32 v20, v6
    s_lshl_b32 s49, s32, 10
    s_add_u32 s49, s49, 122880
    s_mov_b32 s48, 0
    s_add_u32 m0, s49, 0
    s_add_u32 s46, s48, 0
    buffer_load_dwordx4 v6, s[16:19], s46 offen lds
    s_add_u32 m0, s49, 4096
    s_add_u32 s46, s48, 128
    buffer_load_dwordx4 v6, s[16:19], s46 offen lds
    s_add_u32 m0, s49, 8192
    s_add_u32 s46, s48, 256
    buffer_load_dwordx4 v6, s[16:19], s46 offen lds
    s_add_u32 m0, s49, 12288
    s_add_u32 s46, s48, 384
    buffer_load_dwordx4 v6, s[16:19], s46 offen lds
    s_add_u32 m0, s49, 16384
    s_add_u32 s46, s48, 512
    buffer_load_dwordx4 v6, s[16:19], s46 offen lds
    s_add_u32 m0, s49, 20480
    s_add_u32 s46, s48, 640
    buffer_load_dwordx4 v6, s[16:19], s46 offen lds
    s_add_u32 m0, s49, 24576
    s_add_u32 s46, s48, 768
    buffer_load_dwordx4 v6, s[16:19], s46 offen lds
    s_add_u32 m0, s49, 28672
    s_add_u32 s46, s48, 896
    buffer_load_dwordx4 v6, s[16:19], s46 offen lds
    s_add_u32 m0, s49, 32768
    s_add_u32 s46, s48, 1024
    buffer_load_dwordx4 v6, s[16:19], s46 offen lds
    s_add_u32 m0, s49, 36864
    s_add_u32 s46, s48, 1152
    buffer_load_dwordx4 v6, s[16:19], s46 offen lds
    s_cmp_ge_u32 s2, 32
    s_cbranch_scc1 P_GO
WST_63:
    s_sleep 120
WST_63_go:
    buffer_load_dwordx2 v[16:17], off, s[12:15], s95 sc1
    v_and_b32 v18, 7, v2
    v_lshlrev_b32 v18, 3, v18
    buffer_load_dwordx2 v[18:19], v18, s[12:15], 0 offen offset:128 sc1
WST_63_chk:
    s_sub_u32 s33, s33, 1
    s_cbranch_scc1 EXIT
    s_waitcnt vmcnt(0)
    s_cmp_eq_u32 s54, 0
    s_cbranch_scc1 WST_63_v
    v_not_b32 v18, v18
    v_xor_b32 v19, 8192, v19
    v_or_b32 v18, v18, v19
    v_cmp_ne_u32 vcc, 0, v18
    s_cbranch_vccz WST_63_v
    v_xor_b32 v19, 8192, v19
    v_lshrrev_b32 v19, 8, v19
    s_nop 1
    v_add_u32_dpp v19, v19, v19 row_ror:4 row_mask:0xf bank_mask:0xf
    s_nop 1
    v_add_u32_dpp v19, v19, v19 row_ror:2 row_mask:0xf bank_mask:0xf
    s_nop 1
    v_add_u32_dpp v19, v19, v19 row_ror:1 row_mask:0xf bank_mask:0xf
    s_nop 0
    v_readfirstlane_b32 s4, v19
    s_nop 0
    s_cmp_lt_u32 s4, 256
    s_cbranch_scc1 WST_63
    s_branch RESTART
WST_63_v:
    v_readfirstlane_b32 s4, v16
    v_readfirstlane_b32 s5, v17
    s_cmp_lt_u32 s4, 40
    s_cbranch_scc1 WST_63
P_GO:
    s_mul_i32 s39, s32, 6144
    s_movk_i32 s46, 2731
    s_mul_i32 s47, s32, 384
    v_add_u32 v15, s47, v2
    v_add_u32 v15, 0, v15
    v_mul_lo_u32 v16, v15, s46
    v_lshrrev_b32 v16, 16, v16
    v_mul_u32_u24 v17, 24, v16
    v_sub_u32 v17, v15, v17
    v_bfe_u32 v18, v16, 3, 1
    v_lshlrev_b32 v18, 2, v18
    v_and_b32 v19, 2, v16
    v_add_u32 v18, v18, v19
    v_xor_b32 v17, v17, v18
    v_mul_u32_u24 v16, 12288, v16
    v_lshl_add_u32 v16, v17, 4, v16
    v_add_u32 v6, s37, v16
    v_add_u32 v15, s47, v2
    v_add_u32 v15, 64, v15
    v_mul_lo_u32 v16, v15, s46
    v_lshrrev_b32 v16, 16, v16
    v_mul_u32_u24 v17, 24, v16
    v_sub_u32 v17, v15, v17
    v_bfe_u32 v18, v16, 3, 1
    v_lshlrev_b32 v18, 2, v18
    v_and_b32 v19, 2, v16
    v_add_u32 v18, v18, v19
    v_xor_b32 v17, v17, v18
    v_mul_u32_u24 v16, 12288, v16
    v_lshl_add_u32 v16, v17, 4, v16
    v_add_u32 v7, s37, v16
    v_add_u32 v15, s47, v2
    v_add_u32 v15, 128, v15
    v_mul_lo_u32 v16, v15, s46
    v_lshrrev_b32 v16, 16, v16
    v_mul_u32_u24 v17, 24, v16
    v_sub_u32 v17, v15, v17
    v_bfe_u32 v18, v16, 3, 1
    v_lshlrev_b32 v18, 2, v18
    v_and_b32 v19, 2, v16
    v_add_u32 v18, v18, v19
    v_xor_b32 v17, v17, v18
    v_mul_u32_u24 v16, 12288, v16
    v_lshl_add_u32 v16, v17, 4, v16
    v_add_u32 v8, s37, v16
    v_add_u32 v15, s47, v2
    v_add_u32 v15, 192, v15
    v_mul_lo_u32 v16, v15, s46
    v_lshrrev_b32 v16, 16, v16
    v_mul_u32_u24 v17, 24, v16
    v_sub_u32 v17, v15, v17
    v_bfe_u32 v18, v16, 3, 1
    v_lshlrev_b32 v18, 2, v18
    v_and_b32 v19, 2, v16
    v_add_u32 v18, v18, v19
    v_xor_b32 v17, v17, v18
    v_mul_u32_u24 v16, 12288, v16
    v_lshl_add_u32 v16, v17, 4, v16
    v_add_u32 v9, s37, v16
    v_add_u32 v15, s47, v2
    v_add_u32 v15, 256, v15
    v_mul_lo_u32 v16, v15, s46
    v_lshrrev_b32 v16, 16, v16
    v_mul_u32_u24 v17, 24, v16
    v_sub_u32 v17, v15, v17
    v_bfe_u32 v18, v16, 3, 1
    v_lshlrev_b32 v18, 2, v18
    v_and_b32 v19, 2, v16
    v_add_u32 v18, v18, v19
    v_xor_b32 v17, v17, v18
    v_mul_u32_u24 v16, 12288, v16
    v_lshl_add_u32 v16, v17, 4, v16
    v_add_u32 v10, s37, v16
    v_add_u32 v15, s47, v2
    v_add_u32 v15, 320, v15
    v_mul_lo_u32 v16, v15, s46
    v_lshrrev_b32 v16, 16, v16
    v_mul_u32_u24 v17, 24, v16
    v_sub_u32 v17, v15, v17
    v_bfe_u32 v18, v16, 3, 1
    v_lshlrev_b32 v18, 2, v18
    v_and_b32 v19, 2, v16
    v_add_u32 v18, v18, v19
    v_xor_b32 v17, v17, v18
    v_mul_u32_u24 v16, 12288, v16
    v_lshl_add_u32 v16, v17, 4, v16
    v_add_u32 v11, s37, v16
    v_lshrrev_b32 v15, 4, v2
    v_lshlrev_b32 v15, 3, v15
    v_bfe_u32 v16, v2, 2, 2
    v_add_u32 v15, v15, v16
    v_bfe_u32 v18, v15, 3, 1
    v_lshlrev_b32 v18, 2, v18
    v_and_b32 v19, 2, v15
    v_add_u32 v18, v18, v19
    v_mul_u32_u24 v15, 384, v15
    v_and_b32 v16, 3, v2
    v_lshl_add_u32 v15, v16, 3, v15
    s_mul_i32 s46, s32, 6
    s_add_u32 s46, s46, 0
    v_xor_b32 v16, s46, v18
    v_lshl_add_u32 v12, v16, 4, v15
    s_mul_i32 s46, s32, 6
    s_add_u32 s46, s46, 2
    v_xor_b32 v16, s46, v18
    v_lshl_add_u32 v13, v16, 4, v15
    s_mul_i32 s46, s32, 6
    s_add_u32 s46, s46, 4
    v_xor_b32 v16, s46, v18
    v_lshl_add_u32 v14, v16, 4, v15
    s_mov_b32 s46, 0
    s_add_u32 m0, s39, 0
    s_nop 0
    buffer_load_dwordx4 v6, s[20:23], s46 offen  lds
    s_add_u32 m0, s39, 1024
    s_nop 0
    buffer_load_dwordx4 v7, s[20:23], s46 offen  lds
    s_add_u32 m0, s39, 2048
    s_nop 0
    buffer_load_dwordx4 v8, s[20:23], s46 offen  lds
    s_add_u32 m0, s39, 3072
    s_nop 0
    buffer_load_dwordx4 v9, s[20:23], s46 offen  lds
    s_add_u32 m0, s39, 4096
    s_nop 0
    buffer_load_dwordx4 v10, s[20:23], s46 offen  lds
    s_add_u32 m0, s39, 5120
    s_nop 0
    buffer_load_dwordx4 v11, s[20:23], s46 offen  lds
    s_mov_b32 s46, 786432
    s_add_u32 m0, s39, 24576
    s_nop 0
    buffer_load_dwordx4 v6, s[20:23], s46 offen  lds
    s_add_u32 m0, s39, 25600
    s_nop 0
    buffer_load_dwordx4 v7, s[20:23], s46 offen  lds
    s_add_u32 m0, s39, 26624
    s_nop 0
    buffer_load_dwordx4 v8, s[20:23], s46 offen  lds
    s_add_u32 m0, s39, 27648
    s_nop 0
    buffer_load_dwordx4 v9, s[20:23], s46 offen  lds
    s_add_u32 m0, s39, 28672
    s_nop 0
    buffer_load_dwordx4 v10, s[20:23], s46 offen  lds
    s_add_u32 m0, s39, 29696
    s_nop 0
    buffer_load_dwordx4 v11, s[20:23], s46 offen  lds
    s_mov_b32 s46, 1572864
    s_add_u32 m0, s39, 49152
    s_nop 0
    buffer_load_dwordx4 v6, s[20:23], s46 offen  lds
    s_add_u32 m0, s39, 50176
    s_nop 0
    buffer_load_dwordx4 v7, s[20:23], s46 offen  lds
    s_add_u32 m0, s39, 51200
    s_nop 0
    buffer_load_dwordx4 v8, s[20:23], s46 offen  lds
    s_add_u32 m0, s39, 52224
    s_nop 0
    buffer_load_dwordx4 v9, s[20:23], s46 offen  lds
    s_add_u32 m0, s39, 53248
    s_nop 0
    buffer_load_dwordx4 v10, s[20:23], s46 offen  lds
    s_add_u32 m0, s39, 54272
    s_nop 0
    buffer_load_dwordx4 v11, s[20:23], s46 offen  lds
    s_waitcnt vmcnt(12)
    s_barrier
    ds_read_b64_tr_b16 a[0:1], v12 offset:0
    ds_read_b64_tr_b16 a[2:3], v12 offset:1536
    ds_read_b64_tr_b16 a[4:5], v12 offset:12288
    ds_read_b64_tr_b16 a[6:7], v12 offset:13824
    ds_read_b64_tr_b16 a[8:9], v13 offset:0
    ds_read_b64_tr_b16 a[10:11], v13 offset:1536
    ds_read_b64_tr_b16 a[12:13], v13 offset:12288
    ds_read_b64_tr_b16 a[14:15], v13 offset:13824
    ds_read_b64_tr_b16 a[16:17], v14 offset:0
    ds_read_b64_tr_b16 a[18:19], v14 offset:1536
    ds_read_b64_tr_b16 a[20:21], v14 offset:12288
    ds_read_b64_tr_b16 a[22:23], v14 offset:13824
    s_mov_b32 s46, 2359296
    s_add_u32 m0, s39, 73728
    s_nop 0
    buffer_load_dwordx4 v6, s[20:23], s46 offen  lds
    s_add_u32 m0, s39, 74752
    s_nop 0
    buffer_load_dwordx4 v7, s[20:23], s46 offen  lds
    s_add_u32 m0, s39, 75776
    s_nop 0
    buffer_load_dwordx4 v8, s[20:23], s46 offen  lds
    s_add_u32 m0, s39, 76800
    s_nop 0
    buffer_load_dwordx4 v9, s[20:23], s46 offen  lds
    s_add_u32 m0, s39, 77824
    s_nop 0
    buffer_load_dwordx4 v10, s[20:23], s46 offen  lds
    s_add_u32 m0, s39, 78848
    s_nop 0
    buffer_load_dwordx4 v11, s[20:23], s46 offen  lds
    s_waitcnt lgkmcnt(0)
    s_waitcnt vmcnt(12)
    s_barrier
    ds_read_b64_tr_b16 a[24:25], v12 offset:24576
    ds_read_b64_tr_b16 a[26:27], v12 offset:26112
    ds_read_b64_tr_b16 a[28:29], v12 offset:36864
    ds_read_b64_tr_b16 a[30:31], v12 offset:38400
    ds_read_b64_tr_b16 a[32:33], v13 offset:24576
    ds_read_b64_tr_b16 a[34:35], v13 offset:26112
    ds_read_b64_tr_b16 a[36:37], v13 offset:36864
    ds_read_b64_tr_b16 a[38:39], v13 offset:38400
    ds_read_b64_tr_b16 a[40:41], v14 offset:24576
    ds_read_b64_tr_b16 a[42:43], v14 offset:26112
    ds_read_b64_tr_b16 a[44:45], v14 offset:36864
    ds_read_b64_tr_b16 a[46:47], v14 offset:38400
    s_mov_b32 s46, 3145728
    s_add_u32 m0, s39, 0
    s_nop 0
    buffer_load_dwordx4 v6, s[20:23], s46 offen  lds
    s_add_u32 m0, s39, 1024
    s_nop 0
    buffer_load_dwordx4 v7, s[20:23], s46 offen  lds
    s_add_u32 m0, s39, 2048
    s_nop 0
    buffer_load_dwordx4 v8, s[20:23], s46 offen  lds
    s_add_u32 m0, s39, 3072
    s_nop 0
    buffer_load_dwordx4 v9, s[20:23], s46 offen  lds
    s_add_u32 m0, s39, 4096
    s_nop 0
    buffer_load_dwordx4 v10, s[20:23], s46 offen  lds
    s_add_u32 m0, s39, 5120
    s_nop 0
    buffer_load_dwordx4 v11, s[20:23], s46 offen  lds
    s_waitcnt lgkmcnt(0)
    v_add_u32 v12, 49152, v12
    v_add_u32 v13, 49152, v13
    v_add_u32 v14, 49152, v14
    s_waitcnt vmcnt(12)
    s_barrier
    ds_read_b64_tr_b16 a[48:49], v12 offset:0
    ds_read_b64_tr_b16 a[50:51], v12 offset:1536
    ds_read_b64_tr_b16 a[52:53], v12 offset:12288
    ds_read_b64_tr_b16 a[54:55], v12 offset:13824
    ds_read_b64_tr_b16 a[56:57], v13 offset:0
    ds_read_b64_tr_b16 a[58:59], v13 offset:1536
    ds_read_b64_tr_b16 a[60:61], v13 offset:12288
    ds_read_b64_tr_b16 a[62:63], v13 offset:13824
    ds_read_b64_tr_b16 a[64:65], v14 offset:0
    ds_read_b64_tr_b16 a[66:67], v14 offset:1536
    ds_read_b64_tr_b16 a[68:69], v14 offset:12288
    ds_read_b64_tr_b16 a[70:71], v14 offset:13824
    s_mov_b32 s46, 3932160
    s_add_u32 m0, s39, 24576
    s_nop 0
    buffer_load_dwordx4 v6, s[20:23], s46 offen  lds
    s_add_u32 m0, s39, 25600
    s_nop 0
    buffer_load_dwordx4 v7, s[20:23], s46 offen  lds
    s_add_u32 m0, s39, 26624
    s_nop 0
    buffer_load_dwordx4 v8, s[20:23], s46 offen  lds
    s_add_u32 m0, s39, 27648
    s_nop 0
    buffer_load_dwordx4 v9, s[20:23], s46 offen  lds
    s_add_u32 m0, s39, 28672
    s_nop 0
    buffer_load_dwordx4 v10, s[20:23], s46 offen  lds
    s_add_u32 m0, s39, 29696
    s_nop 0
    buffer_load_dwordx4 v11, s[20:23], s46 offen  lds
    s_waitcnt lgkmcnt(0)
    s_waitcnt vmcnt(12)
    s_barrier
    ds_read_b64_tr_b16 a[72:73], v12 offset:24576
    ds_read_b64_tr_b16 a[74:75], v12 offset:26112
    ds_read_b64_tr_b16 a[76:77], v12 offset:36864
    ds_read_b64_tr_b16 a[78:79], v12 offset:38400
    ds_read_b64_tr_b16 a[80:81], v13 offset:24576
    ds_read_b64_tr_b16 a[82:83], v13 offset:26112
    ds_read_b64_tr_b16 a[84:85], v13 offset:36864
    ds_read_b64_tr_b16 a[86:87], v13 offset:38400
    ds_read_b64_tr_b16 a[88:89], v14 offset:24576
    ds_read_b64_tr_b16 a[90:91], v14 offset:26112
    ds_read_b64_tr_b16 a[92:93], v14 offset:36864
    ds_read_b64_tr_b16 a[94:95], v14 offset:38400
    s_mov_b32 s46, 4718592
    s_add_u32 m0, s39, 49152
    s_nop 0
    buffer_load_dwordx4 v6, s[20:23], s46 offen  lds
    s_add_u32 m0, s39, 50176
    s_nop 0
    buffer_load_dwordx4 v7, s[20:23], s46 offen  lds
    s_add_u32 m0, s39, 51200
    s_nop 0
    buffer_load_dwordx4 v8, s[20:23], s46 offen  lds
    s_add_u32 m0, s39, 52224
    s_nop 0
    buffer_load_dwordx4 v9, s[20:23], s46 offen  lds
    s_add_u32 m0, s39, 53248
    s_nop 0
    buffer_load_dwordx4 v10, s[20:23], s46 offen  lds
    s_add_u32 m0, s39, 54272
    s_nop 0
    buffer_load_dwordx4 v11, s[20:23], s46 offen  lds
    s_waitcnt lgkmcnt(0)
    v_add_u32 v12, 4294918144, v12
    v_add_u32 v13, 4294918144, v13
    v_add_u32 v14, 4294918144, v14
    s_waitcnt vmcnt(12)
    s_barrier
    ds_read_b64_tr_b16 a[96:97], v12 offset:0
    ds_read_b64_tr_b16 a[98:99], v12 offset:1536
    ds_read_b64_tr_b16 a[100:101], v12 offset:12288
    ds_read_b64_tr_b16 a[102:103], v12 offset:13824
    ds_read_b64_tr_b16 a[104:105], v13 offset:0
    ds_read_b64_tr_b16 a[106:107], v13 offset:1536
    ds_read_b64_tr_b16 a[108:109], v13 offset:12288
    ds_read_b64_tr_b16 a[110:111], v13 offset:13824
    ds_read_b64_tr_b16 a[112:113], v14 offset:0
    ds_read_b64_tr_b16 a[114:115], v14 offset:1536
    ds_read_b64_tr_b16 a[116:117], v14 offset:12288
    ds_read_b64_tr_b16 a[118:119], v14 offset:13824
    s_mov_b32 s46, 5505024
    s_add_u32 m0, s39, 73728
    s_nop 0
    buffer_load_dwordx4 v6, s[20:23], s46 offen  lds
    s_add_u32 m0, s39, 74752
    s_nop 0
    buffer_load_dwordx4 v7, s[20:23], s46 offen  lds
    s_add_u32 m0, s39, 75776
    s_nop 0
    buffer_load_dwordx4 v8, s[20:23], s46 offen  lds
    s_add_u32 m0, s39, 76800
    s_nop 0
    buffer_load_dwordx4 v9, s[20:23], s46 offen  lds
    s_add_u32 m0, s39, 77824
    s_nop 0
    buffer_load_dwordx4 v10, s[20:23], s46 offen  lds
    s_add_u32 m0, s39, 78848
    s_nop 0
    buffer_load_dwordx4 v11, s[20:23], s46 offen  lds
    s_waitcnt lgkmcnt(0)
    s_waitcnt vmcnt(12)
    s_barrier
    ds_read_b64_tr_b16 a[120:121], v12 offset:24576
    ds_read_b64_tr_b16 a[122:123], v12 offset:26112
    ds_read_b64_tr_b16 a[124:125], v12 offset:36864
    ds_read_b64_tr_b16 a[126:127], v12 offset:38400
    ds_read_b64_tr_b16 a[128:129], v13 offset:24576
    ds_read_b64_tr_b16 a[130:131], v13 offset:26112
    ds_read_b64_tr_b16 a[132:133], v13 offset:36864
    ds_read_b64_tr_b16 a[134:135], v13 offset:38400
    ds_read_b64_tr_b16 a[136:137], v14 offset:24576
    ds_read_b64_tr_b16 a[138:139], v14 offset:26112
    ds_read_b64_tr_b16 a[140:141], v14 offset:36864
    ds_read_b64_tr_b16 a[142:143], v14 offset:38400
    s_mov_b32 s46, 6291456
    s_add_u32 m0, s39, 0
    s_nop 0
    buffer_load_dwordx4 v6, s[20:23], s46 offen  lds
    s_add_u32 m0, s39, 1024
    s_nop 0
    buffer_load_dwordx4 v7, s[20:23], s46 offen  lds
    s_add_u32 m0, s39, 2048
    s_nop 0
    buffer_load_dwordx4 v8, s[20:23], s46 offen  lds
    s_add_u32 m0, s39, 3072
    s_nop 0
    buffer_load_dwordx4 v9, s[20:23], s46 offen  lds
    s_add_u32 m0, s39, 4096
    s_nop 0
    buffer_load_dwordx4 v10, s[20:23], s46 offen  lds
    s_add_u32 m0, s39, 5120
    s_nop 0
    buffer_load_dwordx4 v11, s[20:23], s46 offen  lds
    s_waitcnt lgkmcnt(0)
    v_add_u32 v12, 49152, v12
    v_add_u32 v13, 49152, v13
    v_add_u32 v14, 49152, v14
    s_waitcnt vmcnt(12)
    s_barrier
    ds_read_b64_tr_b16 a[144:145], v12 offset:0
    ds_read_b64_tr_b16 a[146:147], v12 offset:1536
    ds_read_b64_tr_b16 a[148:149], v12 offset:12288
    ds_read_b64_tr_b16 a[150:151], v12 offset:13824
    ds_read_b64_tr_b16 a[152:153], v13 offset:0
    ds_read_b64_tr_b16 a[154:155], v13 offset:1536
    ds_read_b64_tr_b16 a[156:157], v13 offset:12288
    ds_read_b64_tr_b16 a[158:159], v13 offset:13824
    ds_read_b64_tr_b16 a[160:161], v14 offset:0
    ds_read_b64_tr_b16 a[162:163], v14 offset:1536
    ds_read_b64_tr_b16 a[164:165], v14 offset:12288
    ds_read_b64_tr_b16 a[166:167], v14 offset:13824
    s_mov_b32 s46, 7077888
    s_add_u32 m0, s39, 24576
    s_nop 0
    buffer_load_dwordx4 v6, s[20:23], s46 offen  lds
    s_add_u32 m0, s39, 25600
    s_nop 0
    buffer_load_dwordx4 v7, s[20:23], s46 offen  lds
    s_add_u32 m0, s39, 26624
    s_nop 0
    buffer_load_dwordx4 v8, s[20:23], s46 offen  lds
    s_add_u32 m0, s39, 27648
    s_nop 0
    buffer_load_dwordx4 v9, s[20:23], s46 offen  lds
    s_add_u32 m0, s39, 28672
    s_nop 0
    buffer_load_dwordx4 v10, s[20:23], s46 offen  lds
    s_add_u32 m0, s39, 29696
    s_nop 0
    buffer_load_dwordx4 v11, s[20:23], s46 offen  lds
    s_waitcnt lgkmcnt(0)
    s_waitcnt vmcnt(12)
    s_barrier
    ds_read_b64_tr_b16 a[168:169], v12 offset:24576
    ds_read_b64_tr_b16 a[170:171], v12 offset:26112
    ds_read_b64_tr_b16 a[172:173], v12 offset:36864
    ds_read_b64_tr_b16 a[174:175], v12 offset:38400
    ds_read_b64_tr_b16 a[176:177], v13 offset:24576
    ds_read_b64_tr_b16 a[178:179], v13 offset:26112
    ds_read_b64_tr_b16 a[180:181], v13 offset:36864
    ds_read_b64_tr_b16 a[182:183], v13 offset:38400
    ds_read_b64_tr_b16 a[184:185], v14 offset:24576
    ds_read_b64_tr_b16 a[186:187], v14 offset:26112
    ds_read_b64_tr_b16 a[188:189], v14 offset:36864
    ds_read_b64_tr_b16 a[190:191], v14 offset:38400
    s_waitcnt lgkmcnt(0)
    v_add_u32 v12, 4294918144, v12
    v_add_u32 v13, 4294918144, v13
    v_add_u32 v14, 4294918144, v14
    s_waitcnt vmcnt(6)
    s_barrier
    ds_read_b64_tr_b16 a[192:193], v12 offset:0
    ds_read_b64_tr_b16 a[194:195], v12 offset:1536
    ds_read_b64_tr_b16 a[196:197], v12 offset:12288
    ds_read_b64_tr_b16 a[198:199], v12 offset:13824
    ds_read_b64_tr_b16 a[200:201], v13 offset:0
    ds_read_b64_tr_b16 a[202:203], v13 offset:1536
    ds_read_b64_tr_b16 a[204:205], v13 offset:12288
    ds_read_b64_tr_b16 a[206:207], v13 offset:13824
    ds_read_b64_tr_b16 a[208:209], v14 offset:0
    ds_read_b64_tr_b16 a[210:211], v14 offset:1536
    ds_read_b64_tr_b16 a[212:213], v14 offset:12288
    ds_read_b64_tr_b16 a[214:215], v14 offset:13824
    s_waitcnt lgkmcnt(0)
    s_waitcnt vmcnt(0)
    s_barrier
    ds_read_b64_tr_b16 a[216:217], v12 offset:24576
    ds_read_b64_tr_b16 a[218:219], v12 offset:26112
    ds_read_b64_tr_b16 a[220:221], v12 offset:36864
    ds_read_b64_tr_b16 a[222:223], v12 offset:38400
    ds_read_b64_tr_b16 a[224:225], v13 offset:24576
    ds_read_b64_tr_b16 a[226:227], v13 offset:26112
    ds_read_b64_tr_b16 a[228:229], v13 offset:36864
    ds_read_b64_tr_b16 a[230:231], v13 offset:38400
    ds_read_b64_tr_b16 a[232:233], v14 offset:24576
    ds_read_b64_tr_b16 a[234:235], v14 offset:26112
    ds_read_b64_tr_b16 a[236:237], v14 offset:36864
    ds_read_b64_tr_b16 a[238:239], v14 offset:38400
    s_waitcnt lgkmcnt(0)
    v_add_u32 v12, 49152, v12
    v_add_u32 v13, 49152, v13
    v_add_u32 v14, 49152, v14
    s_barrier
    v_mov_b32 v6, v20
    s_lshl_b32 s39, s32, 10
    s_mov_b32 s48, 40960
    s_mov_b32 s49, s39
    s_add_u32 m0, s49, 0
    s_add_u32 s46, s48, 0
    buffer_load_dwordx4 v6, s[16:19], s46 offen lds
    s_add_u32 m0, s49, 4096
    s_add_u32 s46, s48, 128
    buffer_load_dwordx4 v6, s[16:19], s46 offen lds
    s_add_u32 m0, s49, 8192
    s_add_u32 s46, s48, 256
    buffer_load_dwordx4 v6, s[16:19], s46 offen lds
    s_add_u32 m0, s49, 12288
    s_add_u32 s46, s48, 384
    buffer_load_dwordx4 v6, s[16:19], s46 offen lds
    s_add_u32 m0, s49, 16384
    s_add_u32 s46, s48, 512
    buffer_load_dwordx4 v6, s[16:19], s46 offen lds
    s_add_u32 m0, s49, 20480
    s_add_u32 s46, s48, 640
    buffer_load_dwordx4 v6, s[16:19], s46 offen lds
    s_add_u32 m0, s49, 24576
    s_add_u32 s46, s48, 768
    buffer_load_dwordx4 v6, s[16:19], s46 offen lds
    s_add_u32 m0, s49, 28672
    s_add_u32 s46, s48, 896
    buffer_load_dwordx4 v6, s[16:19], s46 offen lds
    s_add_u32 m0, s49, 32768
    s_add_u32 s46, s48, 1024
    buffer_load_dwordx4 v6, s[16:19], s46 offen lds
    s_add_u32 m0, s49, 36864
    s_add_u32 s46, s48, 1152
    buffer_load_dwordx4 v6, s[16:19], s46 offen lds
    v_and_b32 v8, 15, v2
    v_bfe_u32 v9, v2, 1, 3
    v_lshrrev_b32 v7, 4, v2
    v_xor_b32 v14, v7, v9
    v_lshlrev_b32 v14, 4, v14
    v_lshl_add_u32 v10, v8, 7, v14
    v_xor_b32 v11, 64, v10
    v_add_u32 v10, 122880, v10
    v_add_u32 v11, 122880, v11
    v_lshlrev_b32 v15, 4, v2
    v_mov_b32 v5, 0
    s_mul_i32 s47, s2, 12288
    s_mul_i32 s46, s32, 3072
    s_add_u32 s47, s47, s46
    s_add_u32 s47, s47, 8388608
    s_lshl_b32 s38, s2, 7
    s_add_u32 s38, s38, 4194304
    s_mov_b32 s48, 81920
    s_add_u32 s49, s39, 40960
    s_mov_b32 s50, 3
    s_mov_b32 s51, 40960
    s_mov_b32 s34, 0
    ds_read_b128 v[32:35], v10 offset:0
    ds_read_b128 v[36:39], v10 offset:2048
    ds_read_b128 v[40:43], v11 offset:0
    ds_read_b128 v[44:47], v11 offset:2048
    s_waitcnt lgkmcnt(2)
P_LOOP:
    v_mfma_f32_16x16x32_bf16 v[64:67], a[0:3], v[32:35], 0
    ds_read_b128 v[48:51], v10 offset:4096
    v_mfma_f32_16x16x32_bf16 v[68:71], a[0:3], v[36:39], 0
    ds_read_b128 v[52:55], v10 offset:6144
    v_mfma_f32_16x16x32_bf16 v[72:75], a[8:11], v[32:35], 0
    v_mfma_f32_16x16x32_bf16 v[76:79], a[8:11], v[36:39], 0
    v_mfma_f32_16x16x32_bf16 v[80:83], a[16:19], v[32:35], 0
    v_cvt_pk_bf16_f32 v112, v88, v89
    v_mfma_f32_16x16x32_bf16 v[84:87], a[16:19], v[36:39], 0
    s_waitcnt lgkmcnt(2)
    v_cvt_pk_bf16_f32 v113, v90, v91
    v_mfma_f32_16x16x32_bf16 v[64:67], a[4:7], v[40:43], v[64:67]
    ds_read_b128 v[56:59], v11 offset:4096
    v_cvt_pk_bf16_f32 v114, v92, v93
    v_mfma_f32_16x16x32_bf16 v[68:71], a[4:7], v[44:47], v[68:71]
    ds_read_b128 v[60:63], v11 offset:6144
    v_cvt_pk_bf16_f32 v115, v94, v95
    v_mfma_f32_16x16x32_bf16 v[72:75], a[12:15], v[40:43], v[72:75]
    v_permlane16_swap_b32 v112, v114
    v_mfma_f32_16x16x32_bf16 v[76:79], a[12:15], v[44:47], v[76:79]
    v_permlane16_swap_b32 v113, v115
    v_mfma_f32_16x16x32_bf16 v[80:83], a[20:23], v[40:43], v[80:83]
    buffer_store_dwordx4 v[112:115], v15, s[8:11], s47 offen offset:0 sc1
    v_mfma_f32_16x16x32_bf16 v[84:87], a[20:23], v[44:47], v[84:87]
    s_waitcnt lgkmcnt(2)
    v_cvt_pk_bf16_f32 v116, v96, v97
    v_mfma_f32_16x16x32_bf16 v[64:67], a[24:27], v[48:51], v[64:67]
    ds_read_b128 v[32:35], v10 offset:8192
    v_cvt_pk_bf16_f32 v117, v98, v99
    v_mfma_f32_16x16x32_bf16 v[68:71], a[24:27], v[52:55], v[68:71]
    ds_read_b128 v[36:39], v10 offset:10240
    v_cvt_pk_bf16_f32 v118, v100, v101
    v_mfma_f32_16x16x32_bf16 v[72:75], a[32:35], v[48:51], v[72:75]
    v_cvt_pk_bf16_f32 v119, v102, v103
    v_mfma_f32_16x16x32_bf16 v[76:79], a[32:35], v[52:55], v[76:79]
    v_permlane16_swap_b32 v116, v118
    v_mfma_f32_16x16x32_bf16 v[80:83], a[40:43], v[48:51], v[80:83]
    v_permlane16_swap_b32 v117, v119
    v_mfma_f32_16x16x32_bf16 v[84:87], a[40:43], v[52:55], v[84:87]
    s_waitcnt lgkmcnt(2)
    v_mfma_f32_16x16x32_bf16 v[64:67], a[28:31], v[56:59], v[64:67]
    ds_read_b128 v[40:43], v11 offset:8192
    v_mfma_f32_16x16x32_bf16 v[68:71], a[28:31], v[60:63], v[68:71]
    ds_read_b128 v[44:47], v11 offset:10240
    v_mfma_f32_16x16x32_bf16 v[72:75], a[36:39], v[56:59], v[72:75]
    buffer_store_dwordx4 v[116:119], v15, s[8:11], s47 offen offset:1024 sc1
    v_mfma_f32_16x16x32_bf16 v[76:79], a[36:39], v[60:63], v[76:79]
    v_cvt_pk_bf16_f32 v112, v104, v105
    v_mfma_f32_16x16x32_bf16 v[80:83], a[44:47], v[56:59], v[80:83]
    v_cvt_pk_bf16_f32 v113, v106, v107
    v_mfma_f32_16x16x32_bf16 v[84:87], a[44:47], v[60:63], v[84:87]
    s_waitcnt lgkmcnt(2)
    v_cvt_pk_bf16_f32 v114, v108, v109
    v_mfma_f32_16x16x32_bf16 v[64:67], a[48:51], v[32:35], v[64:67]
    ds_read_b128 v[48:51], v10 offset:12288
    v_cvt_pk_bf16_f32 v115, v110, v111
    v_mfma_f32_16x16x32_bf16 v[68:71], a[48:51], v[36:39], v[68:71]
    ds_read_b128 v[52:55], v10 offset:14336
    v_permlane16_swap_b32 v112, v114
    v_mfma_f32_16x16x32_bf16 v[72:75], a[56:59], v[32:35], v[72:75]
    v_permlane16_swap_b32 v113, v115
    v_mfma_f32_16x16x32_bf16 v[76:79], a[56:59], v[36:39], v[76:79]
    buffer_store_dwordx4 v[112:115], v15, s[8:11], s47 offen offset:2048 sc1
    v_mfma_f32_16x16x32_bf16 v[80:83], a[64:67], v[32:35], v[80:83]
    v_mfma_f32_16x16x32_bf16 v[84:87], a[64:67], v[36:39], v[84:87]
    s_waitcnt lgkmcnt(2)
    v_mfma_f32_16x16x32_bf16 v[64:67], a[52:55], v[40:43], v[64:67]
    ds_read_b128 v[56:59], v11 offset:12288
    v_mfma_f32_16x16x32_bf16 v[68:71], a[52:55], v[44:47], v[68:71]
    ds_read_b128 v[60:63], v11 offset:14336
    v_mfma_f32_16x16x32_bf16 v[72:75], a[60:63], v[40:43], v[72:75]
    v_mfma_f32_16x16x32_bf16 v[76:79], a[60:63], v[44:47], v[76:79]
    v_mfma_f32_16x16x32_bf16 v[80:83], a[68:71], v[40:43], v[80:83]
    v_mfma_f32_16x16x32_bf16 v[84:87], a[68:71], v[44:47], v[84:87]
    s_waitcnt lgkmcnt(2)
    v_mfma_f32_16x16x32_bf16 v[64:67], a[72:75], v[48:51], v[64:67]
    ds_read_b128 v[32:35], v10 offset:16384
    v_mfma_f32_16x16x32_bf16 v[68:71], a[72:75], v[52:55], v[68:71]
    ds_read_b128 v[36:39], v10 offset:18432
    v_mfma_f32_16x16x32_bf16 v[72:75], a[80:83], v[48:51], v[72:75]
    s_add_u32 m0, s49, 0
    s_add_u32 s46, s48, 0
    v_mfma_f32_16x16x32_bf16 v[76:79], a[80:83], v[52:55], v[76:79]
    buffer_load_dwordx4 v6, s[16:19], s46 offen lds
    v_mfma_f32_16x16x32_bf16 v[80:83], a[88:91], v[48:51], v[80:83]
    v_mov_b32 v4, s34
    v_mfma_f32_16x16x32_bf16 v[84:87], a[88:91], v[52:55], v[84:87]
    s_waitcnt lgkmcnt(2)
    v_mfma_f32_16x16x32_bf16 v[64:67], a[76:79], v[56:59], v[64:67]
    ds_read_b128 v[40:43], v11 offset:16384
    v_mfma_f32_16x16x32_bf16 v[68:71], a[76:79], v[60:63], v[68:71]
    ds_read_b128 v[44:47], v11 offset:18432
    v_mfma_f32_16x16x32_bf16 v[72:75], a[84:87], v[56:59], v[72:75]
    s_add_u32 m0, s49, 4096
    s_add_u32 s46, s48, 128
    v_mfma_f32_16x16x32_bf16 v[76:79], a[84:87], v[60:63], v[76:79]
    buffer_load_dwordx4 v6, s[16:19], s46 offen lds
    v_mfma_f32_16x16x32_bf16 v[80:83], a[92:95], v[56:59], v[80:83]
    v_mfma_f32_16x16x32_bf16 v[84:87], a[92:95], v[60:63], v[84:87]
    s_waitcnt lgkmcnt(2)
    v_mfma_f32_16x16x32_bf16 v[64:67], a[96:99], v[32:35], v[64:67]
    ds_read_b128 v[48:51], v10 offset:20480
    v_mfma_f32_16x16x32_bf16 v[68:71], a[96:99], v[36:39], v[68:71]
    ds_read_b128 v[52:55], v10 offset:22528
    v_mfma_f32_16x16x32_bf16 v[72:75], a[104:107], v[32:35], v[72:75]
    s_add_u32 m0, s49, 8192
    s_add_u32 s46, s48, 256
    v_mfma_f32_16x16x32_bf16 v[76:79], a[104:107], v[36:39], v[76:79]
    buffer_load_dwordx4 v6, s[16:19], s46 offen lds
    v_mfma_f32_16x16x32_bf16 v[80:83], a[112:115], v[32:35], v[80:83]
    v_mfma_f32_16x16x32_bf16 v[84:87], a[112:115], v[36:39], v[84:87]
    s_waitcnt lgkmcnt(2)
    v_mfma_f32_16x16x32_bf16 v[64:67], a[100:103], v[40:43], v[64:67]
    ds_read_b128 v[56:59], v11 offset:20480
    v_mfma_f32_16x16x32_bf16 v[68:71], a[100:103], v[44:47], v[68:71]
    ds_read_b128 v[60:63], v11 offset:22528
    v_mfma_f32_16x16x32_bf16 v[72:75], a[108:111], v[40:43], v[72:75]
    s_add_u32 m0, s49, 12288
    s_add_u32 s46, s48, 384
    v_mfma_f32_16x16x32_bf16 v[76:79], a[108:111], v[44:47], v[76:79]
    buffer_load_dwordx4 v6, s[16:19], s46 offen lds
    v_mfma_f32_16x16x32_bf16 v[80:83], a[116:119], v[40:43], v[80:83]
    v_mfma_f32_16x16x32_bf16 v[84:87], a[116:119], v[44:47], v[84:87]
    s_waitcnt lgkmcnt(2)
    v_mfma_f32_16x16x32_bf16 v[64:67], a[120:123], v[48:51], v[64:67]
    ds_read_b128 v[32:35], v10 offset:24576
    v_mfma_f32_16x16x32_bf16 v[68:71], a[120:123], v[52:55], v[68:71]
    ds_read_b128 v[36:39], v10 offset:26624
    v_mfma_f32_16x16x32_bf16 v[72:75], a[128:131], v[48:51], v[72:75]
    s_add_u32 m0, s49, 16384
    s_add_u32 s46, s48, 512
    v_mfma_f32_16x16x32_bf16 v[76:79], a[128:131], v[52:55], v[76:79]
    buffer_load_dwordx4 v6, s[16:19], s46 offen lds
    v_mfma_f32_16x16x32_bf16 v[80:83], a[136:139], v[48:51], v[80:83]
    v_mfma_f32_16x16x32_bf16 v[84:87], a[136:139], v[52:55], v[84:87]
    s_waitcnt lgkmcnt(2)
    v_mfma_f32_16x16x32_bf16 v[64:67], a[124:127], v[56:59], v[64:67]
    ds_read_b128 v[40:43], v11 offset:24576
    v_mfma_f32_16x16x32_bf16 v[68:71], a[124:127], v[60:63], v[68:71]
    ds_read_b128 v[44:47], v11 offset:26624
    v_mfma_f32_16x16x32_bf16 v[72:75], a[132:135], v[56:59], v[72:75]
    s_add_u32 m0, s49, 20480
    s_add_u32 s46, s48, 640
    v_mfma_f32_16x16x32_bf16 v[76:79], a[132:135], v[60:63], v[76:79]
    buffer_load_dwordx4 v6, s[16:19], s46 offen lds
    v_mfma_f32_16x16x32_bf16 v[80:83], a[140:143], v[56:59], v[80:83]
    v_mfma_f32_16x16x32_bf16 v[84:87], a[140:143], v[60:63], v[84:87]
    s_waitcnt lgkmcnt(2)
    v_mfma_f32_16x16x32_bf16 v[64:67], a[144:147], v[32:35], v[64:67]
    ds_read_b128 v[48:51], v10 offset:28672
    v_mfma_f32_16x16x32_bf16 v[68:71], a[144:147], v[36:39], v[68:71]
    ds_read_b128 v[52:55], v10 offset:30720
    v_mfma_f32_16x16x32_bf16 v[72:75], a[152:155], v[32:35], v[72:75]
    s_add_u32 m0, s49, 24576
    s_add_u32 s46, s48, 768
    v_mfma_f32_16x16x32_bf16 v[76:79], a[152:155], v[36:39], v[76:79]
    buffer_load_dwordx4 v6, s[16:19], s46 offen lds
    v_mfma_f32_16x16x32_bf16 v[80:83], a[160:163], v[32:35], v[80:83]
    v_mfma_f32_16x16x32_bf16 v[84:87], a[160:163], v[36:39], v[84:87]
    s_waitcnt lgkmcnt(2)
    v_mfma_f32_16x16x32_bf16 v[64:67], a[148:151], v[40:43], v[64:67]
    ds_read_b128 v[56:59], v11 offset:28672
    v_mfma_f32_16x16x32_bf16 v[68:71], a[148:151], v[44:47], v[68:71]
    ds_read_b128 v[60:63], v11 offset:30720
    v_mfma_f32_16x16x32_bf16 v[72:75], a[156:159], v[40:43], v[72:75]
    s_add_u32 m0, s49, 28672
    s_add_u32 s46, s48, 896
    v_mfma_f32_16x16x32_bf16 v[76:79], a[156:159], v[44:47], v[76:79]
    buffer_load_dwordx4 v6, s[16:19], s46 offen lds
    v_mfma_f32_16x16x32_bf16 v[80:83], a[164:167], v[40:43], v[80:83]
    v_mfma_f32_16x16x32_bf16 v[84:87], a[164:167], v[44:47], v[84:87]
    s_waitcnt lgkmcnt(2)
    v_mfma_f32_16x16x32_bf16 v[64:67], a[168:171], v[48:51], v[64:67]
    ds_read_b128 v[32:35], v10 offset:32768
    v_mfma_f32_16x16x32_bf16 v[68:71], a[168:171], v[52:55], v[68:71]
    ds_read_b128 v[36:39], v10 offset:34816
    v_mfma_f32_16x16x32_bf16 v[72:75], a[176:179], v[48:51], v[72:75]
    s_add_u32 m0, s49, 32768
    s_add_u32 s46, s48, 1024
    v_mfma_f32_16x16x32_bf16 v[76:79], a[176:179], v[52:55], v[76:79]
    buffer_load_dwordx4 v6, s[16:19], s46 offen lds
    v_mfma_f32_16x16x32_bf16 v[80:83], a[184:187], v[48:51], v[80:83]
    v_mfma_f32_16x16x32_bf16 v[84:87], a[184:187], v[52:55], v[84:87]
    s_waitcnt lgkmcnt(2)
    v_mfma_f32_16x16x32_bf16 v[64:67], a[172:175], v[56:59], v[64:67]
    ds_read_b128 v[40:43], v11 offset:32768
    v_mfma_f32_16x16x32_bf16 v[68:71], a[172:175], v[60:63], v[68:71]
    ds_read_b128 v[44:47], v11 offset:34816
    v_mfma_f32_16x16x32_bf16 v[72:75], a[180:183], v[56:59], v[72:75]
    s_add_u32 m0, s49, 36864
    s_add_u32 s46, s48, 1152
    v_mfma_f32_16x16x32_bf16 v[76:79], a[180:183], v[60:63], v[76:79]
    buffer_load_dwordx4 v6, s[16:19], s46 offen lds
    v_mfma_f32_16x16x32_bf16 v[80:83], a[188:191], v[56:59], v[80:83]
    v_mfma_f32_16x16x32_bf16 v[84:87], a[188:191], v[60:63], v[84:87]
    s_waitcnt lgkmcnt(2)
    v_mfma_f32_16x16x32_bf16 v[64:67], a[192:195], v[32:35], v[64:67]
    ds_read_b128 v[48:51], v10 offset:36864
    v_mfma_f32_16x16x32_bf16 v[68:71], a[192:195], v[36:39], v[68:71]
    ds_read_b128 v[52:55], v10 offset:38912
    v_mfma_f32_16x16x32_bf16 v[72:75], a[200:203], v[32:35], v[72:75]
    s_add_u32 s48, s48, 40960
    s_min_u32 s48, s48, 2580480
    s_add_u32 s49, s49, 40960
    v_mfma_f32_16x16x32_bf16 v[76:79], a[200:203], v[36:39], v[76:79]
    s_cmp_ge_u32 s49, 163840
    s_cselect_b32 s49, s39, s49
    v_mfma_f32_16x16x32_bf16 v[80:83], a[208:211], v[32:35], v[80:83]
    s_cmp_eq_u32 s34, 0
    s_cselect_b32 s46, 0, 1179648
    s_add_u32 s47, s47, s46
    v_mfma_f32_16x16x32_bf16 v[84:87], a[208:211], v[36:39], v[84:87]
    s_waitcnt lgkmcnt(2)
    v_mfma_f32_16x16x32_bf16 v[64:67], a[196:199], v[40:43], v[64:67]
    ds_read_b128 v[56:59], v11 offset:36864
    v_mfma_f32_16x16x32_bf16 v[68:71], a[196:199], v[44:47], v[68:71]
    ds_read_b128 v[60:63], v11 offset:38912
    v_mfma_f32_16x16x32_bf16 v[72:75], a[204:207], v[40:43], v[72:75]
    s_waitcnt vmcnt(10)
    s_barrier
    s_cmp_lg_u32 s32, 0
    s_cbranch_scc1 PF_64
    s_mov_b64 exec, 1
    buffer_store_dword v4, v5, s[8:11], s38 offen sc1
    s_mov_b64 exec, -1
PF_64:
    v_mfma_f32_16x16x32_bf16 v[76:79], a[204:207], v[44:47], v[76:79]
    s_add_u32 s50, s50, 1
    s_and_b32 s50, s50, 3
    s_cselect_b32 s46, s51, 4294844416
    v_mfma_f32_16x16x32_bf16 v[80:83], a[212:215], v[40:43], v[80:83]
    v_add_u32 v10, s46, v10
    v_mfma_f32_16x16x32_bf16 v[84:87], a[212:215], v[44:47], v[84:87]
    s_waitcnt lgkmcnt(2)
    v_add_u32 v11, s46, v11
    v_mfma_f32_16x16x32_bf16 v[64:67], a[216:219], v[48:51], v[64:67]
    ds_read_b128 v[32:35], v10 offset:0
    v_mfma_f32_16x16x32_bf16 v[68:71], a[216:219], v[52:55], v[68:71]
    ds_read_b128 v[36:39], v10 offset:2048
    v_mfma_f32_16x16x32_bf16 v[72:75], a[224:227], v[48:51], v[72:75]
    v_mfma_f32_16x16x32_bf16 v[76:79], a[224:227], v[52:55], v[76:79]
    v_mfma_f32_16x16x32_bf16 v[80:83], a[232:235], v[48:51], v[80:83]
    v_mfma_f32_16x16x32_bf16 v[84:87], a[232:235], v[52:55], v[84:87]
    s_waitcnt lgkmcnt(2)
    v_mfma_f32_16x16x32_bf16 v[64:67], a[220:223], v[56:59], v[64:67]
    ds_read_b128 v[40:43], v11 offset:0
    v_mfma_f32_16x16x32_bf16 v[68:71], a[220:223], v[60:63], v[68:71]
    ds_read_b128 v[44:47], v11 offset:2048
    v_mfma_f32_16x16x32_bf16 v[72:75], a[228:231], v[56:59], v[72:75]
    v_mfma_f32_16x16x32_bf16 v[76:79], a[228:231], v[60:63], v[76:79]
    v_mfma_f32_16x16x32_bf16 v[80:83], a[236:239], v[56:59], v[80:83]
    v_mfma_f32_16x16x32_bf16 v[84:87], a[236:239], v[60:63], v[84:87]
    s_waitcnt lgkmcnt(2)
    s_cmp_lg_u32 s34, 0
    s_cbranch_scc1 P_N0
    v_cvt_pk_bf16_f32 v112, v64, v65
    v_cvt_pk_bf16_f32 v113, v66, v67
    v_cvt_pk_bf16_f32 v114, v68, v69
    v_cvt_pk_bf16_f32 v115, v70, v71
    s_nop 0
    v_permlane16_swap_b32 v112, v114
    v_permlane16_swap_b32 v113, v115
    buffer_store_dwordx4 v[112:115], v15, s[8:11], s47 offen offset:0 sc1
    s_nop 1
    v_cvt_pk_bf16_f32 v112, v72, v73
    v_cvt_pk_bf16_f32 v113, v74, v75
    v_cvt_pk_bf16_f32 v114, v76, v77
    v_cvt_pk_bf16_f32 v115, v78, v79
    s_nop 0
    v_permlane16_swap_b32 v112, v114
    v_permlane16_swap_b32 v113, v115
    buffer_store_dwordx4 v[112:115], v15, s[8:11], s47 offen offset:1024 sc1
    s_nop 1
    v_cvt_pk_bf16_f32 v112, v80, v81
    v_cvt_pk_bf16_f32 v113, v82, v83
    v_cvt_pk_bf16_f32 v114, v84, v85
    v_cvt_pk_bf16_f32 v115, v86, v87
    s_nop 0
    v_permlane16_swap_b32 v112, v114
    v_permlane16_swap_b32 v113, v115
    buffer_store_dwordx4 v[112:115], v15, s[8:11], s47 offen offset:2048 sc1
    s_branch WST_65_go
WST_65:
    s_sleep 10
WST_65_go:
    buffer_load_dwordx2 v[16:17], off, s[12:15], s95 sc1
    v_and_b32 v18, 7, v2
    v_lshlrev_b32 v18, 3, v18
    buffer_load_dwordx2 v[18:19], v18, s[12:15], 0 offen offset:128 sc1
WST_65_chk:
    s_sub_u32 s33, s33, 1
    s_cbranch_scc1 EXIT
    s_waitcnt vmcnt(0)
    s_cmp_eq_u32 s54, 0
    s_cbranch_scc1 WST_65_v
    v_not_b32 v18, v18
    v_xor_b32 v19, 8192, v19
    v_or_b32 v18, v18, v19
    v_cmp_ne_u32 vcc, 0, v18
    s_cbranch_vccz WST_65_v
    v_xor_b32 v19, 8192, v19
    v_lshrrev_b32 v19, 8, v19
    s_nop 1
    v_add_u32_dpp v19, v19, v19 row_ror:4 row_mask:0xf bank_mask:0xf
    s_nop 1
    v_add_u32_dpp v19, v19, v19 row_ror:2 row_mask:0xf bank_mask:0xf
    s_nop 1
    v_add_u32_dpp v19, v19, v19 row_ror:1 row_mask:0xf bank_mask:0xf
    s_nop 0
    v_readfirstlane_b32 s4, v19
    s_nop 0
    s_cmp_lt_u32 s4, 256
    s_cbranch_scc1 WST_65
    s_branch RESTART
WST_65_v:
    v_readfirstlane_b32 s4, v16
    v_readfirstlane_b32 s5, v17
    s_cmp_lt_u32 s4, 40
    s_cbranch_scc1 WST_65
    s_barrier
    s_cmp_lg_u32 s32, 0
    s_cbranch_scc1 P_N0
    s_mov_b32 s46, 1
    v_mov_b32 v4, s46
    s_mov_b64 exec, 1
    buffer_store_dword v4, v5, s[8:11], s38 offen sc1
    s_mov_b64 exec, -1
P_N0:
    s_add_u32 s34, s34, 1
    v_mfma_f32_16x16x32_bf16 v[88:91], a[0:3], v[32:35], 0
    ds_read_b128 v[48:51], v10 offset:4096
    v_mfma_f32_16x16x32_bf16 v[92:95], a[0:3], v[36:39], 0
    ds_read_b128 v[52:55], v10 offset:6144
    v_mfma_f32_16x16x32_bf16 v[96:99], a[8:11], v[32:35], 0
    v_mfma_f32_16x16x32_bf16 v[100:103], a[8:11], v[36:39], 0
    v_mfma_f32_16x16x32_bf16 v[104:107], a[16:19], v[32:35], 0
    v_cvt_pk_bf16_f32 v112, v64, v65
    v_mfma_f32_16x16x32_bf16 v[108:111], a[16:19], v[36:39], 0
    s_waitcnt lgkmcnt(2)
    v_cvt_pk_bf16_f32 v113, v66, v67
    v_mfma_f32_16x16x32_bf16 v[88:91], a[4:7], v[40:43], v[88:91]
    ds_read_b128 v[56:59], v11 offset:4096
    v_cvt_pk_bf16_f32 v114, v68, v69
    v_mfma_f32_16x16x32_bf16 v[92:95], a[4:7], v[44:47], v[92:95]
    ds_read_b128 v[60:63], v11 offset:6144
    v_cvt_pk_bf16_f32 v115, v70, v71
    v_mfma_f32_16x16x32_bf16 v[96:99], a[12:15], v[40:43], v[96:99]
    v_permlane16_swap_b32 v112, v114
    v_mfma_f32_16x16x32_bf16 v[100:103], a[12:15], v[44:47], v[100:103]
    v_permlane16_swap_b32 v113, v115
    v_mfma_f32_16x16x32_bf16 v[104:107], a[20:23], v[40:43], v[104:107]
    buffer_store_dwordx4 v[112:115], v15, s[8:11], s47 offen offset:0 sc1
    v_mfma_f32_16x16x32_bf16 v[108:111], a[20:23], v[44:47], v[108:111]
    s_waitcnt lgkmcnt(2)
    v_cvt_pk_bf16_f32 v116, v72, v73
    v_mfma_f32_16x16x32_bf16 v[88:91], a[24:27], v[48:51], v[88:91]
    ds_read_b128 v[32:35], v10 offset:8192
    v_cvt_pk_bf16_f32 v117, v74, v75
    v_mfma_f32_16x16x32_bf16 v[92:95], a[24:27], v[52:55], v[92:95]
    ds_read_b128 v[36:39], v10 offset:10240
    v_cvt_pk_bf16_f32 v118, v76, v77
    v_mfma_f32_16x16x32_bf16 v[96:99], a[32:35], v[48:51], v[96:99]
    v_cvt_pk_bf16_f32 v119, v78, v79
    v_mfma_f32_16x16x32_bf16 v[100:103], a[32:35], v[52:55], v[100:103]
    v_permlane16_swap_b32 v116, v118
    v_mfma_f32_16x16x32_bf16 v[104:107], a[40:43], v[48:51], v[104:107]
    v_permlane16_swap_b32 v117, v119
    v_mfma_f32_16x16x32_bf16 v[108:111], a[40:43], v[52:55], v[108:111]
    s_waitcnt lgkmcnt(2)
    v_mfma_f32_16x16x32_bf16 v[88:91], a[28:31], v[56:59], v[88:91]
    ds_read_b128 v[40:43], v11 offset:8192
    v_mfma_f32_16x16x32_bf16 v[92:95], a[28:31], v[60:63], v[92:95]
    ds_read_b128 v[44:47], v11 offset:10240
    v_mfma_f32_16x16x32_bf16 v[96:99], a[36:39], v[56:59], v[96:99]
    buffer_store_dwordx4 v[116:119], v15, s[8:11], s47 offen offset:1024 sc1
    v_mfma_f32_16x16x32_bf16 v[100:103], a[36:39], v[60:63], v[100:103]
    v_cvt_pk_bf16_f32 v112, v80, v81
    v_mfma_f32_16x16x32_bf16 v[104:107], a[44:47], v[56:59], v[104:107]
    v_cvt_pk_bf16_f32 v113, v82, v83
    v_mfma_f32_16x16x32_bf16 v[108:111], a[44:47], v[60:63], v[108:111]
    s_waitcnt lgkmcnt(2)
    v_cvt_pk_bf16_f32 v114, v84, v85
    v_mfma_f32_16x16x32_bf16 v[88:91], a[48:51], v[32:35], v[88:91]
    ds_read_b128 v[48:51], v10 offset:12288
    v_cvt_pk_bf16_f32 v115, v86, v87
    v_mfma_f32_16x16x32_bf16 v[92:95], a[48:51], v[36:39], v[92:95]
    ds_read_b128 v[52:55], v10 offset:14336
    v_permlane16_swap_b32 v112, v114
    v_mfma_f32_16x16x32_bf16 v[96:99], a[56:59], v[32:35], v[96:99]
    v_permlane16_swap_b32 v113, v115
    v_mfma_f32_16x16x32_bf16 v[100:103], a[56:59], v[36:39], v[100:103]
    buffer_store_dwordx4 v[112:115], v15, s[8:11], s47 offen offset:2048 sc1
    v_mfma_f32_16x16x32_bf16 v[104:107], a[64:67], v[32:35], v[104:107]
    v_mfma_f32_16x16x32_bf16 v[108:111], a[64:67], v[36:39], v[108:111]
    s_waitcnt lgkmcnt(2)
    v_mfma_f32_16x16x32_bf16 v[88:91], a[52:55], v[40:43], v[88:91]
    ds_read_b128 v[56:59], v11 offset:12288
    v_mfma_f32_16x16x32_bf16 v[92:95], a[52:55], v[44:47], v[92:95]
    ds_read_b128 v[60:63], v11 offset:14336
    v_mfma_f32_16x16x32_bf16 v[96:99], a[60:63], v[40:43], v[96:99]
    v_mfma_f32_16x16x32_bf16 v[100:103], a[60:63], v[44:47], v[100:103]
    v_mfma_f32_16x16x32_bf16 v[104:107], a[68:71], v[40:43], v[104:107]
    v_mfma_f32_16x16x32_bf16 v[108:111], a[68:71], v[44:47], v[108:111]
    s_waitcnt lgkmcnt(2)
    v_mfma_f32_16x16x32_bf16 v[88:91], a[72:75], v[48:51], v[88:91]
    ds_read_b128 v[32:35], v10 offset:16384
    v_mfma_f32_16x16x32_bf16 v[92:95], a[72:75], v[52:55], v[92:95]
    ds_read_b128 v[36:39], v10 offset:18432
    v_mfma_f32_16x16x32_bf16 v[96:99], a[80:83], v[48:51], v[96:99]
    s_add_u32 m0, s49, 0
    s_add_u32 s46, s48, 0
    v_mfma_f32_16x16x32_bf16 v[100:103], a[80:83], v[52:55], v[100:103]
    buffer_load_dwordx4 v6, s[16:19], s46 offen lds
    v_mfma_f32_16x16x32_bf16 v[104:107], a[88:91], v[48:51], v[104:107]
    v_mov_b32 v4, s34
    v_mfma_f32_16x16x32_bf16 v[108:111], a[88:91], v[52:55], v[108:111]
    s_waitcnt lgkmcnt(2)
    v_mfma_f32_16x16x32_bf16 v[88:91], a[76:79], v[56:59], v[88:91]
    ds_read_b128 v[40:43], v11 offset:16384
    v_mfma_f32_16x16x32_bf16 v[92:95], a[76:79], v[60:63], v[92:95]
    ds_read_b128 v[44:47], v11 offset:18432
    v_mfma_f32_16x16x32_bf16 v[96:99], a[84:87], v[56:59], v[96:99]
    s_add_u32 m0, s49, 4096
    s_add_u32 s46, s48, 128
    v_mfma_f32_16x16x32_bf16 v[100:103], a[84:87], v[60:63], v[100:103]
    buffer_load_dwordx4 v6, s[16:19], s46 offen lds
    v_mfma_f32_16x16x32_bf16 v[104:107], a[92:95], v[56:59], v[104:107]
    v_mfma_f32_16x16x32_bf16 v[108:111], a[92:95], v[60:63], v[108:111]
    s_waitcnt lgkmcnt(2)
    v_mfma_f32_16x16x32_bf16 v[88:91], a[96:99], v[32:35], v[88:91]
    ds_read_b128 v[48:51], v10 offset:20480
    v_mfma_f32_16x16x32_bf16 v[92:95], a[96:99], v[36:39], v[92:95]
    ds_read_b128 v[52:55], v10 offset:22528
    v_mfma_f32_16x16x32_bf16 v[96:99], a[104:107], v[32:35], v[96:99]
    s_add_u32 m0, s49, 8192
    s_add_u32 s46, s48, 256
    v_mfma_f32_16x16x32_bf16 v[100:103], a[104:107], v[36:39], v[100:103]
    buffer_load_dwordx4 v6, s[16:19], s46 offen lds
    v_mfma_f32_16x16x32_bf16 v[104:107], a[112:115], v[32:35], v[104:107]
    v_mfma_f32_16x16x32_bf16 v[108:111], a[112:115], v[36:39], v[108:111]
    s_waitcnt lgkmcnt(2)
    v_mfma_f32_16x16x32_bf16 v[88:91], a[100:103], v[40:43], v[88:91]
    ds_read_b128 v[56:59], v11 offset:20480
    v_mfma_f32_16x16x32_bf16 v[92:95], a[100:103], v[44:47], v[92:95]
    ds_read_b128 v[60:63], v11 offset:22528
    v_mfma_f32_16x16x32_bf16 v[96:99], a[108:111], v[40:43], v[96:99]
    s_add_u32 m0, s49, 12288
    s_add_u32 s46, s48, 384
    v_mfma_f32_16x16x32_bf16 v[100:103], a[108:111], v[44:47], v[100:103]
    buffer_load_dwordx4 v6, s[16:19], s46 offen lds
    v_mfma_f32_16x16x32_bf16 v[104:107], a[116:119], v[40:43], v[104:107]
    v_mfma_f32_16x16x32_bf16 v[108:111], a[116:119], v[44:47], v[108:111]
    s_waitcnt lgkmcnt(2)
    v_mfma_f32_16x16x32_bf16 v[88:91], a[120:123], v[48:51], v[88:91]
    ds_read_b128 v[32:35], v10 offset:24576
    v_mfma_f32_16x16x32_bf16 v[92:95], a[120:123], v[52:55], v[92:95]
    ds_read_b128 v[36:39], v10 offset:26624
    v_mfma_f32_16x16x32_bf16 v[96:99], a[128:131], v[48:51], v[96:99]
    s_add_u32 m0, s49, 16384
    s_add_u32 s46, s48, 512
    v_mfma_f32_16x16x32_bf16 v[100:103], a[128:131], v[52:55], v[100:103]
    buffer_load_dwordx4 v6, s[16:19], s46 offen lds
    v_mfma_f32_16x16x32_bf16 v[104:107], a[136:139], v[48:51], v[104:107]
    v_mfma_f32_16x16x32_bf16 v[108:111], a[136:139], v[52:55], v[108:111]
    s_waitcnt lgkmcnt(2)
    v_mfma_f32_16x16x32_bf16 v[88:91], a[124:127], v[56:59], v[88:91]
    ds_read_b128 v[40:43], v11 offset:24576
    v_mfma_f32_16x16x32_bf16 v[92:95], a[124:127], v[60:63], v[92:95]
    ds_read_b128 v[44:47], v11 offset:26624
    v_mfma_f32_16x16x32_bf16 v[96:99], a[132:135], v[56:59], v[96:99]
    s_add_u32 m0, s49, 20480
    s_add_u32 s46, s48, 640
    v_mfma_f32_16x16x32_bf16 v[100:103], a[132:135], v[60:63], v[100:103]
    buffer_load_dwordx4 v6, s[16:19], s46 offen lds
    v_mfma_f32_16x16x32_bf16 v[104:107], a[140:143], v[56:59], v[104:107]
    v_mfma_f32_16x16x32_bf16 v[108:111], a[140:143], v[60:63], v[108:111]
    s_waitcnt lgkmcnt(2)
    v_mfma_f32_16x16x32_bf16 v[88:91], a[144:147], v[32:35], v[88:91]
    ds_read_b128 v[48:51], v10 offset:28672
    v_mfma_f32_16x16x32_bf16 v[92:95], a[144:147], v[36:39], v[92:95]
    ds_read_b128 v[52:55], v10 offset:30720
    v_mfma_f32_16x16x32_bf16 v[96:99], a[152:155], v[32:35], v[96:99]
    s_add_u32 m0, s49, 24576
    s_add_u32 s46, s48, 768
    v_mfma_f32_16x16x32_bf16 v[100:103], a[152:155], v[36:39], v[100:103]
    buffer_load_dwordx4 v6, s[16:19], s46 offen lds
    v_mfma_f32_16x16x32_bf16 v[104:107], a[160:163], v[32:35], v[104:107]
    v_mfma_f32_16x16x32_bf16 v[108:111], a[160:163], v[36:39], v[108:111]
    s_waitcnt lgkmcnt(2)
    v_mfma_f32_16x16x32_bf16 v[88:91], a[148:151], v[40:43], v[88:91]
    ds_read_b128 v[56:59], v11 offset:28672
    v_mfma_f32_16x16x32_bf16 v[92:95], a[148:151], v[44:47], v[92:95]
    ds_read_b128 v[60:63], v11 offset:30720
    v_mfma_f32_16x16x32_bf16 v[96:99], a[156:159], v[40:43], v[96:99]
    s_add_u32 m0, s49, 28672
    s_add_u32 s46, s48, 896
    v_mfma_f32_16x16x32_bf16 v[100:103], a[156:159], v[44:47], v[100:103]
    buffer_load_dwordx4 v6, s[16:19], s46 offen lds
    v_mfma_f32_16x16x32_bf16 v[104:107], a[164:167], v[40:43], v[104:107]
    v_mfma_f32_16x16x32_bf16 v[108:111], a[164:167], v[44:47], v[108:111]
    s_waitcnt lgkmcnt(2)
    v_mfma_f32_16x16x32_bf16 v[88:91], a[168:171], v[48:51], v[88:91]
    ds_read_b128 v[32:35], v10 offset:32768
    v_mfma_f32_16x16x32_bf16 v[92:95], a[168:171], v[52:55], v[92:95]
    ds_read_b128 v[36:39], v10 offset:34816
    v_mfma_f32_16x16x32_bf16 v[96:99], a[176:179], v[48:51], v[96:99]
    s_add_u32 m0, s49, 32768
    s_add_u32 s46, s48, 1024
    v_mfma_f32_16x16x32_bf16 v[100:103], a[176:179], v[52:55], v[100:103]
    buffer_load_dwordx4 v6, s[16:19], s46 offen lds
    v_mfma_f32_16x16x32_bf16 v[104:107], a[184:187], v[48:51], v[104:107]
    v_mfma_f32_16x16x32_bf16 v[108:111], a[184:187], v[52:55], v[108:111]
    s_waitcnt lgkmcnt(2)
    v_mfma_f32_16x16x32_bf16 v[88:91], a[172:175], v[56:59], v[88:91]
    ds_read_b128 v[40:43], v11 offset:32768
    v_mfma_f32_16x16x32_bf16 v[92:95], a[172:175], v[60:63], v[92:95]
    ds_read_b128 v[44:47], v11 offset:34816
    v_mfma_f32_16x16x32_bf16 v[96:99], a[180:183], v[56:59], v[96:99]
    s_add_u32 m0, s49, 36864
    s_add_u32 s46, s48, 1152
    v_mfma_f32_16x16x32_bf16 v[100:103], a[180:183], v[60:63], v[100:103]
    buffer_load_dwordx4 v6, s[16:19], s46 offen lds
    v_mfma_f32_16x16x32_bf16 v[104:107], a[188:191], v[56:59], v[104:107]
    v_mfma_f32_16x16x32_bf16 v[108:111], a[188:191], v[60:63], v[108:111]
    s_waitcnt lgkmcnt(2)
    v_mfma_f32_16x16x32_bf16 v[88:91], a[192:195], v[32:35], v[88:91]
    ds_read_b128 v[48:51], v10 offset:36864
    v_mfma_f32_16x16x32_bf16 v[92:95], a[192:195], v[36:39], v[92:95]
    ds_read_b128 v[52:55], v10 offset:38912
    v_mfma_f32_16x16x32_bf16 v[96:99], a[200:203], v[32:35], v[96:99]
    s_add_u32 s48, s48, 40960
    s_min_u32 s48, s48, 2580480
    s_add_u32 s49, s49, 40960
    v_mfma_f32_16x16x32_bf16 v[100:103], a[200:203], v[36:39], v[100:103]
    s_cmp_ge_u32 s49, 163840
    s_cselect_b32 s49, s39, s49
    v_mfma_f32_16x16x32_bf16 v[104:107], a[208:211], v[32:35], v[104:107]
    s_add_u32 s47, s47, 1179648
    v_mfma_f32_16x16x32_bf16 v[108:111], a[208:211], v[36:39], v[108:111]
    s_waitcnt lgkmcnt(2)
    v_mfma_f32_16x16x32_bf16 v[88:91], a[196:199], v[40:43], v[88:91]
    ds_read_b128 v[56:59], v11 offset:36864
    v_mfma_f32_16x16x32_bf16 v[92:95], a[196:199], v[44:47], v[92:95]
    ds_read_b128 v[60:63], v11 offset:38912
    v_mfma_f32_16x16x32_bf16 v[96:99], a[204:207], v[40:43], v[96:99]
    s_waitcnt vmcnt(10)
    s_barrier
    s_cmp_lg_u32 s32, 0
    s_cbranch_scc1 PF_66
    s_mov_b64 exec, 1
    buffer_store_dword v4, v5, s[8:11], s38 offen sc1
    s_mov_b64 exec, -1
PF_66:
    v_mfma_f32_16x16x32_bf16 v[100:103], a[204:207], v[44:47], v[100:103]
    s_add_u32 s50, s50, 1
    s_and_b32 s50, s50, 3
    s_cselect_b32 s46, s51, 4294844416
    v_mfma_f32_16x16x32_bf16 v[104:107], a[212:215], v[40:43], v[104:107]
    v_add_u32 v10, s46, v10
    v_mfma_f32_16x16x32_bf16 v[108:111], a[212:215], v[44:47], v[108:111]
    s_waitcnt lgkmcnt(2)
    v_add_u32 v11, s46, v11
    v_mfma_f32_16x16x32_bf16 v[88:91], a[216:219], v[48:51], v[88:91]
    ds_read_b128 v[32:35], v10 offset:0
    v_mfma_f32_16x16x32_bf16 v[92:95], a[216:219], v[52:55], v[92:95]
    ds_read_b128 v[36:39], v10 offset:2048
    v_mfma_f32_16x16x32_bf16 v[96:99], a[224:227], v[48:51], v[96:99]
    v_mfma_f32_16x16x32_bf16 v[100:103], a[224:227], v[52:55], v[100:103]
    v_mfma_f32_16x16x32_bf16 v[104:107], a[232:235], v[48:51], v[104:107]
    v_mfma_f32_16x16x32_bf16 v[108:111], a[232:235], v[52:55], v[108:111]
    s_waitcnt lgkmcnt(2)
    v_mfma_f32_16x16x32_bf16 v[88:91], a[220:223], v[56:59], v[88:91]
    ds_read_b128 v[40:43], v11 offset:0
    v_mfma_f32_16x16x32_bf16 v[92:95], a[220:223], v[60:63], v[92:95]
    ds_read_b128 v[44:47], v11 offset:2048
    v_mfma_f32_16x16x32_bf16 v[96:99], a[228:231], v[56:59], v[96:99]
    v_mfma_f32_16x16x32_bf16 v[100:103], a[228:231], v[60:63], v[100:103]
    v_mfma_f32_16x16x32_bf16 v[104:107], a[236:239], v[56:59], v[104:107]
    v_mfma_f32_16x16x32_bf16 v[108:111], a[236:239], v[60:63], v[108:111]
    s_waitcnt lgkmcnt(2)
    s_add_u32 s34, s34, 1
    s_cmp_lt_u32 s34, 64
    s_cbranch_scc1 P_LOOP
    v_cvt_pk_bf16_f32 v112, v88, v89
    v_cvt_pk_bf16_f32 v113, v90, v91
    v_cvt_pk_bf16_f32 v114, v92, v93
    v_cvt_pk_bf16_f32 v115, v94, v95
    s_nop 0
    v_permlane16_swap_b32 v112, v114
    v_permlane16_swap_b32 v113, v115
    buffer_store_dwordx4 v[112:115], v15, s[8:11], s47 offen offset:0 sc1
    s_nop 1
    v_cvt_pk_bf16_f32 v112, v96, v97
    v_cvt_pk_bf16_f32 v113, v98, v99
    v_cvt_pk_bf16_f32 v114, v100, v101
    v_cvt_pk_bf16_f32 v115, v102, v103
    s_nop 0
    v_permlane16_swap_b32 v112, v114
    v_permlane16_swap_b32 v113, v115
    buffer_store_dwordx4 v[112:115], v15, s[8:11], s47 offen offset:1024 sc1
    s_nop 1
    v_cvt_pk_bf16_f32 v112, v104, v105
    v_cvt_pk_bf16_f32 v113, v106, v107
    v_cvt_pk_bf16_f32 v114, v108, v109
    v_cvt_pk_bf16_f32 v115, v110, v111
    s_nop 0
    v_permlane16_swap_b32 v112, v114
    v_permlane16_swap_b32 v113, v115
    buffer_store_dwordx4 v[112:115], v15, s[8:11], s47 offen offset:2048 sc1
    s_waitcnt vmcnt(0)
    s_barrier
    s_movk_i32 s46, 128
    v_mov_b32 v4, s46
    s_mov_b64 exec, 1
    buffer_store_dword v4, v5, s[8:11], s38 offen sc1
    s_mov_b64 exec, -1
    s_sub_u32 s2, s2, 32
    s_cbranch_scc0 ROLE_B
    s_add_u32 s2, s2, 96
    s_sub_u32 s2, s2, 64
    s_add_u32 s52, s2, 256
    s_cmp_lt_u32 s2, 30
    s_cbranch_scc1 ROLE_O
    s_endpgm
.p2align 6
ROLE_B:
    s_load_dwordx8 s[40:47], s[0:1], 56
    s_load_dwordx2 s[48:49], s[0:1], 88
    s_waitcnt vmcnt(0) lgkmcnt(0)
    s_barrier
    s_mov_b32 s16, s40
    s_mov_b32 s17, s41
    s_mov_b32 s18, 2621440
    s_mov_b32 s19, 0x20000
    s_mov_b32 s20, s42
    s_mov_b32 s21, s43
    s_mov_b32 s22, 2457600
    s_mov_b32 s23, 0x20000
    s_mov_b32 s24, s44
    s_mov_b32 s25, s45
    s_mov_b32 s26, 25600
    s_mov_b32 s27, 0x20000
    s_mov_b32 s28, s48
    s_mov_b32 s29, s49
    s_mov_b32 s30, 5242880
    s_mov_b32 s31, 0x20000
    s_mov_b32 s58, s46
    s_mov_b32 s59, s47
    s_and_b32 s35, s2, 7
    s_lshr_b32 s36, s2, 3
    v_mov_b32 v5, 0
    v_lshlrev_b32 v3, 4, v2
    s_mul_i32 s46, s35, 3200
    s_lshl_b32 s47, s32, 10
    s_add_u32 s46, s46, s47
    s_add_u32 m0, s47, 155200
    v_add_u32 v23, s46, v3
    buffer_load_dwordx4 v23, s[24:27], 0 offen lds
    s_lshl_b32 s46, s32, 5
    v_and_b32 v12, 15, v2
    v_add_u32 v12, s46, v12
    v_lshrrev_b32 v13, 4, v2
    v_mul_u32_u24 v17, 1280, v12
    v_lshl_add_u32 v17, v13, 4, v17
    v_mul_u32_u24 v18, 320, v12
    v_mul_u32_u24 v14, 80, v13
    v_add_u32 v18, v18, v14
    v_add_u32 v18, 81920, v18
    v_mul_u32_u24 v19, 192, v12
    v_mul_u32_u24 v14, 48, v13
    v_add_u32 v19, v19, v14
    v_add_u32 v19, 122880, v19
    v_mul_u32_u24 v14, 40, v13
    v_lshlrev_b32 v20, 3, v2
    v_mul_u32_u24 v21, 2560, v12
    v_add_u32 v21, v21, v14
    s_mul_i32 s45, s36, 327680
    s_lshl_b32 s48, s36, 4
    s_lshl_b32 s46, s32, 1
    s_add_u32 s48, s48, s46
    s_mul_i32 s48, s48, 20480
    s_add_u32 s48, s48, 197197824
    v_lshrrev_b32 v12, 4, v2
    v_and_b32 v13, 15, v2
    v_xor_b32 v124, v12, v13
    v_lshlrev_b32 v124, 4, v124
    s_lshl_b32 s46, s32, 5
    v_add_u32 v12, s46, v12
    v_mul_u32_u24 v125, 1280, v12
    s_lshl_b32 s49, s32, 14
    s_add_u32 s49, s49, 81920
    v_lshlrev_b32 v126, 8, v13
    v_add_u32 v126, s49, v126
    v_xor_b32 v12, 0, v124
    v_add_u32 v12, v12, v125
    s_add_u32 m0, s49, 0
    s_add_u32 s46, s45, 0
    buffer_load_dwordx4 v12, s[16:19], s46 offen lds
    s_add_u32 m0, s49, 4096
    s_add_u32 s46, s45, 20480
    buffer_load_dwordx4 v12, s[16:19], s46 offen lds
    v_xor_b32 v12, 64, v124
    v_add_u32 v12, v12, v125
    s_add_u32 m0, s49, 1024
    s_add_u32 s46, s45, 5120
    buffer_load_dwordx4 v12, s[16:19], s46 offen lds
    s_add_u32 m0, s49, 5120
    s_add_u32 s46, s45, 25600
    buffer_load_dwordx4 v12, s[16:19], s46 offen lds
    v_xor_b32 v12, 128, v124
    v_add_u32 v12, v12, v125
    s_add_u32 m0, s49, 2048
    s_add_u32 s46, s45, 10240
    buffer_load_dwordx4 v12, s[16:19], s46 offen lds
    s_add_u32 m0, s49, 6144
    s_add_u32 s46, s45, 30720
    buffer_load_dwordx4 v12, s[16:19], s46 offen lds
    v_xor_b32 v12, 192, v124
    v_add_u32 v12, v12, v125
    s_add_u32 m0, s49, 3072
    s_add_u32 s46, s45, 15360
    buffer_load_dwordx4 v12, s[16:19], s46 offen lds
    s_add_u32 m0, s49, 7168
    s_add_u32 s46, s45, 35840
    buffer_load_dwordx4 v12, s[16:19], s46 offen lds
    v_xor_b32 v12, 0, v124
    v_add_u32 v12, v12, v125
    s_add_u32 m0, s49, 8192
    s_add_u32 s46, s45, 256
    buffer_load_dwordx4 v12, s[16:19], s46 offen lds
    s_add_u32 m0, s49, 12288
    s_add_u32 s46, s45, 20736
    buffer_load_dwordx4 v12, s[16:19], s46 offen lds
    v_xor_b32 v12, 64, v124
    v_add_u32 v12, v12, v125
    s_add_u32 m0, s49, 9216
    s_add_u32 s46, s45, 5376
    buffer_load_dwordx4 v12, s[16:19], s46 offen lds
    s_add_u32 m0, s49, 13312
    s_add_u32 s46, s45, 25856
    buffer_load_dwordx4 v12, s[16:19], s46 offen lds
    v_xor_b32 v12, 128, v124
    v_add_u32 v12, v12, v125
    s_add_u32 m0, s49, 10240
    s_add_u32 s46, s45, 10496
    buffer_load_dwordx4 v12, s[16:19], s46 offen lds
    s_add_u32 m0, s49, 14336
    s_add_u32 s46, s45, 30976
    buffer_load_dwordx4 v12, s[16:19], s46 offen lds
    v_xor_b32 v12, 192, v124
    v_add_u32 v12, v12, v125
    s_add_u32 m0, s49, 11264
    s_add_u32 s46, s45, 15616
    buffer_load_dwordx4 v12, s[16:19], s46 offen lds
    s_add_u32 m0, s49, 15360
    s_add_u32 s46, s45, 36096
    buffer_load_dwordx4 v12, s[16:19], s46 offen lds
    s_movk_i32 s46, 6554
    s_and_b32 s50, s35, 7
    s_mul_i32 s50, s50, 160
    s_mul_i32 s47, s32, 122880
    s_add_u32 s47, s47, s50
    v_add_u32 v12, 0, v2
    v_mul_lo_u32 v13, v12, s46
    v_lshrrev_b32 v13, 16, v13
    v_mul_u32_u24 v14, 10, v13
    v_sub_u32 v14, v12, v14
    v_and_b32 v12, 19, v13
    v_bfe_u32 v15, v13, 2, 1
    v_lshl_add_u32 v12, v15, 3, v12
    v_bfe_u32 v15, v13, 3, 1
    v_lshl_add_u32 v12, v15, 2, v12
    v_mul_u32_u24 v12, 3840, v12
    v_lshl_add_u32 v12, v14, 4, v12
    v_add_u32 v6, s47, v12
    v_mov_b32 v0, v6
    v_add_u32 v12, 64, v2
    v_mul_lo_u32 v13, v12, s46
    v_lshrrev_b32 v13, 16, v13
    v_mul_u32_u24 v14, 10, v13
    v_sub_u32 v14, v12, v14
    v_and_b32 v12, 19, v13
    v_bfe_u32 v15, v13, 2, 1
    v_lshl_add_u32 v12, v15, 3, v12
    v_bfe_u32 v15, v13, 3, 1
    v_lshl_add_u32 v12, v15, 2, v12
    v_mul_u32_u24 v12, 3840, v12
    v_lshl_add_u32 v12, v14, 4, v12
    v_add_u32 v7, s47, v12
    v_mov_b32 v1, v7
    v_add_u32 v12, 128, v2
    v_mul_lo_u32 v13, v12, s46
    v_lshrrev_b32 v13, 16, v13
    v_mul_u32_u24 v14, 10, v13
    v_sub_u32 v14, v12, v14
    v_and_b32 v12, 19, v13
    v_bfe_u32 v15, v13, 2, 1
    v_lshl_add_u32 v12, v15, 3, v12
    v_bfe_u32 v15, v13, 3, 1
    v_lshl_add_u32 v12, v15, 2, v12
    v_mul_u32_u24 v12, 3840, v12
    v_lshl_add_u32 v12, v14, 4, v12
    v_add_u32 v8, s47, v12
    v_mov_b32 v158, v8
    v_add_u32 v12, 192, v2
    v_mul_lo_u32 v13, v12, s46
    v_lshrrev_b32 v13, 16, v13
    v_mul_u32_u24 v14, 10, v13
    v_sub_u32 v14, v12, v14
    v_and_b32 v12, 19, v13
    v_bfe_u32 v15, v13, 2, 1
    v_lshl_add_u32 v12, v15, 3, v12
    v_bfe_u32 v15, v13, 3, 1
    v_lshl_add_u32 v12, v15, 2, v12
    v_mul_u32_u24 v12, 3840, v12
    v_lshl_add_u32 v12, v14, 4, v12
    v_add_u32 v9, s47, v12
    v_mov_b32 v159, v9
    v_add_u32 v12, 256, v2
    v_mul_lo_u32 v13, v12, s46
    v_lshrrev_b32 v13, 16, v13
    v_mul_u32_u24 v14, 10, v13
    v_sub_u32 v14, v12, v14
    v_and_b32 v12, 19, v13
    v_bfe_u32 v15, v13, 2, 1
    v_lshl_add_u32 v12, v15, 3, v12
    v_bfe_u32 v15, v13, 3, 1
    v_lshl_add_u32 v12, v15, 2, v12
    v_mul_u32_u24 v12, 3840, v12
    v_lshl_add_u32 v12, v14, 4, v12
    v_add_u32 v10, s47, v12
    v_mov_b32 v16, v10
    s_mov_b32 s37, 1280
    s_mov_b32 s40, 1280
    s_mov_b32 s38, 0
    s_mul_i32 s39, s32, 5120
    s_mov_b32 s41, 491520
    s_mov_b32 s42, 1280
    s_mov_b32 s43, 3840
    s_mov_b32 s53, 1966080
    s_mov_b32 s44, 0
    s_add_u32 m0, s39, 0
    s_nop 0
    buffer_load_dwordx4 v6, s[20:23], s37 offen lds
    s_add_u32 m0, s39, 1024
    s_nop 0
    buffer_load_dwordx4 v7, s[20:23], s37 offen lds
    s_add_u32 m0, s39, 2048
    s_nop 0
    buffer_load_dwordx4 v8, s[20:23], s37 offen lds
    s_add_u32 m0, s39, 3072
    s_nop 0
    buffer_load_dwordx4 v9, s[20:23], s37 offen lds
    s_add_u32 m0, s39, 4096
    s_nop 0
    buffer_load_dwordx4 v10, s[20:23], s37 offen lds
    s_add_u32 s37, s37, s41
    s_add_u32 s38, s38, 1
    s_add_u32 s46, s40, s53
    s_cmp_eq_u32 s38, 4
    s_cselect_b32 s37, s46, s37
    s_add_u32 s46, s40, s42
    s_cmp_eq_u32 s46, s43
    s_cselect_b32 s46, 0, s46
    s_cmp_eq_u32 s38, 5
    s_cselect_b32 s40, s46, s40
    s_cselect_b32 s37, s46, s37
    s_cselect_b32 s38, 0, s38
    s_add_u32 s39, s39, 20480
    s_cmp_ge_u32 s39, 81920
    s_cselect_b32 s46, 81920, 0
    s_sub_u32 s39, s39, s46
    s_add_u32 m0, s39, 0
    s_nop 0
    buffer_load_dwordx4 v6, s[20:23], s37 offen lds
    s_add_u32 m0, s39, 1024
    s_nop 0
    buffer_load_dwordx4 v7, s[20:23], s37 offen lds
    s_add_u32 m0, s39, 2048
    s_nop 0
    buffer_load_dwordx4 v8, s[20:23], s37 offen lds
    s_add_u32 m0, s39, 3072
    s_nop 0
    buffer_load_dwordx4 v9, s[20:23], s37 offen lds
    s_add_u32 m0, s39, 4096
    s_nop 0
    buffer_load_dwordx4 v10, s[20:23], s37 offen lds
    s_add_u32 s37, s37, s41
    s_add_u32 s38, s38, 1
    s_add_u32 s46, s40, s53
    s_cmp_eq_u32 s38, 4
    s_cselect_b32 s37, s46, s37
    s_add_u32 s46, s40, s42
    s_cmp_eq_u32 s46, s43
    s_cselect_b32 s46, 0, s46
    s_cmp_eq_u32 s38, 5
    s_cselect_b32 s40, s46, s40
    s_cselect_b32 s37, s46, s37
    s_cselect_b32 s38, 0, s38
    s_add_u32 s39, s39, 20480
    s_cmp_ge_u32 s39, 81920
    s_cselect_b32 s46, 81920, 0
    s_sub_u32 s39, s39, s46
    s_add_u32 m0, s39, 0
    s_nop 0
    buffer_load_dwordx4 v6, s[20:23], s37 offen lds
    s_add_u32 m0, s39, 1024
    s_nop 0
    buffer_load_dwordx4 v7, s[20:23], s37 offen lds
    s_add_u32 m0, s39, 2048
    s_nop 0
    buffer_load_dwordx4 v8, s[20:23], s37 offen lds
    s_add_u32 m0, s39, 3072
    s_nop 0
    buffer_load_dwordx4 v9, s[20:23], s37 offen lds
    s_add_u32 m0, s39, 4096
    s_nop 0
    buffer_load_dwordx4 v10, s[20:23], s37 offen lds
    s_add_u32 s37, s37, s41
    s_add_u32 s38, s38, 1
    s_add_u32 s46, s40, s53
    s_cmp_eq_u32 s38, 4
    s_cselect_b32 s37, s46, s37
    s_add_u32 s46, s40, s42
    s_cmp_eq_u32 s46, s43
    s_cselect_b32 s46, 0, s46
    s_cmp_eq_u32 s38, 5
    s_cselect_b32 s40, s46, s40
    s_cselect_b32 s37, s46, s37
    s_cselect_b32 s38, 0, s38
    s_add_u32 s39, s39, 20480
    s_cmp_ge_u32 s39, 81920
    s_cselect_b32 s46, 81920, 0
    s_sub_u32 s39, s39, s46
    v_lshrrev_b32 v12, 5, v2
    v_lshlrev_b32 v12, 4, v12
    v_bfe_u32 v13, v2, 4, 1
    v_lshl_add_u32 v12, v13, 2, v12
    v_bfe_u32 v13, v2, 2, 2
    v_add_u32 v12, v12, v13
    v_mul_u32_u24 v12, 160, v12
    v_and_b32 v13, 3, v2
    v_mul_u32_u24 v13, 40, v13
    v_add_u32 v11, v12, v13
    s_waitcnt vmcnt(23)
    v_xor_b32 v12, 0, v124
    v_add_u32 v12, v12, v126
    ds_read_b128 a[0:3], v12 offset:0
    ds_read_b128 a[4:7], v12 offset:4096
    v_xor_b32 v12, 64, v124
    v_add_u32 v12, v12, v126
    ds_read_b128 a[8:11], v12 offset:0
    ds_read_b128 a[12:15], v12 offset:4096
    v_xor_b32 v12, 128, v124
    v_add_u32 v12, v12, v126
    ds_read_b128 a[16:19], v12 offset:0
    ds_read_b128 a[20:23], v12 offset:4096
    v_xor_b32 v12, 192, v124
    v_add_u32 v12, v12, v126
    ds_read_b128 a[24:27], v12 offset:0
    ds_read_b128 a[28:31], v12 offset:4096
    s_waitcnt lgkmcnt(0)
    v_xor_b32 v12, 0, v124
    v_add_u32 v12, v12, v125
    s_add_u32 m0, s49, 0
    s_add_u32 s46, s45, 512
    buffer_load_dwordx4 v12, s[16:19], s46 offen lds
    s_add_u32 m0, s49, 4096
    s_add_u32 s46, s45, 20992
    buffer_load_dwordx4 v12, s[16:19], s46 offen lds
    v_xor_b32 v12, 64, v124
    v_add_u32 v12, v12, v125
    s_add_u32 m0, s49, 1024
    s_add_u32 s46, s45, 5632
    buffer_load_dwordx4 v12, s[16:19], s46 offen lds
    s_add_u32 m0, s49, 5120
    s_add_u32 s46, s45, 26112
    buffer_load_dwordx4 v12, s[16:19], s46 offen lds
    v_xor_b32 v12, 128, v124
    v_add_u32 v12, v12, v125
    s_add_u32 m0, s49, 2048
    s_add_u32 s46, s45, 10752
    buffer_load_dwordx4 v12, s[16:19], s46 offen lds
    s_add_u32 m0, s49, 6144
    s_add_u32 s46, s45, 31232
    buffer_load_dwordx4 v12, s[16:19], s46 offen lds
    v_xor_b32 v12, 192, v124
    v_add_u32 v12, v12, v125
    s_add_u32 m0, s49, 3072
    s_add_u32 s46, s45, 15872
    buffer_load_dwordx4 v12, s[16:19], s46 offen lds
    s_add_u32 m0, s49, 7168
    s_add_u32 s46, s45, 36352
    buffer_load_dwordx4 v12, s[16:19], s46 offen lds
    s_waitcnt vmcnt(23)
    v_xor_b32 v12, 0, v124
    v_add_u32 v12, v12, v126
    ds_read_b128 a[32:35], v12 offset:8192
    ds_read_b128 a[36:39], v12 offset:12288
    v_xor_b32 v12, 64, v124
    v_add_u32 v12, v12, v126
    ds_read_b128 a[40:43], v12 offset:8192
    ds_read_b128 a[44:47], v12 offset:12288
    v_xor_b32 v12, 128, v124
    v_add_u32 v12, v12, v126
    ds_read_b128 a[48:51], v12 offset:8192
    ds_read_b128 a[52:55], v12 offset:12288
    v_xor_b32 v12, 192, v124
    v_add_u32 v12, v12, v126
    ds_read_b128 a[56:59], v12 offset:8192
    ds_read_b128 a[60:63], v12 offset:12288
    s_waitcnt lgkmcnt(0)
    v_xor_b32 v12, 0, v124
    v_add_u32 v12, v12, v125
    s_add_u32 m0, s49, 8192
    s_add_u32 s46, s45, 768
    buffer_load_dwordx4 v12, s[16:19], s46 offen lds
    s_add_u32 m0, s49, 12288
    s_add_u32 s46, s45, 21248
    buffer_load_dwordx4 v12, s[16:19], s46 offen lds
    v_xor_b32 v12, 64, v124
    v_add_u32 v12, v12, v125
    s_add_u32 m0, s49, 9216
    s_add_u32 s46, s45, 5888
    buffer_load_dwordx4 v12, s[16:19], s46 offen lds
    s_add_u32 m0, s49, 13312
    s_add_u32 s46, s45, 26368
    buffer_load_dwordx4 v12, s[16:19], s46 offen lds
    v_xor_b32 v12, 128, v124
    v_add_u32 v12, v12, v125
    s_add_u32 m0, s49, 10240
    s_add_u32 s46, s45, 11008
    buffer_load_dwordx4 v12, s[16:19], s46 offen lds
    s_add_u32 m0, s49, 14336
    s_add_u32 s46, s45, 31488
    buffer_load_dwordx4 v12, s[16:19], s46 offen lds
    v_xor_b32 v12, 192, v124
    v_add_u32 v12, v12, v125
    s_add_u32 m0, s49, 11264
    s_add_u32 s46, s45, 16128
    buffer_load_dwordx4 v12, s[16:19], s46 offen lds
    s_add_u32 m0, s49, 15360
    s_add_u32 s46, s45, 36608
    buffer_load_dwordx4 v12, s[16:19], s46 offen lds
    s_waitcnt vmcnt(8)
    v_xor_b32 v12, 0, v124
    v_add_u32 v12, v12, v126
    ds_read_b128 a[64:67], v12 offset:0
    ds_read_b128 a[68:71], v12 offset:4096
    v_xor_b32 v12, 64, v124
    v_add_u32 v12, v12, v126
    ds_read_b128 a[72:75], v12 offset:0
    ds_read_b128 a[76:79], v12 offset:4096
    v_xor_b32 v12, 128, v124
    v_add_u32 v12, v12, v126
    ds_read_b128 a[80:83], v12 offset:0
    ds_read_b128 a[84:87], v12 offset:4096
    v_xor_b32 v12, 192, v124
    v_add_u32 v12, v12, v126
    ds_read_b128 a[88:91], v12 offset:0
    ds_read_b128 a[92:95], v12 offset:4096
    s_waitcnt lgkmcnt(0)
    v_xor_b32 v12, 0, v124
    v_add_u32 v12, v12, v125
    s_add_u32 m0, s49, 0
    s_add_u32 s46, s45, 1024
    buffer_load_dwordx4 v12, s[16:19], s46 offen lds
    s_add_u32 m0, s49, 4096
    s_add_u32 s46, s45, 21504
    buffer_load_dwordx4 v12, s[16:19], s46 offen lds
    v_xor_b32 v12, 64, v124
    v_add_u32 v12, v12, v125
    s_add_u32 m0, s49, 1024
    s_add_u32 s46, s45, 6144
    buffer_load_dwordx4 v12, s[16:19], s46 offen lds
    s_add_u32 m0, s49, 5120
    s_add_u32 s46, s45, 26624
    buffer_load_dwordx4 v12, s[16:19], s46 offen lds
    v_xor_b32 v12, 128, v124
    v_add_u32 v12, v12, v125
    s_add_u32 m0, s49, 2048
    s_add_u32 s46, s45, 11264
    buffer_load_dwordx4 v12, s[16:19], s46 offen lds
    s_add_u32 m0, s49, 6144
    s_add_u32 s46, s45, 31744
    buffer_load_dwordx4 v12, s[16:19], s46 offen lds
    v_xor_b32 v12, 192, v124
    v_add_u32 v12, v12, v125
    s_add_u32 m0, s49, 3072
    s_add_u32 s46, s45, 16384
    buffer_load_dwordx4 v12, s[16:19], s46 offen lds
    s_add_u32 m0, s49, 7168
    s_add_u32 s46, s45, 36864
    buffer_load_dwordx4 v12, s[16:19], s46 offen lds
    s_waitcnt vmcnt(8)
    v_xor_b32 v12, 0, v124
    v_add_u32 v12, v12, v126
    ds_read_b128 a[96:99], v12 offset:8192
    ds_read_b128 a[100:103], v12 offset:12288
    v_xor_b32 v12, 64, v124
    v_add_u32 v12, v12, v126
    ds_read_b128 a[104:107], v12 offset:8192
    ds_read_b128 a[108:111], v12 offset:12288
    v_xor_b32 v12, 128, v124
    v_add_u32 v12, v12, v126
    ds_read_b128 a[112:115], v12 offset:8192
    ds_read_b128 a[116:119], v12 offset:12288
    v_xor_b32 v12, 192, v124
    v_add_u32 v12, v12, v126
    ds_read_b128 a[120:123], v12 offset:8192
    ds_read_b128 a[124:127], v12 offset:12288
    s_waitcnt lgkmcnt(0)
    s_waitcnt vmcnt(0)
    v_xor_b32 v12, 0, v124
    v_add_u32 v12, v12, v126
    ds_read_b128 a[128:131], v12 offset:0
    ds_read_b128 a[132:135], v12 offset:4096
    v_xor_b32 v12, 64, v124
    v_add_u32 v12, v12, v126
    ds_read_b128 a[136:139], v12 offset:0
    ds_read_b128 a[140:143], v12 offset:4096
    v_xor_b32 v12, 128, v124
    v_add_u32 v12, v12, v126
    ds_read_b128 a[144:147], v12 offset:0
    ds_read_b128 a[148:151], v12 offset:4096
    v_xor_b32 v12, 192, v124
    v_add_u32 v12, v12, v126
    ds_read_b128 a[152:155], v12 offset:0
    ds_read_b128 a[156:159], v12 offset:4096
    s_waitcnt lgkmcnt(0)
    v_mov_b32 v12, 0
    v_mov_b32 v13, 0
    v_mov_b32 v14, 0
    v_mov_b32 v15, 0
    v_and_b32 v22, 48, v3
    v_add_u32 v22, 155136, v22
    ds_write_b128 v22, v[12:15]
    s_waitcnt lgkmcnt(0)
    s_barrier
    v_lshrrev_b32 v12, 4, v2
    v_mul_u32_u24 v13, 800, v12
    v_bfe_u32 v14, v2, 2, 2
    v_mul_u32_u24 v14, 40, v14
    v_add_u32 v13, v13, v14
    v_add_u32 v13, 155200, v13
    v_and_b32 v14, 3, v2
    v_cmp_eq_u32 s[56:57], v12, v14
    v_mov_b32 v15, 155136
    v_add_u32 v14, 0, v13
    v_cndmask_b32 v14, v15, v14, s[56:57]
    ds_read_b64_tr_b16 a[160:161], v14
    v_add_u32 v14, 160, v13
    v_cndmask_b32 v14, v15, v14, s[56:57]
    ds_read_b64_tr_b16 a[162:163], v14
    v_add_u32 v14, 320, v13
    v_cndmask_b32 v14, v15, v14, s[56:57]
    ds_read_b64_tr_b16 a[164:165], v14
    v_add_u32 v14, 480, v13
    v_cndmask_b32 v14, v15, v14, s[56:57]
    ds_read_b64_tr_b16 a[166:167], v14
    v_add_u32 v14, 640, v13
    v_cndmask_b32 v14, v15, v14, s[56:57]
    ds_read_b64_tr_b16 a[168:169], v14
    v_add_u32 v14, 8, v13
    v_cndmask_b32 v14, v15, v14, s[56:57]
    ds_read_b64_tr_b16 a[170:171], v14
    v_add_u32 v14, 168, v13
    v_cndmask_b32 v14, v15, v14, s[56:57]
    ds_read_b64_tr_b16 a[172:173], v14
    v_add_u32 v14, 328, v13
    v_cndmask_b32 v14, v15, v14, s[56:57]
    ds_read_b64_tr_b16 a[174:175], v14
    v_add_u32 v14, 488, v13
    v_cndmask_b32 v14, v15, v14, s[56:57]
    ds_read_b64_tr_b16 a[176:177], v14
    v_add_u32 v14, 648, v13
    v_cndmask_b32 v14, v15, v14, s[56:57]
    ds_read_b64_tr_b16 a[178:179], v14
    s_waitcnt lgkmcnt(0)
    v_add_u32 v14, 16, v13
    v_cndmask_b32 v14, v15, v14, s[56:57]
    ds_read_b64_tr_b16 a[180:181], v14
    v_add_u32 v14, 176, v13
    v_cndmask_b32 v14, v15, v14, s[56:57]
    ds_read_b64_tr_b16 a[182:183], v14
    v_add_u32 v14, 336, v13
    v_cndmask_b32 v14, v15, v14, s[56:57]
    ds_read_b64_tr_b16 a[184:185], v14
    v_add_u32 v14, 496, v13
    v_cndmask_b32 v14, v15, v14, s[56:57]
    ds_read_b64_tr_b16 a[186:187], v14
    v_add_u32 v14, 656, v13
    v_cndmask_b32 v14, v15, v14, s[56:57]
    ds_read_b64_tr_b16 a[188:189], v14
    v_add_u32 v14, 24, v13
    v_cndmask_b32 v14, v15, v14, s[56:57]
    ds_read_b64_tr_b16 a[190:191], v14
    v_add_u32 v14, 184, v13
    v_cndmask_b32 v14, v15, v14, s[56:57]
    ds_read_b64_tr_b16 a[192:193], v14
    v_add_u32 v14, 344, v13
    v_cndmask_b32 v14, v15, v14, s[56:57]
    ds_read_b64_tr_b16 a[194:195], v14
    v_add_u32 v14, 504, v13
    v_cndmask_b32 v14, v15, v14, s[56:57]
    ds_read_b64_tr_b16 a[196:197], v14
    v_add_u32 v14, 664, v13
    v_cndmask_b32 v14, v15, v14, s[56:57]
    ds_read_b64_tr_b16 a[198:199], v14
    s_waitcnt lgkmcnt(0)
    v_add_u32 v14, 32, v13
    v_cndmask_b32 v14, v15, v14, s[56:57]
    ds_read_b64_tr_b16 a[200:201], v14
    v_add_u32 v14, 192, v13
    v_cndmask_b32 v14, v15, v14, s[56:57]
    ds_read_b64_tr_b16 a[202:203], v14
    v_add_u32 v14, 352, v13
    v_cndmask_b32 v14, v15, v14, s[56:57]
    ds_read_b64_tr_b16 a[204:205], v14
    v_add_u32 v14, 512, v13
    v_cndmask_b32 v14, v15, v14, s[56:57]
    ds_read_b64_tr_b16 a[206:207], v14
    v_add_u32 v14, 672, v13
    v_cndmask_b32 v14, v15, v14, s[56:57]
    ds_read_b64_tr_b16 a[208:209], v14
    v_lshrrev_b32 v12, 4, v2
    v_lshlrev_b32 v12, 3, v12
    v_bfe_u32 v13, v2, 2, 2
    v_add_u32 v12, v12, v13
    v_and_b32 v13, 3, v2
    v_lshlrev_b32 v13, 3, v13
    s_mul_i32 s46, s32, 80
    s_add_u32 s46, s46, 81920
    v_mul_u32_u24 v22, 320, v12
    v_add3_u32 v22, v22, v13, s46
    s_mul_i32 s46, s32, 48
    s_add_u32 s46, s46, 122880
    v_mul_u32_u24 v23, 192, v12
    v_add3_u32 v23, v23, v13, s46
    s_mov_b32 s50, 1069066811
    s_mov_b32 s34, 0
    v_mov_b32 v240, 0
    v_mov_b32 v241, 0
    v_mov_b32 v242, 0
    v_mov_b32 v243, 0
    v_mov_b32 v244, 0
    v_mov_b32 v245, 0
    v_mov_b32 v246, 0
    v_mov_b32 v247, 0
    v_mov_b32 v248, 0
    v_mov_b32 v249, 0
    v_mov_b32 v250, 0
    v_mov_b32 v251, 0
    v_mov_b32 v252, 0
    v_mov_b32 v253, 0
    v_mov_b32 v254, 0
    v_mov_b32 v255, 0
    v_mov_b32 v24, 0
    v_mov_b32 v25, 0
    v_mov_b32 v26, 0
    v_mov_b32 v27, 0
    v_mov_b32 v28, 0
    v_mov_b32 v29, 0
    v_mov_b32 v30, 0
    v_mov_b32 v31, 0
B_GEMM:
    s_cmp_eq_u32 s34, 7
    s_cbranch_scc1 B_G7
    s_waitcnt vmcnt(0)
B_G7:
    s_waitcnt vmcnt(10)
    s_barrier
    ds_read_b64_tr_b16 v[128:129], v11 offset:0
    ds_read_b64_tr_b16 v[130:131], v11 offset:1280
    ds_read_b64_tr_b16 v[132:133], v11 offset:8
    ds_read_b64_tr_b16 v[134:135], v11 offset:1288
    ds_read_b64_tr_b16 v[136:137], v11 offset:16
    ds_read_b64_tr_b16 v[138:139], v11 offset:1296
    ds_read_b64_tr_b16 v[140:141], v11 offset:24
    ds_read_b64_tr_b16 v[142:143], v11 offset:1304
    ds_read_b64_tr_b16 v[144:145], v11 offset:32
    ds_read_b64_tr_b16 v[146:147], v11 offset:1312
    s_waitcnt lgkmcnt(8)
    v_mfma_f32_16x16x32_bf16 v[32:35], v[128:131], a[0:3], 0
    ds_read_b64_tr_b16 v[148:149], v11 offset:5120
    v_mfma_f32_16x16x32_bf16 v[52:55], v[128:131], a[4:7], 0
    ds_read_b64_tr_b16 v[150:151], v11 offset:6400
    s_waitcnt lgkmcnt(8)
    v_mfma_f32_16x16x32_bf16 v[36:39], v[132:135], a[0:3], 0
    ds_read_b64_tr_b16 v[128:129], v11 offset:5128
    v_mfma_f32_16x16x32_bf16 v[56:59], v[132:135], a[4:7], 0
    ds_read_b64_tr_b16 v[130:131], v11 offset:6408
    s_waitcnt lgkmcnt(8)
    v_mfma_f32_16x16x32_bf16 v[40:43], v[136:139], a[0:3], 0
    ds_read_b64_tr_b16 v[132:133], v11 offset:5136
    v_mfma_f32_16x16x32_bf16 v[60:63], v[136:139], a[4:7], 0
    ds_read_b64_tr_b16 v[134:135], v11 offset:6416
    s_waitcnt lgkmcnt(8)
    v_mfma_f32_16x16x32_bf16 v[44:47], v[140:143], a[0:3], 0
    ds_read_b64_tr_b16 v[136:137], v11 offset:5144
    v_mfma_f32_16x16x32_bf16 v[64:67], v[140:143], a[4:7], 0
    ds_read_b64_tr_b16 v[138:139], v11 offset:6424
    s_waitcnt lgkmcnt(8)
    v_mfma_f32_16x16x32_bf16 v[48:51], v[144:147], a[0:3], 0
    ds_read_b64_tr_b16 v[140:141], v11 offset:5152
    v_mfma_f32_16x16x32_bf16 v[68:71], v[144:147], a[4:7], 0
    ds_read_b64_tr_b16 v[142:143], v11 offset:6432
    s_waitcnt lgkmcnt(8)
    v_mfma_f32_16x16x32_bf16 v[32:35], v[148:151], a[8:11], v[32:35]
    ds_read_b64_tr_b16 v[144:145], v11 offset:10240
    v_mfma_f32_16x16x32_bf16 v[52:55], v[148:151], a[12:15], v[52:55]
    ds_read_b64_tr_b16 v[146:147], v11 offset:11520
    s_waitcnt lgkmcnt(8)
    v_mfma_f32_16x16x32_bf16 v[36:39], v[128:131], a[8:11], v[36:39]
    ds_read_b64_tr_b16 v[148:149], v11 offset:10248
    v_mfma_f32_16x16x32_bf16 v[56:59], v[128:131], a[12:15], v[56:59]
    ds_read_b64_tr_b16 v[150:151], v11 offset:11528
    s_waitcnt lgkmcnt(8)
    v_mfma_f32_16x16x32_bf16 v[40:43], v[132:135], a[8:11], v[40:43]
    ds_read_b64_tr_b16 v[128:129], v11 offset:10256
    v_mfma_f32_16x16x32_bf16 v[60:63], v[132:135], a[12:15], v[60:63]
    ds_read_b64_tr_b16 v[130:131], v11 offset:11536
    s_waitcnt lgkmcnt(8)
    v_mfma_f32_16x16x32_bf16 v[44:47], v[136:139], a[8:11], v[44:47]
    ds_read_b64_tr_b16 v[132:133], v11 offset:10264
    v_mfma_f32_16x16x32_bf16 v[64:67], v[136:139], a[12:15], v[64:67]
    ds_read_b64_tr_b16 v[134:135], v11 offset:11544
    s_waitcnt lgkmcnt(8)
    v_mfma_f32_16x16x32_bf16 v[48:51], v[140:143], a[8:11], v[48:51]
    ds_read_b64_tr_b16 v[136:137], v11 offset:10272
    v_mfma_f32_16x16x32_bf16 v[68:71], v[140:143], a[12:15], v[68:71]
    ds_read_b64_tr_b16 v[138:139], v11 offset:11552
    s_waitcnt lgkmcnt(8)
    v_mfma_f32_16x16x32_bf16 v[32:35], v[144:147], a[16:19], v[32:35]
    ds_read_b64_tr_b16 v[140:141], v11 offset:15360
    v_mfma_f32_16x16x32_bf16 v[52:55], v[144:147], a[20:23], v[52:55]
    ds_read_b64_tr_b16 v[142:143], v11 offset:16640
    s_waitcnt lgkmcnt(8)
    v_mfma_f32_16x16x32_bf16 v[36:39], v[148:151], a[16:19], v[36:39]
    ds_read_b64_tr_b16 v[144:145], v11 offset:15368
    v_mfma_f32_16x16x32_bf16 v[56:59], v[148:151], a[20:23], v[56:59]
    ds_read_b64_tr_b16 v[146:147], v11 offset:16648
    s_waitcnt lgkmcnt(8)
    v_mfma_f32_16x16x32_bf16 v[40:43], v[128:131], a[16:19], v[40:43]
    ds_read_b64_tr_b16 v[148:149], v11 offset:15376
    v_mfma_f32_16x16x32_bf16 v[60:63], v[128:131], a[20:23], v[60:63]
    ds_read_b64_tr_b16 v[150:151], v11 offset:16656
    s_waitcnt lgkmcnt(8)
    v_mfma_f32_16x16x32_bf16 v[44:47], v[132:135], a[16:19], v[44:47]
    ds_read_b64_tr_b16 v[128:129], v11 offset:15384
    v_mfma_f32_16x16x32_bf16 v[64:67], v[132:135], a[20:23], v[64:67]
    ds_read_b64_tr_b16 v[130:131], v11 offset:16664
    s_waitcnt lgkmcnt(8)
    s_add_u32 s44, s44, 1
    s_and_b32 s44, s44, 3
    s_mov_b32 s46, 20480
    s_cselect_b32 s46, s46, 4294905856
    v_mfma_f32_16x16x32_bf16 v[48:51], v[136:139], a[16:19], v[48:51]
    ds_read_b64_tr_b16 v[132:133], v11 offset:15392
    v_mfma_f32_16x16x32_bf16 v[68:71], v[136:139], a[20:23], v[68:71]
    ds_read_b64_tr_b16 v[134:135], v11 offset:16672
    s_waitcnt lgkmcnt(8)
    v_add_u32 v11, s46, v11
    s_cmp_eq_u32 s34, 2
    s_cbranch_scc1 BW_67
    s_waitcnt vmcnt(5)
BW_67:
    s_waitcnt vmcnt(13)
    s_barrier
    v_mfma_f32_16x16x32_bf16 v[32:35], v[140:143], a[24:27], v[32:35]
    s_add_u32 m0, s39, 0
    s_nop 0
    buffer_load_dwordx4 v6, s[20:23], s37 offen lds
    ds_read_b64_tr_b16 v[136:137], v11 offset:0
    v_mfma_f32_16x16x32_bf16 v[52:55], v[140:143], a[28:31], v[52:55]
    ds_read_b64_tr_b16 v[138:139], v11 offset:1280
    s_waitcnt lgkmcnt(8)
    v_mfma_f32_16x16x32_bf16 v[36:39], v[144:147], a[24:27], v[36:39]
    s_add_u32 m0, s39, 1024
    s_nop 0
    buffer_load_dwordx4 v7, s[20:23], s37 offen lds
    ds_read_b64_tr_b16 v[140:141], v11 offset:8
    v_mfma_f32_16x16x32_bf16 v[56:59], v[144:147], a[28:31], v[56:59]
    ds_read_b64_tr_b16 v[142:143], v11 offset:1288
    s_waitcnt lgkmcnt(8)
    v_mfma_f32_16x16x32_bf16 v[40:43], v[148:151], a[24:27], v[40:43]
    s_add_u32 m0, s39, 2048
    s_nop 0
    buffer_load_dwordx4 v8, s[20:23], s37 offen lds
    ds_read_b64_tr_b16 v[144:145], v11 offset:16
    v_mfma_f32_16x16x32_bf16 v[60:63], v[148:151], a[28:31], v[60:63]
    ds_read_b64_tr_b16 v[146:147], v11 offset:1296
    s_waitcnt lgkmcnt(8)
    v_mfma_f32_16x16x32_bf16 v[44:47], v[128:131], a[24:27], v[44:47]
    s_add_u32 m0, s39, 3072
    s_nop 0
    buffer_load_dwordx4 v9, s[20:23], s37 offen lds
    ds_read_b64_tr_b16 v[148:149], v11 offset:24
    v_mfma_f32_16x16x32_bf16 v[64:67], v[128:131], a[28:31], v[64:67]
    ds_read_b64_tr_b16 v[150:151], v11 offset:1304
    s_waitcnt lgkmcnt(8)
    v_mfma_f32_16x16x32_bf16 v[48:51], v[132:135], a[24:27], v[48:51]
    s_add_u32 m0, s39, 4096
    s_nop 0
    buffer_load_dwordx4 v10, s[20:23], s37 offen lds
    ds_read_b64_tr_b16 v[128:129], v11 offset:32
    v_mfma_f32_16x16x32_bf16 v[68:71], v[132:135], a[28:31], v[68:71]
    ds_read_b64_tr_b16 v[130:131], v11 offset:1312
    s_waitcnt lgkmcnt(8)
    s_add_u32 s37, s37, s41
    s_add_u32 s38, s38, 1
    s_add_u32 s46, s40, s53
    s_cmp_eq_u32 s38, 4
    s_cselect_b32 s37, s46, s37
    s_add_u32 s46, s40, s42
    s_cmp_eq_u32 s46, s43
    s_cselect_b32 s46, 0, s46
    s_cmp_eq_u32 s38, 5
    s_cselect_b32 s40, s46, s40
    s_cselect_b32 s37, s46, s37
    s_cselect_b32 s38, 0, s38
    s_add_u32 s39, s39, 20480
    s_cmp_ge_u32 s39, 81920
    s_cselect_b32 s46, 81920, 0
    s_sub_u32 s39, s39, s46
    s_cmp_lg_u32 s34, 2
    s_cbranch_scc1 BR_68
    s_waitcnt vmcnt(13)
    v_xor_b32 v12, 0, v124
    v_add_u32 v12, v12, v126
    ds_read_b128 a[0:3], v12 offset:0
    ds_read_b128 a[4:7], v12 offset:4096
    v_xor_b32 v12, 64, v124
    v_add_u32 v12, v12, v126
    ds_read_b128 a[8:11], v12 offset:0
    ds_read_b128 a[12:15], v12 offset:4096
    v_xor_b32 v12, 128, v124
    v_add_u32 v12, v12, v126
    ds_read_b128 a[16:19], v12 offset:0
    ds_read_b128 a[20:23], v12 offset:4096
    v_xor_b32 v12, 192, v124
    v_add_u32 v12, v12, v126
    ds_read_b128 a[24:27], v12 offset:0
    ds_read_b128 a[28:31], v12 offset:4096
    s_waitcnt lgkmcnt(0)
    v_xor_b32 v12, 0, v124
    v_add_u32 v12, v12, v125
    s_add_u32 m0, s49, 0
    s_add_u32 s46, s45, 164352
    buffer_load_dwordx4 v12, s[16:19], s46 offen lds
    s_add_u32 m0, s49, 4096
    s_add_u32 s46, s45, 184832
    buffer_load_dwordx4 v12, s[16:19], s46 offen lds
    v_xor_b32 v12, 64, v124
    v_add_u32 v12, v12, v125
    s_add_u32 m0, s49, 1024
    s_add_u32 s46, s45, 169472
    buffer_load_dwordx4 v12, s[16:19], s46 offen lds
    s_add_u32 m0, s49, 5120
    s_add_u32 s46, s45, 189952
    buffer_load_dwordx4 v12, s[16:19], s46 offen lds
    v_xor_b32 v12, 128, v124
    v_add_u32 v12, v12, v125
    s_add_u32 m0, s49, 2048
    s_add_u32 s46, s45, 174592
    buffer_load_dwordx4 v12, s[16:19], s46 offen lds
    s_add_u32 m0, s49, 6144
    s_add_u32 s46, s45, 195072
    buffer_load_dwordx4 v12, s[16:19], s46 offen lds
    v_xor_b32 v12, 192, v124
    v_add_u32 v12, v12, v125
    s_add_u32 m0, s49, 3072
    s_add_u32 s46, s45, 179712
    buffer_load_dwordx4 v12, s[16:19], s46 offen lds
    s_add_u32 m0, s49, 7168
    s_add_u32 s46, s45, 200192
    buffer_load_dwordx4 v12, s[16:19], s46 offen lds
BR_68:
    v_mfma_f32_16x16x32_bf16 v[32:35], v[136:139], a[32:35], v[32:35]
    ds_read_b64_tr_b16 v[132:133], v11 offset:5120
    v_mfma_f32_16x16x32_bf16 v[52:55], v[136:139], a[36:39], v[52:55]
    ds_read_b64_tr_b16 v[134:135], v11 offset:6400
    s_waitcnt lgkmcnt(8)
    v_mfma_f32_16x16x32_bf16 v[36:39], v[140:143], a[32:35], v[36:39]
    ds_read_b64_tr_b16 v[136:137], v11 offset:5128
    v_mfma_f32_16x16x32_bf16 v[56:59], v[140:143], a[36:39], v[56:59]
    ds_read_b64_tr_b16 v[138:139], v11 offset:6408
    s_waitcnt lgkmcnt(8)
    v_mfma_f32_16x16x32_bf16 v[40:43], v[144:147], a[32:35], v[40:43]
    ds_read_b64_tr_b16 v[140:141], v11 offset:5136
    v_mfma_f32_16x16x32_bf16 v[60:63], v[144:147], a[36:39], v[60:63]
    ds_read_b64_tr_b16 v[142:143], v11 offset:6416
    s_waitcnt lgkmcnt(8)
    v_mfma_f32_16x16x32_bf16 v[44:47], v[148:151], a[32:35], v[44:47]
    ds_read_b64_tr_b16 v[144:145], v11 offset:5144
    v_mfma_f32_16x16x32_bf16 v[64:67], v[148:151], a[36:39], v[64:67]
    ds_read_b64_tr_b16 v[146:147], v11 offset:6424
    s_waitcnt lgkmcnt(8)
    v_mfma_f32_16x16x32_bf16 v[48:51], v[128:131], a[32:35], v[48:51]
    ds_read_b64_tr_b16 v[148:149], v11 offset:5152
    v_mfma_f32_16x16x32_bf16 v[68:71], v[128:131], a[36:39], v[68:71]
    ds_read_b64_tr_b16 v[150:151], v11 offset:6432
    s_waitcnt lgkmcnt(8)
    v_mfma_f32_16x16x32_bf16 v[32:35], v[132:135], a[40:43], v[32:35]
    ds_read_b64_tr_b16 v[128:129], v11 offset:10240
    v_mfma_f32_16x16x32_bf16 v[52:55], v[132:135], a[44:47], v[52:55]
    ds_read_b64_tr_b16 v[130:131], v11 offset:11520
    s_waitcnt lgkmcnt(8)
    v_mfma_f32_16x16x32_bf16 v[36:39], v[136:139], a[40:43], v[36:39]
    ds_read_b64_tr_b16 v[132:133], v11 offset:10248
    v_mfma_f32_16x16x32_bf16 v[56:59], v[136:139], a[44:47], v[56:59]
    ds_read_b64_tr_b16 v[134:135], v11 offset:11528
    s_waitcnt lgkmcnt(8)
    v_mfma_f32_16x16x32_bf16 v[40:43], v[140:143], a[40:43], v[40:43]
    ds_read_b64_tr_b16 v[136:137], v11 offset:10256
    v_mfma_f32_16x16x32_bf16 v[60:63], v[140:143], a[44:47], v[60:63]
    ds_read_b64_tr_b16 v[138:139], v11 offset:11536
    s_waitcnt lgkmcnt(8)
    v_mfma_f32_16x16x32_bf16 v[44:47], v[144:147], a[40:43], v[44:47]
    ds_read_b64_tr_b16 v[140:141], v11 offset:10264
    v_mfma_f32_16x16x32_bf16 v[64:67], v[144:147], a[44:47], v[64:67]
    ds_read_b64_tr_b16 v[142:143], v11 offset:11544
    s_waitcnt lgkmcnt(8)
    v_mfma_f32_16x16x32_bf16 v[48:51], v[148:151], a[40:43], v[48:51]
    ds_read_b64_tr_b16 v[144:145], v11 offset:10272
    v_mfma_f32_16x16x32_bf16 v[68:71], v[148:151], a[44:47], v[68:71]
    ds_read_b64_tr_b16 v[146:147], v11 offset:11552
    s_waitcnt lgkmcnt(8)
    v_mfma_f32_16x16x32_bf16 v[32:35], v[128:131], a[48:51], v[32:35]
    ds_read_b64_tr_b16 v[148:149], v11 offset:15360
    v_mfma_f32_16x16x32_bf16 v[52:55], v[128:131], a[52:55], v[52:55]
    ds_read_b64_tr_b16 v[150:151], v11 offset:16640
    s_waitcnt lgkmcnt(8)
    v_mfma_f32_16x16x32_bf16 v[36:39], v[132:135], a[48:51], v[36:39]
    ds_read_b64_tr_b16 v[128:129], v11 offset:15368
    v_mfma_f32_16x16x32_bf16 v[56:59], v[132:135], a[52:55], v[56:59]
    ds_read_b64_tr_b16 v[130:131], v11 offset:16648
    s_waitcnt lgkmcnt(8)
    v_mfma_f32_16x16x32_bf16 v[40:43], v[136:139], a[48:51], v[40:43]
    ds_read_b64_tr_b16 v[132:133], v11 offset:15376
    v_mfma_f32_16x16x32_bf16 v[60:63], v[136:139], a[52:55], v[60:63]
    ds_read_b64_tr_b16 v[134:135], v11 offset:16656
    s_waitcnt lgkmcnt(8)
    v_mfma_f32_16x16x32_bf16 v[44:47], v[140:143], a[48:51], v[44:47]
    ds_read_b64_tr_b16 v[136:137], v11 offset:15384
    v_mfma_f32_16x16x32_bf16 v[64:67], v[140:143], a[52:55], v[64:67]
    ds_read_b64_tr_b16 v[138:139], v11 offset:16664
    s_waitcnt lgkmcnt(8)
    s_add_u32 s44, s44, 1
    s_and_b32 s44, s44, 3
    s_mov_b32 s46, 20480
    s_cselect_b32 s46, s46, 4294905856
    v_mfma_f32_16x16x32_bf16 v[48:51], v[144:147], a[48:51], v[48:51]
    ds_read_b64_tr_b16 v[140:141], v11 offset:15392
    v_mfma_f32_16x16x32_bf16 v[68:71], v[144:147], a[52:55], v[68:71]
    ds_read_b64_tr_b16 v[142:143], v11 offset:16672
    s_waitcnt lgkmcnt(8)
    v_add_u32 v11, s46, v11
    s_cmp_eq_u32 s34, 2
    s_cbranch_scc1 BW_69
    s_waitcnt vmcnt(5)
BW_69:
    s_waitcnt vmcnt(13)
    s_barrier
    v_mfma_f32_16x16x32_bf16 v[32:35], v[148:151], a[56:59], v[32:35]
    s_add_u32 m0, s39, 0
    s_nop 0
    buffer_load_dwordx4 v0, s[20:23], s37 offen lds
    ds_read_b64_tr_b16 v[144:145], v11 offset:0
    v_mfma_f32_16x16x32_bf16 v[52:55], v[148:151], a[60:63], v[52:55]
    ds_read_b64_tr_b16 v[146:147], v11 offset:1280
    s_waitcnt lgkmcnt(8)
    v_mfma_f32_16x16x32_bf16 v[36:39], v[128:131], a[56:59], v[36:39]
    s_add_u32 m0, s39, 1024
    s_nop 0
    buffer_load_dwordx4 v1, s[20:23], s37 offen lds
    ds_read_b64_tr_b16 v[148:149], v11 offset:8
    v_mfma_f32_16x16x32_bf16 v[56:59], v[128:131], a[60:63], v[56:59]
    ds_read_b64_tr_b16 v[150:151], v11 offset:1288
    s_waitcnt lgkmcnt(8)
    v_mfma_f32_16x16x32_bf16 v[40:43], v[132:135], a[56:59], v[40:43]
    s_add_u32 m0, s39, 2048
    s_nop 0
    buffer_load_dwordx4 v158, s[20:23], s37 offen lds
    ds_read_b64_tr_b16 v[128:129], v11 offset:16
    v_mfma_f32_16x16x32_bf16 v[60:63], v[132:135], a[60:63], v[60:63]
    ds_read_b64_tr_b16 v[130:131], v11 offset:1296
    s_waitcnt lgkmcnt(8)
    v_mfma_f32_16x16x32_bf16 v[44:47], v[136:139], a[56:59], v[44:47]
    s_add_u32 m0, s39, 3072
    s_nop 0
    buffer_load_dwordx4 v159, s[20:23], s37 offen lds
    ds_read_b64_tr_b16 v[132:133], v11 offset:24
    v_mfma_f32_16x16x32_bf16 v[64:67], v[136:139], a[60:63], v[64:67]
    ds_read_b64_tr_b16 v[134:135], v11 offset:1304
    s_waitcnt lgkmcnt(8)
    v_mfma_f32_16x16x32_bf16 v[48:51], v[140:143], a[56:59], v[48:51]
    s_add_u32 m0, s39, 4096
    s_nop 0
    buffer_load_dwordx4 v16, s[20:23], s37 offen lds
    ds_read_b64_tr_b16 v[136:137], v11 offset:32
    v_mfma_f32_16x16x32_bf16 v[68:71], v[140:143], a[60:63], v[68:71]
    ds_read_b64_tr_b16 v[138:139], v11 offset:1312
    s_waitcnt lgkmcnt(8)
    s_add_u32 s37, s37, s41
    s_add_u32 s38, s38, 1
    s_add_u32 s46, s40, s53
    s_cmp_eq_u32 s38, 4
    s_cselect_b32 s37, s46, s37
    s_add_u32 s46, s40, s42
    s_cmp_eq_u32 s46, s43
    s_cselect_b32 s46, 0, s46
    s_cmp_eq_u32 s38, 5
    s_cselect_b32 s40, s46, s40
    s_cselect_b32 s37, s46, s37
    s_cselect_b32 s38, 0, s38
    s_add_u32 s39, s39, 20480
    s_cmp_ge_u32 s39, 81920
    s_cselect_b32 s46, 81920, 0
    s_sub_u32 s39, s39, s46
    s_cmp_lg_u32 s34, 2
    s_cbranch_scc1 BR_70
    s_waitcnt vmcnt(13)
    v_xor_b32 v12, 0, v124
    v_add_u32 v12, v12, v126
    ds_read_b128 a[32:35], v12 offset:8192
    ds_read_b128 a[36:39], v12 offset:12288
    v_xor_b32 v12, 64, v124
    v_add_u32 v12, v12, v126
    ds_read_b128 a[40:43], v12 offset:8192
    ds_read_b128 a[44:47], v12 offset:12288
    v_xor_b32 v12, 128, v124
    v_add_u32 v12, v12, v126
    ds_read_b128 a[48:51], v12 offset:8192
    ds_read_b128 a[52:55], v12 offset:12288
    v_xor_b32 v12, 192, v124
    v_add_u32 v12, v12, v126
    ds_read_b128 a[56:59], v12 offset:8192
    ds_read_b128 a[60:63], v12 offset:12288
    s_waitcnt lgkmcnt(0)
    v_xor_b32 v12, 0, v124
    v_add_u32 v12, v12, v125
    s_add_u32 m0, s49, 8192
    s_add_u32 s46, s45, 164608
    buffer_load_dwordx4 v12, s[16:19], s46 offen lds
    s_add_u32 m0, s49, 12288
    s_add_u32 s46, s45, 185088
    buffer_load_dwordx4 v12, s[16:19], s46 offen lds
    v_xor_b32 v12, 64, v124
    v_add_u32 v12, v12, v125
    s_add_u32 m0, s49, 9216
    s_add_u32 s46, s45, 169728
    buffer_load_dwordx4 v12, s[16:19], s46 offen lds
    s_add_u32 m0, s49, 13312
    s_add_u32 s46, s45, 190208
    buffer_load_dwordx4 v12, s[16:19], s46 offen lds
    v_xor_b32 v12, 128, v124
    v_add_u32 v12, v12, v125
    s_add_u32 m0, s49, 10240
    s_add_u32 s46, s45, 174848
    buffer_load_dwordx4 v12, s[16:19], s46 offen lds
    s_add_u32 m0, s49, 14336
    s_add_u32 s46, s45, 195328
    buffer_load_dwordx4 v12, s[16:19], s46 offen lds
    v_xor_b32 v12, 192, v124
    v_add_u32 v12, v12, v125
    s_add_u32 m0, s49, 11264
    s_add_u32 s46, s45, 179968
    buffer_load_dwordx4 v12, s[16:19], s46 offen lds
    s_add_u32 m0, s49, 15360
    s_add_u32 s46, s45, 200448
    buffer_load_dwordx4 v12, s[16:19], s46 offen lds
BR_70:
    v_mfma_f32_16x16x32_bf16 v[32:35], v[144:147], a[64:67], v[32:35]
    ds_read_b64_tr_b16 v[140:141], v11 offset:5120
    v_mfma_f32_16x16x32_bf16 v[52:55], v[144:147], a[68:71], v[52:55]
    ds_read_b64_tr_b16 v[142:143], v11 offset:6400
    s_waitcnt lgkmcnt(8)
    v_mfma_f32_16x16x32_bf16 v[36:39], v[148:151], a[64:67], v[36:39]
    ds_read_b64_tr_b16 v[144:145], v11 offset:5128
    v_mfma_f32_16x16x32_bf16 v[56:59], v[148:151], a[68:71], v[56:59]
    ds_read_b64_tr_b16 v[146:147], v11 offset:6408
    s_waitcnt lgkmcnt(8)
    v_mfma_f32_16x16x32_bf16 v[40:43], v[128:131], a[64:67], v[40:43]
    ds_read_b64_tr_b16 v[148:149], v11 offset:5136
    v_mfma_f32_16x16x32_bf16 v[60:63], v[128:131], a[68:71], v[60:63]
    ds_read_b64_tr_b16 v[150:151], v11 offset:6416
    s_waitcnt lgkmcnt(8)
    v_mfma_f32_16x16x32_bf16 v[44:47], v[132:135], a[64:67], v[44:47]
    ds_read_b64_tr_b16 v[128:129], v11 offset:5144
    v_mfma_f32_16x16x32_bf16 v[64:67], v[132:135], a[68:71], v[64:67]
    ds_read_b64_tr_b16 v[130:131], v11 offset:6424
    s_waitcnt lgkmcnt(8)
    v_mfma_f32_16x16x32_bf16 v[48:51], v[136:139], a[64:67], v[48:51]
    ds_read_b64_tr_b16 v[132:133], v11 offset:5152
    v_mfma_f32_16x16x32_bf16 v[68:71], v[136:139], a[68:71], v[68:71]
    ds_read_b64_tr_b16 v[134:135], v11 offset:6432
    s_waitcnt lgkmcnt(8)
    v_mfma_f32_16x16x32_bf16 v[32:35], v[140:143], a[72:75], v[32:35]
    ds_read_b64_tr_b16 v[136:137], v11 offset:10240
    v_mfma_f32_16x16x32_bf16 v[52:55], v[140:143], a[76:79], v[52:55]
    ds_read_b64_tr_b16 v[138:139], v11 offset:11520
    s_waitcnt lgkmcnt(8)
    v_mfma_f32_16x16x32_bf16 v[36:39], v[144:147], a[72:75], v[36:39]
    ds_read_b64_tr_b16 v[140:141], v11 offset:10248
    v_mfma_f32_16x16x32_bf16 v[56:59], v[144:147], a[76:79], v[56:59]
    ds_read_b64_tr_b16 v[142:143], v11 offset:11528
    s_waitcnt lgkmcnt(8)
    v_mfma_f32_16x16x32_bf16 v[40:43], v[148:151], a[72:75], v[40:43]
    ds_read_b64_tr_b16 v[144:145], v11 offset:10256
    v_mfma_f32_16x16x32_bf16 v[60:63], v[148:151], a[76:79], v[60:63]
    ds_read_b64_tr_b16 v[146:147], v11 offset:11536
    s_waitcnt lgkmcnt(8)
    v_mfma_f32_16x16x32_bf16 v[44:47], v[128:131], a[72:75], v[44:47]
    ds_read_b64_tr_b16 v[148:149], v11 offset:10264
    v_mfma_f32_16x16x32_bf16 v[64:67], v[128:131], a[76:79], v[64:67]
    ds_read_b64_tr_b16 v[150:151], v11 offset:11544
    s_waitcnt lgkmcnt(8)
    v_mfma_f32_16x16x32_bf16 v[48:51], v[132:135], a[72:75], v[48:51]
    ds_read_b64_tr_b16 v[128:129], v11 offset:10272
    v_mfma_f32_16x16x32_bf16 v[68:71], v[132:135], a[76:79], v[68:71]
    ds_read_b64_tr_b16 v[130:131], v11 offset:11552
    s_waitcnt lgkmcnt(8)
    v_mfma_f32_16x16x32_bf16 v[32:35], v[136:139], a[80:83], v[32:35]
    ds_read_b64_tr_b16 v[132:133], v11 offset:15360
    v_mfma_f32_16x16x32_bf16 v[52:55], v[136:139], a[84:87], v[52:55]
    ds_read_b64_tr_b16 v[134:135], v11 offset:16640
    s_waitcnt lgkmcnt(8)
    v_mfma_f32_16x16x32_bf16 v[36:39], v[140:143], a[80:83], v[36:39]
    ds_read_b64_tr_b16 v[136:137], v11 offset:15368
    v_mfma_f32_16x16x32_bf16 v[56:59], v[140:143], a[84:87], v[56:59]
    ds_read_b64_tr_b16 v[138:139], v11 offset:16648
    s_waitcnt lgkmcnt(8)
    v_mfma_f32_16x16x32_bf16 v[40:43], v[144:147], a[80:83], v[40:43]
    ds_read_b64_tr_b16 v[140:141], v11 offset:15376
    v_mfma_f32_16x16x32_bf16 v[60:63], v[144:147], a[84:87], v[60:63]
    ds_read_b64_tr_b16 v[142:143], v11 offset:16656
    s_waitcnt lgkmcnt(8)
    v_mfma_f32_16x16x32_bf16 v[44:47], v[148:151], a[80:83], v[44:47]
    ds_read_b64_tr_b16 v[144:145], v11 offset:15384
    v_mfma_f32_16x16x32_bf16 v[64:67], v[148:151], a[84:87], v[64:67]
    ds_read_b64_tr_b16 v[146:147], v11 offset:16664
    s_waitcnt lgkmcnt(8)
    s_add_u32 s44, s44, 1
    s_and_b32 s44, s44, 3
    s_mov_b32 s46, 20480
    s_cselect_b32 s46, s46, 4294905856
    v_mfma_f32_16x16x32_bf16 v[48:51], v[128:131], a[80:83], v[48:51]
    ds_read_b64_tr_b16 v[148:149], v11 offset:15392
    v_mfma_f32_16x16x32_bf16 v[68:71], v[128:131], a[84:87], v[68:71]
    ds_read_b64_tr_b16 v[150:151], v11 offset:16672
    s_waitcnt lgkmcnt(8)
    v_add_u32 v11, s46, v11
    s_cmp_eq_u32 s34, 2
    s_cbranch_scc1 BW_71
    s_waitcnt vmcnt(5)
BW_71:
    s_waitcnt vmcnt(13)
    s_barrier
    v_mfma_f32_16x16x32_bf16 v[32:35], v[132:135], a[88:91], v[32:35]
    s_add_u32 m0, s39, 0
    s_nop 0
    buffer_load_dwordx4 v6, s[20:23], s37 offen lds
    ds_read_b64_tr_b16 v[128:129], v11 offset:0
    v_mfma_f32_16x16x32_bf16 v[52:55], v[132:135], a[92:95], v[52:55]
    ds_read_b64_tr_b16 v[130:131], v11 offset:1280
    s_waitcnt lgkmcnt(8)
    v_mfma_f32_16x16x32_bf16 v[36:39], v[136:139], a[88:91], v[36:39]
    s_add_u32 m0, s39, 1024
    s_nop 0
    buffer_load_dwordx4 v7, s[20:23], s37 offen lds
    ds_read_b64_tr_b16 v[132:133], v11 offset:8
    v_mfma_f32_16x16x32_bf16 v[56:59], v[136:139], a[92:95], v[56:59]
    ds_read_b64_tr_b16 v[134:135], v11 offset:1288
    s_waitcnt lgkmcnt(8)
    v_mfma_f32_16x16x32_bf16 v[40:43], v[140:143], a[88:91], v[40:43]
    s_add_u32 m0, s39, 2048
    s_nop 0
    buffer_load_dwordx4 v8, s[20:23], s37 offen lds
    ds_read_b64_tr_b16 v[136:137], v11 offset:16
    v_mfma_f32_16x16x32_bf16 v[60:63], v[140:143], a[92:95], v[60:63]
    ds_read_b64_tr_b16 v[138:139], v11 offset:1296
    s_waitcnt lgkmcnt(8)
    v_mfma_f32_16x16x32_bf16 v[44:47], v[144:147], a[88:91], v[44:47]
    s_add_u32 m0, s39, 3072
    s_nop 0
    buffer_load_dwordx4 v9, s[20:23], s37 offen lds
    ds_read_b64_tr_b16 v[140:141], v11 offset:24
    v_mfma_f32_16x16x32_bf16 v[64:67], v[144:147], a[92:95], v[64:67]
    ds_read_b64_tr_b16 v[142:143], v11 offset:1304
    s_waitcnt lgkmcnt(8)
    v_mfma_f32_16x16x32_bf16 v[48:51], v[148:151], a[88:91], v[48:51]
    s_add_u32 m0, s39, 4096
    s_nop 0
    buffer_load_dwordx4 v10, s[20:23], s37 offen lds
    ds_read_b64_tr_b16 v[144:145], v11 offset:32
    v_mfma_f32_16x16x32_bf16 v[68:71], v[148:151], a[92:95], v[68:71]
    ds_read_b64_tr_b16 v[146:147], v11 offset:1312
    s_waitcnt lgkmcnt(8)
    s_add_u32 s37, s37, s41
    s_add_u32 s38, s38, 1
    s_add_u32 s46, s40, s53
    s_cmp_eq_u32 s38, 4
    s_cselect_b32 s37, s46, s37
    s_add_u32 s46, s40, s42
    s_cmp_eq_u32 s46, s43
    s_cselect_b32 s46, 0, s46
    s_cmp_eq_u32 s38, 5
    s_cselect_b32 s40, s46, s40
    s_cselect_b32 s37, s46, s37
    s_cselect_b32 s38, 0, s38
    s_add_u32 s39, s39, 20480
    s_cmp_ge_u32 s39, 81920
    s_cselect_b32 s46, 81920, 0
    s_sub_u32 s39, s39, s46
    s_cmp_lg_u32 s34, 2
    s_cbranch_scc1 BR_72
    s_waitcnt vmcnt(13)
    v_xor_b32 v12, 0, v124
    v_add_u32 v12, v12, v126
    ds_read_b128 a[64:67], v12 offset:0
    ds_read_b128 a[68:71], v12 offset:4096
    v_xor_b32 v12, 64, v124
    v_add_u32 v12, v12, v126
    ds_read_b128 a[72:75], v12 offset:0
    ds_read_b128 a[76:79], v12 offset:4096
    v_xor_b32 v12, 128, v124
    v_add_u32 v12, v12, v126
    ds_read_b128 a[80:83], v12 offset:0
    ds_read_b128 a[84:87], v12 offset:4096
    v_xor_b32 v12, 192, v124
    v_add_u32 v12, v12, v126
    ds_read_b128 a[88:91], v12 offset:0
    ds_read_b128 a[92:95], v12 offset:4096
    s_waitcnt lgkmcnt(0)
    v_xor_b32 v12, 0, v124
    v_add_u32 v12, v12, v125
    s_add_u32 m0, s49, 0
    s_add_u32 s46, s45, 164864
    buffer_load_dwordx4 v12, s[16:19], s46 offen lds
    s_add_u32 m0, s49, 4096
    s_add_u32 s46, s45, 185344
    buffer_load_dwordx4 v12, s[16:19], s46 offen lds
    v_xor_b32 v12, 64, v124
    v_add_u32 v12, v12, v125
    s_add_u32 m0, s49, 1024
    s_add_u32 s46, s45, 169984
    buffer_load_dwordx4 v12, s[16:19], s46 offen lds
    s_add_u32 m0, s49, 5120
    s_add_u32 s46, s45, 190464
    buffer_load_dwordx4 v12, s[16:19], s46 offen lds
    v_xor_b32 v12, 128, v124
    v_add_u32 v12, v12, v125
    s_add_u32 m0, s49, 2048
    s_add_u32 s46, s45, 175104
    buffer_load_dwordx4 v12, s[16:19], s46 offen lds
    s_add_u32 m0, s49, 6144
    s_add_u32 s46, s45, 195584
    buffer_load_dwordx4 v12, s[16:19], s46 offen lds
    v_xor_b32 v12, 192, v124
    v_add_u32 v12, v12, v125
    s_add_u32 m0, s49, 3072
    s_add_u32 s46, s45, 180224
    buffer_load_dwordx4 v12, s[16:19], s46 offen lds
    s_add_u32 m0, s49, 7168
    s_add_u32 s46, s45, 200704
    buffer_load_dwordx4 v12, s[16:19], s46 offen lds
BR_72:
    v_mfma_f32_16x16x32_bf16 v[32:35], v[128:131], a[96:99], v[32:35]
    ds_read_b64_tr_b16 v[148:149], v11 offset:5120
    v_mfma_f32_16x16x32_bf16 v[52:55], v[128:131], a[100:103], v[52:55]
    ds_read_b64_tr_b16 v[150:151], v11 offset:6400
    s_waitcnt lgkmcnt(8)
    v_mfma_f32_16x16x32_bf16 v[36:39], v[132:135], a[96:99], v[36:39]
    ds_read_b64_tr_b16 v[128:129], v11 offset:5128
    v_mfma_f32_16x16x32_bf16 v[56:59], v[132:135], a[100:103], v[56:59]
    ds_read_b64_tr_b16 v[130:131], v11 offset:6408
    s_waitcnt lgkmcnt(8)
    v_mfma_f32_16x16x32_bf16 v[40:43], v[136:139], a[96:99], v[40:43]
    ds_read_b64_tr_b16 v[132:133], v11 offset:5136
    v_mfma_f32_16x16x32_bf16 v[60:63], v[136:139], a[100:103], v[60:63]
    ds_read_b64_tr_b16 v[134:135], v11 offset:6416
    s_waitcnt lgkmcnt(8)
    v_mfma_f32_16x16x32_bf16 v[44:47], v[140:143], a[96:99], v[44:47]
    ds_read_b64_tr_b16 v[136:137], v11 offset:5144
    v_mfma_f32_16x16x32_bf16 v[64:67], v[140:143], a[100:103], v[64:67]
    ds_read_b64_tr_b16 v[138:139], v11 offset:6424
    s_waitcnt lgkmcnt(8)
    v_mfma_f32_16x16x32_bf16 v[48:51], v[144:147], a[96:99], v[48:51]
    ds_read_b64_tr_b16 v[140:141], v11 offset:5152
    v_mfma_f32_16x16x32_bf16 v[68:71], v[144:147], a[100:103], v[68:71]
    ds_read_b64_tr_b16 v[142:143], v11 offset:6432
    s_waitcnt lgkmcnt(8)
    v_mfma_f32_16x16x32_bf16 v[32:35], v[148:151], a[104:107], v[32:35]
    ds_read_b64_tr_b16 v[144:145], v11 offset:10240
    v_mfma_f32_16x16x32_bf16 v[52:55], v[148:151], a[108:111], v[52:55]
    ds_read_b64_tr_b16 v[146:147], v11 offset:11520
    s_waitcnt lgkmcnt(8)
    v_mfma_f32_16x16x32_bf16 v[36:39], v[128:131], a[104:107], v[36:39]
    ds_read_b64_tr_b16 v[148:149], v11 offset:10248
    v_mfma_f32_16x16x32_bf16 v[56:59], v[128:131], a[108:111], v[56:59]
    ds_read_b64_tr_b16 v[150:151], v11 offset:11528
    s_waitcnt lgkmcnt(8)
    v_mfma_f32_16x16x32_bf16 v[40:43], v[132:135], a[104:107], v[40:43]
    ds_read_b64_tr_b16 v[128:129], v11 offset:10256
    v_mfma_f32_16x16x32_bf16 v[60:63], v[132:135], a[108:111], v[60:63]
    ds_read_b64_tr_b16 v[130:131], v11 offset:11536
    s_waitcnt lgkmcnt(8)
    v_mfma_f32_16x16x32_bf16 v[44:47], v[136:139], a[104:107], v[44:47]
    ds_read_b64_tr_b16 v[132:133], v11 offset:10264
    v_mfma_f32_16x16x32_bf16 v[64:67], v[136:139], a[108:111], v[64:67]
    ds_read_b64_tr_b16 v[134:135], v11 offset:11544
    s_waitcnt lgkmcnt(8)
    v_mfma_f32_16x16x32_bf16 v[48:51], v[140:143], a[104:107], v[48:51]
    ds_read_b64_tr_b16 v[136:137], v11 offset:10272
    v_mfma_f32_16x16x32_bf16 v[68:71], v[140:143], a[108:111], v[68:71]
    ds_read_b64_tr_b16 v[138:139], v11 offset:11552
    s_waitcnt lgkmcnt(8)
    v_mfma_f32_16x16x32_bf16 v[32:35], v[144:147], a[112:115], v[32:35]
    ds_read_b64_tr_b16 v[140:141], v11 offset:15360
    v_mfma_f32_16x16x32_bf16 v[52:55], v[144:147], a[116:119], v[52:55]
    ds_read_b64_tr_b16 v[142:143], v11 offset:16640
    s_waitcnt lgkmcnt(8)
    v_mfma_f32_16x16x32_bf16 v[36:39], v[148:151], a[112:115], v[36:39]
    ds_read_b64_tr_b16 v[144:145], v11 offset:15368
    v_mfma_f32_16x16x32_bf16 v[56:59], v[148:151], a[116:119], v[56:59]
    ds_read_b64_tr_b16 v[146:147], v11 offset:16648
    s_waitcnt lgkmcnt(8)
    v_mfma_f32_16x16x32_bf16 v[40:43], v[128:131], a[112:115], v[40:43]
    ds_read_b64_tr_b16 v[148:149], v11 offset:15376
    v_mfma_f32_16x16x32_bf16 v[60:63], v[128:131], a[116:119], v[60:63]
    ds_read_b64_tr_b16 v[150:151], v11 offset:16656
    s_waitcnt lgkmcnt(8)
    v_mfma_f32_16x16x32_bf16 v[44:47], v[132:135], a[112:115], v[44:47]
    ds_read_b64_tr_b16 v[128:129], v11 offset:15384
    v_mfma_f32_16x16x32_bf16 v[64:67], v[132:135], a[116:119], v[64:67]
    ds_read_b64_tr_b16 v[130:131], v11 offset:16664
    s_waitcnt lgkmcnt(8)
    s_add_u32 s44, s44, 1
    s_and_b32 s44, s44, 3
    s_mov_b32 s46, 20480
    s_cselect_b32 s46, s46, 4294905856
    v_mfma_f32_16x16x32_bf16 v[48:51], v[136:139], a[112:115], v[48:51]
    ds_read_b64_tr_b16 v[132:133], v11 offset:15392
    v_mfma_f32_16x16x32_bf16 v[68:71], v[136:139], a[116:119], v[68:71]
    ds_read_b64_tr_b16 v[134:135], v11 offset:16672
    s_waitcnt lgkmcnt(8)
    v_add_u32 v11, s46, v11
    s_cmp_eq_u32 s34, 2
    s_cbranch_scc1 BW_73
    s_waitcnt vmcnt(5)
BW_73:
    s_waitcnt vmcnt(13)
    s_barrier
    v_mfma_f32_16x16x32_bf16 v[32:35], v[140:143], a[120:123], v[32:35]
    s_add_u32 m0, s39, 0
    s_nop 0
    buffer_load_dwordx4 v6, s[20:23], s37 offen lds
    ds_read_b64_tr_b16 v[136:137], v11 offset:0
    v_mfma_f32_16x16x32_bf16 v[52:55], v[140:143], a[124:127], v[52:55]
    ds_read_b64_tr_b16 v[138:139], v11 offset:1280
    s_waitcnt lgkmcnt(8)
    v_mfma_f32_16x16x32_bf16 v[36:39], v[144:147], a[120:123], v[36:39]
    s_add_u32 m0, s39, 1024
    s_nop 0
    buffer_load_dwordx4 v7, s[20:23], s37 offen lds
    ds_read_b64_tr_b16 v[140:141], v11 offset:8
    v_mfma_f32_16x16x32_bf16 v[56:59], v[144:147], a[124:127], v[56:59]
    ds_read_b64_tr_b16 v[142:143], v11 offset:1288
    s_waitcnt lgkmcnt(8)
    v_mfma_f32_16x16x32_bf16 v[40:43], v[148:151], a[120:123], v[40:43]
    s_add_u32 m0, s39, 2048
    s_nop 0
    buffer_load_dwordx4 v8, s[20:23], s37 offen lds
    ds_read_b64_tr_b16 v[144:145], v11 offset:16
    v_mfma_f32_16x16x32_bf16 v[60:63], v[148:151], a[124:127], v[60:63]
    ds_read_b64_tr_b16 v[146:147], v11 offset:1296
    s_waitcnt lgkmcnt(8)
    v_mfma_f32_16x16x32_bf16 v[44:47], v[128:131], a[120:123], v[44:47]
    s_add_u32 m0, s39, 3072
    s_nop 0
    buffer_load_dwordx4 v9, s[20:23], s37 offen lds
    ds_read_b64_tr_b16 v[148:149], v11 offset:24
    v_mfma_f32_16x16x32_bf16 v[64:67], v[128:131], a[124:127], v[64:67]
    ds_read_b64_tr_b16 v[150:151], v11 offset:1304
    s_waitcnt lgkmcnt(8)
    v_mfma_f32_16x16x32_bf16 v[48:51], v[132:135], a[120:123], v[48:51]
    s_add_u32 m0, s39, 4096
    s_nop 0
    buffer_load_dwordx4 v10, s[20:23], s37 offen lds
    ds_read_b64_tr_b16 v[128:129], v11 offset:32
    v_mfma_f32_16x16x32_bf16 v[68:71], v[132:135], a[124:127], v[68:71]
    ds_read_b64_tr_b16 v[130:131], v11 offset:1312
    s_waitcnt lgkmcnt(8)
    s_add_u32 s37, s37, s41
    s_add_u32 s38, s38, 1
    s_add_u32 s46, s40, s53
    s_cmp_eq_u32 s38, 4
    s_cselect_b32 s37, s46, s37
    s_add_u32 s46, s40, s42
    s_cmp_eq_u32 s46, s43
    s_cselect_b32 s46, 0, s46
    s_cmp_eq_u32 s38, 5
    s_cselect_b32 s40, s46, s40
    s_cselect_b32 s37, s46, s37
    s_cselect_b32 s38, 0, s38
    s_add_u32 s39, s39, 20480
    s_cmp_ge_u32 s39, 81920
    s_cselect_b32 s46, 81920, 0
    s_sub_u32 s39, s39, s46
    s_cmp_lg_u32 s34, 2
    s_cbranch_scc1 BR_74
    s_waitcnt vmcnt(13)
    v_xor_b32 v12, 0, v124
    v_add_u32 v12, v12, v126
    ds_read_b128 a[96:99], v12 offset:8192
    ds_read_b128 a[100:103], v12 offset:12288
    v_xor_b32 v12, 64, v124
    v_add_u32 v12, v12, v126
    ds_read_b128 a[104:107], v12 offset:8192
    ds_read_b128 a[108:111], v12 offset:12288
    v_xor_b32 v12, 128, v124
    v_add_u32 v12, v12, v126
    ds_read_b128 a[112:115], v12 offset:8192
    ds_read_b128 a[116:119], v12 offset:12288
    v_xor_b32 v12, 192, v124
    v_add_u32 v12, v12, v126
    ds_read_b128 a[120:123], v12 offset:8192
    ds_read_b128 a[124:127], v12 offset:12288
    s_waitcnt lgkmcnt(0)
BR_74:
    v_mfma_f32_16x16x32_bf16 v[32:35], v[136:139], a[128:131], v[32:35]
    ds_read_b64_tr_b16 v[132:133], v11 offset:5120
    v_mfma_f32_16x16x32_bf16 v[52:55], v[136:139], a[132:135], v[52:55]
    ds_read_b64_tr_b16 v[134:135], v11 offset:6400
    s_waitcnt lgkmcnt(8)
    v_mfma_f32_16x16x32_bf16 v[36:39], v[140:143], a[128:131], v[36:39]
    ds_read_b64_tr_b16 v[136:137], v11 offset:5128
    v_mfma_f32_16x16x32_bf16 v[56:59], v[140:143], a[132:135], v[56:59]
    ds_read_b64_tr_b16 v[138:139], v11 offset:6408
    s_waitcnt lgkmcnt(8)
    v_mfma_f32_16x16x32_bf16 v[40:43], v[144:147], a[128:131], v[40:43]
    ds_read_b64_tr_b16 v[140:141], v11 offset:5136
    v_mfma_f32_16x16x32_bf16 v[60:63], v[144:147], a[132:135], v[60:63]
    ds_read_b64_tr_b16 v[142:143], v11 offset:6416
    s_waitcnt lgkmcnt(8)
    v_mfma_f32_16x16x32_bf16 v[44:47], v[148:151], a[128:131], v[44:47]
    ds_read_b64_tr_b16 v[144:145], v11 offset:5144
    v_mfma_f32_16x16x32_bf16 v[64:67], v[148:151], a[132:135], v[64:67]
    ds_read_b64_tr_b16 v[146:147], v11 offset:6424
    s_waitcnt lgkmcnt(8)
    v_mfma_f32_16x16x32_bf16 v[48:51], v[128:131], a[128:131], v[48:51]
    ds_read_b64_tr_b16 v[148:149], v11 offset:5152
    v_mfma_f32_16x16x32_bf16 v[68:71], v[128:131], a[132:135], v[68:71]
    ds_read_b64_tr_b16 v[150:151], v11 offset:6432
    s_waitcnt lgkmcnt(8)
    v_mfma_f32_16x16x32_bf16 v[32:35], v[132:135], a[136:139], v[32:35]
    ds_read_b64_tr_b16 v[128:129], v11 offset:10240
    v_mfma_f32_16x16x32_bf16 v[52:55], v[132:135], a[140:143], v[52:55]
    ds_read_b64_tr_b16 v[130:131], v11 offset:11520
    s_waitcnt lgkmcnt(8)
    v_mfma_f32_16x16x32_bf16 v[36:39], v[136:139], a[136:139], v[36:39]
    ds_read_b64_tr_b16 v[132:133], v11 offset:10248
    v_mfma_f32_16x16x32_bf16 v[56:59], v[136:139], a[140:143], v[56:59]
    ds_read_b64_tr_b16 v[134:135], v11 offset:11528
    s_waitcnt lgkmcnt(8)
    v_mfma_f32_16x16x32_bf16 v[40:43], v[140:143], a[136:139], v[40:43]
    ds_read_b64_tr_b16 v[136:137], v11 offset:10256
    v_mfma_f32_16x16x32_bf16 v[60:63], v[140:143], a[140:143], v[60:63]
    ds_read_b64_tr_b16 v[138:139], v11 offset:11536
    s_waitcnt lgkmcnt(8)
    v_mfma_f32_16x16x32_bf16 v[44:47], v[144:147], a[136:139], v[44:47]
    ds_read_b64_tr_b16 v[140:141], v11 offset:10264
    v_mfma_f32_16x16x32_bf16 v[64:67], v[144:147], a[140:143], v[64:67]
    ds_read_b64_tr_b16 v[142:143], v11 offset:11544
    s_waitcnt lgkmcnt(8)
    v_mfma_f32_16x16x32_bf16 v[48:51], v[148:151], a[136:139], v[48:51]
    ds_read_b64_tr_b16 v[144:145], v11 offset:10272
    v_mfma_f32_16x16x32_bf16 v[68:71], v[148:151], a[140:143], v[68:71]
    ds_read_b64_tr_b16 v[146:147], v11 offset:11552
    s_waitcnt lgkmcnt(8)
    v_mfma_f32_16x16x32_bf16 v[32:35], v[128:131], a[144:147], v[32:35]
    ds_read_b64_tr_b16 v[148:149], v11 offset:15360
    v_mfma_f32_16x16x32_bf16 v[52:55], v[128:131], a[148:151], v[52:55]
    ds_read_b64_tr_b16 v[150:151], v11 offset:16640
    s_waitcnt lgkmcnt(8)
    v_mfma_f32_16x16x32_bf16 v[36:39], v[132:135], a[144:147], v[36:39]
    ds_read_b64_tr_b16 v[128:129], v11 offset:15368
    v_mfma_f32_16x16x32_bf16 v[56:59], v[132:135], a[148:151], v[56:59]
    ds_read_b64_tr_b16 v[130:131], v11 offset:16648
    s_waitcnt lgkmcnt(8)
    v_mfma_f32_16x16x32_bf16 v[40:43], v[136:139], a[144:147], v[40:43]
    ds_read_b64_tr_b16 v[132:133], v11 offset:15376
    v_mfma_f32_16x16x32_bf16 v[60:63], v[136:139], a[148:151], v[60:63]
    ds_read_b64_tr_b16 v[134:135], v11 offset:16656
    s_waitcnt lgkmcnt(8)
    v_mfma_f32_16x16x32_bf16 v[44:47], v[140:143], a[144:147], v[44:47]
    ds_read_b64_tr_b16 v[136:137], v11 offset:15384
    v_mfma_f32_16x16x32_bf16 v[64:67], v[140:143], a[148:151], v[64:67]
    ds_read_b64_tr_b16 v[138:139], v11 offset:16664
    s_waitcnt lgkmcnt(8)
    s_add_u32 s44, s44, 1
    s_and_b32 s44, s44, 3
    s_mov_b32 s46, 20480
    s_cselect_b32 s46, s46, 4294905856
    v_mfma_f32_16x16x32_bf16 v[48:51], v[144:147], a[144:147], v[48:51]
    ds_read_b64_tr_b16 v[140:141], v11 offset:15392
    v_mfma_f32_16x16x32_bf16 v[68:71], v[144:147], a[148:151], v[68:71]
    ds_read_b64_tr_b16 v[142:143], v11 offset:16672
    s_waitcnt lgkmcnt(8)
    v_add_u32 v11, s46, v11
    s_cmp_eq_u32 s34, 2
    s_cbranch_scc1 BW_75
    s_waitcnt vmcnt(5)
BW_75:
    s_waitcnt vmcnt(5)
    s_barrier
    v_mfma_f32_16x16x32_bf16 v[32:35], v[148:151], a[152:155], v[32:35]
    s_add_u32 m0, s39, 0
    s_nop 0
    buffer_load_dwordx4 v6, s[20:23], s37 offen lds
    v_mfma_f32_16x16x32_bf16 v[52:55], v[148:151], a[156:159], v[52:55]
    s_waitcnt lgkmcnt(6)
    v_mfma_f32_16x16x32_bf16 v[36:39], v[128:131], a[152:155], v[36:39]
    s_add_u32 m0, s39, 1024
    s_nop 0
    buffer_load_dwordx4 v7, s[20:23], s37 offen lds
    v_mfma_f32_16x16x32_bf16 v[56:59], v[128:131], a[156:159], v[56:59]
    s_waitcnt lgkmcnt(4)
    v_mfma_f32_16x16x32_bf16 v[40:43], v[132:135], a[152:155], v[40:43]
    s_add_u32 m0, s39, 2048
    s_nop 0
    buffer_load_dwordx4 v8, s[20:23], s37 offen lds
    v_mfma_f32_16x16x32_bf16 v[60:63], v[132:135], a[156:159], v[60:63]
    s_waitcnt lgkmcnt(2)
    v_mfma_f32_16x16x32_bf16 v[44:47], v[136:139], a[152:155], v[44:47]
    s_add_u32 m0, s39, 3072
    s_nop 0
    buffer_load_dwordx4 v9, s[20:23], s37 offen lds
    v_mfma_f32_16x16x32_bf16 v[64:67], v[136:139], a[156:159], v[64:67]
    s_waitcnt lgkmcnt(0)
    v_mfma_f32_16x16x32_bf16 v[48:51], v[140:143], a[152:155], v[48:51]
    s_add_u32 m0, s39, 4096
    s_nop 0
    buffer_load_dwordx4 v10, s[20:23], s37 offen lds
    v_mfma_f32_16x16x32_bf16 v[68:71], v[140:143], a[156:159], v[68:71]
    s_add_u32 s37, s37, s41
    s_add_u32 s38, s38, 1
    s_add_u32 s46, s40, s53
    s_cmp_eq_u32 s38, 4
    s_cselect_b32 s37, s46, s37
    s_add_u32 s46, s40, s42
    s_cmp_eq_u32 s46, s43
    s_cselect_b32 s46, 0, s46
    s_cmp_eq_u32 s38, 5
    s_cselect_b32 s40, s46, s40
    s_cselect_b32 s37, s46, s37
    s_cselect_b32 s38, 0, s38
    s_add_u32 s39, s39, 20480
    s_cmp_ge_u32 s39, 81920
    s_cselect_b32 s46, 81920, 0
    s_sub_u32 s39, s39, s46
    s_cmp_lg_u32 s34, 2
    s_cbranch_scc1 BR_76
    s_waitcnt vmcnt(5)
    v_xor_b32 v12, 0, v124
    v_add_u32 v12, v12, v126
    ds_read_b128 a[128:131], v12 offset:0
    ds_read_b128 a[132:135], v12 offset:4096
    v_xor_b32 v12, 64, v124
    v_add_u32 v12, v12, v126
    ds_read_b128 a[136:139], v12 offset:0
    ds_read_b128 a[140:143], v12 offset:4096
    v_xor_b32 v12, 128, v124
    v_add_u32 v12, v12, v126
    ds_read_b128 a[144:147], v12 offset:0
    ds_read_b128 a[148:151], v12 offset:4096
    v_xor_b32 v12, 192, v124
    v_add_u32 v12, v12, v126
    ds_read_b128 a[152:155], v12 offset:0
    ds_read_b128 a[156:159], v12 offset:4096
    s_waitcnt lgkmcnt(0)
BR_76:
    s_cmp_ge_u32 s34, 6
    s_cbranch_scc1 B_OUT
    s_cmp_eq_u32 s34, 1
    s_cbranch_scc1 B_V
    s_cmp_eq_u32 s34, 4
    s_cbranch_scc1 B_V
    v_cvt_pk_bf16_f32 v112, v32, v33
    v_cvt_pk_bf16_f32 v113, v34, v35
    v_cvt_pk_bf16_f32 v114, v36, v37
    v_cvt_pk_bf16_f32 v115, v38, v39
    v_cvt_pk_bf16_f32 v116, v40, v41
    v_cvt_pk_bf16_f32 v117, v42, v43
    v_cvt_pk_bf16_f32 v118, v44, v45
    v_cvt_pk_bf16_f32 v119, v46, v47
    v_cvt_pk_bf16_f32 v120, v48, v49
    v_cvt_pk_bf16_f32 v121, v50, v51
    v_mfma_f32_16x16x32_bf16 v[72:75], a[160:163], v[112:115], 0
    v_mfma_f32_16x16x32_bf16 v[76:79], a[170:173], v[112:115], 0
    v_mfma_f32_16x16x32_bf16 v[80:83], a[180:183], v[112:115], 0
    v_mfma_f32_16x16x32_bf16 v[84:87], a[190:193], v[112:115], 0
    v_mfma_f32_16x16x32_bf16 v[88:91], a[200:203], v[112:115], 0
    v_mfma_f32_16x16x32_bf16 v[72:75], a[164:167], v[116:119], v[72:75]
    v_mfma_f32_16x16x32_bf16 v[76:79], a[174:177], v[116:119], v[76:79]
    v_mfma_f32_16x16x32_bf16 v[80:83], a[184:187], v[116:119], v[80:83]
    v_mfma_f32_16x16x32_bf16 v[84:87], a[194:197], v[116:119], v[84:87]
    v_mfma_f32_16x16x32_bf16 v[88:91], a[204:207], v[116:119], v[88:91]
    v_mfma_f32_16x16x16_bf16 v[72:75], a[168:169], v[120:121], v[72:75]
    v_mfma_f32_16x16x16_bf16 v[76:79], a[178:179], v[120:121], v[76:79]
    v_mfma_f32_16x16x16_bf16 v[80:83], a[188:189], v[120:121], v[80:83]
    v_mfma_f32_16x16x16_bf16 v[84:87], a[198:199], v[120:121], v[84:87]
    v_mfma_f32_16x16x16_bf16 v[88:91], a[208:209], v[120:121], v[88:91]
    s_nop 3
    v_cvt_pk_bf16_f32 v112, v72, v73
    v_cvt_pk_bf16_f32 v113, v74, v75
    v_cvt_pk_bf16_f32 v114, v76, v77
    v_cvt_pk_bf16_f32 v115, v78, v79
    v_cvt_pk_bf16_f32 v116, v80, v81
    v_cvt_pk_bf16_f32 v117, v82, v83
    v_cvt_pk_bf16_f32 v118, v84, v85
    v_cvt_pk_bf16_f32 v119, v86, v87
    v_cvt_pk_bf16_f32 v120, v88, v89
    v_cvt_pk_bf16_f32 v121, v90, v91
    v_lshlrev_b32 v72, 16, v112
    v_and_b32 v73, 0xffff0000, v112
    v_lshlrev_b32 v74, 16, v113
    v_and_b32 v75, 0xffff0000, v113
    v_lshlrev_b32 v76, 16, v114
    v_and_b32 v77, 0xffff0000, v114
    v_lshlrev_b32 v78, 16, v115
    v_and_b32 v79, 0xffff0000, v115
    v_lshlrev_b32 v80, 16, v116
    v_and_b32 v81, 0xffff0000, v116
    v_lshlrev_b32 v82, 16, v117
    v_and_b32 v83, 0xffff0000, v117
    v_lshlrev_b32 v84, 16, v118
    v_and_b32 v85, 0xffff0000, v118
    v_lshlrev_b32 v86, 16, v119
    v_and_b32 v87, 0xffff0000, v119
    v_lshlrev_b32 v88, 16, v120
    v_and_b32 v89, 0xffff0000, v120
    v_lshlrev_b32 v90, 16, v121
    v_and_b32 v91, 0xffff0000, v121
    v_max_f32 v122, v72, v73
    v_min_f32 v123, v72, v73
    v_max3_f32 v122, v122, v74, v75
    v_min3_f32 v123, v123, v74, v75
    v_max3_f32 v122, v122, v76, v77
    v_min3_f32 v123, v123, v76, v77
    v_max3_f32 v122, v122, v78, v79
    v_min3_f32 v123, v123, v78, v79
    v_max3_f32 v122, v122, v80, v81
    v_min3_f32 v123, v123, v80, v81
    v_max3_f32 v122, v122, v82, v83
    v_min3_f32 v123, v123, v82, v83
    v_max3_f32 v122, v122, v84, v85
    v_min3_f32 v123, v123, v84, v85
    v_max3_f32 v122, v122, v86, v87
    v_min3_f32 v123, v123, v86, v87
    v_max3_f32 v122, v122, v88, v89
    v_min3_f32 v123, v123, v88, v89
    v_max3_f32 v122, v122, v90, v91
    v_min3_f32 v123, v123, v90, v91
    v_mul_f32 v122, s50, v122
    v_mul_f32 v123, s50, v123
    v_fma_f32 v92, -v72, s50, v123
    v_fma_f32 v72, v72, s50, -v122
    v_fma_f32 v93, -v73, s50, v123
    v_fma_f32 v73, v73, s50, -v122
    v_fma_f32 v94, -v74, s50, v123
    v_fma_f32 v74, v74, s50, -v122
    v_fma_f32 v95, -v75, s50, v123
    v_fma_f32 v75, v75, s50, -v122
    v_fma_f32 v96, -v76, s50, v123
    v_fma_f32 v76, v76, s50, -v122
    v_fma_f32 v97, -v77, s50, v123
    v_fma_f32 v77, v77, s50, -v122
    v_fma_f32 v98, -v78, s50, v123
    v_fma_f32 v78, v78, s50, -v122
    v_fma_f32 v99, -v79, s50, v123
    v_fma_f32 v79, v79, s50, -v122
    v_fma_f32 v100, -v80, s50, v123
    v_fma_f32 v80, v80, s50, -v122
    v_fma_f32 v101, -v81, s50, v123
    v_fma_f32 v81, v81, s50, -v122
    v_fma_f32 v102, -v82, s50, v123
    v_fma_f32 v82, v82, s50, -v122
    v_fma_f32 v103, -v83, s50, v123
    v_fma_f32 v83, v83, s50, -v122
    v_fma_f32 v104, -v84, s50, v123
    v_fma_f32 v84, v84, s50, -v122
    v_fma_f32 v105, -v85, s50, v123
    v_fma_f32 v85, v85, s50, -v122
    v_fma_f32 v106, -v86, s50, v123
    v_fma_f32 v86, v86, s50, -v122
    v_fma_f32 v107, -v87, s50, v123
    v_fma_f32 v87, v87, s50, -v122
    v_fma_f32 v108, -v88, s50, v123
    v_fma_f32 v88, v88, s50, -v122
    v_fma_f32 v109, -v89, s50, v123
    v_fma_f32 v89, v89, s50, -v122
    v_fma_f32 v110, -v90, s50, v123
    v_fma_f32 v90, v90, s50, -v122
    v_fma_f32 v111, -v91, s50, v123
    v_fma_f32 v91, v91, s50, -v122
    v_exp_f32 v72, v72
    v_exp_f32 v73, v73
    v_exp_f32 v74, v74
    v_exp_f32 v75, v75
    v_exp_f32 v76, v76
    v_exp_f32 v77, v77
    v_exp_f32 v78, v78
    v_exp_f32 v79, v79
    v_exp_f32 v80, v80
    v_exp_f32 v81, v81
    v_exp_f32 v82, v82
    v_exp_f32 v83, v83
    v_exp_f32 v84, v84
    v_exp_f32 v85, v85
    v_exp_f32 v86, v86
    v_exp_f32 v87, v87
    v_exp_f32 v88, v88
    v_exp_f32 v89, v89
    v_exp_f32 v90, v90
    v_exp_f32 v91, v91
    v_exp_f32 v92, v92
    v_exp_f32 v93, v93
    v_exp_f32 v94, v94
    v_exp_f32 v95, v95
    v_exp_f32 v96, v96
    v_exp_f32 v97, v97
    v_exp_f32 v98, v98
    v_exp_f32 v99, v99
    v_exp_f32 v100, v100
    v_exp_f32 v101, v101
    v_exp_f32 v102, v102
    v_exp_f32 v103, v103
    v_exp_f32 v104, v104
    v_exp_f32 v105, v105
    v_exp_f32 v106, v106
    v_exp_f32 v107, v107
    v_exp_f32 v108, v108
    v_exp_f32 v109, v109
    v_exp_f32 v110, v110
    v_exp_f32 v111, v111
    v_add_f32 v122, v72, v73
    v_add_f32 v123, v92, v93
    v_add_f32 v122, v122, v74
    v_add_f32 v123, v123, v94
    v_add_f32 v122, v122, v75
    v_add_f32 v123, v123, v95
    v_add_f32 v122, v122, v76
    v_add_f32 v123, v123, v96
    v_add_f32 v122, v122, v77
    v_add_f32 v123, v123, v97
    v_add_f32 v122, v122, v78
    v_add_f32 v123, v123, v98
    v_add_f32 v122, v122, v79
    v_add_f32 v123, v123, v99
    v_add_f32 v122, v122, v80
    v_add_f32 v123, v123, v100
    v_add_f32 v122, v122, v81
    v_add_f32 v123, v123, v101
    v_add_f32 v122, v122, v82
    v_add_f32 v123, v123, v102
    v_add_f32 v122, v122, v83
    v_add_f32 v123, v123, v103
    v_add_f32 v122, v122, v84
    v_add_f32 v123, v123, v104
    v_add_f32 v122, v122, v85
    v_add_f32 v123, v123, v105
    v_add_f32 v122, v122, v86
    v_add_f32 v123, v123, v106
    v_add_f32 v122, v122, v87
    v_add_f32 v123, v123, v107
    v_add_f32 v122, v122, v88
    v_add_f32 v123, v123, v108
    v_add_f32 v122, v122, v89
    v_add_f32 v123, v123, v109
    v_add_f32 v122, v122, v90
    v_add_f32 v123, v123, v110
    v_add_f32 v122, v122, v91
    v_add_f32 v123, v123, v111
    v_rcp_f32 v122, v122
    v_rcp_f32 v123, v123
    v_mul_f32 v72, v72, v122
    v_mul_f32 v92, v92, v123
    v_mul_f32 v73, v73, v122
    v_mul_f32 v93, v93, v123
    v_mul_f32 v74, v74, v122
    v_mul_f32 v94, v94, v123
    v_mul_f32 v75, v75, v122
    v_mul_f32 v95, v95, v123
    v_mul_f32 v76, v76, v122
    v_mul_f32 v96, v96, v123
    v_mul_f32 v77, v77, v122
    v_mul_f32 v97, v97, v123
    v_mul_f32 v78, v78, v122
    v_mul_f32 v98, v98, v123
    v_mul_f32 v79, v79, v122
    v_mul_f32 v99, v99, v123
    v_mul_f32 v80, v80, v122
    v_mul_f32 v100, v100, v123
    v_mul_f32 v81, v81, v122
    v_mul_f32 v101, v101, v123
    v_mul_f32 v82, v82, v122
    v_mul_f32 v102, v102, v123
    v_mul_f32 v83, v83, v122
    v_mul_f32 v103, v103, v123
    v_mul_f32 v84, v84, v122
    v_mul_f32 v104, v104, v123
    v_mul_f32 v85, v85, v122
    v_mul_f32 v105, v105, v123
    v_mul_f32 v86, v86, v122
    v_mul_f32 v106, v106, v123
    v_mul_f32 v87, v87, v122
    v_mul_f32 v107, v107, v123
    v_mul_f32 v88, v88, v122
    v_mul_f32 v108, v108, v123
    v_mul_f32 v89, v89, v122
    v_mul_f32 v109, v109, v123
    v_mul_f32 v90, v90, v122
    v_mul_f32 v110, v110, v123
    v_mul_f32 v91, v91, v122
    v_mul_f32 v111, v111, v123
    v_cvt_pk_bf16_f32 v32, v72, v73
    v_cvt_pk_bf16_f32 v33, v74, v75
    v_cvt_pk_bf16_f32 v34, v76, v77
    v_cvt_pk_bf16_f32 v35, v78, v79
    v_cvt_pk_bf16_f32 v36, v80, v81
    v_cvt_pk_bf16_f32 v37, v82, v83
    v_cvt_pk_bf16_f32 v38, v84, v85
    v_cvt_pk_bf16_f32 v39, v86, v87
    v_cvt_pk_bf16_f32 v40, v88, v89
    v_cvt_pk_bf16_f32 v41, v90, v91
    v_cvt_pk_bf16_f32 v42, v92, v93
    v_cvt_pk_bf16_f32 v43, v94, v95
    v_cvt_pk_bf16_f32 v44, v96, v97
    v_cvt_pk_bf16_f32 v45, v98, v99
    v_cvt_pk_bf16_f32 v46, v100, v101
    v_cvt_pk_bf16_f32 v47, v102, v103
    v_cvt_pk_bf16_f32 v48, v104, v105
    v_cvt_pk_bf16_f32 v49, v106, v107
    v_cvt_pk_bf16_f32 v50, v108, v109
    v_cvt_pk_bf16_f32 v51, v110, v111
    v_cvt_pk_bf16_f32 v112, v52, v53
    v_cvt_pk_bf16_f32 v113, v54, v55
    v_cvt_pk_bf16_f32 v114, v56, v57
    v_cvt_pk_bf16_f32 v115, v58, v59
    v_cvt_pk_bf16_f32 v116, v60, v61
    v_cvt_pk_bf16_f32 v117, v62, v63
    v_cvt_pk_bf16_f32 v118, v64, v65
    v_cvt_pk_bf16_f32 v119, v66, v67
    v_cvt_pk_bf16_f32 v120, v68, v69
    v_cvt_pk_bf16_f32 v121, v70, v71
    v_mfma_f32_16x16x32_bf16 v[72:75], a[160:163], v[112:115], 0
    v_mfma_f32_16x16x32_bf16 v[76:79], a[170:173], v[112:115], 0
    v_mfma_f32_16x16x32_bf16 v[80:83], a[180:183], v[112:115], 0
    v_mfma_f32_16x16x32_bf16 v[84:87], a[190:193], v[112:115], 0
    v_mfma_f32_16x16x32_bf16 v[88:91], a[200:203], v[112:115], 0
    v_mfma_f32_16x16x32_bf16 v[72:75], a[164:167], v[116:119], v[72:75]
    v_mfma_f32_16x16x32_bf16 v[76:79], a[174:177], v[116:119], v[76:79]
    v_mfma_f32_16x16x32_bf16 v[80:83], a[184:187], v[116:119], v[80:83]
    v_mfma_f32_16x16x32_bf16 v[84:87], a[194:197], v[116:119], v[84:87]
    v_mfma_f32_16x16x32_bf16 v[88:91], a[204:207], v[116:119], v[88:91]
    v_mfma_f32_16x16x16_bf16 v[72:75], a[168:169], v[120:121], v[72:75]
    v_mfma_f32_16x16x16_bf16 v[76:79], a[178:179], v[120:121], v[76:79]
    v_mfma_f32_16x16x16_bf16 v[80:83], a[188:189], v[120:121], v[80:83]
    v_mfma_f32_16x16x16_bf16 v[84:87], a[198:199], v[120:121], v[84:87]
    v_mfma_f32_16x16x16_bf16 v[88:91], a[208:209], v[120:121], v[88:91]
    s_nop 3
    v_cvt_pk_bf16_f32 v112, v72, v73
    v_cvt_pk_bf16_f32 v113, v74, v75
    v_cvt_pk_bf16_f32 v114, v76, v77
    v_cvt_pk_bf16_f32 v115, v78, v79
    v_cvt_pk_bf16_f32 v116, v80, v81
    v_cvt_pk_bf16_f32 v117, v82, v83
    v_cvt_pk_bf16_f32 v118, v84, v85
    v_cvt_pk_bf16_f32 v119, v86, v87
    v_cvt_pk_bf16_f32 v120, v88, v89
    v_cvt_pk_bf16_f32 v121, v90, v91
    v_lshlrev_b32 v72, 16, v112
    v_and_b32 v73, 0xffff0000, v112
    v_lshlrev_b32 v74, 16, v113
    v_and_b32 v75, 0xffff0000, v113
    v_lshlrev_b32 v76, 16, v114
    v_and_b32 v77, 0xffff0000, v114
    v_lshlrev_b32 v78, 16, v115
    v_and_b32 v79, 0xffff0000, v115
    v_lshlrev_b32 v80, 16, v116
    v_and_b32 v81, 0xffff0000, v116
    v_lshlrev_b32 v82, 16, v117
    v_and_b32 v83, 0xffff0000, v117
    v_lshlrev_b32 v84, 16, v118
    v_and_b32 v85, 0xffff0000, v118
    v_lshlrev_b32 v86, 16, v119
    v_and_b32 v87, 0xffff0000, v119
    v_lshlrev_b32 v88, 16, v120
    v_and_b32 v89, 0xffff0000, v120
    v_lshlrev_b32 v90, 16, v121
    v_and_b32 v91, 0xffff0000, v121
    v_max_f32 v122, v72, v73
    v_min_f32 v123, v72, v73
    v_max3_f32 v122, v122, v74, v75
    v_min3_f32 v123, v123, v74, v75
    v_max3_f32 v122, v122, v76, v77
    v_min3_f32 v123, v123, v76, v77
    v_max3_f32 v122, v122, v78, v79
    v_min3_f32 v123, v123, v78, v79
    v_max3_f32 v122, v122, v80, v81
    v_min3_f32 v123, v123, v80, v81
    v_max3_f32 v122, v122, v82, v83
    v_min3_f32 v123, v123, v82, v83
    v_max3_f32 v122, v122, v84, v85
    v_min3_f32 v123, v123, v84, v85
    v_max3_f32 v122, v122, v86, v87
    v_min3_f32 v123, v123, v86, v87
    v_max3_f32 v122, v122, v88, v89
    v_min3_f32 v123, v123, v88, v89
    v_max3_f32 v122, v122, v90, v91
    v_min3_f32 v123, v123, v90, v91
    v_mul_f32 v122, s50, v122
    v_mul_f32 v123, s50, v123
    v_fma_f32 v92, -v72, s50, v123
    v_fma_f32 v72, v72, s50, -v122
    v_fma_f32 v93, -v73, s50, v123
    v_fma_f32 v73, v73, s50, -v122
    v_fma_f32 v94, -v74, s50, v123
    v_fma_f32 v74, v74, s50, -v122
    v_fma_f32 v95, -v75, s50, v123
    v_fma_f32 v75, v75, s50, -v122
    v_fma_f32 v96, -v76, s50, v123
    v_fma_f32 v76, v76, s50, -v122
    v_fma_f32 v97, -v77, s50, v123
    v_fma_f32 v77, v77, s50, -v122
    v_fma_f32 v98, -v78, s50, v123
    v_fma_f32 v78, v78, s50, -v122
    v_fma_f32 v99, -v79, s50, v123
    v_fma_f32 v79, v79, s50, -v122
    v_fma_f32 v100, -v80, s50, v123
    v_fma_f32 v80, v80, s50, -v122
    v_fma_f32 v101, -v81, s50, v123
    v_fma_f32 v81, v81, s50, -v122
    v_fma_f32 v102, -v82, s50, v123
    v_fma_f32 v82, v82, s50, -v122
    v_fma_f32 v103, -v83, s50, v123
    v_fma_f32 v83, v83, s50, -v122
    v_fma_f32 v104, -v84, s50, v123
    v_fma_f32 v84, v84, s50, -v122
    v_fma_f32 v105, -v85, s50, v123
    v_fma_f32 v85, v85, s50, -v122
    v_fma_f32 v106, -v86, s50, v123
    v_fma_f32 v86, v86, s50, -v122
    v_fma_f32 v107, -v87, s50, v123
    v_fma_f32 v87, v87, s50, -v122
    v_fma_f32 v108, -v88, s50, v123
    v_fma_f32 v88, v88, s50, -v122
    v_fma_f32 v109, -v89, s50, v123
    v_fma_f32 v89, v89, s50, -v122
    v_fma_f32 v110, -v90, s50, v123
    v_fma_f32 v90, v90, s50, -v122
    v_fma_f32 v111, -v91, s50, v123
    v_fma_f32 v91, v91, s50, -v122
    v_exp_f32 v72, v72
    v_exp_f32 v73, v73
    v_exp_f32 v74, v74
    v_exp_f32 v75, v75
    v_exp_f32 v76, v76
    v_exp_f32 v77, v77
    v_exp_f32 v78, v78
    v_exp_f32 v79, v79
    v_exp_f32 v80, v80
    v_exp_f32 v81, v81
    v_exp_f32 v82, v82
    v_exp_f32 v83, v83
    v_exp_f32 v84, v84
    v_exp_f32 v85, v85
    v_exp_f32 v86, v86
    v_exp_f32 v87, v87
    v_exp_f32 v88, v88
    v_exp_f32 v89, v89
    v_exp_f32 v90, v90
    v_exp_f32 v91, v91
    v_exp_f32 v92, v92
    v_exp_f32 v93, v93
    v_exp_f32 v94, v94
    v_exp_f32 v95, v95
    v_exp_f32 v96, v96
    v_exp_f32 v97, v97
    v_exp_f32 v98, v98
    v_exp_f32 v99, v99
    v_exp_f32 v100, v100
    v_exp_f32 v101, v101
    v_exp_f32 v102, v102
    v_exp_f32 v103, v103
    v_exp_f32 v104, v104
    v_exp_f32 v105, v105
    v_exp_f32 v106, v106
    v_exp_f32 v107, v107
    v_exp_f32 v108, v108
    v_exp_f32 v109, v109
    v_exp_f32 v110, v110
    v_exp_f32 v111, v111
    v_add_f32 v122, v72, v73
    v_add_f32 v123, v92, v93
    v_add_f32 v122, v122, v74
    v_add_f32 v123, v123, v94
    v_add_f32 v122, v122, v75
    v_add_f32 v123, v123, v95
    v_add_f32 v122, v122, v76
    v_add_f32 v123, v123, v96
    v_add_f32 v122, v122, v77
    v_add_f32 v123, v123, v97
    v_add_f32 v122, v122, v78
    v_add_f32 v123, v123, v98
    v_add_f32 v122, v122, v79
    v_add_f32 v123, v123, v99
    v_add_f32 v122, v122, v80
    v_add_f32 v123, v123, v100
    v_add_f32 v122, v122, v81
    v_add_f32 v123, v123, v101
    v_add_f32 v122, v122, v82
    v_add_f32 v123, v123, v102
    v_add_f32 v122, v122, v83
    v_add_f32 v123, v123, v103
    v_add_f32 v122, v122, v84
    v_add_f32 v123, v123, v104
    v_add_f32 v122, v122, v85
    v_add_f32 v123, v123, v105
    v_add_f32 v122, v122, v86
    v_add_f32 v123, v123, v106
    v_add_f32 v122, v122, v87
    v_add_f32 v123, v123, v107
    v_add_f32 v122, v122, v88
    v_add_f32 v123, v123, v108
    v_add_f32 v122, v122, v89
    v_add_f32 v123, v123, v109
    v_add_f32 v122, v122, v90
    v_add_f32 v123, v123, v110
    v_add_f32 v122, v122, v91
    v_add_f32 v123, v123, v111
    v_rcp_f32 v122, v122
    v_rcp_f32 v123, v123
    v_mul_f32 v72, v72, v122
    v_mul_f32 v92, v92, v123
    v_mul_f32 v73, v73, v122
    v_mul_f32 v93, v93, v123
    v_mul_f32 v74, v74, v122
    v_mul_f32 v94, v94, v123
    v_mul_f32 v75, v75, v122
    v_mul_f32 v95, v95, v123
    v_mul_f32 v76, v76, v122
    v_mul_f32 v96, v96, v123
    v_mul_f32 v77, v77, v122
    v_mul_f32 v97, v97, v123
    v_mul_f32 v78, v78, v122
    v_mul_f32 v98, v98, v123
    v_mul_f32 v79, v79, v122
    v_mul_f32 v99, v99, v123
    v_mul_f32 v80, v80, v122
    v_mul_f32 v100, v100, v123
    v_mul_f32 v81, v81, v122
    v_mul_f32 v101, v101, v123
    v_mul_f32 v82, v82, v122
    v_mul_f32 v102, v102, v123
    v_mul_f32 v83, v83, v122
    v_mul_f32 v103, v103, v123
    v_mul_f32 v84, v84, v122
    v_mul_f32 v104, v104, v123
    v_mul_f32 v85, v85, v122
    v_mul_f32 v105, v105, v123
    v_mul_f32 v86, v86, v122
    v_mul_f32 v106, v106, v123
    v_mul_f32 v87, v87, v122
    v_mul_f32 v107, v107, v123
    v_mul_f32 v88, v88, v122
    v_mul_f32 v108, v108, v123
    v_mul_f32 v89, v89, v122
    v_mul_f32 v109, v109, v123
    v_mul_f32 v90, v90, v122
    v_mul_f32 v110, v110, v123
    v_mul_f32 v91, v91, v122
    v_mul_f32 v111, v111, v123
    v_cvt_pk_bf16_f32 v52, v72, v73
    v_cvt_pk_bf16_f32 v53, v74, v75
    v_cvt_pk_bf16_f32 v54, v76, v77
    v_cvt_pk_bf16_f32 v55, v78, v79
    v_cvt_pk_bf16_f32 v56, v80, v81
    v_cvt_pk_bf16_f32 v57, v82, v83
    v_cvt_pk_bf16_f32 v58, v84, v85
    v_cvt_pk_bf16_f32 v59, v86, v87
    v_cvt_pk_bf16_f32 v60, v88, v89
    v_cvt_pk_bf16_f32 v61, v90, v91
    v_cvt_pk_bf16_f32 v62, v92, v93
    v_cvt_pk_bf16_f32 v63, v94, v95
    v_cvt_pk_bf16_f32 v64, v96, v97
    v_cvt_pk_bf16_f32 v65, v98, v99
    v_cvt_pk_bf16_f32 v66, v100, v101
    v_cvt_pk_bf16_f32 v67, v102, v103
    v_cvt_pk_bf16_f32 v68, v104, v105
    v_cvt_pk_bf16_f32 v69, v106, v107
    v_cvt_pk_bf16_f32 v70, v108, v109
    v_cvt_pk_bf16_f32 v71, v110, v111
    s_cmp_eq_u32 s34, 2
    s_cbranch_scc1 B_Q0
    s_cmp_eq_u32 s34, 5
    s_cbranch_scc1 B_Q1
    ds_write_b128 v18, v[32:35] offset:0
    ds_write_b128 v18, v[36:39] offset:16
    ds_write_b128 v18, v[40:43] offset:32
    ds_write_b128 v18, v[44:47] offset:48
    ds_write_b128 v18, v[48:51] offset:64
    ds_write_b128 v18, v[52:55] offset:5120
    ds_write_b128 v18, v[56:59] offset:5136
    ds_write_b128 v18, v[60:63] offset:5152
    ds_write_b128 v18, v[64:67] offset:5168
    ds_write_b128 v18, v[68:71] offset:5184
    s_waitcnt lgkmcnt(0)
    s_branch B_NEXT
B_Q0:
    v_mov_b32 v160, v32
    v_mov_b32 v161, v33
    v_mov_b32 v162, v34
    v_mov_b32 v163, v35
    v_mov_b32 v164, v36
    v_mov_b32 v165, v37
    v_mov_b32 v166, v38
    v_mov_b32 v167, v39
    v_mov_b32 v168, v40
    v_mov_b32 v169, v41
    v_mov_b32 v170, v42
    v_mov_b32 v171, v43
    v_mov_b32 v172, v44
    v_mov_b32 v173, v45
    v_mov_b32 v174, v46
    v_mov_b32 v175, v47
    v_mov_b32 v176, v48
    v_mov_b32 v177, v49
    v_mov_b32 v178, v50
    v_mov_b32 v179, v51
    v_mov_b32 v180, v52
    v_mov_b32 v181, v53
    v_mov_b32 v182, v54
    v_mov_b32 v183, v55
    v_mov_b32 v184, v56
    v_mov_b32 v185, v57
    v_mov_b32 v186, v58
    v_mov_b32 v187, v59
    v_mov_b32 v188, v60
    v_mov_b32 v189, v61
    v_mov_b32 v190, v62
    v_mov_b32 v191, v63
    v_mov_b32 v192, v64
    v_mov_b32 v193, v65
    v_mov_b32 v194, v66
    v_mov_b32 v195, v67
    v_mov_b32 v196, v68
    v_mov_b32 v197, v69
    v_mov_b32 v198, v70
    v_mov_b32 v199, v71
B_NEXT:
    s_add_u32 s34, s34, 1
    s_branch B_GEMM
B_V:
    v_cvt_pk_bf16_f32 v72, v32, v33
    v_cvt_pk_bf16_f32 v73, v34, v35
    v_cvt_pk_bf16_f32 v74, v36, v37
    v_cvt_pk_bf16_f32 v75, v38, v39
    v_cvt_pk_bf16_f32 v76, v40, v41
    v_cvt_pk_bf16_f32 v77, v42, v43
    v_cvt_pk_bf16_f32 v78, v44, v45
    v_cvt_pk_bf16_f32 v79, v46, v47
    v_cvt_pk_bf16_f32 v80, v48, v49
    v_cvt_pk_bf16_f32 v81, v50, v51
    v_mov_b32 v82, 0x3f80
    v_mov_b32 v83, 0
    ds_write_b128 v19, v[72:75] offset:0
    ds_write_b128 v19, v[76:79] offset:16
    ds_write_b128 v19, v[80:83] offset:32
    v_cvt_pk_bf16_f32 v84, v52, v53
    v_cvt_pk_bf16_f32 v85, v54, v55
    v_cvt_pk_bf16_f32 v86, v56, v57
    v_cvt_pk_bf16_f32 v87, v58, v59
    v_cvt_pk_bf16_f32 v88, v60, v61
    v_cvt_pk_bf16_f32 v89, v62, v63
    v_cvt_pk_bf16_f32 v90, v64, v65
    v_cvt_pk_bf16_f32 v91, v66, v67
    v_cvt_pk_bf16_f32 v92, v68, v69
    v_cvt_pk_bf16_f32 v93, v70, v71
    v_mov_b32 v94, 0x3f80
    v_mov_b32 v95, 0
    ds_write_b128 v19, v[84:87] offset:3072
    ds_write_b128 v19, v[88:91] offset:3088
    ds_write_b128 v19, v[92:95] offset:3104
    s_waitcnt lgkmcnt(0)
    s_barrier
    ds_read_b64_tr_b16 v[32:33], v22 offset:0
    ds_read_b64_tr_b16 v[34:35], v22 offset:1280
    ds_read_b64_tr_b16 v[36:37], v22 offset:32
    ds_read_b64_tr_b16 v[38:39], v22 offset:1312
    ds_read_b64_tr_b16 v[40:41], v22 offset:64
    ds_read_b64_tr_b16 v[42:43], v22 offset:1344
    ds_read_b64_tr_b16 v[44:45], v23 offset:0
    ds_read_b64_tr_b16 v[46:47], v23 offset:768
    ds_read_b64_tr_b16 v[48:49], v23 offset:32
    ds_read_b64_tr_b16 v[50:51], v23 offset:800
    s_waitcnt lgkmcnt(0)
    v_mfma_f32_16x16x32_bf16 v[240:243], v[32:35], v[44:47], v[240:243]
    v_mfma_f32_16x16x32_bf16 v[244:247], v[32:35], v[48:51], v[244:247]
    v_mfma_f32_16x16x32_bf16 v[248:251], v[36:39], v[44:47], v[248:251]
    v_mfma_f32_16x16x32_bf16 v[252:255], v[36:39], v[48:51], v[252:255]
    v_mfma_f32_16x16x32_bf16 v[24:27], v[40:43], v[44:47], v[24:27]
    v_mfma_f32_16x16x32_bf16 v[28:31], v[40:43], v[48:51], v[28:31]
    ds_read_b64_tr_b16 v[52:53], v22 offset:10240
    ds_read_b64_tr_b16 v[54:55], v22 offset:11520
    ds_read_b64_tr_b16 v[56:57], v22 offset:10272
    ds_read_b64_tr_b16 v[58:59], v22 offset:11552
    ds_read_b64_tr_b16 v[60:61], v22 offset:10304
    ds_read_b64_tr_b16 v[62:63], v22 offset:11584
    ds_read_b64_tr_b16 v[64:65], v23 offset:6144
    ds_read_b64_tr_b16 v[66:67], v23 offset:6912
    ds_read_b64_tr_b16 v[68:69], v23 offset:6176
    ds_read_b64_tr_b16 v[70:71], v23 offset:6944
    s_waitcnt lgkmcnt(0)
    v_mfma_f32_16x16x32_bf16 v[240:243], v[52:55], v[64:67], v[240:243]
    v_mfma_f32_16x16x32_bf16 v[244:247], v[52:55], v[68:71], v[244:247]
    v_mfma_f32_16x16x32_bf16 v[248:251], v[56:59], v[64:67], v[248:251]
    v_mfma_f32_16x16x32_bf16 v[252:255], v[56:59], v[68:71], v[252:255]
    v_mfma_f32_16x16x32_bf16 v[24:27], v[60:63], v[64:67], v[24:27]
    v_mfma_f32_16x16x32_bf16 v[28:31], v[60:63], v[68:71], v[28:31]
    ds_read_b64_tr_b16 v[32:33], v22 offset:20480
    ds_read_b64_tr_b16 v[34:35], v22 offset:21760
    ds_read_b64_tr_b16 v[36:37], v22 offset:20512
    ds_read_b64_tr_b16 v[38:39], v22 offset:21792
    ds_read_b64_tr_b16 v[40:41], v22 offset:20544
    ds_read_b64_tr_b16 v[42:43], v22 offset:21824
    ds_read_b64_tr_b16 v[44:45], v23 offset:12288
    ds_read_b64_tr_b16 v[46:47], v23 offset:13056
    ds_read_b64_tr_b16 v[48:49], v23 offset:12320
    ds_read_b64_tr_b16 v[50:51], v23 offset:13088
    s_waitcnt lgkmcnt(0)
    v_mfma_f32_16x16x32_bf16 v[240:243], v[32:35], v[44:47], v[240:243]
    v_mfma_f32_16x16x32_bf16 v[244:247], v[32:35], v[48:51], v[244:247]
    v_mfma_f32_16x16x32_bf16 v[248:251], v[36:39], v[44:47], v[248:251]
    v_mfma_f32_16x16x32_bf16 v[252:255], v[36:39], v[48:51], v[252:255]
    v_mfma_f32_16x16x32_bf16 v[24:27], v[40:43], v[44:47], v[24:27]
    v_mfma_f32_16x16x32_bf16 v[28:31], v[40:43], v[48:51], v[28:31]
    ds_read_b64_tr_b16 v[52:53], v22 offset:30720
    ds_read_b64_tr_b16 v[54:55], v22 offset:32000
    ds_read_b64_tr_b16 v[56:57], v22 offset:30752
    ds_read_b64_tr_b16 v[58:59], v22 offset:32032
    ds_read_b64_tr_b16 v[60:61], v22 offset:30784
    ds_read_b64_tr_b16 v[62:63], v22 offset:32064
    ds_read_b64_tr_b16 v[64:65], v23 offset:18432
    ds_read_b64_tr_b16 v[66:67], v23 offset:19200
    ds_read_b64_tr_b16 v[68:69], v23 offset:18464
    ds_read_b64_tr_b16 v[70:71], v23 offset:19232
    s_waitcnt lgkmcnt(0)
    v_mfma_f32_16x16x32_bf16 v[240:243], v[52:55], v[64:67], v[240:243]
    v_mfma_f32_16x16x32_bf16 v[244:247], v[52:55], v[68:71], v[244:247]
    v_mfma_f32_16x16x32_bf16 v[248:251], v[56:59], v[64:67], v[248:251]
    v_mfma_f32_16x16x32_bf16 v[252:255], v[56:59], v[68:71], v[252:255]
    v_mfma_f32_16x16x32_bf16 v[24:27], v[60:63], v[64:67], v[24:27]
    v_mfma_f32_16x16x32_bf16 v[28:31], v[60:63], v[68:71], v[28:31]
    s_cmp_eq_u32 s34, 4
    s_cbranch_scc1 BP_77
    s_barrier
    v_xor_b32 v12, 0, v124
    v_add_u32 v12, v12, v125
    s_add_u32 m0, s49, 0
    s_add_u32 s46, s45, 163840
    buffer_load_dwordx4 v12, s[16:19], s46 offen lds
    s_add_u32 m0, s49, 4096
    s_add_u32 s46, s45, 184320
    buffer_load_dwordx4 v12, s[16:19], s46 offen lds
    v_xor_b32 v12, 64, v124
    v_add_u32 v12, v12, v125
    s_add_u32 m0, s49, 1024
    s_add_u32 s46, s45, 168960
    buffer_load_dwordx4 v12, s[16:19], s46 offen lds
    s_add_u32 m0, s49, 5120
    s_add_u32 s46, s45, 189440
    buffer_load_dwordx4 v12, s[16:19], s46 offen lds
    v_xor_b32 v12, 128, v124
    v_add_u32 v12, v12, v125
    s_add_u32 m0, s49, 2048
    s_add_u32 s46, s45, 174080
    buffer_load_dwordx4 v12, s[16:19], s46 offen lds
    s_add_u32 m0, s49, 6144
    s_add_u32 s46, s45, 194560
    buffer_load_dwordx4 v12, s[16:19], s46 offen lds
    v_xor_b32 v12, 192, v124
    v_add_u32 v12, v12, v125
    s_add_u32 m0, s49, 3072
    s_add_u32 s46, s45, 179200
    buffer_load_dwordx4 v12, s[16:19], s46 offen lds
    s_add_u32 m0, s49, 7168
    s_add_u32 s46, s45, 199680
    buffer_load_dwordx4 v12, s[16:19], s46 offen lds
    v_xor_b32 v12, 0, v124
    v_add_u32 v12, v12, v125
    s_add_u32 m0, s49, 8192
    s_add_u32 s46, s45, 164096
    buffer_load_dwordx4 v12, s[16:19], s46 offen lds
    s_add_u32 m0, s49, 12288
    s_add_u32 s46, s45, 184576
    buffer_load_dwordx4 v12, s[16:19], s46 offen lds
    v_xor_b32 v12, 64, v124
    v_add_u32 v12, v12, v125
    s_add_u32 m0, s49, 9216
    s_add_u32 s46, s45, 169216
    buffer_load_dwordx4 v12, s[16:19], s46 offen lds
    s_add_u32 m0, s49, 13312
    s_add_u32 s46, s45, 189696
    buffer_load_dwordx4 v12, s[16:19], s46 offen lds
    v_xor_b32 v12, 128, v124
    v_add_u32 v12, v12, v125
    s_add_u32 m0, s49, 10240
    s_add_u32 s46, s45, 174336
    buffer_load_dwordx4 v12, s[16:19], s46 offen lds
    s_add_u32 m0, s49, 14336
    s_add_u32 s46, s45, 194816
    buffer_load_dwordx4 v12, s[16:19], s46 offen lds
    v_xor_b32 v12, 192, v124
    v_add_u32 v12, v12, v125
    s_add_u32 m0, s49, 11264
    s_add_u32 s46, s45, 179456
    buffer_load_dwordx4 v12, s[16:19], s46 offen lds
    s_add_u32 m0, s49, 15360
    s_add_u32 s46, s45, 199936
    buffer_load_dwordx4 v12, s[16:19], s46 offen lds
    s_branch B_NEXT
BP_77:
    s_lshl_b32 s46, s35, 3
    s_add_u32 s46, s46, s36
    s_lshl_b32 s51, s46, 7
    s_add_u32 s51, s51, 4231168
    s_lshl_b32 s46, s46, 2
    s_add_u32 s46, s46, s32
    s_mul_i32 s46, s46, 6144
    s_add_u32 s46, s46, 195624960
    s_add_u32 s47, s46, 4096
    buffer_store_dwordx4 v[240:243], v3, s[8:11], s46 offen offset:0 sc1
    buffer_store_dwordx4 v[244:247], v3, s[8:11], s46 offen offset:1024 sc1
    buffer_store_dwordx4 v[248:251], v3, s[8:11], s46 offen offset:2048 sc1
    buffer_store_dwordx4 v[252:255], v3, s[8:11], s46 offen offset:3072 sc1
    buffer_store_dwordx4 v[24:27], v3, s[8:11], s47 offen offset:0 sc1
    buffer_store_dwordx4 v[28:31], v3, s[8:11], s47 offen offset:1024 sc1
    s_waitcnt vmcnt(0)
    s_barrier
    s_cmp_lg_u32 s32, 0
    s_cbranch_scc1 B_NEXT
    s_mov_b32 s46, 1
    v_mov_b32 v4, s46
    s_mov_b64 exec, 1
    buffer_store_dword v4, v5, s[8:11], s51 offen sc1
    s_mov_b64 exec, -1
    s_branch B_NEXT
B_Q1:
    v_mov_b32 v200, v32
    v_mov_b32 v201, v33
    v_mov_b32 v202, v34
    v_mov_b32 v203, v35
    v_mov_b32 v204, v36
    v_mov_b32 v205, v37
    v_mov_b32 v206, v38
    v_mov_b32 v207, v39
    v_mov_b32 v208, v40
    v_mov_b32 v209, v41
    v_mov_b32 v210, v42
    v_mov_b32 v211, v43
    v_mov_b32 v212, v44
    v_mov_b32 v213, v45
    v_mov_b32 v214, v46
    v_mov_b32 v215, v47
    v_mov_b32 v216, v48
    v_mov_b32 v217, v49
    v_mov_b32 v218, v50
    v_mov_b32 v219, v51
    v_mov_b32 v220, v52
    v_mov_b32 v221, v53
    v_mov_b32 v222, v54
    v_mov_b32 v223, v55
    v_mov_b32 v224, v56
    v_mov_b32 v225, v57
    v_mov_b32 v226, v58
    v_mov_b32 v227, v59
    v_mov_b32 v228, v60
    v_mov_b32 v229, v61
    v_mov_b32 v230, v62
    v_mov_b32 v231, v63
    v_mov_b32 v232, v64
    v_mov_b32 v233, v65
    v_mov_b32 v234, v66
    v_mov_b32 v235, v67
    v_mov_b32 v236, v68
    v_mov_b32 v237, v69
    v_mov_b32 v238, v70
    v_mov_b32 v239, v71
    s_waitcnt vmcnt(0)
    s_barrier
    s_mov_b32 s20, s58
    s_mov_b32 s21, s59
    s_mov_b32 s22, 819200
    s_mov_b32 s23, 0x20000
    s_movk_i32 s46, 6554
    s_and_b32 s50, s35, 6
    s_mul_i32 s50, s50, 160
    s_lshr_b32 s47, s32, 1
    s_mul_i32 s47, s47, 80
    s_and_b32 s51, s32, 1
    s_lshl_b32 s51, s51, 3
    s_add_u32 s47, s47, s51
    s_mul_i32 s47, s47, 1280
    s_mul_i32 s51, s32, 204800
    s_add_u32 s51, s51, 20480
    s_add_u32 s51, s51, s50
    s_add_u32 s47, s47, s50
    v_add_u32 v12, 0, v2
    v_mul_lo_u32 v13, v12, s46
    v_lshrrev_b32 v13, 16, v13
    v_mul_u32_u24 v14, 10, v13
    v_sub_u32 v14, v12, v14
    v_and_b32 v12, 19, v13
    v_bfe_u32 v15, v13, 2, 1
    v_lshl_add_u32 v12, v15, 3, v12
    v_bfe_u32 v15, v13, 3, 1
    v_lshl_add_u32 v12, v15, 2, v12
    v_lshrrev_b32 v13, 3, v12
    v_mul_u32_u24 v13, 12, v13
    v_add_u32 v12, v12, v13
    v_mul_u32_u24 v15, 97280, v15
    v_mul_u32_u24 v12, 1280, v12
    v_lshl_add_u32 v12, v14, 4, v12
    v_add_u32 v6, s47, v12
    v_add3_u32 v0, v12, v15, s51
    v_add_u32 v12, 64, v2
    v_mul_lo_u32 v13, v12, s46
    v_lshrrev_b32 v13, 16, v13
    v_mul_u32_u24 v14, 10, v13
    v_sub_u32 v14, v12, v14
    v_and_b32 v12, 19, v13
    v_bfe_u32 v15, v13, 2, 1
    v_lshl_add_u32 v12, v15, 3, v12
    v_bfe_u32 v15, v13, 3, 1
    v_lshl_add_u32 v12, v15, 2, v12
    v_lshrrev_b32 v13, 3, v12
    v_mul_u32_u24 v13, 12, v13
    v_add_u32 v12, v12, v13
    v_mul_u32_u24 v15, 97280, v15
    v_mul_u32_u24 v12, 1280, v12
    v_lshl_add_u32 v12, v14, 4, v12
    v_add_u32 v7, s47, v12
    v_add3_u32 v1, v12, v15, s51
    v_add_u32 v12, 128, v2
    v_mul_lo_u32 v13, v12, s46
    v_lshrrev_b32 v13, 16, v13
    v_mul_u32_u24 v14, 10, v13
    v_sub_u32 v14, v12, v14
    v_and_b32 v12, 19, v13
    v_bfe_u32 v15, v13, 2, 1
    v_lshl_add_u32 v12, v15, 3, v12
    v_bfe_u32 v15, v13, 3, 1
    v_lshl_add_u32 v12, v15, 2, v12
    v_lshrrev_b32 v13, 3, v12
    v_mul_u32_u24 v13, 12, v13
    v_add_u32 v12, v12, v13
    v_mul_u32_u24 v15, 97280, v15
    v_mul_u32_u24 v12, 1280, v12
    v_lshl_add_u32 v12, v14, 4, v12
    v_add_u32 v8, s47, v12
    v_add3_u32 v158, v12, v15, s51
    v_add_u32 v12, 192, v2
    v_mul_lo_u32 v13, v12, s46
    v_lshrrev_b32 v13, 16, v13
    v_mul_u32_u24 v14, 10, v13
    v_sub_u32 v14, v12, v14
    v_and_b32 v12, 19, v13
    v_bfe_u32 v15, v13, 2, 1
    v_lshl_add_u32 v12, v15, 3, v12
    v_bfe_u32 v15, v13, 3, 1
    v_lshl_add_u32 v12, v15, 2, v12
    v_lshrrev_b32 v13, 3, v12
    v_mul_u32_u24 v13, 12, v13
    v_add_u32 v12, v12, v13
    v_mul_u32_u24 v15, 97280, v15
    v_mul_u32_u24 v12, 1280, v12
    v_lshl_add_u32 v12, v14, 4, v12
    v_add_u32 v9, s47, v12
    v_add3_u32 v159, v12, v15, s51
    v_add_u32 v12, 256, v2
    v_mul_lo_u32 v13, v12, s46
    v_lshrrev_b32 v13, 16, v13
    v_mul_u32_u24 v14, 10, v13
    v_sub_u32 v14, v12, v14
    v_and_b32 v12, 19, v13
    v_bfe_u32 v15, v13, 2, 1
    v_lshl_add_u32 v12, v15, 3, v12
    v_bfe_u32 v15, v13, 3, 1
    v_lshl_add_u32 v12, v15, 2, v12
    v_lshrrev_b32 v13, 3, v12
    v_mul_u32_u24 v13, 12, v13
    v_add_u32 v12, v12, v13
    v_mul_u32_u24 v15, 97280, v15
    v_mul_u32_u24 v12, 1280, v12
    v_lshl_add_u32 v12, v14, 4, v12
    v_add_u32 v10, s47, v12
    v_add3_u32 v16, v12, v15, s51
    s_mov_b32 s37, 0
    s_mov_b32 s40, 0
    s_mov_b32 s38, 0
    s_mul_i32 s39, s32, 5120
    s_mov_b32 s41, 204800
    s_mov_b32 s42, 160
    s_mov_b32 s43, 320
    s_mov_b32 s53, 0
    s_mov_b32 s44, 0
    s_add_u32 m0, s39, 0
    s_nop 0
    buffer_load_dwordx4 v6, s[20:23], s37 offen lds
    s_add_u32 m0, s39, 1024
    s_nop 0
    buffer_load_dwordx4 v7, s[20:23], s37 offen lds
    s_add_u32 m0, s39, 2048
    s_nop 0
    buffer_load_dwordx4 v8, s[20:23], s37 offen lds
    s_add_u32 m0, s39, 3072
    s_nop 0
    buffer_load_dwordx4 v9, s[20:23], s37 offen lds
    s_add_u32 m0, s39, 4096
    s_nop 0
    buffer_load_dwordx4 v10, s[20:23], s37 offen lds
    s_add_u32 s37, s37, s41
    s_add_u32 s38, s38, 1
    s_add_u32 s46, s40, s53
    s_cmp_eq_u32 s38, 4
    s_cselect_b32 s37, s46, s37
    s_add_u32 s46, s40, s42
    s_cmp_eq_u32 s46, s43
    s_cselect_b32 s46, 0, s46
    s_cmp_eq_u32 s38, 5
    s_cselect_b32 s40, s46, s40
    s_cselect_b32 s37, s46, s37
    s_cselect_b32 s38, 0, s38
    s_add_u32 s39, s39, 20480
    s_cmp_ge_u32 s39, 81920
    s_cselect_b32 s46, 81920, 0
    s_sub_u32 s39, s39, s46
    s_add_u32 m0, s39, 0
    s_nop 0
    buffer_load_dwordx4 v6, s[20:23], s37 offen lds
    s_add_u32 m0, s39, 1024
    s_nop 0
    buffer_load_dwordx4 v7, s[20:23], s37 offen lds
    s_add_u32 m0, s39, 2048
    s_nop 0
    buffer_load_dwordx4 v8, s[20:23], s37 offen lds
    s_add_u32 m0, s39, 3072
    s_nop 0
    buffer_load_dwordx4 v9, s[20:23], s37 offen lds
    s_add_u32 m0, s39, 4096
    s_nop 0
    buffer_load_dwordx4 v10, s[20:23], s37 offen lds
    s_add_u32 s37, s37, s41
    s_add_u32 s38, s38, 1
    s_add_u32 s46, s40, s53
    s_cmp_eq_u32 s38, 4
    s_cselect_b32 s37, s46, s37
    s_add_u32 s46, s40, s42
    s_cmp_eq_u32 s46, s43
    s_cselect_b32 s46, 0, s46
    s_cmp_eq_u32 s38, 5
    s_cselect_b32 s40, s46, s40
    s_cselect_b32 s37, s46, s37
    s_cselect_b32 s38, 0, s38
    s_add_u32 s39, s39, 20480
    s_cmp_ge_u32 s39, 81920
    s_cselect_b32 s46, 81920, 0
    s_sub_u32 s39, s39, s46
    s_add_u32 m0, s39, 0
    s_nop 0
    buffer_load_dwordx4 v6, s[20:23], s37 offen lds
    s_add_u32 m0, s39, 1024
    s_nop 0
    buffer_load_dwordx4 v7, s[20:23], s37 offen lds
    s_add_u32 m0, s39, 2048
    s_nop 0
    buffer_load_dwordx4 v8, s[20:23], s37 offen lds
    s_add_u32 m0, s39, 3072
    s_nop 0
    buffer_load_dwordx4 v9, s[20:23], s37 offen lds
    s_add_u32 m0, s39, 4096
    s_nop 0
    buffer_load_dwordx4 v10, s[20:23], s37 offen lds
    s_add_u32 s37, s37, s41
    s_add_u32 s38, s38, 1
    s_add_u32 s46, s40, s53
    s_cmp_eq_u32 s38, 4
    s_cselect_b32 s37, s46, s37
    s_add_u32 s46, s40, s42
    s_cmp_eq_u32 s46, s43
    s_cselect_b32 s46, 0, s46
    s_cmp_eq_u32 s38, 5
    s_cselect_b32 s40, s46, s40
    s_cselect_b32 s37, s46, s37
    s_cselect_b32 s38, 0, s38
    s_add_u32 s39, s39, 20480
    s_cmp_ge_u32 s39, 81920
    s_cselect_b32 s46, 81920, 0
    s_sub_u32 s39, s39, s46
    v_lshrrev_b32 v12, 5, v2
    v_lshlrev_b32 v12, 4, v12
    v_bfe_u32 v13, v2, 4, 1
    v_lshl_add_u32 v12, v13, 2, v12
    v_bfe_u32 v13, v2, 2, 2
    v_add_u32 v12, v12, v13
    v_mul_u32_u24 v12, 160, v12
    v_and_b32 v13, 3, v2
    v_mul_u32_u24 v13, 40, v13
    v_add_u32 v11, v12, v13
    s_lshl_b32 s46, s35, 10
    s_add_u32 s46, s46, 4231168
    v_and_b32 v12, 7, v2
    v_lshl_add_u32 v12, v12, 7, s46
    s_mov_b32 s47, 0
    s_mov_b32 s51, 1
    s_cmp_ge_u32 s47, s51
    s_cbranch_scc1 FWD_79
    s_branch FW_78_go
FW_78:
    s_sleep 2
    s_sub_u32 s33, s33, 1
    s_cbranch_scc1 EXIT
FW_78_go:
    buffer_load_dword v4, v12, s[8:11], 0 offen sc1
    s_waitcnt vmcnt(0)
    v_cmp_gt_u32 vcc, s51, v4
    s_cbranch_vccnz FW_78
    s_mov_b32 s47, s51
    s_add_u32 s4, s51, 1
    v_cmp_gt_u32 vcc, s4, v4
    s_cbranch_vccnz FWD_79
    s_mov_b32 s47, s4
    s_add_u32 s4, s51, 3
    v_cmp_gt_u32 vcc, s4, v4
    s_cbranch_vccnz FWD_79
    s_mov_b32 s47, s4
    s_add_u32 s4, s51, 8
    v_cmp_gt_u32 vcc, s4, v4
    s_cbranch_vccnz FWD_79
    s_mov_b32 s47, s4
    s_add_u32 s4, s51, 20
    v_cmp_gt_u32 vcc, s4, v4
    s_cbranch_vccnz FWD_79
    s_mov_b32 s47, s4
FWD_79:
    s_lshl_b32 s46, s35, 5
    s_add_u32 s46, s46, s32
    s_mul_i32 s46, s46, 6144
    s_add_u32 s46, s46, 195624960
    s_add_u32 s47, s46, 4096
    buffer_load_dwordx4 v[32:35], v3, s[8:11], s46 offen offset:0 sc1
    buffer_load_dwordx4 v[36:39], v3, s[8:11], s46 offen offset:1024 sc1
    buffer_load_dwordx4 v[40:43], v3, s[8:11], s46 offen offset:2048 sc1
    buffer_load_dwordx4 v[44:47], v3, s[8:11], s46 offen offset:3072 sc1
    buffer_load_dwordx4 v[48:51], v3, s[8:11], s47 offen offset:0 sc1
    buffer_load_dwordx4 v[52:55], v3, s[8:11], s47 offen offset:1024 sc1
    s_add_u32 s46, s46, 24576
    s_add_u32 s47, s46, 4096
    buffer_load_dwordx4 v[56:59], v3, s[8:11], s46 offen offset:0 sc1
    buffer_load_dwordx4 v[60:63], v3, s[8:11], s46 offen offset:1024 sc1
    buffer_load_dwordx4 v[64:67], v3, s[8:11], s46 offen offset:2048 sc1
    buffer_load_dwordx4 v[68:71], v3, s[8:11], s46 offen offset:3072 sc1
    buffer_load_dwordx4 v[72:75], v3, s[8:11], s47 offen offset:0 sc1
    buffer_load_dwordx4 v[76:79], v3, s[8:11], s47 offen offset:1024 sc1
    s_add_u32 s46, s46, 24576
    s_add_u32 s47, s46, 4096
    buffer_load_dwordx4 v[80:83], v3, s[8:11], s46 offen offset:0 sc1
    buffer_load_dwordx4 v[84:87], v3, s[8:11], s46 offen offset:1024 sc1
    buffer_load_dwordx4 v[88:91], v3, s[8:11], s46 offen offset:2048 sc1
    buffer_load_dwordx4 v[92:95], v3, s[8:11], s46 offen offset:3072 sc1
    buffer_load_dwordx4 v[96:99], v3, s[8:11], s47 offen offset:0 sc1
    buffer_load_dwordx4 v[100:103], v3, s[8:11], s47 offen offset:1024 sc1
    s_add_u32 s46, s46, 24576
    s_add_u32 s47, s46, 4096
    buffer_load_dwordx4 v[104:107], v3, s[8:11], s46 offen offset:0 sc1
    buffer_load_dwordx4 v[108:111], v3, s[8:11], s46 offen offset:1024 sc1
    buffer_load_dwordx4 v[112:115], v3, s[8:11], s46 offen offset:2048 sc1
    buffer_load_dwordx4 v[116:119], v3, s[8:11], s46 offen offset:3072 sc1
    buffer_load_dwordx4 v[120:123], v3, s[8:11], s47 offen offset:0 sc1
    buffer_load_dwordx4 v[124:127], v3, s[8:11], s47 offen offset:1024 sc1
    s_add_u32 s46, s46, 24576
    s_waitcnt vmcnt(0)
    v_add_f32 v240, v32, v56
    v_add_f32 v240, v240, v80
    v_add_f32 v240, v240, v104
    v_add_f32 v241, v33, v57
    v_add_f32 v241, v241, v81
    v_add_f32 v241, v241, v105
    v_add_f32 v242, v34, v58
    v_add_f32 v242, v242, v82
    v_add_f32 v242, v242, v106
    v_add_f32 v243, v35, v59
    v_add_f32 v243, v243, v83
    v_add_f32 v243, v243, v107
    v_add_f32 v244, v36, v60
    v_add_f32 v244, v244, v84
    v_add_f32 v244, v244, v108
    v_add_f32 v245, v37, v61
    v_add_f32 v245, v245, v85
    v_add_f32 v245, v245, v109
    v_add_f32 v246, v38, v62
    v_add_f32 v246, v246, v86
    v_add_f32 v246, v246, v110
    v_add_f32 v247, v39, v63
    v_add_f32 v247, v247, v87
    v_add_f32 v247, v247, v111
    v_add_f32 v248, v40, v64
    v_add_f32 v248, v248, v88
    v_add_f32 v248, v248, v112
    v_add_f32 v249, v41, v65
    v_add_f32 v249, v249, v89
    v_add_f32 v249, v249, v113
    v_add_f32 v250, v42, v66
    v_add_f32 v250, v250, v90
    v_add_f32 v250, v250, v114
    v_add_f32 v251, v43, v67
    v_add_f32 v251, v251, v91
    v_add_f32 v251, v251, v115
    v_add_f32 v252, v44, v68
    v_add_f32 v252, v252, v92
    v_add_f32 v252, v252, v116
    v_add_f32 v253, v45, v69
    v_add_f32 v253, v253, v93
    v_add_f32 v253, v253, v117
    v_add_f32 v254, v46, v70
    v_add_f32 v254, v254, v94
    v_add_f32 v254, v254, v118
    v_add_f32 v255, v47, v71
    v_add_f32 v255, v255, v95
    v_add_f32 v255, v255, v119
    v_add_f32 v24, v48, v72
    v_add_f32 v24, v24, v96
    v_add_f32 v24, v24, v120
    v_add_f32 v25, v49, v73
    v_add_f32 v25, v25, v97
    v_add_f32 v25, v25, v121
    v_add_f32 v26, v50, v74
    v_add_f32 v26, v26, v98
    v_add_f32 v26, v26, v122
    v_add_f32 v27, v51, v75
    v_add_f32 v27, v27, v99
    v_add_f32 v27, v27, v123
    v_add_f32 v28, v52, v76
    v_add_f32 v28, v28, v100
    v_add_f32 v28, v28, v124
    v_add_f32 v29, v53, v77
    v_add_f32 v29, v29, v101
    v_add_f32 v29, v29, v125
    v_add_f32 v30, v54, v78
    v_add_f32 v30, v30, v102
    v_add_f32 v30, v30, v126
    v_add_f32 v31, v55, v79
    v_add_f32 v31, v31, v103
    v_add_f32 v31, v31, v127
    s_add_u32 s47, s46, 4096
    buffer_load_dwordx4 v[32:35], v3, s[8:11], s46 offen offset:0 sc1
    buffer_load_dwordx4 v[36:39], v3, s[8:11], s46 offen offset:1024 sc1
    buffer_load_dwordx4 v[40:43], v3, s[8:11], s46 offen offset:2048 sc1
    buffer_load_dwordx4 v[44:47], v3, s[8:11], s46 offen offset:3072 sc1
    buffer_load_dwordx4 v[48:51], v3, s[8:11], s47 offen offset:0 sc1
    buffer_load_dwordx4 v[52:55], v3, s[8:11], s47 offen offset:1024 sc1
    s_add_u32 s46, s46, 24576
    s_add_u32 s47, s46, 4096
    buffer_load_dwordx4 v[56:59], v3, s[8:11], s46 offen offset:0 sc1
    buffer_load_dwordx4 v[60:63], v3, s[8:11], s46 offen offset:1024 sc1
    buffer_load_dwordx4 v[64:67], v3, s[8:11], s46 offen offset:2048 sc1
    buffer_load_dwordx4 v[68:71], v3, s[8:11], s46 offen offset:3072 sc1
    buffer_load_dwordx4 v[72:75], v3, s[8:11], s47 offen offset:0 sc1
    buffer_load_dwordx4 v[76:79], v3, s[8:11], s47 offen offset:1024 sc1
    s_add_u32 s46, s46, 24576
    s_add_u32 s47, s46, 4096
    buffer_load_dwordx4 v[80:83], v3, s[8:11], s46 offen offset:0 sc1
    buffer_load_dwordx4 v[84:87], v3, s[8:11], s46 offen offset:1024 sc1
    buffer_load_dwordx4 v[88:91], v3, s[8:11], s46 offen offset:2048 sc1
    buffer_load_dwordx4 v[92:95], v3, s[8:11], s46 offen offset:3072 sc1
    buffer_load_dwordx4 v[96:99], v3, s[8:11], s47 offen offset:0 sc1
    buffer_load_dwordx4 v[100:103], v3, s[8:11], s47 offen offset:1024 sc1
    s_add_u32 s46, s46, 24576
    s_add_u32 s47, s46, 4096
    buffer_load_dwordx4 v[104:107], v3, s[8:11], s46 offen offset:0 sc1
    buffer_load_dwordx4 v[108:111], v3, s[8:11], s46 offen offset:1024 sc1
    buffer_load_dwordx4 v[112:115], v3, s[8:11], s46 offen offset:2048 sc1
    buffer_load_dwordx4 v[116:119], v3, s[8:11], s46 offen offset:3072 sc1
    buffer_load_dwordx4 v[120:123], v3, s[8:11], s47 offen offset:0 sc1
    buffer_load_dwordx4 v[124:127], v3, s[8:11], s47 offen offset:1024 sc1
    s_add_u32 s46, s46, 24576
    s_waitcnt vmcnt(0)
    v_add_f32 v240, v240, v32
    v_add_f32 v240, v240, v56
    v_add_f32 v240, v240, v80
    v_add_f32 v240, v240, v104
    v_add_f32 v241, v241, v33
    v_add_f32 v241, v241, v57
    v_add_f32 v241, v241, v81
    v_add_f32 v241, v241, v105
    v_add_f32 v242, v242, v34
    v_add_f32 v242, v242, v58
    v_add_f32 v242, v242, v82
    v_add_f32 v242, v242, v106
    v_add_f32 v243, v243, v35
    v_add_f32 v243, v243, v59
    v_add_f32 v243, v243, v83
    v_add_f32 v243, v243, v107
    v_add_f32 v244, v244, v36
    v_add_f32 v244, v244, v60
    v_add_f32 v244, v244, v84
    v_add_f32 v244, v244, v108
    v_add_f32 v245, v245, v37
    v_add_f32 v245, v245, v61
    v_add_f32 v245, v245, v85
    v_add_f32 v245, v245, v109
    v_add_f32 v246, v246, v38
    v_add_f32 v246, v246, v62
    v_add_f32 v246, v246, v86
    v_add_f32 v246, v246, v110
    v_add_f32 v247, v247, v39
    v_add_f32 v247, v247, v63
    v_add_f32 v247, v247, v87
    v_add_f32 v247, v247, v111
    v_add_f32 v248, v248, v40
    v_add_f32 v248, v248, v64
    v_add_f32 v248, v248, v88
    v_add_f32 v248, v248, v112
    v_add_f32 v249, v249, v41
    v_add_f32 v249, v249, v65
    v_add_f32 v249, v249, v89
    v_add_f32 v249, v249, v113
    v_add_f32 v250, v250, v42
    v_add_f32 v250, v250, v66
    v_add_f32 v250, v250, v90
    v_add_f32 v250, v250, v114
    v_add_f32 v251, v251, v43
    v_add_f32 v251, v251, v67
    v_add_f32 v251, v251, v91
    v_add_f32 v251, v251, v115
    v_add_f32 v252, v252, v44
    v_add_f32 v252, v252, v68
    v_add_f32 v252, v252, v92
    v_add_f32 v252, v252, v116
    v_add_f32 v253, v253, v45
    v_add_f32 v253, v253, v69
    v_add_f32 v253, v253, v93
    v_add_f32 v253, v253, v117
    v_add_f32 v254, v254, v46
    v_add_f32 v254, v254, v70
    v_add_f32 v254, v254, v94
    v_add_f32 v254, v254, v118
    v_add_f32 v255, v255, v47
    v_add_f32 v255, v255, v71
    v_add_f32 v255, v255, v95
    v_add_f32 v255, v255, v119
    v_add_f32 v24, v24, v48
    v_add_f32 v24, v24, v72
    v_add_f32 v24, v24, v96
    v_add_f32 v24, v24, v120
    v_add_f32 v25, v25, v49
    v_add_f32 v25, v25, v73
    v_add_f32 v25, v25, v97
    v_add_f32 v25, v25, v121
    v_add_f32 v26, v26, v50
    v_add_f32 v26, v26, v74
    v_add_f32 v26, v26, v98
    v_add_f32 v26, v26, v122
    v_add_f32 v27, v27, v51
    v_add_f32 v27, v27, v75
    v_add_f32 v27, v27, v99
    v_add_f32 v27, v27, v123
    v_add_f32 v28, v28, v52
    v_add_f32 v28, v28, v76
    v_add_f32 v28, v28, v100
    v_add_f32 v28, v28, v124
    v_add_f32 v29, v29, v53
    v_add_f32 v29, v29, v77
    v_add_f32 v29, v29, v101
    v_add_f32 v29, v29, v125
    v_add_f32 v30, v30, v54
    v_add_f32 v30, v30, v78
    v_add_f32 v30, v30, v102
    v_add_f32 v30, v30, v126
    v_add_f32 v31, v31, v55
    v_add_f32 v31, v31, v79
    v_add_f32 v31, v31, v103
    v_add_f32 v31, v31, v127
    s_mul_i32 s46, s32, 1920
    s_add_u32 s46, s46, 147456
    v_and_b32 v12, 15, v2
    v_mul_u32_u24 v13, 80, v12
    v_lshrrev_b32 v14, 4, v2
    v_lshl_add_u32 v13, v14, 3, v13
    v_add_u32 v13, s46, v13
    s_mov_b32 s54, 0x001f001f
    s_mov_b32 s55, 0x001f001f
    v_cvt_pk_bf16_f32 v240, v240, v241
    v_cvt_pk_bf16_f32 v241, v242, v243
    s_mov_b64 exec, -1
    ds_write_b64 v13, v[240:241] offset:0
    s_mov_b64 exec, -1
    v_cvt_pk_bf16_f32 v244, v244, v245
    v_cvt_pk_bf16_f32 v245, v246, v247
    s_mov_b64 exec, s[54:55]
    ds_write_b64 v13, v[244:245] offset:1280
    s_mov_b64 exec, -1
    v_cvt_pk_bf16_f32 v248, v248, v249
    v_cvt_pk_bf16_f32 v249, v250, v251
    s_mov_b64 exec, -1
    ds_write_b64 v13, v[248:249] offset:32
    s_mov_b64 exec, -1
    v_cvt_pk_bf16_f32 v252, v252, v253
    v_cvt_pk_bf16_f32 v253, v254, v255
    s_mov_b64 exec, s[54:55]
    ds_write_b64 v13, v[252:253] offset:1312
    s_mov_b64 exec, -1
    v_cvt_pk_bf16_f32 v24, v24, v25
    v_cvt_pk_bf16_f32 v25, v26, v27
    s_mov_b64 exec, -1
    s_mov_b32 exec_hi, 0
    ds_write_b64 v13, v[24:25] offset:64
    s_mov_b64 exec, -1
    v_cvt_pk_bf16_f32 v28, v28, v29
    v_cvt_pk_bf16_f32 v29, v30, v31
    s_mov_b64 exec, s[54:55]
    s_mov_b32 exec_hi, 0
    ds_write_b64 v13, v[28:29] offset:1344
    s_mov_b64 exec, -1
    s_waitcnt lgkmcnt(0)
    s_barrier
    v_mul_u32_u24 v13, 1920, v14
    v_and_b32 v15, 3, v2
    v_mul_u32_u24 v15, 80, v15
    v_add_u32 v13, v13, v15
    v_add_u32 v13, 147456, v13
    v_bfe_u32 v15, v2, 2, 2
    v_cmp_eq_u32 s[56:57], v14, v15
    v_mov_b32 v12, 155136
    v_add_u32 v14, 0, v13
    v_cndmask_b32 v14, v12, v14, s[56:57]
    ds_read_b128 a[0:3], v14
    v_add_u32 v14, 16, v13
    v_cndmask_b32 v14, v12, v14, s[56:57]
    ds_read_b128 a[4:7], v14
    v_add_u32 v14, 32, v13
    v_cndmask_b32 v14, v12, v14, s[56:57]
    ds_read_b128 a[8:11], v14
    v_add_u32 v14, 48, v13
    v_cndmask_b32 v14, v12, v14, s[56:57]
    ds_read_b128 a[12:15], v14
    v_add_u32 v14, 64, v13
    v_cndmask_b32 v14, v12, v14, s[56:57]
    ds_read_b128 a[16:19], v14
    v_add_u32 v14, 320, v13
    v_cndmask_b32 v14, v12, v14, s[56:57]
    ds_read_b128 a[20:23], v14
    v_add_u32 v14, 336, v13
    v_cndmask_b32 v14, v12, v14, s[56:57]
    ds_read_b128 a[24:27], v14
    v_add_u32 v14, 352, v13
    v_cndmask_b32 v14, v12, v14, s[56:57]
    ds_read_b128 a[28:31], v14
    v_add_u32 v14, 368, v13
    v_cndmask_b32 v14, v12, v14, s[56:57]
    ds_read_b128 a[32:35], v14
    v_add_u32 v14, 384, v13
    v_cndmask_b32 v14, v12, v14, s[56:57]
    ds_read_b128 a[36:39], v14
    s_waitcnt lgkmcnt(0)
    v_add_u32 v14, 640, v13
    v_cndmask_b32 v14, v12, v14, s[56:57]
    ds_read_b128 a[40:43], v14
    v_add_u32 v14, 656, v13
    v_cndmask_b32 v14, v12, v14, s[56:57]
    ds_read_b128 a[44:47], v14
    v_add_u32 v14, 672, v13
    v_cndmask_b32 v14, v12, v14, s[56:57]
    ds_read_b128 a[48:51], v14
    v_add_u32 v14, 688, v13
    v_cndmask_b32 v14, v12, v14, s[56:57]
    ds_read_b128 a[52:55], v14
    v_add_u32 v14, 704, v13
    v_cndmask_b32 v14, v12, v14, s[56:57]
    ds_read_b128 a[56:59], v14
    v_add_u32 v14, 960, v13
    v_cndmask_b32 v14, v12, v14, s[56:57]
    ds_read_b128 a[60:63], v14
    v_add_u32 v14, 976, v13
    v_cndmask_b32 v14, v12, v14, s[56:57]
    ds_read_b128 a[64:67], v14
    v_add_u32 v14, 992, v13
    v_cndmask_b32 v14, v12, v14, s[56:57]
    ds_read_b128 a[68:71], v14
    v_add_u32 v14, 1008, v13
    v_cndmask_b32 v14, v12, v14, s[56:57]
    ds_read_b128 a[72:75], v14
    v_add_u32 v14, 1024, v13
    v_cndmask_b32 v14, v12, v14, s[56:57]
    ds_read_b128 a[76:79], v14
    s_waitcnt lgkmcnt(0)
    v_add_u32 v14, 1280, v13
    v_cndmask_b32 v14, v12, v14, s[56:57]
    ds_read_b128 a[80:83], v14
    v_add_u32 v14, 1296, v13
    v_cndmask_b32 v14, v12, v14, s[56:57]
    ds_read_b128 a[84:87], v14
    v_add_u32 v14, 1312, v13
    v_cndmask_b32 v14, v12, v14, s[56:57]
    ds_read_b128 a[88:91], v14
    v_add_u32 v14, 1328, v13
    v_cndmask_b32 v14, v12, v14, s[56:57]
    ds_read_b128 a[92:95], v14
    v_add_u32 v14, 1344, v13
    v_cndmask_b32 v14, v12, v14, s[56:57]
    ds_read_b128 a[96:99], v14
    v_add_u32 v14, 1600, v13
    v_cndmask_b32 v14, v12, v14, s[56:57]
    ds_read_b128 a[100:103], v14
    v_add_u32 v14, 1616, v13
    v_cndmask_b32 v14, v12, v14, s[56:57]
    ds_read_b128 a[104:107], v14
    v_add_u32 v14, 1632, v13
    v_cndmask_b32 v14, v12, v14, s[56:57]
    ds_read_b128 a[108:111], v14
    v_add_u32 v14, 1648, v13
    v_cndmask_b32 v14, v12, v14, s[56:57]
    ds_read_b128 a[112:115], v14
    v_add_u32 v14, 1664, v13
    v_cndmask_b32 v14, v12, v14, s[56:57]
    ds_read_b128 a[116:119], v14
    s_waitcnt lgkmcnt(0)
    s_mul_i32 s46, s35, 2560
    s_add_u32 s46, s46, s48
    s_mov_b32 s47, 897988541
    v_mfma_f32_16x16x32_bf16 v[32:35], a[0:3], v[160:163], 0
    v_mfma_f32_16x16x32_bf16 v[36:39], a[20:23], v[160:163], 0
    v_mfma_f32_16x16x32_bf16 v[40:43], a[40:43], v[160:163], 0
    v_mfma_f32_16x16x32_bf16 v[44:47], a[60:63], v[160:163], 0
    v_mfma_f32_16x16x32_bf16 v[48:51], a[80:83], v[160:163], 0
    v_mfma_f32_16x16x32_bf16 v[52:55], a[100:103], v[160:163], 0
    v_mfma_f32_16x16x32_bf16 v[32:35], a[4:7], v[164:167], v[32:35]
    v_mfma_f32_16x16x32_bf16 v[36:39], a[24:27], v[164:167], v[36:39]
    v_mfma_f32_16x16x32_bf16 v[40:43], a[44:47], v[164:167], v[40:43]
    v_mfma_f32_16x16x32_bf16 v[44:47], a[64:67], v[164:167], v[44:47]
    v_mfma_f32_16x16x32_bf16 v[48:51], a[84:87], v[164:167], v[48:51]
    v_mfma_f32_16x16x32_bf16 v[52:55], a[104:107], v[164:167], v[52:55]
    v_mfma_f32_16x16x32_bf16 v[32:35], a[8:11], v[168:171], v[32:35]
    v_mfma_f32_16x16x32_bf16 v[36:39], a[28:31], v[168:171], v[36:39]
    v_mfma_f32_16x16x32_bf16 v[40:43], a[48:51], v[168:171], v[40:43]
    v_mfma_f32_16x16x32_bf16 v[44:47], a[68:71], v[168:171], v[44:47]
    v_mfma_f32_16x16x32_bf16 v[48:51], a[88:91], v[168:171], v[48:51]
    v_mfma_f32_16x16x32_bf16 v[52:55], a[108:111], v[168:171], v[52:55]
    v_mfma_f32_16x16x32_bf16 v[32:35], a[12:15], v[172:175], v[32:35]
    v_mfma_f32_16x16x32_bf16 v[36:39], a[32:35], v[172:175], v[36:39]
    v_mfma_f32_16x16x32_bf16 v[40:43], a[52:55], v[172:175], v[40:43]
    v_mfma_f32_16x16x32_bf16 v[44:47], a[72:75], v[172:175], v[44:47]
    v_mfma_f32_16x16x32_bf16 v[48:51], a[92:95], v[172:175], v[48:51]
    v_mfma_f32_16x16x32_bf16 v[52:55], a[112:115], v[172:175], v[52:55]
    v_mfma_f32_16x16x32_bf16 v[32:35], a[16:19], v[176:179], v[32:35]
    v_mfma_f32_16x16x32_bf16 v[36:39], a[36:39], v[176:179], v[36:39]
    v_mfma_f32_16x16x32_bf16 v[40:43], a[56:59], v[176:179], v[40:43]
    v_mfma_f32_16x16x32_bf16 v[44:47], a[76:79], v[176:179], v[44:47]
    v_mfma_f32_16x16x32_bf16 v[48:51], a[96:99], v[176:179], v[48:51]
    v_mfma_f32_16x16x32_bf16 v[52:55], a[116:119], v[176:179], v[52:55]
    s_nop 7
    v_add_f32 v52, s47, v52
    v_rcp_f32 v52, v52
    s_nop 0
    v_mul_f32 v32, v32, v52
    v_mul_f32 v33, v33, v52
    v_mul_f32 v34, v34, v52
    v_mul_f32 v35, v35, v52
    v_mul_f32 v36, v36, v52
    v_mul_f32 v37, v37, v52
    v_mul_f32 v38, v38, v52
    v_mul_f32 v39, v39, v52
    v_mul_f32 v40, v40, v52
    v_mul_f32 v41, v41, v52
    v_mul_f32 v42, v42, v52
    v_mul_f32 v43, v43, v52
    v_mul_f32 v44, v44, v52
    v_mul_f32 v45, v45, v52
    v_mul_f32 v46, v46, v52
    v_mul_f32 v47, v47, v52
    v_mul_f32 v48, v48, v52
    v_mul_f32 v49, v49, v52
    v_mul_f32 v50, v50, v52
    v_mul_f32 v51, v51, v52
    v_cvt_pk_bf16_f32 v88, v32, v33
    v_cvt_pk_bf16_f32 v89, v34, v35
    v_cvt_pk_bf16_f32 v90, v36, v37
    v_cvt_pk_bf16_f32 v91, v38, v39
    v_cvt_pk_bf16_f32 v92, v40, v41
    v_cvt_pk_bf16_f32 v93, v42, v43
    v_cvt_pk_bf16_f32 v94, v44, v45
    v_cvt_pk_bf16_f32 v95, v46, v47
    v_cvt_pk_bf16_f32 v96, v48, v49
    v_cvt_pk_bf16_f32 v97, v50, v51
    s_add_u32 s51, s46, 0
    buffer_store_dwordx4 v[88:91], v3, s[8:11], s51 offen sc1
    buffer_store_dwordx4 v[92:95], v3, s[8:11], s51 offen offset:1024 sc1
    buffer_store_dwordx2 v[96:97], v20, s[8:11], s51 offen offset:2048 sc1
    v_mfma_f32_16x16x32_bf16 v[56:59], a[0:3], v[180:183], 0
    v_mfma_f32_16x16x32_bf16 v[60:63], a[20:23], v[180:183], 0
    v_mfma_f32_16x16x32_bf16 v[64:67], a[40:43], v[180:183], 0
    v_mfma_f32_16x16x32_bf16 v[68:71], a[60:63], v[180:183], 0
    v_mfma_f32_16x16x32_bf16 v[72:75], a[80:83], v[180:183], 0
    v_mfma_f32_16x16x32_bf16 v[76:79], a[100:103], v[180:183], 0
    v_mfma_f32_16x16x32_bf16 v[56:59], a[4:7], v[184:187], v[56:59]
    v_mfma_f32_16x16x32_bf16 v[60:63], a[24:27], v[184:187], v[60:63]
    v_mfma_f32_16x16x32_bf16 v[64:67], a[44:47], v[184:187], v[64:67]
    v_mfma_f32_16x16x32_bf16 v[68:71], a[64:67], v[184:187], v[68:71]
    v_mfma_f32_16x16x32_bf16 v[72:75], a[84:87], v[184:187], v[72:75]
    v_mfma_f32_16x16x32_bf16 v[76:79], a[104:107], v[184:187], v[76:79]
    v_mfma_f32_16x16x32_bf16 v[56:59], a[8:11], v[188:191], v[56:59]
    v_mfma_f32_16x16x32_bf16 v[60:63], a[28:31], v[188:191], v[60:63]
    v_mfma_f32_16x16x32_bf16 v[64:67], a[48:51], v[188:191], v[64:67]
    v_mfma_f32_16x16x32_bf16 v[68:71], a[68:71], v[188:191], v[68:71]
    v_mfma_f32_16x16x32_bf16 v[72:75], a[88:91], v[188:191], v[72:75]
    v_mfma_f32_16x16x32_bf16 v[76:79], a[108:111], v[188:191], v[76:79]
    v_mfma_f32_16x16x32_bf16 v[56:59], a[12:15], v[192:195], v[56:59]
    v_mfma_f32_16x16x32_bf16 v[60:63], a[32:35], v[192:195], v[60:63]
    v_mfma_f32_16x16x32_bf16 v[64:67], a[52:55], v[192:195], v[64:67]
    v_mfma_f32_16x16x32_bf16 v[68:71], a[72:75], v[192:195], v[68:71]
    v_mfma_f32_16x16x32_bf16 v[72:75], a[92:95], v[192:195], v[72:75]
    v_mfma_f32_16x16x32_bf16 v[76:79], a[112:115], v[192:195], v[76:79]
    v_mfma_f32_16x16x32_bf16 v[56:59], a[16:19], v[196:199], v[56:59]
    v_mfma_f32_16x16x32_bf16 v[60:63], a[36:39], v[196:199], v[60:63]
    v_mfma_f32_16x16x32_bf16 v[64:67], a[56:59], v[196:199], v[64:67]
    v_mfma_f32_16x16x32_bf16 v[68:71], a[76:79], v[196:199], v[68:71]
    v_mfma_f32_16x16x32_bf16 v[72:75], a[96:99], v[196:199], v[72:75]
    v_mfma_f32_16x16x32_bf16 v[76:79], a[116:119], v[196:199], v[76:79]
    s_nop 7
    v_add_f32 v76, s47, v76
    v_rcp_f32 v76, v76
    s_nop 0
    v_mul_f32 v56, v56, v76
    v_mul_f32 v57, v57, v76
    v_mul_f32 v58, v58, v76
    v_mul_f32 v59, v59, v76
    v_mul_f32 v60, v60, v76
    v_mul_f32 v61, v61, v76
    v_mul_f32 v62, v62, v76
    v_mul_f32 v63, v63, v76
    v_mul_f32 v64, v64, v76
    v_mul_f32 v65, v65, v76
    v_mul_f32 v66, v66, v76
    v_mul_f32 v67, v67, v76
    v_mul_f32 v68, v68, v76
    v_mul_f32 v69, v69, v76
    v_mul_f32 v70, v70, v76
    v_mul_f32 v71, v71, v76
    v_mul_f32 v72, v72, v76
    v_mul_f32 v73, v73, v76
    v_mul_f32 v74, v74, v76
    v_mul_f32 v75, v75, v76
    v_cvt_pk_bf16_f32 v100, v56, v57
    v_cvt_pk_bf16_f32 v101, v58, v59
    v_cvt_pk_bf16_f32 v102, v60, v61
    v_cvt_pk_bf16_f32 v103, v62, v63
    v_cvt_pk_bf16_f32 v104, v64, v65
    v_cvt_pk_bf16_f32 v105, v66, v67
    v_cvt_pk_bf16_f32 v106, v68, v69
    v_cvt_pk_bf16_f32 v107, v70, v71
    v_cvt_pk_bf16_f32 v108, v72, v73
    v_cvt_pk_bf16_f32 v109, v74, v75
    s_add_u32 s51, s46, 20480
    buffer_store_dwordx4 v[100:103], v3, s[8:11], s51 offen sc1
    buffer_store_dwordx4 v[104:107], v3, s[8:11], s51 offen offset:1024 sc1
    buffer_store_dwordx2 v[108:109], v20, s[8:11], s51 offen offset:2048 sc1
    v_mfma_f32_16x16x32_bf16 v[32:35], a[0:3], v[200:203], 0
    v_mfma_f32_16x16x32_bf16 v[36:39], a[20:23], v[200:203], 0
    v_mfma_f32_16x16x32_bf16 v[40:43], a[40:43], v[200:203], 0
    v_mfma_f32_16x16x32_bf16 v[44:47], a[60:63], v[200:203], 0
    v_mfma_f32_16x16x32_bf16 v[48:51], a[80:83], v[200:203], 0
    v_mfma_f32_16x16x32_bf16 v[52:55], a[100:103], v[200:203], 0
    v_mfma_f32_16x16x32_bf16 v[32:35], a[4:7], v[204:207], v[32:35]
    v_mfma_f32_16x16x32_bf16 v[36:39], a[24:27], v[204:207], v[36:39]
    v_mfma_f32_16x16x32_bf16 v[40:43], a[44:47], v[204:207], v[40:43]
    v_mfma_f32_16x16x32_bf16 v[44:47], a[64:67], v[204:207], v[44:47]
    v_mfma_f32_16x16x32_bf16 v[48:51], a[84:87], v[204:207], v[48:51]
    v_mfma_f32_16x16x32_bf16 v[52:55], a[104:107], v[204:207], v[52:55]
    v_mfma_f32_16x16x32_bf16 v[32:35], a[8:11], v[208:211], v[32:35]
    v_mfma_f32_16x16x32_bf16 v[36:39], a[28:31], v[208:211], v[36:39]
    v_mfma_f32_16x16x32_bf16 v[40:43], a[48:51], v[208:211], v[40:43]
    v_mfma_f32_16x16x32_bf16 v[44:47], a[68:71], v[208:211], v[44:47]
    v_mfma_f32_16x16x32_bf16 v[48:51], a[88:91], v[208:211], v[48:51]
    v_mfma_f32_16x16x32_bf16 v[52:55], a[108:111], v[208:211], v[52:55]
    v_mfma_f32_16x16x32_bf16 v[32:35], a[12:15], v[212:215], v[32:35]
    v_mfma_f32_16x16x32_bf16 v[36:39], a[32:35], v[212:215], v[36:39]
    v_mfma_f32_16x16x32_bf16 v[40:43], a[52:55], v[212:215], v[40:43]
    v_mfma_f32_16x16x32_bf16 v[44:47], a[72:75], v[212:215], v[44:47]
    v_mfma_f32_16x16x32_bf16 v[48:51], a[92:95], v[212:215], v[48:51]
    v_mfma_f32_16x16x32_bf16 v[52:55], a[112:115], v[212:215], v[52:55]
    v_mfma_f32_16x16x32_bf16 v[32:35], a[16:19], v[216:219], v[32:35]
    v_mfma_f32_16x16x32_bf16 v[36:39], a[36:39], v[216:219], v[36:39]
    v_mfma_f32_16x16x32_bf16 v[40:43], a[56:59], v[216:219], v[40:43]
    v_mfma_f32_16x16x32_bf16 v[44:47], a[76:79], v[216:219], v[44:47]
    v_mfma_f32_16x16x32_bf16 v[48:51], a[96:99], v[216:219], v[48:51]
    v_mfma_f32_16x16x32_bf16 v[52:55], a[116:119], v[216:219], v[52:55]
    s_nop 7
    v_add_f32 v52, s47, v52
    v_rcp_f32 v52, v52
    s_nop 0
    v_mul_f32 v32, v32, v52
    v_mul_f32 v33, v33, v52
    v_mul_f32 v34, v34, v52
    v_mul_f32 v35, v35, v52
    v_mul_f32 v36, v36, v52
    v_mul_f32 v37, v37, v52
    v_mul_f32 v38, v38, v52
    v_mul_f32 v39, v39, v52
    v_mul_f32 v40, v40, v52
    v_mul_f32 v41, v41, v52
    v_mul_f32 v42, v42, v52
    v_mul_f32 v43, v43, v52
    v_mul_f32 v44, v44, v52
    v_mul_f32 v45, v45, v52
    v_mul_f32 v46, v46, v52
    v_mul_f32 v47, v47, v52
    v_mul_f32 v48, v48, v52
    v_mul_f32 v49, v49, v52
    v_mul_f32 v50, v50, v52
    v_mul_f32 v51, v51, v52
    v_cvt_pk_bf16_f32 v88, v32, v33
    v_cvt_pk_bf16_f32 v89, v34, v35
    v_cvt_pk_bf16_f32 v90, v36, v37
    v_cvt_pk_bf16_f32 v91, v38, v39
    v_cvt_pk_bf16_f32 v92, v40, v41
    v_cvt_pk_bf16_f32 v93, v42, v43
    v_cvt_pk_bf16_f32 v94, v44, v45
    v_cvt_pk_bf16_f32 v95, v46, v47
    v_cvt_pk_bf16_f32 v96, v48, v49
    v_cvt_pk_bf16_f32 v97, v50, v51
    s_add_u32 s51, s46, 163840
    buffer_store_dwordx4 v[88:91], v3, s[8:11], s51 offen sc1
    buffer_store_dwordx4 v[92:95], v3, s[8:11], s51 offen offset:1024 sc1
    buffer_store_dwordx2 v[96:97], v20, s[8:11], s51 offen offset:2048 sc1
    v_mfma_f32_16x16x32_bf16 v[56:59], a[0:3], v[220:223], 0
    v_mfma_f32_16x16x32_bf16 v[60:63], a[20:23], v[220:223], 0
    v_mfma_f32_16x16x32_bf16 v[64:67], a[40:43], v[220:223], 0
    v_mfma_f32_16x16x32_bf16 v[68:71], a[60:63], v[220:223], 0
    v_mfma_f32_16x16x32_bf16 v[72:75], a[80:83], v[220:223], 0
    v_mfma_f32_16x16x32_bf16 v[76:79], a[100:103], v[220:223], 0
    v_mfma_f32_16x16x32_bf16 v[56:59], a[4:7], v[224:227], v[56:59]
    v_mfma_f32_16x16x32_bf16 v[60:63], a[24:27], v[224:227], v[60:63]
    v_mfma_f32_16x16x32_bf16 v[64:67], a[44:47], v[224:227], v[64:67]
    v_mfma_f32_16x16x32_bf16 v[68:71], a[64:67], v[224:227], v[68:71]
    v_mfma_f32_16x16x32_bf16 v[72:75], a[84:87], v[224:227], v[72:75]
    v_mfma_f32_16x16x32_bf16 v[76:79], a[104:107], v[224:227], v[76:79]
    v_mfma_f32_16x16x32_bf16 v[56:59], a[8:11], v[228:231], v[56:59]
    v_mfma_f32_16x16x32_bf16 v[60:63], a[28:31], v[228:231], v[60:63]
    v_mfma_f32_16x16x32_bf16 v[64:67], a[48:51], v[228:231], v[64:67]
    v_mfma_f32_16x16x32_bf16 v[68:71], a[68:71], v[228:231], v[68:71]
    v_mfma_f32_16x16x32_bf16 v[72:75], a[88:91], v[228:231], v[72:75]
    v_mfma_f32_16x16x32_bf16 v[76:79], a[108:111], v[228:231], v[76:79]
    v_mfma_f32_16x16x32_bf16 v[56:59], a[12:15], v[232:235], v[56:59]
    v_mfma_f32_16x16x32_bf16 v[60:63], a[32:35], v[232:235], v[60:63]
    v_mfma_f32_16x16x32_bf16 v[64:67], a[52:55], v[232:235], v[64:67]
    v_mfma_f32_16x16x32_bf16 v[68:71], a[72:75], v[232:235], v[68:71]
    v_mfma_f32_16x16x32_bf16 v[72:75], a[92:95], v[232:235], v[72:75]
    v_mfma_f32_16x16x32_bf16 v[76:79], a[112:115], v[232:235], v[76:79]
    v_mfma_f32_16x16x32_bf16 v[56:59], a[16:19], v[236:239], v[56:59]
    v_mfma_f32_16x16x32_bf16 v[60:63], a[36:39], v[236:239], v[60:63]
    v_mfma_f32_16x16x32_bf16 v[64:67], a[56:59], v[236:239], v[64:67]
    v_mfma_f32_16x16x32_bf16 v[68:71], a[76:79], v[236:239], v[68:71]
    v_mfma_f32_16x16x32_bf16 v[72:75], a[96:99], v[236:239], v[72:75]
    v_mfma_f32_16x16x32_bf16 v[76:79], a[116:119], v[236:239], v[76:79]
    s_nop 7
    v_add_f32 v76, s47, v76
    v_rcp_f32 v76, v76
    s_nop 0
    v_mul_f32 v56, v56, v76
    v_mul_f32 v57, v57, v76
    v_mul_f32 v58, v58, v76
    v_mul_f32 v59, v59, v76
    v_mul_f32 v60, v60, v76
    v_mul_f32 v61, v61, v76
    v_mul_f32 v62, v62, v76
    v_mul_f32 v63, v63, v76
    v_mul_f32 v64, v64, v76
    v_mul_f32 v65, v65, v76
    v_mul_f32 v66, v66, v76
    v_mul_f32 v67, v67, v76
    v_mul_f32 v68, v68, v76
    v_mul_f32 v69, v69, v76
    v_mul_f32 v70, v70, v76
    v_mul_f32 v71, v71, v76
    v_mul_f32 v72, v72, v76
    v_mul_f32 v73, v73, v76
    v_mul_f32 v74, v74, v76
    v_mul_f32 v75, v75, v76
    v_cvt_pk_bf16_f32 v100, v56, v57
    v_cvt_pk_bf16_f32 v101, v58, v59
    v_cvt_pk_bf16_f32 v102, v60, v61
    v_cvt_pk_bf16_f32 v103, v62, v63
    v_cvt_pk_bf16_f32 v104, v64, v65
    v_cvt_pk_bf16_f32 v105, v66, v67
    v_cvt_pk_bf16_f32 v106, v68, v69
    v_cvt_pk_bf16_f32 v107, v70, v71
    v_cvt_pk_bf16_f32 v108, v72, v73
    v_cvt_pk_bf16_f32 v109, v74, v75
    s_add_u32 s51, s46, 184320
    buffer_store_dwordx4 v[100:103], v3, s[8:11], s51 offen sc1
    buffer_store_dwordx4 v[104:107], v3, s[8:11], s51 offen offset:1024 sc1
    buffer_store_dwordx2 v[108:109], v20, s[8:11], s51 offen offset:2048 sc1
    s_waitcnt vmcnt(0)
    s_barrier
    s_lshl_b32 s51, s2, 7
    s_add_u32 s51, s51, 4239360
    s_mov_b32 s46, 1
    s_cmp_lg_u32 s32, 0
    s_cbranch_scc1 BF_80
    v_mov_b32 v4, s46
    s_mov_b64 exec, 1
    buffer_store_dword v4, v5, s[8:11], s51 offen sc1
    s_mov_b64 exec, -1
BF_80:
    s_lshl_b32 s46, s36, 10
    s_add_u32 s46, s46, 4239360
    v_and_b32 v12, 7, v2
    v_lshl_add_u32 v12, v12, 7, s46
    s_mov_b32 s47, 0
    s_mov_b32 s51, 1
    s_cmp_ge_u32 s47, s51
    s_cbranch_scc1 FWD_82
    s_branch FW_81_go
FW_81:
    s_sleep 2
    s_sub_u32 s33, s33, 1
    s_cbranch_scc1 EXIT
FW_81_go:
    buffer_load_dword v4, v12, s[8:11], 0 offen sc1
    s_waitcnt vmcnt(0)
    v_cmp_gt_u32 vcc, s51, v4
    s_cbranch_vccnz FW_81
    s_mov_b32 s47, s51
    s_add_u32 s4, s51, 1
    v_cmp_gt_u32 vcc, s4, v4
    s_cbranch_vccnz FWD_82
    s_mov_b32 s47, s4
    s_add_u32 s4, s51, 3
    v_cmp_gt_u32 vcc, s4, v4
    s_cbranch_vccnz FWD_82
    s_mov_b32 s47, s4
    s_add_u32 s4, s51, 8
    v_cmp_gt_u32 vcc, s4, v4
    s_cbranch_vccnz FWD_82
    s_mov_b32 s47, s4
    s_add_u32 s4, s51, 20
    v_cmp_gt_u32 vcc, s4, v4
    s_cbranch_vccnz FWD_82
    s_mov_b32 s47, s4
FWD_82:
    s_and_b32 s46, s35, 1
    s_mul_i32 s46, s46, 163840
    s_add_u32 s48, s48, s46
    s_add_u32 s46, s48, 0
    buffer_load_dwordx4 a[0:3], v3, s[8:11], s46 offen offset:0 sc1
    buffer_load_dwordx4 a[8:11], v3, s[8:11], s46 offen offset:1024 sc1
    s_add_u32 s46, s48, 2560
    buffer_load_dwordx4 a[16:19], v3, s[8:11], s46 offen offset:0 sc1
    buffer_load_dwordx4 a[24:27], v3, s[8:11], s46 offen offset:1024 sc1
    s_add_u32 s46, s48, 20480
    buffer_load_dwordx4 a[4:7], v3, s[8:11], s46 offen offset:0 sc1
    buffer_load_dwordx4 a[12:15], v3, s[8:11], s46 offen offset:1024 sc1
    s_add_u32 s46, s48, 23040
    buffer_load_dwordx4 a[20:23], v3, s[8:11], s46 offen offset:0 sc1
    buffer_load_dwordx4 a[28:31], v3, s[8:11], s46 offen offset:1024 sc1
    s_add_u32 s46, s48, 5120
    buffer_load_dwordx4 a[32:35], v3, s[8:11], s46 offen offset:0 sc1
    buffer_load_dwordx4 a[40:43], v3, s[8:11], s46 offen offset:1024 sc1
    s_add_u32 s46, s48, 7680
    buffer_load_dwordx4 a[48:51], v3, s[8:11], s46 offen offset:0 sc1
    buffer_load_dwordx4 a[56:59], v3, s[8:11], s46 offen offset:1024 sc1
    s_add_u32 s46, s48, 25600
    buffer_load_dwordx4 a[36:39], v3, s[8:11], s46 offen offset:0 sc1
    buffer_load_dwordx4 a[44:47], v3, s[8:11], s46 offen offset:1024 sc1
    s_add_u32 s46, s48, 28160
    buffer_load_dwordx4 a[52:55], v3, s[8:11], s46 offen offset:0 sc1
    buffer_load_dwordx4 a[60:63], v3, s[8:11], s46 offen offset:1024 sc1
    s_add_u32 s46, s48, 10240
    buffer_load_dwordx4 a[64:67], v3, s[8:11], s46 offen offset:0 sc1
    buffer_load_dwordx4 a[72:75], v3, s[8:11], s46 offen offset:1024 sc1
    s_add_u32 s46, s48, 12800
    buffer_load_dwordx4 a[80:83], v3, s[8:11], s46 offen offset:0 sc1
    buffer_load_dwordx4 a[88:91], v3, s[8:11], s46 offen offset:1024 sc1
    s_add_u32 s46, s48, 30720
    buffer_load_dwordx4 a[68:71], v3, s[8:11], s46 offen offset:0 sc1
    buffer_load_dwordx4 a[76:79], v3, s[8:11], s46 offen offset:1024 sc1
    s_add_u32 s46, s48, 33280
    buffer_load_dwordx4 a[84:87], v3, s[8:11], s46 offen offset:0 sc1
    buffer_load_dwordx4 a[92:95], v3, s[8:11], s46 offen offset:1024 sc1
    s_add_u32 s46, s48, 15360
    buffer_load_dwordx4 a[96:99], v3, s[8:11], s46 offen offset:0 sc1
    buffer_load_dwordx4 a[104:107], v3, s[8:11], s46 offen offset:1024 sc1
    s_add_u32 s46, s48, 17920
    buffer_load_dwordx4 a[112:115], v3, s[8:11], s46 offen offset:0 sc1
    buffer_load_dwordx4 a[120:123], v3, s[8:11], s46 offen offset:1024 sc1
    s_add_u32 s46, s48, 35840
    buffer_load_dwordx4 a[100:103], v3, s[8:11], s46 offen offset:0 sc1
    buffer_load_dwordx4 a[108:111], v3, s[8:11], s46 offen offset:1024 sc1
    s_add_u32 s46, s48, 38400
    buffer_load_dwordx4 a[116:119], v3, s[8:11], s46 offen offset:0 sc1
    buffer_load_dwordx4 a[124:127], v3, s[8:11], s46 offen offset:1024 sc1
    s_add_u32 s46, s48, 2048
    buffer_load_dwordx2 a[128:129], v20, s[8:11], s46 offen sc1
    buffer_load_dwordx2 a[130:131], v20, s[8:11], s46 offen offset:2560 sc1
    s_add_u32 s46, s48, 7168
    buffer_load_dwordx2 a[136:137], v20, s[8:11], s46 offen sc1
    buffer_load_dwordx2 a[138:139], v20, s[8:11], s46 offen offset:2560 sc1
    s_add_u32 s46, s48, 12288
    buffer_load_dwordx2 a[144:145], v20, s[8:11], s46 offen sc1
    buffer_load_dwordx2 a[146:147], v20, s[8:11], s46 offen offset:2560 sc1
    s_add_u32 s46, s48, 17408
    buffer_load_dwordx2 a[152:153], v20, s[8:11], s46 offen sc1
    buffer_load_dwordx2 a[154:155], v20, s[8:11], s46 offen offset:2560 sc1
    s_add_u32 s46, s48, 22528
    buffer_load_dwordx2 a[132:133], v20, s[8:11], s46 offen sc1
    buffer_load_dwordx2 a[134:135], v20, s[8:11], s46 offen offset:2560 sc1
    s_add_u32 s46, s48, 27648
    buffer_load_dwordx2 a[140:141], v20, s[8:11], s46 offen sc1
    buffer_load_dwordx2 a[142:143], v20, s[8:11], s46 offen offset:2560 sc1
    s_add_u32 s46, s48, 32768
    buffer_load_dwordx2 a[148:149], v20, s[8:11], s46 offen sc1
    buffer_load_dwordx2 a[150:151], v20, s[8:11], s46 offen offset:2560 sc1
    s_add_u32 s46, s48, 37888
    buffer_load_dwordx2 a[156:157], v20, s[8:11], s46 offen sc1
    buffer_load_dwordx2 a[158:159], v20, s[8:11], s46 offen offset:2560 sc1
    s_branch B_NEXT
B_OUT:
    s_and_b32 s46, s35, 1
    s_mul_i32 s46, s46, 327680
    s_lshl_b32 s47, s45, 1
    s_add_u32 s46, s46, s47
    s_and_b32 s47, s35, 6
    s_add_u32 s47, s47, s34
    s_mul_i32 s47, s47, 160
    s_add_u32 s46, s46, s47
    s_add_u32 s46, s46, 320
    v_cvt_pk_bf16_f32 v72, v32, v33
    v_cvt_pk_bf16_f32 v73, v34, v35
    v_cvt_pk_bf16_f32 v74, v36, v37
    v_cvt_pk_bf16_f32 v75, v38, v39
    v_cvt_pk_bf16_f32 v76, v40, v41
    v_cvt_pk_bf16_f32 v77, v42, v43
    v_cvt_pk_bf16_f32 v78, v44, v45
    v_cvt_pk_bf16_f32 v79, v46, v47
    v_cvt_pk_bf16_f32 v80, v48, v49
    v_cvt_pk_bf16_f32 v81, v50, v51
    buffer_store_dwordx2 v[72:73], v21, s[28:31], s46 offen offset:0
    buffer_store_dwordx2 v[74:75], v21, s[28:31], s46 offen offset:8
    buffer_store_dwordx2 v[76:77], v21, s[28:31], s46 offen offset:16
    buffer_store_dwordx2 v[78:79], v21, s[28:31], s46 offen offset:24
    buffer_store_dwordx2 v[80:81], v21, s[28:31], s46 offen offset:32
    s_add_u32 s46, s46, 40960
    v_cvt_pk_bf16_f32 v82, v52, v53
    v_cvt_pk_bf16_f32 v83, v54, v55
    v_cvt_pk_bf16_f32 v84, v56, v57
    v_cvt_pk_bf16_f32 v85, v58, v59
    v_cvt_pk_bf16_f32 v86, v60, v61
    v_cvt_pk_bf16_f32 v87, v62, v63
    v_cvt_pk_bf16_f32 v88, v64, v65
    v_cvt_pk_bf16_f32 v89, v66, v67
    v_cvt_pk_bf16_f32 v90, v68, v69
    v_cvt_pk_bf16_f32 v91, v70, v71
    buffer_store_dwordx2 v[82:83], v21, s[28:31], s46 offen offset:0
    buffer_store_dwordx2 v[84:85], v21, s[28:31], s46 offen offset:8
    buffer_store_dwordx2 v[86:87], v21, s[28:31], s46 offen offset:16
    buffer_store_dwordx2 v[88:89], v21, s[28:31], s46 offen offset:24
    buffer_store_dwordx2 v[90:91], v21, s[28:31], s46 offen offset:32
    s_add_u32 s46, s46, 40960
    s_cmp_eq_u32 s34, 6
    s_cbranch_scc1 B_NEXT
    s_waitcnt vmcnt(0)
    s_endpgm
CODE_END:
.section .rodata,"a"
.p2align 6
.amdhsa_kernel concat_heads__memory_aug_recurrent_mem_tr__linear_kernel_hedgehog__prompt_kernel
  .amdhsa_next_free_vgpr 512
  .amdhsa_next_free_sgpr 102
  .amdhsa_accum_offset 256
  .amdhsa_group_segment_fixed_size 0
  .amdhsa_kernarg_size 112
  .amdhsa_user_sgpr_count 2
  .amdhsa_user_sgpr_kernarg_segment_ptr 1
  .amdhsa_system_sgpr_workgroup_id_x 1
.end_amdhsa_kernel
```
